```python
import torch

def _softmax(x, axis=-1):
    return torch.softmax(x, dim=axis)
def _gelu(x):
    return torch.nn.functional.gelu(x, approximate="tanh")
def _silu(x):
    return torch.nn.functional.silu(x)
def _sigmoid(x):
    return torch.sigmoid(x)
def _layernorm(x, axis=-1, eps=1e-5):
    m = x.mean(dim=axis, keepdim=True)
    v = x.var(dim=axis, keepdim=True, unbiased=False)
    return (x - m) / torch.sqrt(v + eps)
def _scatter_add(tgt, idx, src, axis=0):
    return tgt.clone().index_add_(axis, idx, src)
def _segment_sum(src, seg, n):
    out = torch.zeros((n,) + src.shape[1:], dtype=src.dtype)
    return out.index_add_(0, seg, src)
def _pad(x, pw):
    flat = tuple(v for pair in reversed(pw) for v in pair)
    return torch.nn.functional.pad(x, flat)

kernel_name = 'concat_heads__ssm_conv_s4d__compressed_kv_cla__prompt'

def setup_inputs():

    _w = (lambda a: (lambda t: t.to(torch.bfloat16) if t.is_floating_point() else t)(torch.as_tensor(a)))
    def _A_setup():
        Bsz, L, D, N = 1, 2048, 512, 128
        return {
            "u": _w((lambda *s: torch.randn(*s, dtype=torch.bfloat16) * 0.05)(Bsz, L, D)),
            "log_A_real": _w((lambda *s: torch.randn(*s, dtype=torch.bfloat16) * 6.4)(D, N) * 0.5),
            "A_imag": _w((lambda *s: torch.randn(*s, dtype=torch.bfloat16) * 0.05)(D, N) * 3.14),
            "C_real": _w((lambda *s: torch.randn(*s, dtype=torch.bfloat16) * 0.05)(D, N) / N ** 0.5),
            "C_imag": _w((lambda *s: torch.randn(*s, dtype=torch.bfloat16) * 0.05)(D, N) / N ** 0.5),
            "log_dt": _w((lambda *s: torch.randn(*s, dtype=torch.bfloat16) * 0.05)(D) * 0.5 - 4.0),
            "D_skip": _w((lambda *s: torch.randn(*s, dtype=torch.bfloat16) * 0.05)(D)),
        }
    _A_in = _A_setup()

    def _B_setup():
        B, H, Sq, Sk, D, M = 1, 32, 2048, 2048, 128, 512
        Dc = 4 * D
        return {
            "x": _w((lambda *s: torch.randn(*s, dtype=torch.bfloat16) * 0.8)(B, Sq, M)),
            "c_kv": _w((lambda *s: torch.randn(*s, dtype=torch.bfloat16) * 0.2)(B, Sk, Dc)),
            "w_q": _w((lambda *s: torch.randn(*s, dtype=torch.bfloat16) * 3.2)(M, H, D) * (M ** -0.5)),
            "w_uk": _w((lambda *s: torch.randn(*s, dtype=torch.bfloat16) * 3.2)(Dc, H, D) * (Dc ** -0.5)),
            "w_uv": _w((lambda *s: torch.randn(*s, dtype=torch.bfloat16) * 0.2)(Dc, H, D) * (Dc ** -0.5)),
            "w_o": _w((lambda *s: torch.randn(*s, dtype=torch.bfloat16) * 0.2)(H, D, M) * ((H * D) ** -0.5)),
        }
    _B_in = _B_setup()

    return {
        "A_u": _A_in["u"],
        "A_log_A_real": _A_in["log_A_real"],
        "A_A_imag": _A_in["A_imag"],
        "A_C_real": _A_in["C_real"],
        "A_C_imag": _A_in["C_imag"],
        "A_log_dt": _A_in["log_dt"],
        "A_D_skip": _A_in["D_skip"],
        "B_x": _B_in["x"],
        "B_c_kv": _B_in["c_kv"],
        "B_w_q": _B_in["w_q"],
        "B_w_uk": _B_in["w_uk"],
        "B_w_uv": _B_in["w_uv"],
        "B_w_o": _B_in["w_o"],
    }

def reference(A_u, A_log_A_real, A_A_imag, A_C_real, A_C_imag, A_log_dt, A_D_skip, B_x, B_c_kv, B_w_q, B_w_uk, B_w_uv, B_w_o):
    def _A_ref(u, log_A_real, A_imag, C_real, C_imag, log_dt, D_skip):
        L = u.shape[1]
        dt = torch.exp(log_dt)
        A = -torch.exp(log_A_real) + 1j * A_imag
        C = (C_real + 1j * C_imag) * dt[:, None]
        pos = (lambda x, dt: x.to(dt))(torch.arange(L), log_dt.dtype)
        P = torch.exp((A * dt[:, None])[:, :, None] * pos[None, None, :])
        K = 2.0 * torch.einsum("dn,dnl->dl", C, P).real
        L2 = 2 * L
        u_t = (lambda x, *d: x.permute(*d))(u, 0, 2, 1)
        Kf = (lambda x, *a, **k: torch.fft.rfft(x.float(), *a, **k))(K, L2)
        Uf = (lambda x, *a, **k: torch.fft.rfft(x.float(), *a, **k))(u_t, L2)
        y = (lambda x, *a, **k: torch.fft.irfft(x, *a, **k).to(torch.bfloat16))(Uf * Kf[None, :, :], L2)[:, :, :L]
        y = (lambda x, *d: x.permute(*d))(y, 0, 2, 1)
        return y + u * D_skip[None, None, :]

    def _B_ref(x, c_kv, w_q, w_uk, w_uv, w_o):
        B, Sq, M = x.shape[0], x.shape[1], x.shape[2]
        Sk = c_kv.shape[1]
        H, D = w_q.shape[1], w_q.shape[2]
        q = torch.einsum("bqm,mhd->bhqd", x, w_q)
        k = torch.einsum("bkc,chd->bhkd", c_kv, w_uk)
        v = torch.einsum("bkc,chd->bhkd", c_kv, w_uv)
        scores = torch.einsum("bhqd,bhkd->bhqk", q, k) * (D ** -0.5)
        off = Sk - Sq
        qi = torch.arange(Sq)[:, None]
        kj = torch.arange(Sk)[None, :]
        cmask = kj <= (qi + off)
        scores = torch.where(cmask[None, None], scores, -1e9)
        p = _softmax(scores, axis=-1)
        ctx = torch.einsum("bhqk,bhkd->bhqd", p, v)
        return torch.einsum("bhqd,hdm->bqm", ctx, w_o)

    a = _A_ref(A_u, A_log_A_real, A_A_imag, A_C_real, A_C_imag, A_log_dt, A_D_skip)
    b = _B_ref(B_x, B_c_kv, B_w_q, B_w_uk, B_w_uv, B_w_o)
    return torch.concatenate([a, b], axis=-1)
```

```asm
; @launch kernel=main_kernel grid=(256,1,1) block=(512,1,1) lds=163840
.amdgcn_target "amdgcn-amd-amdhsa--gfx950"
.text
.globl main_kernel
.p2align 8
.type main_kernel,@function
main_kernel:
    s_cmp_ge_u32 s2, 256
    s_cbranch_scc1 main_kernel_end_1
    s_load_dwordx16 s[76:91], s[0:1], 0
    s_load_dwordx16 s[52:67], s[0:1], 64
    s_getpc_b64 s[100:101]
main_kernel_pc_2:
    s_lshr_b32 s6, s2, 3
    s_and_b32 s6, s6, 15
    s_lshl_b32 s6, s6, 13
    v_subrev_u32 v100, 0, v0
    v_cmp_gt_u32 s[4:5], 64, v100
    v_lshlrev_b32 v100, 7, v100
    v_add_u32 v100, s6, v100
    v_cmp_gt_u32 vcc, main_kernel_end_1-main_kernel_pc_2, v100
    s_nop 0
    s_and_b64 exec, vcc, s[4:5]
    s_cbranch_execz main_kernel_ct_3
    global_load_dword v101, v100, s[100:101]
main_kernel_ct_3:
    s_mov_b64 exec, -1
    v_lshrrev_b32 v1, 6, v0
    v_and_b32 v2, 63, v0
    v_readfirstlane_b32 s20, v1
    s_and_b32 s3, s2, 7
    s_lshr_b32 s4, s2, 3
    s_lshl_b32 s21, s3, 2
    s_lshr_b32 s5, s4, 3
    s_add_u32 s21, s21, s5
    s_and_b32 s22, s4, 7
    s_lshl_b32 s45, s21, 1
    s_add_u32 s45, s45, s22
    s_and_b32 s45, s45, 7
    v_lshrrev_b32 v21, 3, v2
    v_and_b32 v22, 7, v2
    v_lshrrev_b32 v23, 4, v2
    v_and_b32 v24, 1, v23
    s_lshl_b32 s44, s21, 8
    s_and_b32 s42, s20, 1
    s_lshl_b32 s42, s42, 4
    s_lshr_b32 s43, s20, 1
    s_and_b32 s43, s43, 1
    s_lshl_b32 s43, s43, 7
    s_add_u32 s43, s43, s44
    v_or_b32 v25, 0, v24
    v_lshlrev_b32 v25, 1, v25
    v_xor_b32 v25, v25, v22
    v_lshlrev_b32 v25, 4, v25
    v_add_u32 v25, s43, v25
    v_add_u32 v26, 0, v21
    v_add_u32 v26, s42, v26
    v_lshlrev_b32 v26, 13, v26
    v_add_u32 v25, v25, v26
    v_subrev_u32 v8, 0, v25
    v_or_b32 v25, 2, v24
    v_lshlrev_b32 v25, 1, v25
    v_xor_b32 v25, v25, v22
    v_lshlrev_b32 v25, 4, v25
    v_add_u32 v25, s43, v25
    v_add_u32 v26, 8, v21
    v_add_u32 v26, s42, v26
    v_lshlrev_b32 v26, 13, v26
    v_add_u32 v25, v25, v26
    v_subrev_u32 v9, 1024, v25
    s_and_b32 s42, s20, 3
    s_lshl_b32 s42, s42, 4
    s_lshr_b32 s43, s20, 2
    s_lshl_b32 s43, s43, 7
    s_add_u32 s43, s43, s44
    v_or_b32 v25, 0, v24
    v_lshlrev_b32 v25, 1, v25
    v_xor_b32 v25, v25, v22
    v_lshlrev_b32 v25, 4, v25
    v_add_u32 v25, s43, v25
    v_add_u32 v26, 0, v21
    v_add_u32 v26, s42, v26
    v_lshlrev_b32 v26, 13, v26
    v_add_u32 v25, v25, v26
    v_subrev_u32 v10, 0, v25
    v_or_b32 v25, 2, v24
    v_lshlrev_b32 v25, 1, v25
    v_xor_b32 v25, v25, v22
    v_lshlrev_b32 v25, 4, v25
    v_add_u32 v25, s43, v25
    v_add_u32 v26, 8, v21
    v_add_u32 v26, s42, v26
    v_lshlrev_b32 v26, 13, v26
    v_add_u32 v25, v25, v26
    v_subrev_u32 v11, 1024, v25
    s_lshl_b32 s40, s20, 12
    s_lshl_b32 s41, s20, 11
    s_add_u32 s41, s41, 98304
    s_sub_u32 s46, 15, s22
    s_cmp_ge_u32 s20, 4
    s_cselect_b32 s46, s22, s46
    s_lshl_b32 s47, s46, 7
    s_and_b32 s48, s20, 3
    s_lshl_b32 s48, s48, 5
    s_add_u32 s47, s47, s48
    v_add_u32 v24, 0, v23
    v_and_b32 v24, 7, v24
    v_xor_b32 v24, v24, v22
    v_lshlrev_b32 v24, 4, v24
    v_add_u32 v25, 0, v21
    v_add_u32 v25, s47, v25
    v_lshlrev_b32 v25, 10, v25
    v_add_u32 v24, v24, v25
    v_subrev_u32 v4, 0, v24
    v_add_u32 v24, 4, v23
    v_and_b32 v24, 7, v24
    v_xor_b32 v24, v24, v22
    v_lshlrev_b32 v24, 4, v24
    v_add_u32 v25, 8, v21
    v_add_u32 v25, s47, v25
    v_lshlrev_b32 v25, 10, v25
    v_add_u32 v24, v24, v25
    v_subrev_u32 v5, 1024, v24
    v_add_u32 v24, 0, v23
    v_and_b32 v24, 7, v24
    v_xor_b32 v24, v24, v22
    v_lshlrev_b32 v24, 4, v24
    v_add_u32 v25, 16, v21
    v_add_u32 v25, s47, v25
    v_lshlrev_b32 v25, 10, v25
    v_add_u32 v24, v24, v25
    v_subrev_u32 v6, 2048, v24
    v_add_u32 v24, 4, v23
    v_and_b32 v24, 7, v24
    v_xor_b32 v24, v24, v22
    v_lshlrev_b32 v24, 4, v24
    v_add_u32 v25, 24, v21
    v_add_u32 v25, s47, v25
    v_lshlrev_b32 v25, 10, v25
    v_add_u32 v24, v24, v25
    v_subrev_u32 v7, 3072, v24
    s_and_b32 s46, s20, 1
    s_lshl_b32 s46, s46, 14
    s_lshr_b32 s47, s20, 1
    s_lshl_b32 s47, s47, 12
    v_lshrrev_b32 v23, 4, v2
    v_and_b32 v24, 15, v2
    v_lshrrev_b32 v25, 1, v24
    v_xor_b32 v25, v25, v23
    v_lshlrev_b32 v24, 7, v24
    v_add_u32 v24, s46, v24
    v_xor_b32 v26, 0, v25
    v_lshlrev_b32 v26, 4, v26
    v_add_u32 v12, v24, v26
    v_add_u32 v13, 0x10000, v12
    v_xor_b32 v26, 4, v25
    v_lshlrev_b32 v26, 4, v26
    v_add_u32 v14, v24, v26
    v_add_u32 v15, 0x10000, v14
    v_and_b32 v24, 15, v2
    v_lshrrev_b32 v25, 2, v24
    v_and_b32 v24, 3, v24
    v_lshlrev_b32 v24, 3, v24
    v_lshlrev_b32 v26, 7, v25
    v_add_u32 v24, v24, v26
    v_lshlrev_b32 v26, 10, v23
    v_add_u32 v24, v24, v26
    v_lshrrev_b32 v25, 1, v25
    v_and_b32 v26, 1, v23
    v_lshlrev_b32 v26, 1, v26
    v_or_b32 v25, v25, v26
    v_add_u32 v24, s47, v24
    v_add_u32 v24, 98304, v24
    v_xor_b32 v26, 0, v25
    v_lshlrev_b32 v26, 5, v26
    v_add_u32 v16, v24, v26
    v_xor_b32 v26, 1, v25
    v_lshlrev_b32 v26, 5, v26
    v_add_u32 v17, v24, v26
    v_xor_b32 v26, 2, v25
    v_lshlrev_b32 v26, 5, v26
    v_add_u32 v18, v24, v26
    v_xor_b32 v26, 3, v25
    v_lshlrev_b32 v26, 5, v26
    v_add_u32 v19, v24, v26
    s_waitcnt lgkmcnt(0)
    s_mov_b32 s12, s52
    s_and_b32 s13, s53, 0xffff
    s_mov_b32 s14, 2097152
    s_mov_b32 s15, 0x00020000
    s_cmp_ge_u32 s20, 4
    s_cselect_b32 s16, s58, s56
    s_cselect_b32 s17, s59, s57
    s_and_b32 s17, s17, 0xffff
    s_mov_b32 s18, 0x400000
    s_mov_b32 s19, 0x00020000
    s_mov_b32 s7, s54
    s_mov_b32 s6, s55
    s_and_b32 s3, s2, 7
    s_lshr_b32 s4, s2, 3
    s_lshl_b32 s54, s3, 6
    s_lshl_b32 s4, s4, 1
    s_add_u32 s54, s54, s4
    s_cmp_ge_u32 s20, 4
    s_cbranch_scc1 main_kernel_v0_4
    s_mov_b32 s24, s78
    s_and_b32 s25, s79, 0xffff
    s_mov_b32 s26, 131072
    s_mov_b32 s27, 0x00020000
    s_mov_b32 s28, s80
    s_and_b32 s29, s81, 0xffff
    s_mov_b32 s30, 131072
    s_mov_b32 s31, 0x00020000
    s_mov_b32 s32, s82
    s_and_b32 s33, s83, 0xffff
    s_mov_b32 s34, 131072
    s_mov_b32 s35, 0x00020000
    s_mov_b32 s36, s84
    s_and_b32 s37, s85, 0xffff
    s_mov_b32 s38, 131072
    s_mov_b32 s39, 0x00020000
    s_mov_b32 s68, s86
    s_and_b32 s69, s87, 0xffff
    s_mov_b32 s70, 1024
    s_mov_b32 s71, 0x00020000
    v_lshrrev_b32 v103, 5, v2
    v_add_u32 v103, s54, v103
    v_and_b32 v102, 31, v2
    v_lshl_add_u32 v102, v103, 7, v102
    s_lshl_b32 s3, s20, 5
    v_add_u32 v102, s3, v102
    v_lshlrev_b32 v102, 1, v102
    v_lshlrev_b32 v103, 1, v103
    buffer_load_ushort v96, v102, s[24:27], 0 offen
    buffer_load_ushort v97, v102, s[28:31], 0 offen
    buffer_load_ushort v98, v102, s[32:35], 0 offen
    buffer_load_ushort v99, v102, s[36:39], 0 offen
    buffer_load_ushort v100, v103, s[68:71], 0 offen
    s_mov_b32 s24, s76
    s_and_b32 s25, s77, 0xffff
    s_mov_b32 s26, 2097152
    s_mov_b32 s27, 0x00020000
    s_and_b32 s3, s2, 7
    s_lshl_b32 s3, s3, 7
    s_lshr_b32 s4, s2, 3
    s_lshl_b32 s4, s4, 16
    s_add_u32 s3, s3, s4
    v_lshrrev_b32 v120, 3, v0
    v_lshlrev_b32 v120, 10, v120
    v_and_b32 v121, 7, v0
    v_lshl_add_u32 v120, v121, 4, v120
    buffer_load_dwordx4 v[124:127], v120, s[24:27], s3 offen
    s_mov_b32 s8, s66
    s_and_b32 s9, s67, 0xffff
    s_mov_b32 s10, 268435456
    s_mov_b32 s11, 0x00020000
    v_and_b32 v131, 15, v2
    v_lshrrev_b32 v132, 4, v2
    v_lshrrev_b32 v128, 3, v131
    v_lshlrev_b32 v128, 7, v128
    v_and_b32 v129, 7, v131
    v_add_u32 v128, v128, v129
    v_cvt_f32_u32 v140, v128
    v_lshrrev_b32 v128, 2, v131
    v_lshlrev_b32 v128, 7, v128
    v_and_b32 v129, 3, v131
    v_lshl_add_u32 v128, v129, 1, v128
    v_add_u32 v128, 256, v128
    v_subrev_u32 v129, 8, v131
    v_lshrrev_b32 v130, 1, v129
    v_lshlrev_b32 v130, 7, v130
    v_and_b32 v129, 1, v129
    v_lshl_add_u32 v130, v129, 2, v130
    v_add_u32 v130, 512, v130
    v_cmp_gt_u32 vcc, 8, v131
    s_nop 1
    v_cndmask_b32 v128, v130, v128, vcc
    v_cvt_f32_u32 v141, v128
    v_lshlrev_b32 v128, 7, v131
    v_add_u32 v128, 1024, v128
    v_cvt_f32_u32 v142, v128
    v_lshlrev_b32 v128, 3, v131
    v_cvt_f32_u32 v143, v128
    s_lshl_b32 s3, s20, 10
    v_lshlrev_b32 v133, 6, v132
    v_add_u32 v133, s3, v133
    v_add_u32 v133, 65536, v133
    v_mov_b32 v220, v140
    v_mov_b32 v221, v140
    v_mov_b32 v222, v141
    v_mov_b32 v223, v141
    v_mov_b32 v224, v142
    v_mov_b32 v225, v142
    v_mov_b32 v226, v143
    v_mov_b32 v227, v143
    s_waitcnt vmcnt(5)
    v_lshlrev_b32 v96, 16, v96
    s_waitcnt vmcnt(4)
    v_lshlrev_b32 v97, 16, v97
    s_waitcnt vmcnt(3)
    v_lshlrev_b32 v98, 16, v98
    s_waitcnt vmcnt(2)
    v_lshlrev_b32 v99, 16, v99
    s_waitcnt vmcnt(1)
    v_lshlrev_b32 v100, 16, v100
    v_mul_f32 v128, 1069066752, v100
    v_rndne_f32 v129, v128
    v_sub_f32 v128, v128, v129
    v_mov_b32 v130, 921478512
    v_fma_f32 v128, v100, v130, v128
    v_exp_f32 v128, v128
    v_cvt_i32_f32 v129, v129
    v_ldexp_f32 v128, v128, v129
    v_cvt_pk_bf16_f32 v100, v128, v128
    v_lshlrev_b32 v100, 16, v100
    v_mul_f32 v128, 1069066752, v96
    v_rndne_f32 v129, v128
    v_sub_f32 v128, v128, v129
    v_mov_b32 v130, 921478512
    v_fma_f32 v128, v96, v130, v128
    v_exp_f32 v128, v128
    v_cvt_i32_f32 v129, v129
    v_ldexp_f32 v128, v128, v129
    v_cvt_pk_bf16_f32 v96, v128, v128
    v_lshlrev_b32 v96, 16, v96
    v_mul_f32 v96, v96, v100
    v_mul_f32 v96, 3216550459, v96
    v_mul_f32 v97, v97, v100
    v_mul_f32 v97, 0.15915494, v97
    v_mul_f32 v98, v98, v100
    v_add_f32 v98, v98, v98
    v_mul_f32 v99, v99, v100
    v_add_f32 v99, v99, v99
    v_lshlrev_b32 v128, 4, v0
    v_add_u32 v128, 65536, v128
    ds_write_b128 v128, v[96:99]
    s_waitcnt lgkmcnt(0)
    s_mul_i32 s4, s20, 3072
    v_lshlrev_b32 v128, 8, v132
    v_lshl_add_u32 v128, v131, 2, v128
    v_add_u32 v128, s4, v128
    v_add_u32 v128, 69632, v128
    s_mov_b32 s4, 0
main_kernel_kgc_6:
    v_mov_b32 v192, 0
    v_mov_b32 v193, 0
    v_mov_b32 v194, 0
    v_mov_b32 v195, 0
    v_mov_b32 v196, 0
    v_mov_b32 v197, 0
    v_mov_b32 v198, 0
    v_mov_b32 v199, 0
    v_mov_b32 v200, 0
    v_mov_b32 v201, 0
    v_mov_b32 v202, 0
    v_mov_b32 v203, 0
main_kernel_kgk_7:
    ds_read_b128 v[144:147], v133 offset:0
    ds_read_b128 v[148:151], v133 offset:16
    ds_read_b128 v[152:155], v133 offset:32
    ds_read_b128 v[156:159], v133 offset:48
    v_add_u32 v133, 256, v133
    s_waitcnt lgkmcnt(3)
    v_pk_mul_f32 v[204:205], v[144:145], v[220:221]
    s_waitcnt lgkmcnt(2)
    v_pk_mul_f32 v[208:209], v[148:149], v[220:221]
    s_waitcnt lgkmcnt(1)
    v_pk_mul_f32 v[212:213], v[152:153], v[220:221]
    s_waitcnt lgkmcnt(0)
    v_pk_mul_f32 v[216:217], v[156:157], v[220:221]
    v_exp_f32 v204, v204
    v_exp_f32 v208, v208
    v_exp_f32 v212, v212
    v_exp_f32 v216, v216
    v_fract_f32 v205, v205
    v_fract_f32 v209, v209
    v_fract_f32 v213, v213
    v_fract_f32 v217, v217
    v_cos_f32 v206, v205
    v_cos_f32 v210, v209
    v_cos_f32 v214, v213
    v_cos_f32 v218, v217
    v_sin_f32 v207, v205
    v_sin_f32 v211, v209
    v_sin_f32 v215, v213
    v_sin_f32 v219, v217
    v_pk_mul_f32 v[206:207], v[206:207], v[204:205] op_sel_hi:[1,0]
    v_pk_mul_f32 v[210:211], v[210:211], v[208:209] op_sel_hi:[1,0]
    v_pk_mul_f32 v[214:215], v[214:215], v[212:213] op_sel_hi:[1,0]
    v_pk_mul_f32 v[218:219], v[218:219], v[216:217] op_sel_hi:[1,0]
    v_cvt_pk_bf16_f32 v160, v206, v207
    v_cvt_pk_bf16_f32 v161, v210, v211
    v_cvt_pk_bf16_f32 v162, v214, v215
    v_cvt_pk_bf16_f32 v163, v218, v219
    v_lshlrev_b32 v204, 16, v160
    v_lshlrev_b32 v208, 16, v161
    v_lshlrev_b32 v212, 16, v162
    v_lshlrev_b32 v216, 16, v163
    v_and_b32 v205, 0xffff0000, v160
    v_and_b32 v209, 0xffff0000, v161
    v_and_b32 v213, 0xffff0000, v162
    v_and_b32 v217, 0xffff0000, v163
    v_pk_add_f32 v[206:207], v[206:207], v[204:205] neg_lo:[0,1] neg_hi:[0,1]
    v_pk_add_f32 v[210:211], v[210:211], v[208:209] neg_lo:[0,1] neg_hi:[0,1]
    v_pk_add_f32 v[214:215], v[214:215], v[212:213] neg_lo:[0,1] neg_hi:[0,1]
    v_pk_add_f32 v[218:219], v[218:219], v[216:217] neg_lo:[0,1] neg_hi:[0,1]
    v_cvt_pk_bf16_f32 v172, v206, v207
    v_cvt_pk_bf16_f32 v173, v210, v211
    v_cvt_pk_bf16_f32 v174, v214, v215
    v_cvt_pk_bf16_f32 v175, v218, v219
    v_pk_mul_f32 v[204:205], v[144:145], v[222:223]
    v_pk_mul_f32 v[208:209], v[148:149], v[222:223]
    v_pk_mul_f32 v[212:213], v[152:153], v[222:223]
    v_pk_mul_f32 v[216:217], v[156:157], v[222:223]
    v_exp_f32 v204, v204
    v_exp_f32 v208, v208
    v_exp_f32 v212, v212
    v_exp_f32 v216, v216
    v_fract_f32 v205, v205
    v_fract_f32 v209, v209
    v_fract_f32 v213, v213
    v_fract_f32 v217, v217
    v_cos_f32 v206, v205
    v_cos_f32 v210, v209
    v_cos_f32 v214, v213
    v_cos_f32 v218, v217
    v_sin_f32 v207, v205
    v_sin_f32 v211, v209
    v_sin_f32 v215, v213
    v_sin_f32 v219, v217
    v_pk_mul_f32 v[206:207], v[206:207], v[204:205] op_sel_hi:[1,0]
    v_pk_mul_f32 v[210:211], v[210:211], v[208:209] op_sel_hi:[1,0]
    v_pk_mul_f32 v[214:215], v[214:215], v[212:213] op_sel_hi:[1,0]
    v_pk_mul_f32 v[218:219], v[218:219], v[216:217] op_sel_hi:[1,0]
    v_cvt_pk_bf16_f32 v164, v206, v207
    v_cvt_pk_bf16_f32 v165, v210, v211
    v_cvt_pk_bf16_f32 v166, v214, v215
    v_cvt_pk_bf16_f32 v167, v218, v219
    v_lshlrev_b32 v204, 16, v164
    v_lshlrev_b32 v208, 16, v165
    v_lshlrev_b32 v212, 16, v166
    v_lshlrev_b32 v216, 16, v167
    v_and_b32 v205, 0xffff0000, v164
    v_and_b32 v209, 0xffff0000, v165
    v_and_b32 v213, 0xffff0000, v166
    v_and_b32 v217, 0xffff0000, v167
    v_pk_add_f32 v[206:207], v[206:207], v[204:205] neg_lo:[0,1] neg_hi:[0,1]
    v_pk_add_f32 v[210:211], v[210:211], v[208:209] neg_lo:[0,1] neg_hi:[0,1]
    v_pk_add_f32 v[214:215], v[214:215], v[212:213] neg_lo:[0,1] neg_hi:[0,1]
    v_pk_add_f32 v[218:219], v[218:219], v[216:217] neg_lo:[0,1] neg_hi:[0,1]
    v_cvt_pk_bf16_f32 v176, v206, v207
    v_cvt_pk_bf16_f32 v177, v210, v211
    v_cvt_pk_bf16_f32 v178, v214, v215
    v_cvt_pk_bf16_f32 v179, v218, v219
    v_pk_mul_f32 v[204:205], v[144:145], v[224:225]
    v_pk_mul_f32 v[208:209], v[148:149], v[224:225]
    v_pk_mul_f32 v[212:213], v[152:153], v[224:225]
    v_pk_mul_f32 v[216:217], v[156:157], v[224:225]
    v_exp_f32 v204, v204
    v_exp_f32 v208, v208
    v_exp_f32 v212, v212
    v_exp_f32 v216, v216
    v_fract_f32 v205, v205
    v_fract_f32 v209, v209
    v_fract_f32 v213, v213
    v_fract_f32 v217, v217
    v_cos_f32 v206, v205
    v_cos_f32 v210, v209
    v_cos_f32 v214, v213
    v_cos_f32 v218, v217
    v_sin_f32 v207, v205
    v_sin_f32 v211, v209
    v_sin_f32 v215, v213
    v_sin_f32 v219, v217
    v_pk_mul_f32 v[206:207], v[206:207], v[204:205] op_sel_hi:[1,0]
    v_pk_mul_f32 v[210:211], v[210:211], v[208:209] op_sel_hi:[1,0]
    v_pk_mul_f32 v[214:215], v[214:215], v[212:213] op_sel_hi:[1,0]
    v_pk_mul_f32 v[218:219], v[218:219], v[216:217] op_sel_hi:[1,0]
    v_cvt_pk_bf16_f32 v168, v206, v207
    v_cvt_pk_bf16_f32 v169, v210, v211
    v_cvt_pk_bf16_f32 v170, v214, v215
    v_cvt_pk_bf16_f32 v171, v218, v219
    v_lshlrev_b32 v204, 16, v168
    v_lshlrev_b32 v208, 16, v169
    v_lshlrev_b32 v212, 16, v170
    v_lshlrev_b32 v216, 16, v171
    v_and_b32 v205, 0xffff0000, v168
    v_and_b32 v209, 0xffff0000, v169
    v_and_b32 v213, 0xffff0000, v170
    v_and_b32 v217, 0xffff0000, v171
    v_pk_add_f32 v[206:207], v[206:207], v[204:205] neg_lo:[0,1] neg_hi:[0,1]
    v_pk_add_f32 v[210:211], v[210:211], v[208:209] neg_lo:[0,1] neg_hi:[0,1]
    v_pk_add_f32 v[214:215], v[214:215], v[212:213] neg_lo:[0,1] neg_hi:[0,1]
    v_pk_add_f32 v[218:219], v[218:219], v[216:217] neg_lo:[0,1] neg_hi:[0,1]
    v_cvt_pk_bf16_f32 v180, v206, v207
    v_cvt_pk_bf16_f32 v181, v210, v211
    v_cvt_pk_bf16_f32 v182, v214, v215
    v_cvt_pk_bf16_f32 v183, v218, v219
    v_pk_mul_f32 v[204:205], v[144:145], v[226:227]
    v_pk_mul_f32 v[208:209], v[148:149], v[226:227]
    v_pk_mul_f32 v[212:213], v[152:153], v[226:227]
    v_pk_mul_f32 v[216:217], v[156:157], v[226:227]
    v_exp_f32 v204, v204
    v_exp_f32 v208, v208
    v_exp_f32 v212, v212
    v_exp_f32 v216, v216
    v_fract_f32 v205, v205
    v_fract_f32 v209, v209
    v_fract_f32 v213, v213
    v_fract_f32 v217, v217
    v_cos_f32 v206, v205
    v_cos_f32 v210, v209
    v_cos_f32 v214, v213
    v_cos_f32 v218, v217
    v_sin_f32 v207, v205
    v_sin_f32 v211, v209
    v_sin_f32 v215, v213
    v_sin_f32 v219, v217
    v_pk_mul_f32 v[206:207], v[206:207], v[204:205] op_sel_hi:[1,0]
    v_pk_mul_f32 v[210:211], v[210:211], v[208:209] op_sel_hi:[1,0]
    v_pk_mul_f32 v[214:215], v[214:215], v[212:213] op_sel_hi:[1,0]
    v_pk_mul_f32 v[218:219], v[218:219], v[216:217] op_sel_hi:[1,0]
    v_mul_f32 v204, v146, v206
    v_mul_f32 v208, v150, v210
    v_mul_f32 v212, v154, v214
    v_mul_f32 v216, v158, v218
    v_mul_f32 v205, v146, v207
    v_mul_f32 v209, v150, v211
    v_mul_f32 v213, v154, v215
    v_mul_f32 v217, v158, v219
    v_fma_f32 v204, -v147, v207, v204
    v_fma_f32 v208, -v151, v211, v208
    v_fma_f32 v212, -v155, v215, v212
    v_fma_f32 v216, -v159, v219, v216
    v_fma_f32 v205, -v147, v206, -v205
    v_fma_f32 v209, -v151, v210, -v209
    v_fma_f32 v213, -v155, v214, -v213
    v_fma_f32 v217, -v159, v218, -v217
    v_cvt_pk_bf16_f32 v184, v204, v205
    v_cvt_pk_bf16_f32 v185, v208, v209
    v_cvt_pk_bf16_f32 v186, v212, v213
    v_cvt_pk_bf16_f32 v187, v216, v217
    v_lshlrev_b32 v206, 16, v184
    v_lshlrev_b32 v210, 16, v185
    v_lshlrev_b32 v214, 16, v186
    v_lshlrev_b32 v218, 16, v187
    v_and_b32 v207, 0xffff0000, v184
    v_and_b32 v211, 0xffff0000, v185
    v_and_b32 v215, 0xffff0000, v186
    v_and_b32 v219, 0xffff0000, v187
    v_pk_add_f32 v[204:205], v[204:205], v[206:207] neg_lo:[0,1] neg_hi:[0,1]
    v_pk_add_f32 v[208:209], v[208:209], v[210:211] neg_lo:[0,1] neg_hi:[0,1]
    v_pk_add_f32 v[212:213], v[212:213], v[214:215] neg_lo:[0,1] neg_hi:[0,1]
    v_pk_add_f32 v[216:217], v[216:217], v[218:219] neg_lo:[0,1] neg_hi:[0,1]
    v_cvt_pk_bf16_f32 v188, v204, v205
    v_cvt_pk_bf16_f32 v189, v208, v209
    v_cvt_pk_bf16_f32 v190, v212, v213
    v_cvt_pk_bf16_f32 v191, v216, v217
    v_mfma_f32_16x16x32_bf16 v[192:195], v[172:175], v[184:187], v[192:195]
    s_nop 0
    s_nop 0
    v_mfma_f32_16x16x32_bf16 v[192:195], v[160:163], v[188:191], v[192:195]
    v_mfma_f32_16x16x32_bf16 v[192:195], v[160:163], v[184:187], v[192:195]
    v_mfma_f32_16x16x32_bf16 v[196:199], v[176:179], v[184:187], v[196:199]
    v_mfma_f32_16x16x32_bf16 v[196:199], v[164:167], v[188:191], v[196:199]
    v_mfma_f32_16x16x32_bf16 v[196:199], v[164:167], v[184:187], v[196:199]
    v_mfma_f32_16x16x32_bf16 v[200:203], v[180:183], v[184:187], v[200:203]
    v_mfma_f32_16x16x32_bf16 v[200:203], v[168:171], v[188:191], v[200:203]
    v_mfma_f32_16x16x32_bf16 v[200:203], v[168:171], v[184:187], v[200:203]
    s_add_u32 s4, s4, 1
    s_bitcmp1_b32 s4, 0
    s_cbranch_scc1 main_kernel_kgk_7
    s_nop 0
    ds_write_b32 v128, v192 offset:0
    ds_write_b32 v128, v193 offset:64
    ds_write_b32 v128, v194 offset:128
    ds_write_b32 v128, v195 offset:192
    ds_write_b32 v128, v196 offset:1024
    ds_write_b32 v128, v197 offset:1088
    ds_write_b32 v128, v198 offset:1152
    ds_write_b32 v128, v199 offset:1216
    ds_write_b32 v128, v200 offset:2048
    ds_write_b32 v128, v201 offset:2112
    ds_write_b32 v128, v202 offset:2176
    ds_write_b32 v128, v203 offset:2240
    v_add_u32 v128, 12288, v128
    s_cmp_lt_u32 s4, 4
    s_cbranch_scc1 main_kernel_kgc_6
    s_branch main_kernel_j0_5
main_kernel_v0_4:
    s_mov_b32 s28, s56
    s_and_b32 s29, s57, 0xffff
    s_mov_b32 s30, 4194304
    s_mov_b32 s31, 0x00020000
    s_lshl_b32 s49, s22, 1
    s_sub_u32 s49, 15, s49
    s_lshl_b32 s49, s49, 17
    s_mov_b32 s24, s76
    s_and_b32 s25, s77, 0xffff
    s_mov_b32 s26, 2097152
    s_mov_b32 s27, 0x00020000
    s_and_b32 s3, s2, 7
    s_lshl_b32 s3, s3, 7
    s_lshr_b32 s4, s2, 3
    s_lshl_b32 s4, s4, 16
    s_add_u32 s3, s3, s4
    v_lshrrev_b32 v120, 3, v0
    v_lshlrev_b32 v120, 10, v120
    v_and_b32 v121, 7, v0
    v_lshl_add_u32 v120, v121, 4, v120
    buffer_load_dwordx4 v[124:127], v120, s[24:27], s3 offen
    s_mov_b32 s8, s66
    s_and_b32 s9, s67, 0xffff
    s_mov_b32 s10, 268435456
    s_mov_b32 s11, 0x00020000
    s_add_u32 s43, s45, 0
    s_and_b32 s43, s43, 7
    s_lshl_b32 s43, s43, 19
    s_add_u32 m0, s41, 0
    s_nop 0
    buffer_load_dwordx4 v8, s[16:19], s43 offen offset:0 lds
    buffer_load_dwordx4 v9, s[16:19], s43 offen offset:1024 lds
    s_sub_u32 m0, m0, 8192
    s_nop 0
    buffer_load_dwordx4 v8, s[28:31], s43 offen offset:0 lds
    buffer_load_dwordx4 v9, s[28:31], s43 offen offset:1024 lds
    s_add_u32 s42, s45, 0
    s_and_b32 s42, s42, 7
    s_lshl_b32 s42, s42, 7
    s_add_u32 m0, s40, 0
    s_nop 0
    buffer_load_dwordx4 v4, s[12:15], s42 offen offset:0 lds
    buffer_load_dwordx4 v5, s[12:15], s42 offen offset:1024 lds
    buffer_load_dwordx4 v6, s[12:15], s42 offen offset:2048 lds
    buffer_load_dwordx4 v7, s[12:15], s42 offen offset:3072 lds
    s_sub_u32 m0, m0, 16384
    s_add_u32 s42, s42, s49
    buffer_load_dwordx4 v4, s[12:15], s42 offen offset:0 lds
    buffer_load_dwordx4 v5, s[12:15], s42 offen offset:1024 lds
    buffer_load_dwordx4 v6, s[12:15], s42 offen offset:2048 lds
    buffer_load_dwordx4 v7, s[12:15], s42 offen offset:3072 lds
    s_add_u32 s43, s45, 0
    s_and_b32 s43, s43, 7
    s_lshl_b32 s43, s43, 19
    s_add_u32 s43, s43, 262144
    s_add_u32 m0, s41, 16384
    s_nop 0
    buffer_load_dwordx4 v8, s[16:19], s43 offen offset:0 lds
    buffer_load_dwordx4 v9, s[16:19], s43 offen offset:1024 lds
    s_sub_u32 m0, m0, 8192
    s_nop 0
    buffer_load_dwordx4 v8, s[28:31], s43 offen offset:0 lds
    buffer_load_dwordx4 v9, s[28:31], s43 offen offset:1024 lds
    s_add_u32 s43, s45, 1
    s_and_b32 s43, s43, 7
    s_lshl_b32 s43, s43, 19
    s_add_u32 m0, s41, 32768
    s_nop 0
    buffer_load_dwordx4 v8, s[16:19], s43 offen offset:0 lds
    buffer_load_dwordx4 v9, s[16:19], s43 offen offset:1024 lds
    s_sub_u32 m0, m0, 8192
    s_nop 0
    buffer_load_dwordx4 v8, s[28:31], s43 offen offset:0 lds
    buffer_load_dwordx4 v9, s[28:31], s43 offen offset:1024 lds
    s_add_u32 s42, s45, 1
    s_and_b32 s42, s42, 7
    s_lshl_b32 s42, s42, 7
    s_add_u32 m0, s40, 32768
    s_nop 0
    buffer_load_dwordx4 v4, s[12:15], s42 offen offset:0 lds
    buffer_load_dwordx4 v5, s[12:15], s42 offen offset:1024 lds
    buffer_load_dwordx4 v6, s[12:15], s42 offen offset:2048 lds
    buffer_load_dwordx4 v7, s[12:15], s42 offen offset:3072 lds
    s_sub_u32 m0, m0, 16384
    s_add_u32 s42, s42, s49
    buffer_load_dwordx4 v4, s[12:15], s42 offen offset:0 lds
    buffer_load_dwordx4 v5, s[12:15], s42 offen offset:1024 lds
    buffer_load_dwordx4 v6, s[12:15], s42 offen offset:2048 lds
    buffer_load_dwordx4 v7, s[12:15], s42 offen offset:3072 lds
    s_lshl_b32 s3, s21, 3
    s_add_u32 s3, s3, s22
    s_lshl_b32 s3, s3, 7
    s_add_u32 s3, s3, 71303168
    v_and_b32 v104, 31, v2
    v_lshlrev_b32 v104, 2, v104
    v_mov_b32 v105, 0
    buffer_store_dword v105, v104, s[8:11], s3 offen sc1
main_kernel_j0_5:
    s_mov_b32 s68, s90
    s_and_b32 s69, s91, 0xffff
    s_mov_b32 s70, 2097152
    s_mov_b32 s71, 0x00020000
    s_mov_b32 s72, s7
    s_and_b32 s73, s6, 0xffff
    s_mov_b32 s74, 0x400000
    s_mov_b32 s75, 0x00020000
    s_mov_b32 s60, s64
    s_and_b32 s61, s65, 0xffff
    s_mov_b32 s62, 256
    s_mov_b32 s63, 0x00020000
    s_lshl_b32 s3, s54, 1
    s_load_dword s55, s[88:89], s3
    s_lshr_b32 s23, s20, 2
    s_and_b32 s24, s20, 3
    s_lshl_b32 s39, s24, 13
    s_sub_u32 s3, 3, s24
    s_cmp_eq_u32 s23, 0
    s_cselect_b32 s24, s24, s3
    s_sub_u32 s35, 15, s22
    s_lshl_b32 s32, s21, 19
    s_mov_b32 s36, 0x40004000
    s_mov_b32 s25, 0
    s_mov_b32 s28, 0
    v_lshlrev_b32 v3, 4, v2
    v_add_u32 v3, s39, v3
    v_lshlrev_b32 v120, 4, v0
    v_add_u32 v120, 147456, v120
    s_waitcnt vmcnt(0)
    ds_write_b128 v120, v[124:127]
    s_waitcnt lgkmcnt(0)
    s_lshr_b32 s47, s20, 1
    s_and_b32 s47, s47, 1
    s_lshl_b32 s48, s47, 11
    s_lshl_b32 s49, s47, 12
    s_cmp_ge_u32 s20, 4
    s_cselect_b32 s48, s49, s48
    s_movk_i32 s52, 4096
    s_cselect_b32 s52, 2048, s52
    s_cselect_b32 s50, 16777216, 0
    s_cselect_b32 s51, 0x10000, 0
    s_add_u32 s51, s51, s48
    s_add_u32 s50, s50, s48
    s_add_u32 s50, s50, s32
    s_and_b32 s46, s20, 1
    s_cmp_eq_u32 s46, 0
    s_cselect_b32 s46, s35, s22
    s_lshl_b32 s46, s46, 15
    s_add_u32 s50, s50, s46
    v_lshlrev_b32 v20, 4, v2
    v_add_u32 v20, s50, v20
    v_add_u32 v31, s52, v20
    s_cmp_ge_u32 s20, 4
    s_cbranch_scc1 main_kernel_vtype_8
    s_waitcnt vmcnt(6)
    s_barrier
    v_and_b32 v120, 15, v2
    v_lshrrev_b32 v121, 4, v2
    v_lshrrev_b32 v122, 2, v120
    v_lshl_add_u32 v122, v121, 3, v122
    v_lshlrev_b32 v122, 7, v122
    v_and_b32 v124, 3, v120
    v_lshl_add_u32 v122, v124, 3, v122
    s_and_b32 s3, s20, 3
    s_lshl_b32 s4, s3, 5
    s_lshr_b32 s5, s20, 2
    s_lshl_b32 s6, s5, 12
    s_add_u32 s4, s4, s6
    s_add_u32 s4, s4, 147456
    v_add_u32 v122, s4, v122
    ds_read_b64_tr_b16 v[124:125], v122
    ds_read_b64_tr_b16 v[126:127], v122 offset:512
    v_lshlrev_b32 v120, 12, v120
    v_lshl_add_u32 v120, v121, 4, v120
    s_and_b32 s4, s2, 7
    s_lshl_b32 s4, s4, 2
    s_add_u32 s4, s4, s3
    s_lshl_b32 s4, s4, 16
    s_lshr_b32 s6, s2, 3
    s_lshl_b32 s6, s6, 7
    s_add_u32 s4, s4, s6
    s_lshl_b32 s5, s5, 6
    s_add_u32 s4, s4, s5
    s_add_u32 s4, s4, 67108864
    s_waitcnt lgkmcnt(0)
    buffer_store_dwordx4 v[124:127], v120, s[8:11], s4 offen sc1
    s_lshr_b32 s3, s20, 2
    s_mul_i32 s3, s3, 12288
    s_add_u32 s3, s3, 69632
    v_and_b32 v101, 255, v0
    v_lshl_add_u32 v101, v101, 2, s3
    ds_read_b32 v104, v101 offset:0
    ds_read_b32 v105, v101 offset:3072
    ds_read_b32 v106, v101 offset:6144
    ds_read_b32 v107, v101 offset:9216
    ds_read_b32 v108, v101 offset:1024
    ds_read_b32 v109, v101 offset:4096
    ds_read_b32 v110, v101 offset:7168
    ds_read_b32 v111, v101 offset:10240
    ds_read_b32 v112, v101 offset:2048
    ds_read_b32 v113, v101 offset:5120
    ds_read_b32 v114, v101 offset:8192
    ds_read_b32 v115, v101 offset:11264
    s_waitcnt lgkmcnt(10)
    v_add_f32 v104, v104, v105
    s_waitcnt lgkmcnt(8)
    v_add_f32 v106, v106, v107
    v_add_f32 v28, v104, v106
    s_waitcnt lgkmcnt(6)
    v_add_f32 v108, v108, v109
    s_waitcnt lgkmcnt(4)
    v_add_f32 v110, v110, v111
    v_add_f32 v29, v108, v110
    s_waitcnt lgkmcnt(2)
    v_add_f32 v112, v112, v113
    s_waitcnt lgkmcnt(0)
    v_add_f32 v114, v114, v115
    v_add_f32_e64 v30, v112, v114
    ds_read_b64_tr_b16 v[32:33], v16 offset:0
    ds_read_b64_tr_b16 v[34:35], v16 offset:512
    ds_read_b64_tr_b16 v[36:37], v17 offset:0
    ds_read_b64_tr_b16 v[38:39], v17 offset:512
    ds_read_b64_tr_b16 v[40:41], v18 offset:0
    ds_read_b64_tr_b16 v[42:43], v18 offset:512
    ds_read_b64_tr_b16 v[44:45], v19 offset:0
    ds_read_b64_tr_b16 v[46:47], v19 offset:512
    ds_read_b128 v[64:67], v12 offset:0
    ds_read_b128 v[68:71], v12 offset:2048
    ds_read_b128 v[72:75], v12 offset:4096
    ds_read_b128 v[76:79], v12 offset:6144
    s_waitcnt lgkmcnt(3)
    s_nop 0
    v_mfma_f32_16x16x32_bf16 v[128:131], v[32:35], v[64:67], 0
    ds_read_b128 v[80:83], v12 offset:8192
    v_mfma_f32_16x16x32_bf16 v[132:135], v[36:39], v[64:67], 0
    v_mfma_f32_16x16x32_bf16 v[136:139], v[40:43], v[64:67], 0
    v_mfma_f32_16x16x32_bf16 v[140:143], v[44:47], v[64:67], 0
    s_waitcnt lgkmcnt(3)
    s_nop 0
    v_mfma_f32_16x16x32_bf16 v[144:147], v[32:35], v[68:71], 0
    ds_read_b128 v[84:87], v12 offset:10240
    v_mfma_f32_16x16x32_bf16 v[148:151], v[36:39], v[68:71], 0
    v_mfma_f32_16x16x32_bf16 v[152:155], v[40:43], v[68:71], 0
    s_waitcnt vmcnt(7)
    s_barrier
    v_mfma_f32_16x16x32_bf16 v[156:159], v[44:47], v[68:71], 0
    ds_read_b64_tr_b16 v[48:49], v16 offset:16384
    s_waitcnt lgkmcnt(4)
    s_nop 0
    v_mfma_f32_16x16x32_bf16 v[160:163], v[32:35], v[72:75], 0
    ds_read_b128 v[64:67], v12 offset:12288
    ds_read_b64_tr_b16 v[50:51], v16 offset:16896
    v_mfma_f32_16x16x32_bf16 v[164:167], v[36:39], v[72:75], 0
    ds_read_b64_tr_b16 v[52:53], v17 offset:16384
    s_add_u32 s43, s45, 1
    s_and_b32 s43, s43, 7
    s_lshl_b32 s43, s43, 19
    s_add_u32 s43, s43, 262144
    s_add_u32 m0, s41, 49152
    s_nop 0
    v_mfma_f32_16x16x32_bf16 v[168:171], v[40:43], v[72:75], 0
    ds_read_b64_tr_b16 v[54:55], v17 offset:16896
    v_mfma_f32_16x16x32_bf16 v[172:175], v[44:47], v[72:75], 0
    ds_read_b64_tr_b16 v[56:57], v18 offset:16384
    buffer_load_dwordx4 v8, s[16:19], s43 offen offset:0 lds
    s_waitcnt lgkmcnt(8)
    s_nop 0
    v_mfma_f32_16x16x32_bf16 v[176:179], v[32:35], v[76:79], 0
    ds_read_b128 v[68:71], v12 offset:14336
    ds_read_b64_tr_b16 v[58:59], v18 offset:16896
    v_mfma_f32_16x16x32_bf16 v[180:183], v[36:39], v[76:79], 0
    ds_read_b64_tr_b16 v[60:61], v19 offset:16384
    buffer_load_dwordx4 v9, s[16:19], s43 offen offset:1024 lds
    v_mfma_f32_16x16x32_bf16 v[184:187], v[40:43], v[76:79], 0
    ds_read_b64_tr_b16 v[62:63], v19 offset:16896
    v_mfma_f32_16x16x32_bf16 v[188:191], v[44:47], v[76:79], 0
    s_add_u32 s42, s45, 2
    s_and_b32 s42, s42, 7
    s_lshl_b32 s42, s42, 7
    s_add_u32 m0, s40, 65536
    s_waitcnt lgkmcnt(11)
    v_mfma_f32_16x16x32_bf16 v[192:195], v[32:35], v[80:83], 0
    ds_read_b128 v[72:75], v14 offset:0
    v_mfma_f32_16x16x32_bf16 v[196:199], v[36:39], v[80:83], 0
    buffer_load_dwordx4 v4, s[12:15], s42 offen offset:0 lds
    v_mfma_f32_16x16x32_bf16 v[200:203], v[40:43], v[80:83], 0
    v_mfma_f32_16x16x32_bf16 v[204:207], v[44:47], v[80:83], 0
    buffer_load_dwordx4 v5, s[12:15], s42 offen offset:1024 lds
    s_waitcnt lgkmcnt(11)
    s_nop 0
    v_mfma_f32_16x16x32_bf16 v[208:211], v[32:35], v[84:87], 0
    ds_read_b128 v[76:79], v14 offset:2048
    v_mfma_f32_16x16x32_bf16 v[212:215], v[36:39], v[84:87], 0
    buffer_load_dwordx4 v6, s[12:15], s42 offen offset:2048 lds
    v_mfma_f32_16x16x32_bf16 v[216:219], v[40:43], v[84:87], 0
    v_mfma_f32_16x16x32_bf16 v[220:223], v[44:47], v[84:87], 0
    buffer_load_dwordx4 v7, s[12:15], s42 offen offset:3072 lds
    s_waitcnt lgkmcnt(10)
    s_nop 0
    v_mfma_f32_16x16x32_bf16 v[224:227], v[32:35], v[64:67], 0
    ds_read_b128 v[80:83], v14 offset:4096
    v_mfma_f32_16x16x32_bf16 v[228:231], v[36:39], v[64:67], 0
    v_mfma_f32_16x16x32_bf16 v[232:235], v[40:43], v[64:67], 0
    v_mfma_f32_16x16x32_bf16 v[236:239], v[44:47], v[64:67], 0
    s_waitcnt lgkmcnt(6)
    s_nop 0
    v_mfma_f32_16x16x32_bf16 v[240:243], v[32:35], v[68:71], 0
    ds_read_b128 v[84:87], v14 offset:6144
    v_mfma_f32_16x16x32_bf16 v[244:247], v[36:39], v[68:71], 0
    v_mfma_f32_16x16x32_bf16 v[248:251], v[40:43], v[68:71], 0
    v_mfma_f32_16x16x32_bf16 v[252:255], v[44:47], v[68:71], 0
    s_waitcnt lgkmcnt(3)
    s_nop 0
    v_mfma_f32_16x16x32_bf16 v[128:131], v[48:51], v[72:75], v[128:131]
    ds_read_b128 v[64:67], v14 offset:8192
    v_mfma_f32_16x16x32_bf16 v[132:135], v[52:55], v[72:75], v[132:135]
    v_mfma_f32_16x16x32_bf16 v[136:139], v[56:59], v[72:75], v[136:139]
    v_mfma_f32_16x16x32_bf16 v[140:143], v[60:63], v[72:75], v[140:143]
    s_waitcnt lgkmcnt(3)
    s_nop 0
    v_mfma_f32_16x16x32_bf16 v[144:147], v[48:51], v[76:79], v[144:147]
    ds_read_b128 v[68:71], v14 offset:10240
    v_mfma_f32_16x16x32_bf16 v[148:151], v[52:55], v[76:79], v[148:151]
    v_mfma_f32_16x16x32_bf16 v[152:155], v[56:59], v[76:79], v[152:155]
    s_waitcnt vmcnt(13)
    s_barrier
    v_mfma_f32_16x16x32_bf16 v[156:159], v[60:63], v[76:79], v[156:159]
    ds_read_b64_tr_b16 v[32:33], v16 offset:32768
    s_waitcnt lgkmcnt(4)
    s_nop 0
    v_mfma_f32_16x16x32_bf16 v[160:163], v[48:51], v[80:83], v[160:163]
    ds_read_b128 v[72:75], v14 offset:12288
    ds_read_b64_tr_b16 v[34:35], v16 offset:33280
    v_mfma_f32_16x16x32_bf16 v[164:167], v[52:55], v[80:83], v[164:167]
    ds_read_b64_tr_b16 v[36:37], v17 offset:32768
    s_add_u32 s43, s45, 2
    s_and_b32 s43, s43, 7
    s_lshl_b32 s43, s43, 19
    s_add_u32 m0, s41, 0
    v_mfma_f32_16x16x32_bf16 v[168:171], v[56:59], v[80:83], v[168:171]
    ds_read_b64_tr_b16 v[38:39], v17 offset:33280
    v_mfma_f32_16x16x32_bf16 v[172:175], v[60:63], v[80:83], v[172:175]
    ds_read_b64_tr_b16 v[40:41], v18 offset:32768
    s_waitcnt lgkmcnt(8)
    s_nop 0
    v_mfma_f32_16x16x32_bf16 v[176:179], v[48:51], v[84:87], v[176:179]
    ds_read_b128 v[76:79], v14 offset:14336
    ds_read_b64_tr_b16 v[42:43], v18 offset:33280
    buffer_load_dwordx4 v8, s[16:19], s43 offen offset:0 lds
    v_mfma_f32_16x16x32_bf16 v[180:183], v[52:55], v[84:87], v[180:183]
    ds_read_b64_tr_b16 v[44:45], v19 offset:32768
    v_mfma_f32_16x16x32_bf16 v[184:187], v[56:59], v[84:87], v[184:187]
    ds_read_b64_tr_b16 v[46:47], v19 offset:33280
    v_mfma_f32_16x16x32_bf16 v[188:191], v[60:63], v[84:87], v[188:191]
    buffer_load_dwordx4 v9, s[16:19], s43 offen offset:1024 lds
    s_waitcnt lgkmcnt(11)
    s_nop 0
    v_mfma_f32_16x16x32_bf16 v[192:195], v[48:51], v[64:67], v[192:195]
    ds_read_b128 v[80:83], v12 offset:32768
    v_mfma_f32_16x16x32_bf16 v[196:199], v[52:55], v[64:67], v[196:199]
    v_mfma_f32_16x16x32_bf16 v[200:203], v[56:59], v[64:67], v[200:203]
    v_mfma_f32_16x16x32_bf16 v[204:207], v[60:63], v[64:67], v[204:207]
    s_waitcnt lgkmcnt(11)
    s_nop 0
    v_mfma_f32_16x16x32_bf16 v[208:211], v[48:51], v[68:71], v[208:211]
    ds_read_b128 v[84:87], v12 offset:34816
    v_mfma_f32_16x16x32_bf16 v[212:215], v[52:55], v[68:71], v[212:215]
    v_mfma_f32_16x16x32_bf16 v[216:219], v[56:59], v[68:71], v[216:219]
    v_mfma_f32_16x16x32_bf16 v[220:223], v[60:63], v[68:71], v[220:223]
    s_waitcnt lgkmcnt(10)
    s_nop 0
    v_mfma_f32_16x16x32_bf16 v[224:227], v[48:51], v[72:75], v[224:227]
    ds_read_b128 v[64:67], v12 offset:36864
    v_mfma_f32_16x16x32_bf16 v[228:231], v[52:55], v[72:75], v[228:231]
    v_mfma_f32_16x16x32_bf16 v[232:235], v[56:59], v[72:75], v[232:235]
    v_mfma_f32_16x16x32_bf16 v[236:239], v[60:63], v[72:75], v[236:239]
    s_waitcnt lgkmcnt(6)
    s_nop 0
    v_mfma_f32_16x16x32_bf16 v[240:243], v[48:51], v[76:79], v[240:243]
    ds_read_b128 v[68:71], v12 offset:38912
    v_mfma_f32_16x16x32_bf16 v[244:247], v[52:55], v[76:79], v[244:247]
    v_mfma_f32_16x16x32_bf16 v[248:251], v[56:59], v[76:79], v[248:251]
    v_mfma_f32_16x16x32_bf16 v[252:255], v[60:63], v[76:79], v[252:255]
    s_waitcnt lgkmcnt(3)
    s_nop 0
    v_mfma_f32_16x16x32_bf16 v[128:131], v[32:35], v[80:83], v[128:131]
    ds_read_b128 v[72:75], v12 offset:40960
    v_mfma_f32_16x16x32_bf16 v[132:135], v[36:39], v[80:83], v[132:135]
    v_mfma_f32_16x16x32_bf16 v[136:139], v[40:43], v[80:83], v[136:139]
    v_mfma_f32_16x16x32_bf16 v[140:143], v[44:47], v[80:83], v[140:143]
    s_waitcnt lgkmcnt(3)
    s_nop 0
    v_mfma_f32_16x16x32_bf16 v[144:147], v[32:35], v[84:87], v[144:147]
    ds_read_b128 v[76:79], v12 offset:43008
    v_mfma_f32_16x16x32_bf16 v[148:151], v[36:39], v[84:87], v[148:151]
    v_mfma_f32_16x16x32_bf16 v[152:155], v[40:43], v[84:87], v[152:155]
    s_waitcnt vmcnt(6)
    s_barrier
    v_mfma_f32_16x16x32_bf16 v[156:159], v[44:47], v[84:87], v[156:159]
    ds_read_b64_tr_b16 v[48:49], v16 offset:49152
    s_waitcnt lgkmcnt(4)
    s_nop 0
    v_mfma_f32_16x16x32_bf16 v[160:163], v[32:35], v[64:67], v[160:163]
    ds_read_b128 v[80:83], v12 offset:45056
    ds_read_b64_tr_b16 v[50:51], v16 offset:49664
    v_mfma_f32_16x16x32_bf16 v[164:167], v[36:39], v[64:67], v[164:167]
    ds_read_b64_tr_b16 v[52:53], v17 offset:49152
    s_add_u32 s43, s45, 2
    s_and_b32 s43, s43, 7
    s_lshl_b32 s43, s43, 19
    s_add_u32 s43, s43, 262144
    s_add_u32 m0, s41, 16384
    s_nop 0
    v_mfma_f32_16x16x32_bf16 v[168:171], v[40:43], v[64:67], v[168:171]
    ds_read_b64_tr_b16 v[54:55], v17 offset:49664
    v_mfma_f32_16x16x32_bf16 v[172:175], v[44:47], v[64:67], v[172:175]
    ds_read_b64_tr_b16 v[56:57], v18 offset:49152
    s_waitcnt lgkmcnt(8)
    s_nop 0
    v_mfma_f32_16x16x32_bf16 v[176:179], v[32:35], v[68:71], v[176:179]
    ds_read_b128 v[84:87], v12 offset:47104
    ds_read_b64_tr_b16 v[58:59], v18 offset:49664
    buffer_load_dwordx4 v8, s[16:19], s43 offen offset:0 lds
    v_mfma_f32_16x16x32_bf16 v[180:183], v[36:39], v[68:71], v[180:183]
    ds_read_b64_tr_b16 v[60:61], v19 offset:49152
    v_mfma_f32_16x16x32_bf16 v[184:187], v[40:43], v[68:71], v[184:187]
    ds_read_b64_tr_b16 v[62:63], v19 offset:49664
    v_mfma_f32_16x16x32_bf16 v[188:191], v[44:47], v[68:71], v[188:191]
    buffer_load_dwordx4 v9, s[16:19], s43 offen offset:1024 lds
    s_waitcnt lgkmcnt(11)
    s_nop 0
    v_mfma_f32_16x16x32_bf16 v[192:195], v[32:35], v[72:75], v[192:195]
    ds_read_b128 v[64:67], v14 offset:32768
    v_mfma_f32_16x16x32_bf16 v[196:199], v[36:39], v[72:75], v[196:199]
    v_mfma_f32_16x16x32_bf16 v[200:203], v[40:43], v[72:75], v[200:203]
    s_add_u32 s42, s45, 3
    s_and_b32 s42, s42, 7
    s_lshl_b32 s42, s42, 7
    s_add_u32 m0, s40, 0
    v_mfma_f32_16x16x32_bf16 v[204:207], v[44:47], v[72:75], v[204:207]
    s_waitcnt lgkmcnt(11)
    s_nop 0
    v_mfma_f32_16x16x32_bf16 v[208:211], v[32:35], v[76:79], v[208:211]
    ds_read_b128 v[68:71], v14 offset:34816
    v_mfma_f32_16x16x32_bf16 v[212:215], v[36:39], v[76:79], v[212:215]
    buffer_load_dwordx4 v4, s[12:15], s42 offen offset:0 lds
    v_mfma_f32_16x16x32_bf16 v[216:219], v[40:43], v[76:79], v[216:219]
    v_mfma_f32_16x16x32_bf16 v[220:223], v[44:47], v[76:79], v[220:223]
    s_waitcnt lgkmcnt(10)
    s_nop 0
    v_mfma_f32_16x16x32_bf16 v[224:227], v[32:35], v[80:83], v[224:227]
    ds_read_b128 v[72:75], v14 offset:36864
    buffer_load_dwordx4 v5, s[12:15], s42 offen offset:1024 lds
    v_mfma_f32_16x16x32_bf16 v[228:231], v[36:39], v[80:83], v[228:231]
    v_mfma_f32_16x16x32_bf16 v[232:235], v[40:43], v[80:83], v[232:235]
    v_mfma_f32_16x16x32_bf16 v[236:239], v[44:47], v[80:83], v[236:239]
    s_waitcnt lgkmcnt(6)
    s_nop 0
    v_mfma_f32_16x16x32_bf16 v[240:243], v[32:35], v[84:87], v[240:243]
    ds_read_b128 v[76:79], v14 offset:38912
    v_mfma_f32_16x16x32_bf16 v[244:247], v[36:39], v[84:87], v[244:247]
    v_mfma_f32_16x16x32_bf16 v[248:251], v[40:43], v[84:87], v[248:251]
    v_mfma_f32_16x16x32_bf16 v[252:255], v[44:47], v[84:87], v[252:255]
    s_waitcnt lgkmcnt(3)
    s_nop 0
    v_mfma_f32_16x16x32_bf16 v[128:131], v[48:51], v[64:67], v[128:131]
    ds_read_b128 v[80:83], v14 offset:40960
    v_mfma_f32_16x16x32_bf16 v[132:135], v[52:55], v[64:67], v[132:135]
    v_mfma_f32_16x16x32_bf16 v[136:139], v[56:59], v[64:67], v[136:139]
    v_mfma_f32_16x16x32_bf16 v[140:143], v[60:63], v[64:67], v[140:143]
    s_waitcnt lgkmcnt(3)
    s_nop 0
    v_mfma_f32_16x16x32_bf16 v[144:147], v[48:51], v[68:71], v[144:147]
    ds_read_b128 v[84:87], v14 offset:43008
    v_mfma_f32_16x16x32_bf16 v[148:151], v[52:55], v[68:71], v[148:151]
    v_mfma_f32_16x16x32_bf16 v[152:155], v[56:59], v[68:71], v[152:155]
    s_waitcnt vmcnt(4)
    s_barrier
    v_mfma_f32_16x16x32_bf16 v[156:159], v[60:63], v[68:71], v[156:159]
    ds_read_b64_tr_b16 v[32:33], v16 offset:0
    s_waitcnt lgkmcnt(4)
    s_nop 0
    v_mfma_f32_16x16x32_bf16 v[160:163], v[48:51], v[72:75], v[160:163]
    ds_read_b128 v[64:67], v14 offset:45056
    ds_read_b64_tr_b16 v[34:35], v16 offset:512
    v_mfma_f32_16x16x32_bf16 v[164:167], v[52:55], v[72:75], v[164:167]
    ds_read_b64_tr_b16 v[36:37], v17 offset:0
    s_add_u32 s43, s45, 3
    s_and_b32 s43, s43, 7
    s_lshl_b32 s43, s43, 19
    s_add_u32 m0, s41, 32768
    s_nop 0
    v_mfma_f32_16x16x32_bf16 v[168:171], v[56:59], v[72:75], v[168:171]
    ds_read_b64_tr_b16 v[38:39], v17 offset:512
    v_mfma_f32_16x16x32_bf16 v[172:175], v[60:63], v[72:75], v[172:175]
    ds_read_b64_tr_b16 v[40:41], v18 offset:0
    s_waitcnt lgkmcnt(8)
    s_nop 0
    v_mfma_f32_16x16x32_bf16 v[176:179], v[48:51], v[76:79], v[176:179]
    ds_read_b128 v[68:71], v14 offset:47104
    ds_read_b64_tr_b16 v[42:43], v18 offset:512
    buffer_load_dwordx4 v8, s[16:19], s43 offen offset:0 lds
    v_mfma_f32_16x16x32_bf16 v[180:183], v[52:55], v[76:79], v[180:183]
    ds_read_b64_tr_b16 v[44:45], v19 offset:0
    v_mfma_f32_16x16x32_bf16 v[184:187], v[56:59], v[76:79], v[184:187]
    ds_read_b64_tr_b16 v[46:47], v19 offset:512
    v_mfma_f32_16x16x32_bf16 v[188:191], v[60:63], v[76:79], v[188:191]
    buffer_load_dwordx4 v9, s[16:19], s43 offen offset:1024 lds
    s_waitcnt lgkmcnt(11)
    s_nop 0
    v_mfma_f32_16x16x32_bf16 v[192:195], v[48:51], v[80:83], v[192:195]
    ds_read_b128 v[72:75], v13 offset:0
    v_mfma_f32_16x16x32_bf16 v[196:199], v[52:55], v[80:83], v[196:199]
    v_mfma_f32_16x16x32_bf16 v[200:203], v[56:59], v[80:83], v[200:203]
    s_add_u32 s42, s45, 3
    s_and_b32 s42, s42, 7
    s_lshl_b32 s42, s42, 7
    s_add_u32 m0, s40, 0
    v_mfma_f32_16x16x32_bf16 v[204:207], v[60:63], v[80:83], v[204:207]
    s_waitcnt lgkmcnt(11)
    s_nop 0
    v_mfma_f32_16x16x32_bf16 v[208:211], v[48:51], v[84:87], v[208:211]
    ds_read_b128 v[76:79], v13 offset:2048
    v_mfma_f32_16x16x32_bf16 v[212:215], v[52:55], v[84:87], v[212:215]
    buffer_load_dwordx4 v6, s[12:15], s42 offen offset:2048 lds
    v_mfma_f32_16x16x32_bf16 v[216:219], v[56:59], v[84:87], v[216:219]
    v_mfma_f32_16x16x32_bf16 v[220:223], v[60:63], v[84:87], v[220:223]
    s_waitcnt lgkmcnt(10)
    s_nop 0
    v_mfma_f32_16x16x32_bf16 v[224:227], v[48:51], v[64:67], v[224:227]
    ds_read_b128 v[80:83], v13 offset:4096
    buffer_load_dwordx4 v7, s[12:15], s42 offen offset:3072 lds
    v_mfma_f32_16x16x32_bf16 v[228:231], v[52:55], v[64:67], v[228:231]
    v_mfma_f32_16x16x32_bf16 v[232:235], v[56:59], v[64:67], v[232:235]
    s_cmp_lg_u32 s20, 0
    s_cbranch_scc1 main_kernel_noflag_10
    s_lshl_b32 s3, s21, 3
    s_add_u32 s3, s3, s22
    v_mov_b32 v21, s3
    v_mov_b32 v22, 1
    s_mov_b64 exec, 1
    buffer_store_byte v22, v21, s[60:63], 0 offen sc1
    s_mov_b64 exec, -1
main_kernel_noflag_10:
    v_mfma_f32_16x16x32_bf16 v[236:239], v[60:63], v[64:67], v[236:239]
    s_waitcnt lgkmcnt(6)
    s_nop 0
    v_mfma_f32_16x16x32_bf16 v[240:243], v[48:51], v[68:71], v[240:243]
    ds_read_b128 v[84:87], v13 offset:6144
    v_mfma_f32_16x16x32_bf16 v[244:247], v[52:55], v[68:71], v[244:247]
    v_mfma_f32_16x16x32_bf16 v[248:251], v[56:59], v[68:71], v[248:251]
    v_mfma_f32_16x16x32_bf16 v[252:255], v[60:63], v[68:71], v[252:255]
    s_waitcnt lgkmcnt(3)
    s_nop 0
    v_mfma_f32_16x16x32_bf16 v[128:131], v[32:35], v[72:75], v[128:131]
    ds_read_b128 v[64:67], v13 offset:8192
    v_mfma_f32_16x16x32_bf16 v[132:135], v[36:39], v[72:75], v[132:135]
    v_mfma_f32_16x16x32_bf16 v[136:139], v[40:43], v[72:75], v[136:139]
    v_mfma_f32_16x16x32_bf16 v[140:143], v[44:47], v[72:75], v[140:143]
    s_waitcnt lgkmcnt(3)
    s_nop 0
    v_mfma_f32_16x16x32_bf16 v[144:147], v[32:35], v[76:79], v[144:147]
    ds_read_b128 v[68:71], v13 offset:10240
    v_mfma_f32_16x16x32_bf16 v[148:151], v[36:39], v[76:79], v[148:151]
    v_mfma_f32_16x16x32_bf16 v[152:155], v[40:43], v[76:79], v[152:155]
    s_waitcnt vmcnt(6)
    s_barrier
    v_mfma_f32_16x16x32_bf16 v[156:159], v[44:47], v[76:79], v[156:159]
    ds_read_b64_tr_b16 v[48:49], v16 offset:16384
    s_waitcnt lgkmcnt(4)
    s_nop 0
    v_mfma_f32_16x16x32_bf16 v[160:163], v[32:35], v[80:83], v[160:163]
    ds_read_b128 v[72:75], v13 offset:12288
    ds_read_b64_tr_b16 v[50:51], v16 offset:16896
    v_mfma_f32_16x16x32_bf16 v[164:167], v[36:39], v[80:83], v[164:167]
    ds_read_b64_tr_b16 v[52:53], v17 offset:16384
    s_add_u32 s43, s45, 3
    s_and_b32 s43, s43, 7
    s_lshl_b32 s43, s43, 19
    s_add_u32 s43, s43, 262144
    s_add_u32 m0, s41, 49152
    s_nop 0
    v_mfma_f32_16x16x32_bf16 v[168:171], v[40:43], v[80:83], v[168:171]
    ds_read_b64_tr_b16 v[54:55], v17 offset:16896
    v_mfma_f32_16x16x32_bf16 v[172:175], v[44:47], v[80:83], v[172:175]
    ds_read_b64_tr_b16 v[56:57], v18 offset:16384
    s_waitcnt lgkmcnt(8)
    s_nop 0
    v_mfma_f32_16x16x32_bf16 v[176:179], v[32:35], v[84:87], v[176:179]
    ds_read_b128 v[76:79], v13 offset:14336
    ds_read_b64_tr_b16 v[58:59], v18 offset:16896
    buffer_load_dwordx4 v8, s[16:19], s43 offen offset:0 lds
    v_mfma_f32_16x16x32_bf16 v[180:183], v[36:39], v[84:87], v[180:183]
    ds_read_b64_tr_b16 v[60:61], v19 offset:16384
    v_mfma_f32_16x16x32_bf16 v[184:187], v[40:43], v[84:87], v[184:187]
    ds_read_b64_tr_b16 v[62:63], v19 offset:16896
    v_mfma_f32_16x16x32_bf16 v[188:191], v[44:47], v[84:87], v[188:191]
    buffer_load_dwordx4 v9, s[16:19], s43 offen offset:1024 lds
    s_waitcnt lgkmcnt(11)
    s_nop 0
    v_mfma_f32_16x16x32_bf16 v[192:195], v[32:35], v[64:67], v[192:195]
    ds_read_b128 v[80:83], v15 offset:0
    v_mfma_f32_16x16x32_bf16 v[196:199], v[36:39], v[64:67], v[196:199]
    v_mfma_f32_16x16x32_bf16 v[200:203], v[40:43], v[64:67], v[200:203]
    s_add_u32 s42, s45, 4
    s_and_b32 s42, s42, 7
    s_lshl_b32 s42, s42, 7
    s_add_u32 m0, s40, 32768
    s_nop 0
    v_mfma_f32_16x16x32_bf16 v[204:207], v[44:47], v[64:67], v[204:207]
    s_waitcnt lgkmcnt(11)
    s_nop 0
    v_mfma_f32_16x16x32_bf16 v[208:211], v[32:35], v[68:71], v[208:211]
    ds_read_b128 v[84:87], v15 offset:2048
    v_mfma_f32_16x16x32_bf16 v[212:215], v[36:39], v[68:71], v[212:215]
    buffer_load_dwordx4 v4, s[12:15], s42 offen offset:0 lds
    v_mfma_f32_16x16x32_bf16 v[216:219], v[40:43], v[68:71], v[216:219]
    v_mfma_f32_16x16x32_bf16 v[220:223], v[44:47], v[68:71], v[220:223]
    s_waitcnt lgkmcnt(10)
    s_nop 0
    v_mfma_f32_16x16x32_bf16 v[224:227], v[32:35], v[72:75], v[224:227]
    ds_read_b128 v[64:67], v15 offset:4096
    buffer_load_dwordx4 v5, s[12:15], s42 offen offset:1024 lds
    v_mfma_f32_16x16x32_bf16 v[228:231], v[36:39], v[72:75], v[228:231]
    v_mfma_f32_16x16x32_bf16 v[232:235], v[40:43], v[72:75], v[232:235]
    v_mfma_f32_16x16x32_bf16 v[236:239], v[44:47], v[72:75], v[236:239]
    s_waitcnt lgkmcnt(6)
    s_nop 0
    v_mfma_f32_16x16x32_bf16 v[240:243], v[32:35], v[76:79], v[240:243]
    ds_read_b128 v[68:71], v15 offset:6144
    v_mfma_f32_16x16x32_bf16 v[244:247], v[36:39], v[76:79], v[244:247]
    v_mfma_f32_16x16x32_bf16 v[248:251], v[40:43], v[76:79], v[248:251]
    v_mfma_f32_16x16x32_bf16 v[252:255], v[44:47], v[76:79], v[252:255]
    s_waitcnt lgkmcnt(3)
    s_nop 0
    v_mfma_f32_16x16x32_bf16 v[128:131], v[48:51], v[80:83], v[128:131]
    ds_read_b128 v[72:75], v15 offset:8192
    v_mfma_f32_16x16x32_bf16 v[132:135], v[52:55], v[80:83], v[132:135]
    v_mfma_f32_16x16x32_bf16 v[136:139], v[56:59], v[80:83], v[136:139]
    v_mfma_f32_16x16x32_bf16 v[140:143], v[60:63], v[80:83], v[140:143]
    s_waitcnt lgkmcnt(3)
    s_nop 0
    v_mfma_f32_16x16x32_bf16 v[144:147], v[48:51], v[84:87], v[144:147]
    ds_read_b128 v[76:79], v15 offset:10240
    v_mfma_f32_16x16x32_bf16 v[148:151], v[52:55], v[84:87], v[148:151]
    v_mfma_f32_16x16x32_bf16 v[152:155], v[56:59], v[84:87], v[152:155]
    s_waitcnt vmcnt(4)
    s_barrier
    v_mfma_f32_16x16x32_bf16 v[156:159], v[60:63], v[84:87], v[156:159]
    ds_read_b64_tr_b16 v[32:33], v16 offset:32768
    s_waitcnt lgkmcnt(4)
    s_nop 0
    v_mfma_f32_16x16x32_bf16 v[160:163], v[48:51], v[64:67], v[160:163]
    ds_read_b128 v[80:83], v15 offset:12288
    ds_read_b64_tr_b16 v[34:35], v16 offset:33280
    v_mfma_f32_16x16x32_bf16 v[164:167], v[52:55], v[64:67], v[164:167]
    ds_read_b64_tr_b16 v[36:37], v17 offset:32768
    s_add_u32 s43, s45, 4
    s_and_b32 s43, s43, 7
    s_lshl_b32 s43, s43, 19
    s_add_u32 m0, s41, 0
    v_mfma_f32_16x16x32_bf16 v[168:171], v[56:59], v[64:67], v[168:171]
    ds_read_b64_tr_b16 v[38:39], v17 offset:33280
    v_mfma_f32_16x16x32_bf16 v[172:175], v[60:63], v[64:67], v[172:175]
    ds_read_b64_tr_b16 v[40:41], v18 offset:32768
    s_waitcnt lgkmcnt(8)
    s_nop 0
    v_mfma_f32_16x16x32_bf16 v[176:179], v[48:51], v[68:71], v[176:179]
    ds_read_b128 v[84:87], v15 offset:14336
    ds_read_b64_tr_b16 v[42:43], v18 offset:33280
    buffer_load_dwordx4 v8, s[16:19], s43 offen offset:0 lds
    v_mfma_f32_16x16x32_bf16 v[180:183], v[52:55], v[68:71], v[180:183]
    ds_read_b64_tr_b16 v[44:45], v19 offset:32768
    v_mfma_f32_16x16x32_bf16 v[184:187], v[56:59], v[68:71], v[184:187]
    ds_read_b64_tr_b16 v[46:47], v19 offset:33280
    v_mfma_f32_16x16x32_bf16 v[188:191], v[60:63], v[68:71], v[188:191]
    buffer_load_dwordx4 v9, s[16:19], s43 offen offset:1024 lds
    s_waitcnt lgkmcnt(11)
    s_nop 0
    v_mfma_f32_16x16x32_bf16 v[192:195], v[48:51], v[72:75], v[192:195]
    ds_read_b128 v[64:67], v12 offset:0
    v_mfma_f32_16x16x32_bf16 v[196:199], v[52:55], v[72:75], v[196:199]
    v_mfma_f32_16x16x32_bf16 v[200:203], v[56:59], v[72:75], v[200:203]
    s_add_u32 s42, s45, 4
    s_and_b32 s42, s42, 7
    s_lshl_b32 s42, s42, 7
    s_add_u32 m0, s40, 32768
    s_nop 0
    v_mfma_f32_16x16x32_bf16 v[204:207], v[60:63], v[72:75], v[204:207]
    s_waitcnt lgkmcnt(11)
    s_nop 0
    v_mfma_f32_16x16x32_bf16 v[208:211], v[48:51], v[76:79], v[208:211]
    ds_read_b128 v[68:71], v12 offset:2048
    v_mfma_f32_16x16x32_bf16 v[212:215], v[52:55], v[76:79], v[212:215]
    buffer_load_dwordx4 v6, s[12:15], s42 offen offset:2048 lds
    v_mfma_f32_16x16x32_bf16 v[216:219], v[56:59], v[76:79], v[216:219]
    v_mfma_f32_16x16x32_bf16 v[220:223], v[60:63], v[76:79], v[220:223]
    s_waitcnt lgkmcnt(10)
    s_nop 0
    v_mfma_f32_16x16x32_bf16 v[224:227], v[48:51], v[80:83], v[224:227]
    ds_read_b128 v[72:75], v12 offset:4096
    buffer_load_dwordx4 v7, s[12:15], s42 offen offset:3072 lds
    v_mfma_f32_16x16x32_bf16 v[228:231], v[52:55], v[80:83], v[228:231]
    v_mfma_f32_16x16x32_bf16 v[232:235], v[56:59], v[80:83], v[232:235]
    v_mfma_f32_16x16x32_bf16 v[236:239], v[60:63], v[80:83], v[236:239]
    s_waitcnt lgkmcnt(6)
    s_nop 0
    v_mfma_f32_16x16x32_bf16 v[240:243], v[48:51], v[84:87], v[240:243]
    ds_read_b128 v[76:79], v12 offset:6144
    v_mfma_f32_16x16x32_bf16 v[244:247], v[52:55], v[84:87], v[244:247]
    v_mfma_f32_16x16x32_bf16 v[248:251], v[56:59], v[84:87], v[248:251]
    v_mfma_f32_16x16x32_bf16 v[252:255], v[60:63], v[84:87], v[252:255]
    s_waitcnt lgkmcnt(3)
    s_nop 0
    v_mfma_f32_16x16x32_bf16 v[128:131], v[32:35], v[64:67], v[128:131]
    ds_read_b128 v[80:83], v12 offset:8192
    v_mfma_f32_16x16x32_bf16 v[132:135], v[36:39], v[64:67], v[132:135]
    v_mfma_f32_16x16x32_bf16 v[136:139], v[40:43], v[64:67], v[136:139]
    v_mfma_f32_16x16x32_bf16 v[140:143], v[44:47], v[64:67], v[140:143]
    s_waitcnt lgkmcnt(3)
    s_nop 0
    v_mfma_f32_16x16x32_bf16 v[144:147], v[32:35], v[68:71], v[144:147]
    ds_read_b128 v[84:87], v12 offset:10240
    v_mfma_f32_16x16x32_bf16 v[148:151], v[36:39], v[68:71], v[148:151]
    v_mfma_f32_16x16x32_bf16 v[152:155], v[40:43], v[68:71], v[152:155]
    s_waitcnt vmcnt(6)
    s_barrier
    v_mfma_f32_16x16x32_bf16 v[156:159], v[44:47], v[68:71], v[156:159]
    ds_read_b64_tr_b16 v[48:49], v16 offset:49152
    s_waitcnt lgkmcnt(4)
    s_nop 0
    v_mfma_f32_16x16x32_bf16 v[160:163], v[32:35], v[72:75], v[160:163]
    ds_read_b128 v[64:67], v12 offset:12288
    ds_read_b64_tr_b16 v[50:51], v16 offset:49664
    v_mfma_f32_16x16x32_bf16 v[164:167], v[36:39], v[72:75], v[164:167]
    ds_read_b64_tr_b16 v[52:53], v17 offset:49152
    s_add_u32 s43, s45, 4
    s_and_b32 s43, s43, 7
    s_lshl_b32 s43, s43, 19
    s_add_u32 s43, s43, 262144
    s_add_u32 m0, s41, 16384
    s_nop 0
    v_mfma_f32_16x16x32_bf16 v[168:171], v[40:43], v[72:75], v[168:171]
    ds_read_b64_tr_b16 v[54:55], v17 offset:49664
    v_mfma_f32_16x16x32_bf16 v[172:175], v[44:47], v[72:75], v[172:175]
    ds_read_b64_tr_b16 v[56:57], v18 offset:49152
    s_waitcnt lgkmcnt(8)
    s_nop 0
    v_mfma_f32_16x16x32_bf16 v[176:179], v[32:35], v[76:79], v[176:179]
    ds_read_b128 v[68:71], v12 offset:14336
    ds_read_b64_tr_b16 v[58:59], v18 offset:49664
    buffer_load_dwordx4 v8, s[16:19], s43 offen offset:0 lds
    v_mfma_f32_16x16x32_bf16 v[180:183], v[36:39], v[76:79], v[180:183]
    ds_read_b64_tr_b16 v[60:61], v19 offset:49152
    v_mfma_f32_16x16x32_bf16 v[184:187], v[40:43], v[76:79], v[184:187]
    ds_read_b64_tr_b16 v[62:63], v19 offset:49664
    v_mfma_f32_16x16x32_bf16 v[188:191], v[44:47], v[76:79], v[188:191]
    buffer_load_dwordx4 v9, s[16:19], s43 offen offset:1024 lds
    s_waitcnt lgkmcnt(11)
    s_nop 0
    v_mfma_f32_16x16x32_bf16 v[192:195], v[32:35], v[80:83], v[192:195]
    ds_read_b128 v[72:75], v14 offset:0
    v_mfma_f32_16x16x32_bf16 v[196:199], v[36:39], v[80:83], v[196:199]
    v_mfma_f32_16x16x32_bf16 v[200:203], v[40:43], v[80:83], v[200:203]
    s_add_u32 s42, s45, 5
    s_and_b32 s42, s42, 7
    s_lshl_b32 s42, s42, 7
    s_add_u32 m0, s40, 65536
    s_nop 0
    v_mfma_f32_16x16x32_bf16 v[204:207], v[44:47], v[80:83], v[204:207]
    s_waitcnt lgkmcnt(11)
    s_nop 0
    v_mfma_f32_16x16x32_bf16 v[208:211], v[32:35], v[84:87], v[208:211]
    ds_read_b128 v[76:79], v14 offset:2048
    v_mfma_f32_16x16x32_bf16 v[212:215], v[36:39], v[84:87], v[212:215]
    buffer_load_dwordx4 v4, s[12:15], s42 offen offset:0 lds
    v_mfma_f32_16x16x32_bf16 v[216:219], v[40:43], v[84:87], v[216:219]
    v_mfma_f32_16x16x32_bf16 v[220:223], v[44:47], v[84:87], v[220:223]
    s_waitcnt lgkmcnt(10)
    s_nop 0
    v_mfma_f32_16x16x32_bf16 v[224:227], v[32:35], v[64:67], v[224:227]
    ds_read_b128 v[80:83], v14 offset:4096
    buffer_load_dwordx4 v5, s[12:15], s42 offen offset:1024 lds
    v_mfma_f32_16x16x32_bf16 v[228:231], v[36:39], v[64:67], v[228:231]
    v_mfma_f32_16x16x32_bf16 v[232:235], v[40:43], v[64:67], v[232:235]
    v_mfma_f32_16x16x32_bf16 v[236:239], v[44:47], v[64:67], v[236:239]
    s_waitcnt lgkmcnt(6)
    s_nop 0
    v_mfma_f32_16x16x32_bf16 v[240:243], v[32:35], v[68:71], v[240:243]
    ds_read_b128 v[84:87], v14 offset:6144
    v_mfma_f32_16x16x32_bf16 v[244:247], v[36:39], v[68:71], v[244:247]
    v_mfma_f32_16x16x32_bf16 v[248:251], v[40:43], v[68:71], v[248:251]
    v_mfma_f32_16x16x32_bf16 v[252:255], v[44:47], v[68:71], v[252:255]
    s_waitcnt lgkmcnt(3)
    s_nop 0
    v_mfma_f32_16x16x32_bf16 v[128:131], v[48:51], v[72:75], v[128:131]
    ds_read_b128 v[64:67], v14 offset:8192
    v_mfma_f32_16x16x32_bf16 v[132:135], v[52:55], v[72:75], v[132:135]
    v_mfma_f32_16x16x32_bf16 v[136:139], v[56:59], v[72:75], v[136:139]
    v_mfma_f32_16x16x32_bf16 v[140:143], v[60:63], v[72:75], v[140:143]
    s_waitcnt lgkmcnt(3)
    s_nop 0
    v_mfma_f32_16x16x32_bf16 v[144:147], v[48:51], v[76:79], v[144:147]
    ds_read_b128 v[68:71], v14 offset:10240
    v_mfma_f32_16x16x32_bf16 v[148:151], v[52:55], v[76:79], v[148:151]
    v_mfma_f32_16x16x32_bf16 v[152:155], v[56:59], v[76:79], v[152:155]
    s_waitcnt vmcnt(4)
    s_barrier
    v_mfma_f32_16x16x32_bf16 v[156:159], v[60:63], v[76:79], v[156:159]
    ds_read_b64_tr_b16 v[32:33], v16 offset:0
    s_waitcnt lgkmcnt(4)
    s_nop 0
    v_mfma_f32_16x16x32_bf16 v[160:163], v[48:51], v[80:83], v[160:163]
    ds_read_b128 v[72:75], v14 offset:12288
    ds_read_b64_tr_b16 v[34:35], v16 offset:512
    v_mfma_f32_16x16x32_bf16 v[164:167], v[52:55], v[80:83], v[164:167]
    ds_read_b64_tr_b16 v[36:37], v17 offset:0
    s_add_u32 s43, s45, 5
    s_and_b32 s43, s43, 7
    s_lshl_b32 s43, s43, 19
    s_add_u32 m0, s41, 32768
    s_nop 0
    v_mfma_f32_16x16x32_bf16 v[168:171], v[56:59], v[80:83], v[168:171]
    ds_read_b64_tr_b16 v[38:39], v17 offset:512
    v_mfma_f32_16x16x32_bf16 v[172:175], v[60:63], v[80:83], v[172:175]
    ds_read_b64_tr_b16 v[40:41], v18 offset:0
    s_waitcnt lgkmcnt(8)
    s_nop 0
    v_mfma_f32_16x16x32_bf16 v[176:179], v[48:51], v[84:87], v[176:179]
    ds_read_b128 v[76:79], v14 offset:14336
    ds_read_b64_tr_b16 v[42:43], v18 offset:512
    buffer_load_dwordx4 v8, s[16:19], s43 offen offset:0 lds
    v_mfma_f32_16x16x32_bf16 v[180:183], v[52:55], v[84:87], v[180:183]
    ds_read_b64_tr_b16 v[44:45], v19 offset:0
    v_mfma_f32_16x16x32_bf16 v[184:187], v[56:59], v[84:87], v[184:187]
    ds_read_b64_tr_b16 v[46:47], v19 offset:512
    v_mfma_f32_16x16x32_bf16 v[188:191], v[60:63], v[84:87], v[188:191]
    buffer_load_dwordx4 v9, s[16:19], s43 offen offset:1024 lds
    s_waitcnt lgkmcnt(11)
    s_nop 0
    v_mfma_f32_16x16x32_bf16 v[192:195], v[48:51], v[64:67], v[192:195]
    ds_read_b128 v[80:83], v12 offset:32768
    v_mfma_f32_16x16x32_bf16 v[196:199], v[52:55], v[64:67], v[196:199]
    v_mfma_f32_16x16x32_bf16 v[200:203], v[56:59], v[64:67], v[200:203]
    s_add_u32 s42, s45, 5
    s_and_b32 s42, s42, 7
    s_lshl_b32 s42, s42, 7
    s_add_u32 m0, s40, 65536
    s_nop 0
    v_mfma_f32_16x16x32_bf16 v[204:207], v[60:63], v[64:67], v[204:207]
    s_waitcnt lgkmcnt(11)
    s_nop 0
    v_mfma_f32_16x16x32_bf16 v[208:211], v[48:51], v[68:71], v[208:211]
    ds_read_b128 v[84:87], v12 offset:34816
    v_mfma_f32_16x16x32_bf16 v[212:215], v[52:55], v[68:71], v[212:215]
    buffer_load_dwordx4 v6, s[12:15], s42 offen offset:2048 lds
    v_mfma_f32_16x16x32_bf16 v[216:219], v[56:59], v[68:71], v[216:219]
    v_mfma_f32_16x16x32_bf16 v[220:223], v[60:63], v[68:71], v[220:223]
    s_waitcnt lgkmcnt(10)
    s_nop 0
    v_mfma_f32_16x16x32_bf16 v[224:227], v[48:51], v[72:75], v[224:227]
    ds_read_b128 v[64:67], v12 offset:36864
    buffer_load_dwordx4 v7, s[12:15], s42 offen offset:3072 lds
    v_mfma_f32_16x16x32_bf16 v[228:231], v[52:55], v[72:75], v[228:231]
    v_mfma_f32_16x16x32_bf16 v[232:235], v[56:59], v[72:75], v[232:235]
    v_mfma_f32_16x16x32_bf16 v[236:239], v[60:63], v[72:75], v[236:239]
    s_waitcnt lgkmcnt(6)
    s_nop 0
    v_mfma_f32_16x16x32_bf16 v[240:243], v[48:51], v[76:79], v[240:243]
    ds_read_b128 v[68:71], v12 offset:38912
    v_mfma_f32_16x16x32_bf16 v[244:247], v[52:55], v[76:79], v[244:247]
    v_mfma_f32_16x16x32_bf16 v[248:251], v[56:59], v[76:79], v[248:251]
    v_mfma_f32_16x16x32_bf16 v[252:255], v[60:63], v[76:79], v[252:255]
    s_waitcnt lgkmcnt(3)
    s_nop 0
    v_mfma_f32_16x16x32_bf16 v[128:131], v[32:35], v[80:83], v[128:131]
    ds_read_b128 v[72:75], v12 offset:40960
    v_mfma_f32_16x16x32_bf16 v[132:135], v[36:39], v[80:83], v[132:135]
    v_mfma_f32_16x16x32_bf16 v[136:139], v[40:43], v[80:83], v[136:139]
    v_mfma_f32_16x16x32_bf16 v[140:143], v[44:47], v[80:83], v[140:143]
    s_waitcnt lgkmcnt(3)
    s_nop 0
    v_mfma_f32_16x16x32_bf16 v[144:147], v[32:35], v[84:87], v[144:147]
    ds_read_b128 v[76:79], v12 offset:43008
    v_mfma_f32_16x16x32_bf16 v[148:151], v[36:39], v[84:87], v[148:151]
    v_mfma_f32_16x16x32_bf16 v[152:155], v[40:43], v[84:87], v[152:155]
    s_waitcnt vmcnt(6)
    s_barrier
    v_mfma_f32_16x16x32_bf16 v[156:159], v[44:47], v[84:87], v[156:159]
    ds_read_b64_tr_b16 v[48:49], v16 offset:16384
    s_waitcnt lgkmcnt(4)
    s_nop 0
    v_mfma_f32_16x16x32_bf16 v[160:163], v[32:35], v[64:67], v[160:163]
    ds_read_b128 v[80:83], v12 offset:45056
    ds_read_b64_tr_b16 v[50:51], v16 offset:16896
    v_mfma_f32_16x16x32_bf16 v[164:167], v[36:39], v[64:67], v[164:167]
    ds_read_b64_tr_b16 v[52:53], v17 offset:16384
    s_add_u32 s43, s45, 5
    s_and_b32 s43, s43, 7
    s_lshl_b32 s43, s43, 19
    s_add_u32 s43, s43, 262144
    s_add_u32 m0, s41, 49152
    s_nop 0
    v_mfma_f32_16x16x32_bf16 v[168:171], v[40:43], v[64:67], v[168:171]
    ds_read_b64_tr_b16 v[54:55], v17 offset:16896
    v_mfma_f32_16x16x32_bf16 v[172:175], v[44:47], v[64:67], v[172:175]
    ds_read_b64_tr_b16 v[56:57], v18 offset:16384
    s_waitcnt lgkmcnt(8)
    s_nop 0
    v_mfma_f32_16x16x32_bf16 v[176:179], v[32:35], v[68:71], v[176:179]
    ds_read_b128 v[84:87], v12 offset:47104
    ds_read_b64_tr_b16 v[58:59], v18 offset:16896
    buffer_load_dwordx4 v8, s[16:19], s43 offen offset:0 lds
    v_mfma_f32_16x16x32_bf16 v[180:183], v[36:39], v[68:71], v[180:183]
    ds_read_b64_tr_b16 v[60:61], v19 offset:16384
    v_mfma_f32_16x16x32_bf16 v[184:187], v[40:43], v[68:71], v[184:187]
    ds_read_b64_tr_b16 v[62:63], v19 offset:16896
    v_mfma_f32_16x16x32_bf16 v[188:191], v[44:47], v[68:71], v[188:191]
    buffer_load_dwordx4 v9, s[16:19], s43 offen offset:1024 lds
    s_waitcnt lgkmcnt(11)
    s_nop 0
    v_mfma_f32_16x16x32_bf16 v[192:195], v[32:35], v[72:75], v[192:195]
    ds_read_b128 v[64:67], v14 offset:32768
    v_mfma_f32_16x16x32_bf16 v[196:199], v[36:39], v[72:75], v[196:199]
    v_mfma_f32_16x16x32_bf16 v[200:203], v[40:43], v[72:75], v[200:203]
    s_add_u32 s42, s45, 6
    s_and_b32 s42, s42, 7
    s_lshl_b32 s42, s42, 7
    s_add_u32 m0, s40, 0
    v_mfma_f32_16x16x32_bf16 v[204:207], v[44:47], v[72:75], v[204:207]
    s_waitcnt lgkmcnt(11)
    s_nop 0
    v_mfma_f32_16x16x32_bf16 v[208:211], v[32:35], v[76:79], v[208:211]
    ds_read_b128 v[68:71], v14 offset:34816
    v_mfma_f32_16x16x32_bf16 v[212:215], v[36:39], v[76:79], v[212:215]
    buffer_load_dwordx4 v4, s[12:15], s42 offen offset:0 lds
    v_mfma_f32_16x16x32_bf16 v[216:219], v[40:43], v[76:79], v[216:219]
    v_mfma_f32_16x16x32_bf16 v[220:223], v[44:47], v[76:79], v[220:223]
    s_waitcnt lgkmcnt(10)
    s_nop 0
    v_mfma_f32_16x16x32_bf16 v[224:227], v[32:35], v[80:83], v[224:227]
    ds_read_b128 v[72:75], v14 offset:36864
    buffer_load_dwordx4 v5, s[12:15], s42 offen offset:1024 lds
    v_mfma_f32_16x16x32_bf16 v[228:231], v[36:39], v[80:83], v[228:231]
    v_mfma_f32_16x16x32_bf16 v[232:235], v[40:43], v[80:83], v[232:235]
    v_mfma_f32_16x16x32_bf16 v[236:239], v[44:47], v[80:83], v[236:239]
    s_waitcnt lgkmcnt(6)
    s_nop 0
    v_mfma_f32_16x16x32_bf16 v[240:243], v[32:35], v[84:87], v[240:243]
    ds_read_b128 v[76:79], v14 offset:38912
    v_mfma_f32_16x16x32_bf16 v[244:247], v[36:39], v[84:87], v[244:247]
    v_mfma_f32_16x16x32_bf16 v[248:251], v[40:43], v[84:87], v[248:251]
    v_mfma_f32_16x16x32_bf16 v[252:255], v[44:47], v[84:87], v[252:255]
    s_waitcnt lgkmcnt(3)
    s_nop 0
    v_mfma_f32_16x16x32_bf16 v[128:131], v[48:51], v[64:67], v[128:131]
    ds_read_b128 v[80:83], v14 offset:40960
    v_mfma_f32_16x16x32_bf16 v[132:135], v[52:55], v[64:67], v[132:135]
    v_mfma_f32_16x16x32_bf16 v[136:139], v[56:59], v[64:67], v[136:139]
    v_mfma_f32_16x16x32_bf16 v[140:143], v[60:63], v[64:67], v[140:143]
    s_waitcnt lgkmcnt(3)
    s_nop 0
    v_mfma_f32_16x16x32_bf16 v[144:147], v[48:51], v[68:71], v[144:147]
    ds_read_b128 v[84:87], v14 offset:43008
    v_mfma_f32_16x16x32_bf16 v[148:151], v[52:55], v[68:71], v[148:151]
    v_mfma_f32_16x16x32_bf16 v[152:155], v[56:59], v[68:71], v[152:155]
    s_waitcnt vmcnt(4)
    s_barrier
    v_mfma_f32_16x16x32_bf16 v[156:159], v[60:63], v[68:71], v[156:159]
    ds_read_b64_tr_b16 v[32:33], v16 offset:32768
    s_waitcnt lgkmcnt(4)
    s_nop 0
    v_mfma_f32_16x16x32_bf16 v[160:163], v[48:51], v[72:75], v[160:163]
    ds_read_b128 v[64:67], v14 offset:45056
    ds_read_b64_tr_b16 v[34:35], v16 offset:33280
    v_mfma_f32_16x16x32_bf16 v[164:167], v[52:55], v[72:75], v[164:167]
    ds_read_b64_tr_b16 v[36:37], v17 offset:32768
    s_add_u32 s43, s45, 6
    s_and_b32 s43, s43, 7
    s_lshl_b32 s43, s43, 19
    s_add_u32 m0, s41, 0
    v_mfma_f32_16x16x32_bf16 v[168:171], v[56:59], v[72:75], v[168:171]
    ds_read_b64_tr_b16 v[38:39], v17 offset:33280
    v_mfma_f32_16x16x32_bf16 v[172:175], v[60:63], v[72:75], v[172:175]
    ds_read_b64_tr_b16 v[40:41], v18 offset:32768
    s_waitcnt lgkmcnt(8)
    s_nop 0
    v_mfma_f32_16x16x32_bf16 v[176:179], v[48:51], v[76:79], v[176:179]
    ds_read_b128 v[68:71], v14 offset:47104
    ds_read_b64_tr_b16 v[42:43], v18 offset:33280
    buffer_load_dwordx4 v8, s[16:19], s43 offen offset:0 lds
    v_mfma_f32_16x16x32_bf16 v[180:183], v[52:55], v[76:79], v[180:183]
    ds_read_b64_tr_b16 v[44:45], v19 offset:32768
    v_mfma_f32_16x16x32_bf16 v[184:187], v[56:59], v[76:79], v[184:187]
    ds_read_b64_tr_b16 v[46:47], v19 offset:33280
    v_mfma_f32_16x16x32_bf16 v[188:191], v[60:63], v[76:79], v[188:191]
    buffer_load_dwordx4 v9, s[16:19], s43 offen offset:1024 lds
    s_waitcnt lgkmcnt(11)
    s_nop 0
    v_mfma_f32_16x16x32_bf16 v[192:195], v[48:51], v[80:83], v[192:195]
    ds_read_b128 v[72:75], v13 offset:0
    v_mfma_f32_16x16x32_bf16 v[196:199], v[52:55], v[80:83], v[196:199]
    v_mfma_f32_16x16x32_bf16 v[200:203], v[56:59], v[80:83], v[200:203]
    s_add_u32 s42, s45, 6
    s_and_b32 s42, s42, 7
    s_lshl_b32 s42, s42, 7
    s_add_u32 m0, s40, 0
    v_mfma_f32_16x16x32_bf16 v[204:207], v[60:63], v[80:83], v[204:207]
    s_waitcnt lgkmcnt(11)
    s_nop 0
    v_mfma_f32_16x16x32_bf16 v[208:211], v[48:51], v[84:87], v[208:211]
    ds_read_b128 v[76:79], v13 offset:2048
    v_mfma_f32_16x16x32_bf16 v[212:215], v[52:55], v[84:87], v[212:215]
    buffer_load_dwordx4 v6, s[12:15], s42 offen offset:2048 lds
    v_mfma_f32_16x16x32_bf16 v[216:219], v[56:59], v[84:87], v[216:219]
    v_mfma_f32_16x16x32_bf16 v[220:223], v[60:63], v[84:87], v[220:223]
    s_waitcnt lgkmcnt(10)
    s_nop 0
    v_mfma_f32_16x16x32_bf16 v[224:227], v[48:51], v[64:67], v[224:227]
    ds_read_b128 v[80:83], v13 offset:4096
    buffer_load_dwordx4 v7, s[12:15], s42 offen offset:3072 lds
    v_mfma_f32_16x16x32_bf16 v[228:231], v[52:55], v[64:67], v[228:231]
    v_mfma_f32_16x16x32_bf16 v[232:235], v[56:59], v[64:67], v[232:235]
    v_mfma_f32_16x16x32_bf16 v[236:239], v[60:63], v[64:67], v[236:239]
    s_waitcnt lgkmcnt(6)
    s_nop 0
    v_mfma_f32_16x16x32_bf16 v[240:243], v[48:51], v[68:71], v[240:243]
    ds_read_b128 v[84:87], v13 offset:6144
    v_mfma_f32_16x16x32_bf16 v[244:247], v[52:55], v[68:71], v[244:247]
    v_mfma_f32_16x16x32_bf16 v[248:251], v[56:59], v[68:71], v[248:251]
    v_mfma_f32_16x16x32_bf16 v[252:255], v[60:63], v[68:71], v[252:255]
    s_waitcnt lgkmcnt(3)
    s_nop 0
    v_mfma_f32_16x16x32_bf16 v[128:131], v[32:35], v[72:75], v[128:131]
    ds_read_b128 v[64:67], v13 offset:8192
    v_mfma_f32_16x16x32_bf16 v[132:135], v[36:39], v[72:75], v[132:135]
    v_mfma_f32_16x16x32_bf16 v[136:139], v[40:43], v[72:75], v[136:139]
    v_mfma_f32_16x16x32_bf16 v[140:143], v[44:47], v[72:75], v[140:143]
    s_waitcnt lgkmcnt(3)
    s_nop 0
    v_mfma_f32_16x16x32_bf16 v[144:147], v[32:35], v[76:79], v[144:147]
    ds_read_b128 v[68:71], v13 offset:10240
    v_mfma_f32_16x16x32_bf16 v[148:151], v[36:39], v[76:79], v[148:151]
    v_mfma_f32_16x16x32_bf16 v[152:155], v[40:43], v[76:79], v[152:155]
    s_waitcnt vmcnt(6)
    s_barrier
    v_mfma_f32_16x16x32_bf16 v[156:159], v[44:47], v[76:79], v[156:159]
    ds_read_b64_tr_b16 v[48:49], v16 offset:49152
    s_waitcnt lgkmcnt(4)
    s_nop 0
    v_mfma_f32_16x16x32_bf16 v[160:163], v[32:35], v[80:83], v[160:163]
    ds_read_b128 v[72:75], v13 offset:12288
    ds_read_b64_tr_b16 v[50:51], v16 offset:49664
    v_mfma_f32_16x16x32_bf16 v[164:167], v[36:39], v[80:83], v[164:167]
    ds_read_b64_tr_b16 v[52:53], v17 offset:49152
    s_add_u32 s43, s45, 6
    s_and_b32 s43, s43, 7
    s_lshl_b32 s43, s43, 19
    s_add_u32 s43, s43, 262144
    s_add_u32 m0, s41, 16384
    s_nop 0
    v_mfma_f32_16x16x32_bf16 v[168:171], v[40:43], v[80:83], v[168:171]
    ds_read_b64_tr_b16 v[54:55], v17 offset:49664
    v_mfma_f32_16x16x32_bf16 v[172:175], v[44:47], v[80:83], v[172:175]
    ds_read_b64_tr_b16 v[56:57], v18 offset:49152
    s_waitcnt lgkmcnt(8)
    s_nop 0
    v_mfma_f32_16x16x32_bf16 v[176:179], v[32:35], v[84:87], v[176:179]
    ds_read_b128 v[76:79], v13 offset:14336
    ds_read_b64_tr_b16 v[58:59], v18 offset:49664
    buffer_load_dwordx4 v8, s[16:19], s43 offen offset:0 lds
    v_mfma_f32_16x16x32_bf16 v[180:183], v[36:39], v[84:87], v[180:183]
    ds_read_b64_tr_b16 v[60:61], v19 offset:49152
    v_mfma_f32_16x16x32_bf16 v[184:187], v[40:43], v[84:87], v[184:187]
    ds_read_b64_tr_b16 v[62:63], v19 offset:49664
    v_mfma_f32_16x16x32_bf16 v[188:191], v[44:47], v[84:87], v[188:191]
    buffer_load_dwordx4 v9, s[16:19], s43 offen offset:1024 lds
    s_waitcnt lgkmcnt(11)
    s_nop 0
    v_mfma_f32_16x16x32_bf16 v[192:195], v[32:35], v[64:67], v[192:195]
    ds_read_b128 v[80:83], v15 offset:0
    v_mfma_f32_16x16x32_bf16 v[196:199], v[36:39], v[64:67], v[196:199]
    v_mfma_f32_16x16x32_bf16 v[200:203], v[40:43], v[64:67], v[200:203]
    s_add_u32 s42, s45, 7
    s_and_b32 s42, s42, 7
    s_lshl_b32 s42, s42, 7
    s_add_u32 m0, s40, 32768
    s_nop 0
    v_mfma_f32_16x16x32_bf16 v[204:207], v[44:47], v[64:67], v[204:207]
    s_waitcnt lgkmcnt(11)
    s_nop 0
    v_mfma_f32_16x16x32_bf16 v[208:211], v[32:35], v[68:71], v[208:211]
    ds_read_b128 v[84:87], v15 offset:2048
    v_mfma_f32_16x16x32_bf16 v[212:215], v[36:39], v[68:71], v[212:215]
    buffer_load_dwordx4 v4, s[12:15], s42 offen offset:0 lds
    v_mfma_f32_16x16x32_bf16 v[216:219], v[40:43], v[68:71], v[216:219]
    v_mfma_f32_16x16x32_bf16 v[220:223], v[44:47], v[68:71], v[220:223]
    s_waitcnt lgkmcnt(10)
    s_nop 0
    v_mfma_f32_16x16x32_bf16 v[224:227], v[32:35], v[72:75], v[224:227]
    ds_read_b128 v[64:67], v15 offset:4096
    buffer_load_dwordx4 v5, s[12:15], s42 offen offset:1024 lds
    v_mfma_f32_16x16x32_bf16 v[228:231], v[36:39], v[72:75], v[228:231]
    v_mfma_f32_16x16x32_bf16 v[232:235], v[40:43], v[72:75], v[232:235]
    v_mfma_f32_16x16x32_bf16 v[236:239], v[44:47], v[72:75], v[236:239]
    s_waitcnt lgkmcnt(6)
    s_nop 0
    v_mfma_f32_16x16x32_bf16 v[240:243], v[32:35], v[76:79], v[240:243]
    ds_read_b128 v[68:71], v15 offset:6144
    v_mfma_f32_16x16x32_bf16 v[244:247], v[36:39], v[76:79], v[244:247]
    v_mfma_f32_16x16x32_bf16 v[248:251], v[40:43], v[76:79], v[248:251]
    v_mfma_f32_16x16x32_bf16 v[252:255], v[44:47], v[76:79], v[252:255]
    s_waitcnt lgkmcnt(3)
    s_nop 0
    v_mfma_f32_16x16x32_bf16 v[128:131], v[48:51], v[80:83], v[128:131]
    ds_read_b128 v[72:75], v15 offset:8192
    v_mfma_f32_16x16x32_bf16 v[132:135], v[52:55], v[80:83], v[132:135]
    v_mfma_f32_16x16x32_bf16 v[136:139], v[56:59], v[80:83], v[136:139]
    v_mfma_f32_16x16x32_bf16 v[140:143], v[60:63], v[80:83], v[140:143]
    s_waitcnt lgkmcnt(3)
    s_nop 0
    v_mfma_f32_16x16x32_bf16 v[144:147], v[48:51], v[84:87], v[144:147]
    ds_read_b128 v[76:79], v15 offset:10240
    v_mfma_f32_16x16x32_bf16 v[148:151], v[52:55], v[84:87], v[148:151]
    v_mfma_f32_16x16x32_bf16 v[152:155], v[56:59], v[84:87], v[152:155]
    s_waitcnt vmcnt(4)
    s_barrier
    v_mfma_f32_16x16x32_bf16 v[156:159], v[60:63], v[84:87], v[156:159]
    ds_read_b64_tr_b16 v[32:33], v16 offset:0
    s_waitcnt lgkmcnt(4)
    s_nop 0
    v_mfma_f32_16x16x32_bf16 v[160:163], v[48:51], v[64:67], v[160:163]
    ds_read_b128 v[80:83], v15 offset:12288
    ds_read_b64_tr_b16 v[34:35], v16 offset:512
    v_mfma_f32_16x16x32_bf16 v[164:167], v[52:55], v[64:67], v[164:167]
    ds_read_b64_tr_b16 v[36:37], v17 offset:0
    s_add_u32 s43, s45, 7
    s_and_b32 s43, s43, 7
    s_lshl_b32 s43, s43, 19
    s_add_u32 m0, s41, 32768
    s_nop 0
    v_mfma_f32_16x16x32_bf16 v[168:171], v[56:59], v[64:67], v[168:171]
    ds_read_b64_tr_b16 v[38:39], v17 offset:512
    v_mfma_f32_16x16x32_bf16 v[172:175], v[60:63], v[64:67], v[172:175]
    ds_read_b64_tr_b16 v[40:41], v18 offset:0
    s_waitcnt lgkmcnt(8)
    s_nop 0
    v_mfma_f32_16x16x32_bf16 v[176:179], v[48:51], v[68:71], v[176:179]
    ds_read_b128 v[84:87], v15 offset:14336
    ds_read_b64_tr_b16 v[42:43], v18 offset:512
    buffer_load_dwordx4 v8, s[16:19], s43 offen offset:0 lds
    v_mfma_f32_16x16x32_bf16 v[180:183], v[52:55], v[68:71], v[180:183]
    ds_read_b64_tr_b16 v[44:45], v19 offset:0
    v_mfma_f32_16x16x32_bf16 v[184:187], v[56:59], v[68:71], v[184:187]
    ds_read_b64_tr_b16 v[46:47], v19 offset:512
    v_mfma_f32_16x16x32_bf16 v[188:191], v[60:63], v[68:71], v[188:191]
    buffer_load_dwordx4 v9, s[16:19], s43 offen offset:1024 lds
    s_waitcnt lgkmcnt(11)
    s_nop 0
    v_mfma_f32_16x16x32_bf16 v[192:195], v[48:51], v[72:75], v[192:195]
    ds_read_b128 v[64:67], v12 offset:0
    v_mfma_f32_16x16x32_bf16 v[196:199], v[52:55], v[72:75], v[196:199]
    v_mfma_f32_16x16x32_bf16 v[200:203], v[56:59], v[72:75], v[200:203]
    s_add_u32 s42, s45, 7
    s_and_b32 s42, s42, 7
    s_lshl_b32 s42, s42, 7
    s_add_u32 m0, s40, 32768
    s_nop 0
    v_mfma_f32_16x16x32_bf16 v[204:207], v[60:63], v[72:75], v[204:207]
    s_waitcnt lgkmcnt(11)
    s_nop 0
    v_mfma_f32_16x16x32_bf16 v[208:211], v[48:51], v[76:79], v[208:211]
    ds_read_b128 v[68:71], v12 offset:2048
    v_mfma_f32_16x16x32_bf16 v[212:215], v[52:55], v[76:79], v[212:215]
    buffer_load_dwordx4 v6, s[12:15], s42 offen offset:2048 lds
    v_mfma_f32_16x16x32_bf16 v[216:219], v[56:59], v[76:79], v[216:219]
    v_mfma_f32_16x16x32_bf16 v[220:223], v[60:63], v[76:79], v[220:223]
    s_waitcnt lgkmcnt(10)
    s_nop 0
    v_mfma_f32_16x16x32_bf16 v[224:227], v[48:51], v[80:83], v[224:227]
    ds_read_b128 v[72:75], v12 offset:4096
    buffer_load_dwordx4 v7, s[12:15], s42 offen offset:3072 lds
    v_mfma_f32_16x16x32_bf16 v[228:231], v[52:55], v[80:83], v[228:231]
    v_mfma_f32_16x16x32_bf16 v[232:235], v[56:59], v[80:83], v[232:235]
    s_mov_b32 s4, 0x10000
    v_lshlrev_b32 v92, 2, v2
    s_cmp_lg_u32 s20, 0
    s_cbranch_scc1 main_kernel_pollud_12
main_kernel_pollu_11:
    buffer_load_dword v93, v92, s[60:63], 0 offen sc1
    s_waitcnt vmcnt(0)
    v_and_b32 v93, 0x01010101, v93
    v_cmp_ne_u32 vcc, 0x01010101, v93
    s_nop 0
    s_cbranch_vccz main_kernel_pollud_12
    s_sleep 12
    s_sub_u32 s4, s4, 1
    s_cmp_lg_u32 s4, 0
    s_cbranch_scc1 main_kernel_pollu_11
main_kernel_pollud_12:
    v_mfma_f32_16x16x32_bf16 v[236:239], v[60:63], v[80:83], v[236:239]
    s_waitcnt lgkmcnt(6)
    s_nop 0
    v_mfma_f32_16x16x32_bf16 v[240:243], v[48:51], v[84:87], v[240:243]
    ds_read_b128 v[76:79], v12 offset:6144
    v_mfma_f32_16x16x32_bf16 v[244:247], v[52:55], v[84:87], v[244:247]
    v_mfma_f32_16x16x32_bf16 v[248:251], v[56:59], v[84:87], v[248:251]
    v_mfma_f32_16x16x32_bf16 v[252:255], v[60:63], v[84:87], v[252:255]
    s_waitcnt lgkmcnt(3)
    s_nop 0
    v_mfma_f32_16x16x32_bf16 v[128:131], v[32:35], v[64:67], v[128:131]
    ds_read_b128 v[80:83], v12 offset:8192
    v_mfma_f32_16x16x32_bf16 v[132:135], v[36:39], v[64:67], v[132:135]
    v_mfma_f32_16x16x32_bf16 v[136:139], v[40:43], v[64:67], v[136:139]
    v_mfma_f32_16x16x32_bf16 v[140:143], v[44:47], v[64:67], v[140:143]
    s_waitcnt lgkmcnt(3)
    s_nop 0
    v_mfma_f32_16x16x32_bf16 v[144:147], v[32:35], v[68:71], v[144:147]
    ds_read_b128 v[84:87], v12 offset:10240
    v_mfma_f32_16x16x32_bf16 v[148:151], v[36:39], v[68:71], v[148:151]
    v_mfma_f32_16x16x32_bf16 v[152:155], v[40:43], v[68:71], v[152:155]
    s_waitcnt vmcnt(6)
    s_barrier
    v_mfma_f32_16x16x32_bf16 v[156:159], v[44:47], v[68:71], v[156:159]
    ds_read_b64_tr_b16 v[48:49], v16 offset:16384
    s_waitcnt lgkmcnt(4)
    s_nop 0
    v_mfma_f32_16x16x32_bf16 v[160:163], v[32:35], v[72:75], v[160:163]
    ds_read_b128 v[64:67], v12 offset:12288
    ds_read_b64_tr_b16 v[50:51], v16 offset:16896
    v_mfma_f32_16x16x32_bf16 v[164:167], v[36:39], v[72:75], v[164:167]
    ds_read_b64_tr_b16 v[52:53], v17 offset:16384
    s_add_u32 s43, s45, 7
    s_and_b32 s43, s43, 7
    s_lshl_b32 s43, s43, 19
    s_add_u32 s43, s43, 262144
    s_add_u32 m0, s41, 49152
    s_nop 0
    v_mfma_f32_16x16x32_bf16 v[168:171], v[40:43], v[72:75], v[168:171]
    ds_read_b64_tr_b16 v[54:55], v17 offset:16896
    v_mfma_f32_16x16x32_bf16 v[172:175], v[44:47], v[72:75], v[172:175]
    ds_read_b64_tr_b16 v[56:57], v18 offset:16384
    s_waitcnt lgkmcnt(8)
    s_nop 0
    v_mfma_f32_16x16x32_bf16 v[176:179], v[32:35], v[76:79], v[176:179]
    ds_read_b128 v[68:71], v12 offset:14336
    ds_read_b64_tr_b16 v[58:59], v18 offset:16896
    buffer_load_dwordx4 v8, s[16:19], s43 offen offset:0 lds
    v_mfma_f32_16x16x32_bf16 v[180:183], v[36:39], v[76:79], v[180:183]
    ds_read_b64_tr_b16 v[60:61], v19 offset:16384
    v_mfma_f32_16x16x32_bf16 v[184:187], v[40:43], v[76:79], v[184:187]
    ds_read_b64_tr_b16 v[62:63], v19 offset:16896
    v_mfma_f32_16x16x32_bf16 v[188:191], v[44:47], v[76:79], v[188:191]
    buffer_load_dwordx4 v9, s[16:19], s43 offen offset:1024 lds
    s_waitcnt lgkmcnt(11)
    s_nop 0
    v_mfma_f32_16x16x32_bf16 v[192:195], v[32:35], v[80:83], v[192:195]
    ds_read_b128 v[72:75], v14 offset:0
    v_mfma_f32_16x16x32_bf16 v[196:199], v[36:39], v[80:83], v[196:199]
    v_mfma_f32_16x16x32_bf16 v[200:203], v[40:43], v[80:83], v[200:203]
    s_add_u32 s42, s45, 0
    s_and_b32 s42, s42, 7
    s_lshl_b32 s42, s42, 7
    s_add_u32 m0, s40, 65536
    s_nop 0
    v_mfma_f32_16x16x32_bf16 v[204:207], v[44:47], v[80:83], v[204:207]
    s_waitcnt lgkmcnt(11)
    s_nop 0
    v_mfma_f32_16x16x32_bf16 v[208:211], v[32:35], v[84:87], v[208:211]
    ds_read_b128 v[76:79], v14 offset:2048
    v_mfma_f32_16x16x32_bf16 v[212:215], v[36:39], v[84:87], v[212:215]
    buffer_load_dwordx4 v4, s[68:71], s42 offen offset:0 lds
    v_mfma_f32_16x16x32_bf16 v[216:219], v[40:43], v[84:87], v[216:219]
    v_mfma_f32_16x16x32_bf16 v[220:223], v[44:47], v[84:87], v[220:223]
    s_waitcnt lgkmcnt(10)
    s_nop 0
    v_mfma_f32_16x16x32_bf16 v[224:227], v[32:35], v[64:67], v[224:227]
    ds_read_b128 v[80:83], v14 offset:4096
    buffer_load_dwordx4 v5, s[68:71], s42 offen offset:1024 lds
    v_mfma_f32_16x16x32_bf16 v[228:231], v[36:39], v[64:67], v[228:231]
    v_mfma_f32_16x16x32_bf16 v[232:235], v[40:43], v[64:67], v[232:235]
    s_lshl_b32 s3, s54, 12
    s_add_u32 s3, s3, 67108864
    v_lshlrev_b32 v92, 4, v0
    v_mfma_f32_16x16x32_bf16 v[236:239], v[44:47], v[64:67], v[236:239]
    buffer_load_dwordx4 v[88:91], v92, s[8:11], s3 offen
    s_waitcnt lgkmcnt(6)
    s_nop 0
    v_mfma_f32_16x16x32_bf16 v[240:243], v[32:35], v[68:71], v[240:243]
    ds_read_b128 v[84:87], v14 offset:6144
    v_mfma_f32_16x16x32_bf16 v[244:247], v[36:39], v[68:71], v[244:247]
    v_mfma_f32_16x16x32_bf16 v[248:251], v[40:43], v[68:71], v[248:251]
    v_mfma_f32_16x16x32_bf16 v[252:255], v[44:47], v[68:71], v[252:255]
    s_waitcnt lgkmcnt(3)
    s_nop 0
    v_mfma_f32_16x16x32_bf16 v[128:131], v[48:51], v[72:75], v[128:131]
    ds_read_b128 v[64:67], v14 offset:8192
    v_mfma_f32_16x16x32_bf16 v[132:135], v[52:55], v[72:75], v[132:135]
    v_mfma_f32_16x16x32_bf16 v[136:139], v[56:59], v[72:75], v[136:139]
    v_mfma_f32_16x16x32_bf16 v[140:143], v[60:63], v[72:75], v[140:143]
    s_waitcnt lgkmcnt(3)
    s_nop 0
    v_mfma_f32_16x16x32_bf16 v[144:147], v[48:51], v[76:79], v[144:147]
    ds_read_b128 v[68:71], v14 offset:10240
    v_mfma_f32_16x16x32_bf16 v[148:151], v[52:55], v[76:79], v[148:151]
    v_mfma_f32_16x16x32_bf16 v[152:155], v[56:59], v[76:79], v[152:155]
    s_waitcnt vmcnt(5)
    s_barrier
    v_mfma_f32_16x16x32_bf16 v[156:159], v[60:63], v[76:79], v[156:159]
    ds_read_b64_tr_b16 v[32:33], v16 offset:32768
    s_waitcnt lgkmcnt(4)
    s_nop 0
    v_mfma_f32_16x16x32_bf16 v[160:163], v[48:51], v[80:83], v[160:163]
    ds_read_b128 v[72:75], v14 offset:12288
    ds_read_b64_tr_b16 v[34:35], v16 offset:33280
    v_mfma_f32_16x16x32_bf16 v[164:167], v[52:55], v[80:83], v[164:167]
    ds_read_b64_tr_b16 v[36:37], v17 offset:32768
    s_add_u32 s43, s45, 0
    s_and_b32 s43, s43, 7
    s_lshl_b32 s43, s43, 19
    s_add_u32 m0, s41, 0
    v_mfma_f32_16x16x32_bf16 v[168:171], v[56:59], v[80:83], v[168:171]
    ds_read_b64_tr_b16 v[38:39], v17 offset:33280
    v_mfma_f32_16x16x32_bf16 v[172:175], v[60:63], v[80:83], v[172:175]
    ds_read_b64_tr_b16 v[40:41], v18 offset:32768
    s_waitcnt lgkmcnt(8)
    s_nop 0
    v_mfma_f32_16x16x32_bf16 v[176:179], v[48:51], v[84:87], v[176:179]
    ds_read_b128 v[76:79], v14 offset:14336
    ds_read_b64_tr_b16 v[42:43], v18 offset:33280
    buffer_load_dwordx4 v10, s[72:75], s43 offen offset:0 lds
    v_mfma_f32_16x16x32_bf16 v[180:183], v[52:55], v[84:87], v[180:183]
    ds_read_b64_tr_b16 v[44:45], v19 offset:32768
    v_mfma_f32_16x16x32_bf16 v[184:187], v[56:59], v[84:87], v[184:187]
    ds_read_b64_tr_b16 v[46:47], v19 offset:33280
    v_mfma_f32_16x16x32_bf16 v[188:191], v[60:63], v[84:87], v[188:191]
    buffer_load_dwordx4 v11, s[72:75], s43 offen offset:1024 lds
    s_waitcnt lgkmcnt(11)
    s_nop 0
    v_mfma_f32_16x16x32_bf16 v[192:195], v[48:51], v[64:67], v[192:195]
    ds_read_b128 v[80:83], v12 offset:32768
    v_mfma_f32_16x16x32_bf16 v[196:199], v[52:55], v[64:67], v[196:199]
    v_mfma_f32_16x16x32_bf16 v[200:203], v[56:59], v[64:67], v[200:203]
    s_add_u32 s42, s45, 0
    s_and_b32 s42, s42, 7
    s_lshl_b32 s42, s42, 7
    s_add_u32 m0, s40, 65536
    s_nop 0
    v_mfma_f32_16x16x32_bf16 v[204:207], v[60:63], v[64:67], v[204:207]
    s_waitcnt lgkmcnt(11)
    s_nop 0
    v_mfma_f32_16x16x32_bf16 v[208:211], v[48:51], v[68:71], v[208:211]
    ds_read_b128 v[84:87], v12 offset:34816
    v_mfma_f32_16x16x32_bf16 v[212:215], v[52:55], v[68:71], v[212:215]
    buffer_load_dwordx4 v6, s[68:71], s42 offen offset:2048 lds
    v_mfma_f32_16x16x32_bf16 v[216:219], v[56:59], v[68:71], v[216:219]
    v_mfma_f32_16x16x32_bf16 v[220:223], v[60:63], v[68:71], v[220:223]
    s_waitcnt lgkmcnt(10)
    s_nop 0
    v_mfma_f32_16x16x32_bf16 v[224:227], v[48:51], v[72:75], v[224:227]
    ds_read_b128 v[64:67], v12 offset:36864
    buffer_load_dwordx4 v7, s[68:71], s42 offen offset:3072 lds
    v_mfma_f32_16x16x32_bf16 v[228:231], v[52:55], v[72:75], v[228:231]
    v_mfma_f32_16x16x32_bf16 v[232:235], v[56:59], v[72:75], v[232:235]
    v_mfma_f32_16x16x32_bf16 v[236:239], v[60:63], v[72:75], v[236:239]
    s_waitcnt lgkmcnt(6)
    s_nop 0
    v_mfma_f32_16x16x32_bf16 v[240:243], v[48:51], v[76:79], v[240:243]
    ds_read_b128 v[68:71], v12 offset:38912
    v_mfma_f32_16x16x32_bf16 v[244:247], v[52:55], v[76:79], v[244:247]
    v_mfma_f32_16x16x32_bf16 v[248:251], v[56:59], v[76:79], v[248:251]
    v_mfma_f32_16x16x32_bf16 v[252:255], v[60:63], v[76:79], v[252:255]
    s_waitcnt lgkmcnt(3)
    s_nop 0
    v_mfma_f32_16x16x32_bf16 v[128:131], v[32:35], v[80:83], v[128:131]
    ds_read_b128 v[72:75], v12 offset:40960
    v_mfma_f32_16x16x32_bf16 v[132:135], v[36:39], v[80:83], v[132:135]
    v_mfma_f32_16x16x32_bf16 v[136:139], v[40:43], v[80:83], v[136:139]
    v_mfma_f32_16x16x32_bf16 v[140:143], v[44:47], v[80:83], v[140:143]
    s_waitcnt lgkmcnt(3)
    s_nop 0
    v_mfma_f32_16x16x32_bf16 v[144:147], v[32:35], v[84:87], v[144:147]
    ds_read_b128 v[76:79], v12 offset:43008
    v_mfma_f32_16x16x32_bf16 v[148:151], v[36:39], v[84:87], v[148:151]
    v_mfma_f32_16x16x32_bf16 v[152:155], v[40:43], v[84:87], v[152:155]
    s_waitcnt vmcnt(7)
    s_barrier
    v_mfma_f32_16x16x32_bf16 v[156:159], v[44:47], v[84:87], v[156:159]
    ds_read_b64_tr_b16 v[48:49], v16 offset:49152
    s_waitcnt lgkmcnt(4)
    s_nop 0
    v_mfma_f32_16x16x32_bf16 v[160:163], v[32:35], v[64:67], v[160:163]
    ds_read_b128 v[80:83], v12 offset:45056
    ds_read_b64_tr_b16 v[50:51], v16 offset:49664
    v_mfma_f32_16x16x32_bf16 v[164:167], v[36:39], v[64:67], v[164:167]
    ds_read_b64_tr_b16 v[52:53], v17 offset:49152
    s_add_u32 s43, s45, 1
    s_and_b32 s43, s43, 7
    s_lshl_b32 s43, s43, 19
    s_add_u32 m0, s41, 16384
    s_nop 0
    v_mfma_f32_16x16x32_bf16 v[168:171], v[40:43], v[64:67], v[168:171]
    ds_read_b64_tr_b16 v[54:55], v17 offset:49664
    v_mfma_f32_16x16x32_bf16 v[172:175], v[44:47], v[64:67], v[172:175]
    ds_read_b64_tr_b16 v[56:57], v18 offset:49152
    s_waitcnt lgkmcnt(8)
    s_nop 0
    v_mfma_f32_16x16x32_bf16 v[176:179], v[32:35], v[68:71], v[176:179]
    ds_read_b128 v[84:87], v12 offset:47104
    ds_read_b64_tr_b16 v[58:59], v18 offset:49664
    buffer_load_dwordx4 v10, s[72:75], s43 offen offset:0 lds
    v_mfma_f32_16x16x32_bf16 v[180:183], v[36:39], v[68:71], v[180:183]
    ds_read_b64_tr_b16 v[60:61], v19 offset:49152
    v_mfma_f32_16x16x32_bf16 v[184:187], v[40:43], v[68:71], v[184:187]
    ds_read_b64_tr_b16 v[62:63], v19 offset:49664
    v_mfma_f32_16x16x32_bf16 v[188:191], v[44:47], v[68:71], v[188:191]
    buffer_load_dwordx4 v11, s[72:75], s43 offen offset:1024 lds
    s_waitcnt lgkmcnt(11)
    s_nop 0
    v_mfma_f32_16x16x32_bf16 v[192:195], v[32:35], v[72:75], v[192:195]
    ds_read_b128 v[64:67], v14 offset:32768
    v_mfma_f32_16x16x32_bf16 v[196:199], v[36:39], v[72:75], v[196:199]
    v_mfma_f32_16x16x32_bf16 v[200:203], v[40:43], v[72:75], v[200:203]
    v_and_b32 v101, 255, v0
    v_lshlrev_b32 v92, 4, v101
    v_lshrrev_b32 v93, 8, v0
    v_mul_u32_u24 v102, 8704, v93
    v_add_u32 v92, v92, v102
    v_add_u32 v92, 0, v92
    v_mfma_f32_16x16x32_bf16 v[204:207], v[44:47], v[72:75], v[204:207]
    s_waitcnt lgkmcnt(11)
    s_nop 0
    v_mfma_f32_16x16x32_bf16 v[208:211], v[32:35], v[76:79], v[208:211]
    ds_read_b128 v[68:71], v14 offset:34816
    v_mfma_f32_16x16x32_bf16 v[212:215], v[36:39], v[76:79], v[212:215]
    s_waitcnt vmcnt(6)
    s_nop 0
    ds_write_b128 v92, v[88:91] offset:32
    v_alignbit_b32 v104, v89, v88, 16
    v_alignbit_b32 v105, v90, v89, 16
    v_alignbit_b32 v106, v91, v90, 16
    ds_write_b16 v92, v88 offset:4382
    ds_write_b64 v92, v[104:105] offset:4384
    ds_write_b32 v92, v106 offset:4392
    ds_write_b16_d16_hi v92, v91 offset:4396
    v_mfma_f32_16x16x32_bf16 v[216:219], v[40:43], v[76:79], v[216:219]
    v_mfma_f32_16x16x32_bf16 v[220:223], v[44:47], v[76:79], v[220:223]
    s_waitcnt lgkmcnt(15)
    s_nop 0
    v_mfma_f32_16x16x32_bf16 v[224:227], v[32:35], v[80:83], v[224:227]
    ds_read_b128 v[72:75], v14 offset:36864
    v_mov_b32 v24, v88
    v_mov_b32 v25, v89
    v_mov_b32 v26, v90
    v_mov_b32 v27, v91
    v_mfma_f32_16x16x32_bf16 v[228:231], v[36:39], v[80:83], v[228:231]
    v_mfma_f32_16x16x32_bf16 v[232:235], v[40:43], v[80:83], v[232:235]
    v_mfma_f32_16x16x32_bf16 v[236:239], v[44:47], v[80:83], v[236:239]
    v_mul_u32_u24 v93, 3072, v93
    v_lshl_add_u32 v93, v101, 2, v93
    ds_write_b32 v93, v28 offset:22016
    ds_write_b32 v93, v29 offset:23040
    ds_write_b32 v93, v30 offset:24064
    s_waitcnt lgkmcnt(14)
    s_nop 0
    v_mfma_f32_16x16x32_bf16 v[240:243], v[32:35], v[84:87], v[240:243]
    ds_read_b128 v[76:79], v14 offset:38912
    v_mfma_f32_16x16x32_bf16 v[244:247], v[36:39], v[84:87], v[244:247]
    v_mfma_f32_16x16x32_bf16 v[248:251], v[40:43], v[84:87], v[248:251]
    v_mfma_f32_16x16x32_bf16 v[252:255], v[44:47], v[84:87], v[252:255]
    s_waitcnt lgkmcnt(11)
    s_nop 0
    v_mfma_f32_16x16x32_bf16 v[128:131], v[48:51], v[64:67], v[128:131]
    ds_read_b128 v[80:83], v14 offset:40960
    v_mfma_f32_16x16x32_bf16 v[132:135], v[52:55], v[64:67], v[132:135]
    v_mfma_f32_16x16x32_bf16 v[136:139], v[56:59], v[64:67], v[136:139]
    v_mfma_f32_16x16x32_bf16 v[140:143], v[60:63], v[64:67], v[140:143]
    s_waitcnt lgkmcnt(11)
    s_nop 0
    v_mfma_f32_16x16x32_bf16 v[144:147], v[48:51], v[68:71], v[144:147]
    ds_read_b128 v[84:87], v14 offset:43008
    v_mfma_f32_16x16x32_bf16 v[148:151], v[52:55], v[68:71], v[148:151]
    v_mfma_f32_16x16x32_bf16 v[152:155], v[56:59], v[68:71], v[152:155]
    s_waitcnt vmcnt(2)
    s_barrier
    v_mfma_f32_16x16x32_bf16 v[156:159], v[60:63], v[68:71], v[156:159]
    s_waitcnt lgkmcnt(6)
    s_nop 0
    v_mfma_f32_16x16x32_bf16 v[160:163], v[48:51], v[72:75], v[160:163]
    ds_read_b128 v[64:67], v14 offset:45056
    v_cvt_pk_bf16_f32 v88, v128, v129
    v_cvt_pk_bf16_f32 v89, v130, v131
    v_mfma_f32_16x16x32_bf16 v[164:167], v[52:55], v[72:75], v[164:167]
    s_add_u32 s43, s45, 2
    s_and_b32 s43, s43, 7
    s_lshl_b32 s43, s43, 19
    s_add_u32 m0, s41, 32768
    v_cvt_pk_bf16_f32 v90, v132, v133
    v_cvt_pk_bf16_f32 v91, v134, v135
    s_nop 0
    v_mfma_f32_16x16x32_bf16 v[168:171], v[56:59], v[72:75], v[168:171]
    v_cvt_pk_bf16_f32 v92, v136, v137
    v_cvt_pk_bf16_f32 v93, v138, v139
    v_mfma_f32_16x16x32_bf16 v[172:175], v[60:63], v[72:75], v[172:175]
    v_cvt_pk_bf16_f32 v94, v140, v141
    v_cvt_pk_bf16_f32 v95, v142, v143
    s_waitcnt lgkmcnt(3)
    s_nop 0
    v_mfma_f32_16x16x32_bf16 v[176:179], v[48:51], v[76:79], v[176:179]
    ds_read_b128 v[68:71], v14 offset:47104
    buffer_load_dwordx4 v10, s[72:75], s43 offen offset:0 lds
    v_cvt_pk_bf16_f32 v96, v144, v145
    v_cvt_pk_bf16_f32 v97, v146, v147
    v_mfma_f32_16x16x32_bf16 v[180:183], v[52:55], v[76:79], v[180:183]
    v_cvt_pk_bf16_f32 v98, v148, v149
    v_cvt_pk_bf16_f32 v99, v150, v151
    v_mfma_f32_16x16x32_bf16 v[184:187], v[56:59], v[76:79], v[184:187]
    v_cvt_pk_bf16_f32 v100, v152, v153
    v_cvt_pk_bf16_f32 v101, v154, v155
    v_mfma_f32_16x16x32_bf16 v[188:191], v[60:63], v[76:79], v[188:191]
    buffer_load_dwordx4 v11, s[72:75], s43 offen offset:1024 lds
    v_cvt_pk_bf16_f32 v102, v156, v157
    v_cvt_pk_bf16_f32 v103, v158, v159
    s_waitcnt lgkmcnt(3)
    s_nop 0
    v_mfma_f32_16x16x32_bf16 v[192:195], v[48:51], v[80:83], v[192:195]
    v_cvt_pk_bf16_f32 v104, v160, v161
    v_cvt_pk_bf16_f32 v105, v162, v163
    v_mfma_f32_16x16x32_bf16 v[196:199], v[52:55], v[80:83], v[196:199]
    v_cvt_pk_bf16_f32 v106, v164, v165
    v_cvt_pk_bf16_f32 v107, v166, v167
    v_mfma_f32_16x16x32_bf16 v[200:203], v[56:59], v[80:83], v[200:203]
    v_cvt_pk_bf16_f32 v108, v168, v169
    v_cvt_pk_bf16_f32 v109, v170, v171
    v_mfma_f32_16x16x32_bf16 v[204:207], v[60:63], v[80:83], v[204:207]
    v_cvt_pk_bf16_f32 v110, v172, v173
    v_cvt_pk_bf16_f32 v111, v174, v175
    s_waitcnt lgkmcnt(2)
    s_nop 0
    v_mfma_f32_16x16x32_bf16 v[208:211], v[48:51], v[84:87], v[208:211]
    s_waitcnt lgkmcnt(0)
    s_barrier
    v_cvt_pk_bf16_f32 v112, v176, v177
    v_cvt_pk_bf16_f32 v113, v178, v179
    v_mfma_f32_16x16x32_bf16 v[212:215], v[52:55], v[84:87], v[212:215]
    s_add_u32 s42, s45, 1
    s_and_b32 s42, s42, 7
    s_lshl_b32 s42, s42, 7
    s_add_u32 m0, s40, 32768
    v_cvt_pk_bf16_f32 v114, v180, v181
    v_cvt_pk_bf16_f32 v115, v182, v183
    s_nop 0
    v_mfma_f32_16x16x32_bf16 v[216:219], v[56:59], v[84:87], v[216:219]
    buffer_load_dwordx4 v4, s[68:71], s42 offen offset:0 lds
    v_cvt_pk_bf16_f32 v116, v184, v185
    v_cvt_pk_bf16_f32 v117, v186, v187
    v_mfma_f32_16x16x32_bf16 v[220:223], v[60:63], v[84:87], v[220:223]
    buffer_load_dwordx4 v5, s[68:71], s42 offen offset:1024 lds
    v_cvt_pk_bf16_f32 v118, v188, v189
    v_cvt_pk_bf16_f32 v119, v190, v191
    v_mfma_f32_16x16x32_bf16 v[224:227], v[48:51], v[64:67], v[224:227]
    buffer_load_dwordx4 v6, s[68:71], s42 offen offset:2048 lds
    v_cvt_pk_bf16_f32 v120, v192, v193
    v_cvt_pk_bf16_f32 v121, v194, v195
    v_mfma_f32_16x16x32_bf16 v[228:231], v[52:55], v[64:67], v[228:231]
    buffer_load_dwordx4 v7, s[68:71], s42 offen offset:3072 lds
    v_cvt_pk_bf16_f32 v122, v196, v197
    v_cvt_pk_bf16_f32 v123, v198, v199
    v_mfma_f32_16x16x32_bf16 v[232:235], v[56:59], v[64:67], v[232:235]
    v_cvt_pk_bf16_f32 v124, v200, v201
    v_cvt_pk_bf16_f32 v125, v202, v203
    s_movk_i32 s53, 0
    buffer_store_dwordx4 v[88:91], v20, s[8:11], s53 offen offset:0 sc1
    s_nop 0
    v_mfma_f32_16x16x32_bf16 v[236:239], v[60:63], v[64:67], v[236:239]
    v_cvt_pk_bf16_f32 v126, v204, v205
    v_cvt_pk_bf16_f32 v127, v206, v207
    v_mfma_f32_16x16x32_bf16 v[240:243], v[48:51], v[68:71], v[240:243]
    s_movk_i32 s53, 0
    buffer_store_dwordx4 v[92:95], v20, s[8:11], s53 offen offset:1024 sc1
    s_nop 0
    v_mfma_f32_16x16x32_bf16 v[244:247], v[52:55], v[68:71], v[244:247]
    v_mfma_f32_16x16x32_bf16 v[248:251], v[56:59], v[68:71], v[248:251]
    s_movk_i32 s53, 0
    buffer_store_dwordx4 v[96:99], v31, s[8:11], s53 offen offset:0 sc1
    s_nop 0
    v_mfma_f32_16x16x32_bf16 v[252:255], v[60:63], v[68:71], v[252:255]
    v_cvt_pk_bf16_f32 v64, v208, v209
    v_cvt_pk_bf16_f32 v65, v210, v211
    v_cvt_pk_bf16_f32 v66, v212, v213
    v_cvt_pk_bf16_f32 v67, v214, v215
    v_cvt_pk_bf16_f32 v68, v216, v217
    v_cvt_pk_bf16_f32 v69, v218, v219
    v_cvt_pk_bf16_f32 v70, v220, v221
    v_cvt_pk_bf16_f32 v71, v222, v223
    v_cvt_pk_bf16_f32 v72, v224, v225
    v_cvt_pk_bf16_f32 v73, v226, v227
    v_cvt_pk_bf16_f32 v74, v228, v229
    v_cvt_pk_bf16_f32 v75, v230, v231
    v_cvt_pk_bf16_f32 v76, v232, v233
    v_cvt_pk_bf16_f32 v77, v234, v235
    v_cvt_pk_bf16_f32 v78, v236, v237
    v_cvt_pk_bf16_f32 v79, v238, v239
    v_cvt_pk_bf16_f32 v80, v240, v241
    v_cvt_pk_bf16_f32 v81, v242, v243
    v_cvt_pk_bf16_f32 v82, v244, v245
    v_cvt_pk_bf16_f32 v83, v246, v247
    v_cvt_pk_bf16_f32 v84, v248, v249
    v_cvt_pk_bf16_f32 v85, v250, v251
    v_cvt_pk_bf16_f32 v86, v252, v253
    v_cvt_pk_bf16_f32 v87, v254, v255
    s_branch main_kernel_qphase_9
main_kernel_vtype_8:
    s_waitcnt vmcnt(17)
    s_barrier
    v_and_b32 v120, 15, v2
    v_lshrrev_b32 v121, 4, v2
    v_lshrrev_b32 v122, 2, v120
    v_lshl_add_u32 v122, v121, 3, v122
    v_lshlrev_b32 v122, 7, v122
    v_and_b32 v124, 3, v120
    v_lshl_add_u32 v122, v124, 3, v122
    s_and_b32 s3, s20, 3
    s_lshl_b32 s4, s3, 5
    s_lshr_b32 s5, s20, 2
    s_lshl_b32 s6, s5, 12
    s_add_u32 s4, s4, s6
    s_add_u32 s4, s4, 147456
    v_add_u32 v122, s4, v122
    ds_read_b64_tr_b16 v[124:125], v122
    ds_read_b64_tr_b16 v[126:127], v122 offset:512
    v_lshlrev_b32 v120, 12, v120
    v_lshl_add_u32 v120, v121, 4, v120
    s_and_b32 s4, s2, 7
    s_lshl_b32 s4, s4, 2
    s_add_u32 s4, s4, s3
    s_lshl_b32 s4, s4, 16
    s_lshr_b32 s6, s2, 3
    s_lshl_b32 s6, s6, 7
    s_add_u32 s4, s4, s6
    s_lshl_b32 s5, s5, 6
    s_add_u32 s4, s4, s5
    s_add_u32 s4, s4, 67108864
    s_waitcnt lgkmcnt(0)
    buffer_store_dwordx4 v[124:127], v120, s[8:11], s4 offen sc1
    s_lshr_b32 s3, s20, 2
    s_mul_i32 s3, s3, 12288
    s_add_u32 s3, s3, 69632
    v_and_b32 v101, 255, v0
    v_lshl_add_u32 v101, v101, 2, s3
    ds_read_b32 v104, v101 offset:0
    ds_read_b32 v105, v101 offset:3072
    ds_read_b32 v106, v101 offset:6144
    ds_read_b32 v107, v101 offset:9216
    ds_read_b32 v108, v101 offset:1024
    ds_read_b32 v109, v101 offset:4096
    ds_read_b32 v110, v101 offset:7168
    ds_read_b32 v111, v101 offset:10240
    ds_read_b32 v112, v101 offset:2048
    ds_read_b32 v113, v101 offset:5120
    ds_read_b32 v114, v101 offset:8192
    ds_read_b32 v115, v101 offset:11264
    s_waitcnt lgkmcnt(10)
    v_add_f32 v104, v104, v105
    s_waitcnt lgkmcnt(8)
    v_add_f32 v106, v106, v107
    v_add_f32 v28, v104, v106
    s_waitcnt lgkmcnt(6)
    v_add_f32 v108, v108, v109
    s_waitcnt lgkmcnt(4)
    v_add_f32 v110, v110, v111
    v_add_f32 v29, v108, v110
    s_waitcnt lgkmcnt(2)
    v_add_f32 v112, v112, v113
    s_waitcnt lgkmcnt(0)
    v_add_f32 v114, v114, v115
    v_add_f32_e64 v30, v112, v114
    ds_read_b64_tr_b16 v[32:33], v16 offset:0
    ds_read_b64_tr_b16 v[34:35], v16 offset:512
    ds_read_b64_tr_b16 v[36:37], v17 offset:0
    ds_read_b64_tr_b16 v[38:39], v17 offset:512
    ds_read_b64_tr_b16 v[40:41], v18 offset:0
    ds_read_b64_tr_b16 v[42:43], v18 offset:512
    ds_read_b64_tr_b16 v[44:45], v19 offset:0
    ds_read_b64_tr_b16 v[46:47], v19 offset:512
    ds_read_b128 v[64:67], v12 offset:0
    ds_read_b128 v[68:71], v12 offset:2048
    ds_read_b128 v[72:75], v12 offset:4096
    ds_read_b128 v[76:79], v12 offset:6144
    s_waitcnt lgkmcnt(3)
    s_nop 0
    v_mfma_f32_16x16x32_bf16 v[128:131], v[64:67], v[32:35], 0
    ds_read_b128 v[80:83], v12 offset:8192
    v_mfma_f32_16x16x32_bf16 v[132:135], v[64:67], v[36:39], 0
    v_mfma_f32_16x16x32_bf16 v[136:139], v[64:67], v[40:43], 0
    v_mfma_f32_16x16x32_bf16 v[140:143], v[64:67], v[44:47], 0
    s_waitcnt lgkmcnt(3)
    s_nop 0
    v_mfma_f32_16x16x32_bf16 v[144:147], v[68:71], v[32:35], 0
    ds_read_b128 v[84:87], v12 offset:10240
    v_mfma_f32_16x16x32_bf16 v[148:151], v[68:71], v[36:39], 0
    v_mfma_f32_16x16x32_bf16 v[152:155], v[68:71], v[40:43], 0
    s_waitcnt vmcnt(14)
    s_barrier
    v_mfma_f32_16x16x32_bf16 v[156:159], v[68:71], v[44:47], 0
    ds_read_b64_tr_b16 v[48:49], v16 offset:16384
    s_waitcnt lgkmcnt(4)
    s_nop 0
    v_mfma_f32_16x16x32_bf16 v[160:163], v[72:75], v[32:35], 0
    ds_read_b128 v[64:67], v12 offset:12288
    ds_read_b64_tr_b16 v[50:51], v16 offset:16896
    v_mfma_f32_16x16x32_bf16 v[164:167], v[72:75], v[36:39], 0
    ds_read_b64_tr_b16 v[52:53], v17 offset:16384
    s_add_u32 s43, s45, 1
    s_and_b32 s43, s43, 7
    s_lshl_b32 s43, s43, 19
    s_add_u32 s43, s43, 262144
    s_add_u32 m0, s41, 49152
    s_nop 0
    v_mfma_f32_16x16x32_bf16 v[168:171], v[72:75], v[40:43], 0
    ds_read_b64_tr_b16 v[54:55], v17 offset:16896
    v_mfma_f32_16x16x32_bf16 v[172:175], v[72:75], v[44:47], 0
    ds_read_b64_tr_b16 v[56:57], v18 offset:16384
    buffer_load_dwordx4 v8, s[16:19], s43 offen offset:0 lds
    s_waitcnt lgkmcnt(8)
    s_nop 0
    v_mfma_f32_16x16x32_bf16 v[176:179], v[76:79], v[32:35], 0
    ds_read_b128 v[68:71], v12 offset:14336
    ds_read_b64_tr_b16 v[58:59], v18 offset:16896
    v_mfma_f32_16x16x32_bf16 v[180:183], v[76:79], v[36:39], 0
    ds_read_b64_tr_b16 v[60:61], v19 offset:16384
    buffer_load_dwordx4 v9, s[16:19], s43 offen offset:1024 lds
    v_mfma_f32_16x16x32_bf16 v[184:187], v[76:79], v[40:43], 0
    ds_read_b64_tr_b16 v[62:63], v19 offset:16896
    v_mfma_f32_16x16x32_bf16 v[188:191], v[76:79], v[44:47], 0
    s_add_u32 s42, s45, 2
    s_and_b32 s42, s42, 7
    s_lshl_b32 s42, s42, 7
    s_add_u32 m0, s40, 65536
    s_waitcnt lgkmcnt(11)
    v_mfma_f32_16x16x32_bf16 v[192:195], v[80:83], v[32:35], 0
    ds_read_b128 v[72:75], v14 offset:0
    v_mfma_f32_16x16x32_bf16 v[196:199], v[80:83], v[36:39], 0
    buffer_load_dwordx4 v4, s[12:15], s42 offen offset:0 lds
    v_mfma_f32_16x16x32_bf16 v[200:203], v[80:83], v[40:43], 0
    v_mfma_f32_16x16x32_bf16 v[204:207], v[80:83], v[44:47], 0
    buffer_load_dwordx4 v5, s[12:15], s42 offen offset:1024 lds
    s_waitcnt lgkmcnt(11)
    s_nop 0
    v_mfma_f32_16x16x32_bf16 v[208:211], v[84:87], v[32:35], 0
    ds_read_b128 v[76:79], v14 offset:2048
    v_mfma_f32_16x16x32_bf16 v[212:215], v[84:87], v[36:39], 0
    buffer_load_dwordx4 v6, s[12:15], s42 offen offset:2048 lds
    v_mfma_f32_16x16x32_bf16 v[216:219], v[84:87], v[40:43], 0
    v_mfma_f32_16x16x32_bf16 v[220:223], v[84:87], v[44:47], 0
    buffer_load_dwordx4 v7, s[12:15], s42 offen offset:3072 lds
    s_waitcnt lgkmcnt(10)
    s_nop 0
    v_mfma_f32_16x16x32_bf16 v[224:227], v[64:67], v[32:35], 0
    ds_read_b128 v[80:83], v14 offset:4096
    v_mfma_f32_16x16x32_bf16 v[228:231], v[64:67], v[36:39], 0
    v_mfma_f32_16x16x32_bf16 v[232:235], v[64:67], v[40:43], 0
    v_mfma_f32_16x16x32_bf16 v[236:239], v[64:67], v[44:47], 0
    s_waitcnt lgkmcnt(6)
    s_nop 0
    v_mfma_f32_16x16x32_bf16 v[240:243], v[68:71], v[32:35], 0
    ds_read_b128 v[84:87], v14 offset:6144
    v_mfma_f32_16x16x32_bf16 v[244:247], v[68:71], v[36:39], 0
    v_mfma_f32_16x16x32_bf16 v[248:251], v[68:71], v[40:43], 0
    v_mfma_f32_16x16x32_bf16 v[252:255], v[68:71], v[44:47], 0
    s_waitcnt lgkmcnt(3)
    s_nop 0
    v_mfma_f32_16x16x32_bf16 v[128:131], v[72:75], v[48:51], v[128:131]
    ds_read_b128 v[64:67], v14 offset:8192
    v_mfma_f32_16x16x32_bf16 v[132:135], v[72:75], v[52:55], v[132:135]
    v_mfma_f32_16x16x32_bf16 v[136:139], v[72:75], v[56:59], v[136:139]
    v_mfma_f32_16x16x32_bf16 v[140:143], v[72:75], v[60:63], v[140:143]
    s_waitcnt lgkmcnt(3)
    s_nop 0
    v_mfma_f32_16x16x32_bf16 v[144:147], v[76:79], v[48:51], v[144:147]
    ds_read_b128 v[68:71], v14 offset:10240
    v_mfma_f32_16x16x32_bf16 v[148:151], v[76:79], v[52:55], v[148:151]
    v_mfma_f32_16x16x32_bf16 v[152:155], v[76:79], v[56:59], v[152:155]
    s_waitcnt vmcnt(8)
    s_barrier
    v_mfma_f32_16x16x32_bf16 v[156:159], v[76:79], v[60:63], v[156:159]
    ds_read_b64_tr_b16 v[32:33], v16 offset:32768
    s_waitcnt lgkmcnt(4)
    s_nop 0
    v_mfma_f32_16x16x32_bf16 v[160:163], v[80:83], v[48:51], v[160:163]
    ds_read_b128 v[72:75], v14 offset:12288
    ds_read_b64_tr_b16 v[34:35], v16 offset:33280
    v_mfma_f32_16x16x32_bf16 v[164:167], v[80:83], v[52:55], v[164:167]
    ds_read_b64_tr_b16 v[36:37], v17 offset:32768
    s_add_u32 s43, s45, 2
    s_and_b32 s43, s43, 7
    s_lshl_b32 s43, s43, 19
    s_add_u32 m0, s41, 0
    v_mfma_f32_16x16x32_bf16 v[168:171], v[80:83], v[56:59], v[168:171]
    ds_read_b64_tr_b16 v[38:39], v17 offset:33280
    v_mfma_f32_16x16x32_bf16 v[172:175], v[80:83], v[60:63], v[172:175]
    ds_read_b64_tr_b16 v[40:41], v18 offset:32768
    s_waitcnt lgkmcnt(8)
    s_nop 0
    v_mfma_f32_16x16x32_bf16 v[176:179], v[84:87], v[48:51], v[176:179]
    ds_read_b128 v[76:79], v14 offset:14336
    ds_read_b64_tr_b16 v[42:43], v18 offset:33280
    buffer_load_dwordx4 v8, s[16:19], s43 offen offset:0 lds
    v_mfma_f32_16x16x32_bf16 v[180:183], v[84:87], v[52:55], v[180:183]
    ds_read_b64_tr_b16 v[44:45], v19 offset:32768
    v_mfma_f32_16x16x32_bf16 v[184:187], v[84:87], v[56:59], v[184:187]
    ds_read_b64_tr_b16 v[46:47], v19 offset:33280
    v_mfma_f32_16x16x32_bf16 v[188:191], v[84:87], v[60:63], v[188:191]
    buffer_load_dwordx4 v9, s[16:19], s43 offen offset:1024 lds
    s_waitcnt lgkmcnt(11)
    s_nop 0
    v_mfma_f32_16x16x32_bf16 v[192:195], v[64:67], v[48:51], v[192:195]
    ds_read_b128 v[80:83], v12 offset:32768
    v_mfma_f32_16x16x32_bf16 v[196:199], v[64:67], v[52:55], v[196:199]
    v_mfma_f32_16x16x32_bf16 v[200:203], v[64:67], v[56:59], v[200:203]
    v_mfma_f32_16x16x32_bf16 v[204:207], v[64:67], v[60:63], v[204:207]
    s_waitcnt lgkmcnt(11)
    s_nop 0
    v_mfma_f32_16x16x32_bf16 v[208:211], v[68:71], v[48:51], v[208:211]
    ds_read_b128 v[84:87], v12 offset:34816
    v_mfma_f32_16x16x32_bf16 v[212:215], v[68:71], v[52:55], v[212:215]
    v_mfma_f32_16x16x32_bf16 v[216:219], v[68:71], v[56:59], v[216:219]
    v_mfma_f32_16x16x32_bf16 v[220:223], v[68:71], v[60:63], v[220:223]
    s_waitcnt lgkmcnt(10)
    s_nop 0
    v_mfma_f32_16x16x32_bf16 v[224:227], v[72:75], v[48:51], v[224:227]
    ds_read_b128 v[64:67], v12 offset:36864
    v_mfma_f32_16x16x32_bf16 v[228:231], v[72:75], v[52:55], v[228:231]
    v_mfma_f32_16x16x32_bf16 v[232:235], v[72:75], v[56:59], v[232:235]
    v_mfma_f32_16x16x32_bf16 v[236:239], v[72:75], v[60:63], v[236:239]
    s_waitcnt lgkmcnt(6)
    s_nop 0
    v_mfma_f32_16x16x32_bf16 v[240:243], v[76:79], v[48:51], v[240:243]
    ds_read_b128 v[68:71], v12 offset:38912
    v_mfma_f32_16x16x32_bf16 v[244:247], v[76:79], v[52:55], v[244:247]
    v_mfma_f32_16x16x32_bf16 v[248:251], v[76:79], v[56:59], v[248:251]
    v_mfma_f32_16x16x32_bf16 v[252:255], v[76:79], v[60:63], v[252:255]
    s_waitcnt lgkmcnt(3)
    s_nop 0
    v_mfma_f32_16x16x32_bf16 v[128:131], v[80:83], v[32:35], v[128:131]
    ds_read_b128 v[72:75], v12 offset:40960
    v_mfma_f32_16x16x32_bf16 v[132:135], v[80:83], v[36:39], v[132:135]
    v_mfma_f32_16x16x32_bf16 v[136:139], v[80:83], v[40:43], v[136:139]
    v_mfma_f32_16x16x32_bf16 v[140:143], v[80:83], v[44:47], v[140:143]
    s_waitcnt lgkmcnt(3)
    s_nop 0
    v_mfma_f32_16x16x32_bf16 v[144:147], v[84:87], v[32:35], v[144:147]
    ds_read_b128 v[76:79], v12 offset:43008
    v_mfma_f32_16x16x32_bf16 v[148:151], v[84:87], v[36:39], v[148:151]
    v_mfma_f32_16x16x32_bf16 v[152:155], v[84:87], v[40:43], v[152:155]
    s_waitcnt vmcnt(6)
    s_barrier
    v_mfma_f32_16x16x32_bf16 v[156:159], v[84:87], v[44:47], v[156:159]
    ds_read_b64_tr_b16 v[48:49], v16 offset:49152
    s_waitcnt lgkmcnt(4)
    s_nop 0
    v_mfma_f32_16x16x32_bf16 v[160:163], v[64:67], v[32:35], v[160:163]
    ds_read_b128 v[80:83], v12 offset:45056
    ds_read_b64_tr_b16 v[50:51], v16 offset:49664
    v_mfma_f32_16x16x32_bf16 v[164:167], v[64:67], v[36:39], v[164:167]
    ds_read_b64_tr_b16 v[52:53], v17 offset:49152
    s_add_u32 s43, s45, 2
    s_and_b32 s43, s43, 7
    s_lshl_b32 s43, s43, 19
    s_add_u32 s43, s43, 262144
    s_add_u32 m0, s41, 16384
    s_nop 0
    v_mfma_f32_16x16x32_bf16 v[168:171], v[64:67], v[40:43], v[168:171]
    ds_read_b64_tr_b16 v[54:55], v17 offset:49664
    v_mfma_f32_16x16x32_bf16 v[172:175], v[64:67], v[44:47], v[172:175]
    ds_read_b64_tr_b16 v[56:57], v18 offset:49152
    s_waitcnt lgkmcnt(8)
    s_nop 0
    v_mfma_f32_16x16x32_bf16 v[176:179], v[68:71], v[32:35], v[176:179]
    ds_read_b128 v[84:87], v12 offset:47104
    ds_read_b64_tr_b16 v[58:59], v18 offset:49664
    buffer_load_dwordx4 v8, s[16:19], s43 offen offset:0 lds
    v_mfma_f32_16x16x32_bf16 v[180:183], v[68:71], v[36:39], v[180:183]
    ds_read_b64_tr_b16 v[60:61], v19 offset:49152
    v_mfma_f32_16x16x32_bf16 v[184:187], v[68:71], v[40:43], v[184:187]
    ds_read_b64_tr_b16 v[62:63], v19 offset:49664
    v_mfma_f32_16x16x32_bf16 v[188:191], v[68:71], v[44:47], v[188:191]
    buffer_load_dwordx4 v9, s[16:19], s43 offen offset:1024 lds
    s_waitcnt lgkmcnt(11)
    s_nop 0
    v_mfma_f32_16x16x32_bf16 v[192:195], v[72:75], v[32:35], v[192:195]
    ds_read_b128 v[64:67], v14 offset:32768
    v_mfma_f32_16x16x32_bf16 v[196:199], v[72:75], v[36:39], v[196:199]
    v_mfma_f32_16x16x32_bf16 v[200:203], v[72:75], v[40:43], v[200:203]
    s_add_u32 s42, s45, 3
    s_and_b32 s42, s42, 7
    s_lshl_b32 s42, s42, 7
    s_add_u32 m0, s40, 0
    v_mfma_f32_16x16x32_bf16 v[204:207], v[72:75], v[44:47], v[204:207]
    s_waitcnt lgkmcnt(11)
    s_nop 0
    v_mfma_f32_16x16x32_bf16 v[208:211], v[76:79], v[32:35], v[208:211]
    ds_read_b128 v[68:71], v14 offset:34816
    v_mfma_f32_16x16x32_bf16 v[212:215], v[76:79], v[36:39], v[212:215]
    buffer_load_dwordx4 v4, s[12:15], s42 offen offset:0 lds
    v_mfma_f32_16x16x32_bf16 v[216:219], v[76:79], v[40:43], v[216:219]
    v_mfma_f32_16x16x32_bf16 v[220:223], v[76:79], v[44:47], v[220:223]
    s_waitcnt lgkmcnt(10)
    s_nop 0
    v_mfma_f32_16x16x32_bf16 v[224:227], v[80:83], v[32:35], v[224:227]
    ds_read_b128 v[72:75], v14 offset:36864
    buffer_load_dwordx4 v5, s[12:15], s42 offen offset:1024 lds
    v_mfma_f32_16x16x32_bf16 v[228:231], v[80:83], v[36:39], v[228:231]
    v_mfma_f32_16x16x32_bf16 v[232:235], v[80:83], v[40:43], v[232:235]
    v_mfma_f32_16x16x32_bf16 v[236:239], v[80:83], v[44:47], v[236:239]
    s_waitcnt lgkmcnt(6)
    s_nop 0
    v_mfma_f32_16x16x32_bf16 v[240:243], v[84:87], v[32:35], v[240:243]
    ds_read_b128 v[76:79], v14 offset:38912
    v_mfma_f32_16x16x32_bf16 v[244:247], v[84:87], v[36:39], v[244:247]
    v_mfma_f32_16x16x32_bf16 v[248:251], v[84:87], v[40:43], v[248:251]
    v_mfma_f32_16x16x32_bf16 v[252:255], v[84:87], v[44:47], v[252:255]
    s_waitcnt lgkmcnt(3)
    s_nop 0
    v_mfma_f32_16x16x32_bf16 v[128:131], v[64:67], v[48:51], v[128:131]
    ds_read_b128 v[80:83], v14 offset:40960
    v_mfma_f32_16x16x32_bf16 v[132:135], v[64:67], v[52:55], v[132:135]
    v_mfma_f32_16x16x32_bf16 v[136:139], v[64:67], v[56:59], v[136:139]
    v_mfma_f32_16x16x32_bf16 v[140:143], v[64:67], v[60:63], v[140:143]
    s_waitcnt lgkmcnt(3)
    s_nop 0
    v_mfma_f32_16x16x32_bf16 v[144:147], v[68:71], v[48:51], v[144:147]
    ds_read_b128 v[84:87], v14 offset:43008
    v_mfma_f32_16x16x32_bf16 v[148:151], v[68:71], v[52:55], v[148:151]
    v_mfma_f32_16x16x32_bf16 v[152:155], v[68:71], v[56:59], v[152:155]
    s_waitcnt vmcnt(4)
    s_barrier
    v_mfma_f32_16x16x32_bf16 v[156:159], v[68:71], v[60:63], v[156:159]
    ds_read_b64_tr_b16 v[32:33], v16 offset:0
    s_waitcnt lgkmcnt(4)
    s_nop 0
    v_mfma_f32_16x16x32_bf16 v[160:163], v[72:75], v[48:51], v[160:163]
    ds_read_b128 v[64:67], v14 offset:45056
    ds_read_b64_tr_b16 v[34:35], v16 offset:512
    v_mfma_f32_16x16x32_bf16 v[164:167], v[72:75], v[52:55], v[164:167]
    ds_read_b64_tr_b16 v[36:37], v17 offset:0
    s_add_u32 s43, s45, 3
    s_and_b32 s43, s43, 7
    s_lshl_b32 s43, s43, 19
    s_add_u32 m0, s41, 32768
    s_nop 0
    v_mfma_f32_16x16x32_bf16 v[168:171], v[72:75], v[56:59], v[168:171]
    ds_read_b64_tr_b16 v[38:39], v17 offset:512
    v_mfma_f32_16x16x32_bf16 v[172:175], v[72:75], v[60:63], v[172:175]
    ds_read_b64_tr_b16 v[40:41], v18 offset:0
    s_waitcnt lgkmcnt(8)
    s_nop 0
    v_mfma_f32_16x16x32_bf16 v[176:179], v[76:79], v[48:51], v[176:179]
    ds_read_b128 v[68:71], v14 offset:47104
    ds_read_b64_tr_b16 v[42:43], v18 offset:512
    buffer_load_dwordx4 v8, s[16:19], s43 offen offset:0 lds
    v_mfma_f32_16x16x32_bf16 v[180:183], v[76:79], v[52:55], v[180:183]
    ds_read_b64_tr_b16 v[44:45], v19 offset:0
    v_mfma_f32_16x16x32_bf16 v[184:187], v[76:79], v[56:59], v[184:187]
    ds_read_b64_tr_b16 v[46:47], v19 offset:512
    v_mfma_f32_16x16x32_bf16 v[188:191], v[76:79], v[60:63], v[188:191]
    buffer_load_dwordx4 v9, s[16:19], s43 offen offset:1024 lds
    s_waitcnt lgkmcnt(11)
    s_nop 0
    v_mfma_f32_16x16x32_bf16 v[192:195], v[80:83], v[48:51], v[192:195]
    ds_read_b128 v[72:75], v13 offset:0
    v_mfma_f32_16x16x32_bf16 v[196:199], v[80:83], v[52:55], v[196:199]
    v_mfma_f32_16x16x32_bf16 v[200:203], v[80:83], v[56:59], v[200:203]
    s_add_u32 s42, s45, 3
    s_and_b32 s42, s42, 7
    s_lshl_b32 s42, s42, 7
    s_add_u32 m0, s40, 0
    v_mfma_f32_16x16x32_bf16 v[204:207], v[80:83], v[60:63], v[204:207]
    s_waitcnt lgkmcnt(11)
    s_nop 0
    v_mfma_f32_16x16x32_bf16 v[208:211], v[84:87], v[48:51], v[208:211]
    ds_read_b128 v[76:79], v13 offset:2048
    v_mfma_f32_16x16x32_bf16 v[212:215], v[84:87], v[52:55], v[212:215]
    buffer_load_dwordx4 v6, s[12:15], s42 offen offset:2048 lds
    v_mfma_f32_16x16x32_bf16 v[216:219], v[84:87], v[56:59], v[216:219]
    v_mfma_f32_16x16x32_bf16 v[220:223], v[84:87], v[60:63], v[220:223]
    s_waitcnt lgkmcnt(10)
    s_nop 0
    v_mfma_f32_16x16x32_bf16 v[224:227], v[64:67], v[48:51], v[224:227]
    ds_read_b128 v[80:83], v13 offset:4096
    buffer_load_dwordx4 v7, s[12:15], s42 offen offset:3072 lds
    v_mfma_f32_16x16x32_bf16 v[228:231], v[64:67], v[52:55], v[228:231]
    v_mfma_f32_16x16x32_bf16 v[232:235], v[64:67], v[56:59], v[232:235]
    s_cmp_lg_u32 s20, 0
    s_cbranch_scc1 main_kernel_noflag_13
    s_lshl_b32 s3, s21, 3
    s_add_u32 s3, s3, s22
    v_mov_b32 v21, s3
    v_mov_b32 v22, 1
    s_mov_b64 exec, 1
    buffer_store_byte v22, v21, s[60:63], 0 offen sc1
    s_mov_b64 exec, -1
main_kernel_noflag_13:
    v_mfma_f32_16x16x32_bf16 v[236:239], v[64:67], v[60:63], v[236:239]
    s_waitcnt lgkmcnt(6)
    s_nop 0
    v_mfma_f32_16x16x32_bf16 v[240:243], v[68:71], v[48:51], v[240:243]
    ds_read_b128 v[84:87], v13 offset:6144
    v_mfma_f32_16x16x32_bf16 v[244:247], v[68:71], v[52:55], v[244:247]
    v_mfma_f32_16x16x32_bf16 v[248:251], v[68:71], v[56:59], v[248:251]
    v_mfma_f32_16x16x32_bf16 v[252:255], v[68:71], v[60:63], v[252:255]
    s_waitcnt lgkmcnt(3)
    s_nop 0
    v_mfma_f32_16x16x32_bf16 v[128:131], v[72:75], v[32:35], v[128:131]
    ds_read_b128 v[64:67], v13 offset:8192
    v_mfma_f32_16x16x32_bf16 v[132:135], v[72:75], v[36:39], v[132:135]
    v_mfma_f32_16x16x32_bf16 v[136:139], v[72:75], v[40:43], v[136:139]
    v_mfma_f32_16x16x32_bf16 v[140:143], v[72:75], v[44:47], v[140:143]
    s_waitcnt lgkmcnt(3)
    s_nop 0
    v_mfma_f32_16x16x32_bf16 v[144:147], v[76:79], v[32:35], v[144:147]
    ds_read_b128 v[68:71], v13 offset:10240
    v_mfma_f32_16x16x32_bf16 v[148:151], v[76:79], v[36:39], v[148:151]
    v_mfma_f32_16x16x32_bf16 v[152:155], v[76:79], v[40:43], v[152:155]
    s_waitcnt vmcnt(6)
    s_barrier
    v_mfma_f32_16x16x32_bf16 v[156:159], v[76:79], v[44:47], v[156:159]
    ds_read_b64_tr_b16 v[48:49], v16 offset:16384
    s_waitcnt lgkmcnt(4)
    s_nop 0
    v_mfma_f32_16x16x32_bf16 v[160:163], v[80:83], v[32:35], v[160:163]
    ds_read_b128 v[72:75], v13 offset:12288
    ds_read_b64_tr_b16 v[50:51], v16 offset:16896
    v_mfma_f32_16x16x32_bf16 v[164:167], v[80:83], v[36:39], v[164:167]
    ds_read_b64_tr_b16 v[52:53], v17 offset:16384
    s_add_u32 s43, s45, 3
    s_and_b32 s43, s43, 7
    s_lshl_b32 s43, s43, 19
    s_add_u32 s43, s43, 262144
    s_add_u32 m0, s41, 49152
    s_nop 0
    v_mfma_f32_16x16x32_bf16 v[168:171], v[80:83], v[40:43], v[168:171]
    ds_read_b64_tr_b16 v[54:55], v17 offset:16896
    v_mfma_f32_16x16x32_bf16 v[172:175], v[80:83], v[44:47], v[172:175]
    ds_read_b64_tr_b16 v[56:57], v18 offset:16384
    s_waitcnt lgkmcnt(8)
    s_nop 0
    v_mfma_f32_16x16x32_bf16 v[176:179], v[84:87], v[32:35], v[176:179]
    ds_read_b128 v[76:79], v13 offset:14336
    ds_read_b64_tr_b16 v[58:59], v18 offset:16896
    buffer_load_dwordx4 v8, s[16:19], s43 offen offset:0 lds
    v_mfma_f32_16x16x32_bf16 v[180:183], v[84:87], v[36:39], v[180:183]
    ds_read_b64_tr_b16 v[60:61], v19 offset:16384
    v_mfma_f32_16x16x32_bf16 v[184:187], v[84:87], v[40:43], v[184:187]
    ds_read_b64_tr_b16 v[62:63], v19 offset:16896
    v_mfma_f32_16x16x32_bf16 v[188:191], v[84:87], v[44:47], v[188:191]
    buffer_load_dwordx4 v9, s[16:19], s43 offen offset:1024 lds
    s_waitcnt lgkmcnt(11)
    s_nop 0
    v_mfma_f32_16x16x32_bf16 v[192:195], v[64:67], v[32:35], v[192:195]
    ds_read_b128 v[80:83], v15 offset:0
    v_mfma_f32_16x16x32_bf16 v[196:199], v[64:67], v[36:39], v[196:199]
    v_mfma_f32_16x16x32_bf16 v[200:203], v[64:67], v[40:43], v[200:203]
    s_add_u32 s42, s45, 4
    s_and_b32 s42, s42, 7
    s_lshl_b32 s42, s42, 7
    s_add_u32 m0, s40, 32768
    s_nop 0
    v_mfma_f32_16x16x32_bf16 v[204:207], v[64:67], v[44:47], v[204:207]
    s_waitcnt lgkmcnt(11)
    s_nop 0
    v_mfma_f32_16x16x32_bf16 v[208:211], v[68:71], v[32:35], v[208:211]
    ds_read_b128 v[84:87], v15 offset:2048
    v_mfma_f32_16x16x32_bf16 v[212:215], v[68:71], v[36:39], v[212:215]
    buffer_load_dwordx4 v4, s[12:15], s42 offen offset:0 lds
    v_mfma_f32_16x16x32_bf16 v[216:219], v[68:71], v[40:43], v[216:219]
    v_mfma_f32_16x16x32_bf16 v[220:223], v[68:71], v[44:47], v[220:223]
    s_waitcnt lgkmcnt(10)
    s_nop 0
    v_mfma_f32_16x16x32_bf16 v[224:227], v[72:75], v[32:35], v[224:227]
    ds_read_b128 v[64:67], v15 offset:4096
    buffer_load_dwordx4 v5, s[12:15], s42 offen offset:1024 lds
    v_mfma_f32_16x16x32_bf16 v[228:231], v[72:75], v[36:39], v[228:231]
    v_mfma_f32_16x16x32_bf16 v[232:235], v[72:75], v[40:43], v[232:235]
    v_mfma_f32_16x16x32_bf16 v[236:239], v[72:75], v[44:47], v[236:239]
    s_waitcnt lgkmcnt(6)
    s_nop 0
    v_mfma_f32_16x16x32_bf16 v[240:243], v[76:79], v[32:35], v[240:243]
    ds_read_b128 v[68:71], v15 offset:6144
    v_mfma_f32_16x16x32_bf16 v[244:247], v[76:79], v[36:39], v[244:247]
    v_mfma_f32_16x16x32_bf16 v[248:251], v[76:79], v[40:43], v[248:251]
    v_mfma_f32_16x16x32_bf16 v[252:255], v[76:79], v[44:47], v[252:255]
    s_waitcnt lgkmcnt(3)
    s_nop 0
    v_mfma_f32_16x16x32_bf16 v[128:131], v[80:83], v[48:51], v[128:131]
    ds_read_b128 v[72:75], v15 offset:8192
    v_mfma_f32_16x16x32_bf16 v[132:135], v[80:83], v[52:55], v[132:135]
    v_mfma_f32_16x16x32_bf16 v[136:139], v[80:83], v[56:59], v[136:139]
    v_mfma_f32_16x16x32_bf16 v[140:143], v[80:83], v[60:63], v[140:143]
    s_waitcnt lgkmcnt(3)
    s_nop 0
    v_mfma_f32_16x16x32_bf16 v[144:147], v[84:87], v[48:51], v[144:147]
    ds_read_b128 v[76:79], v15 offset:10240
    v_mfma_f32_16x16x32_bf16 v[148:151], v[84:87], v[52:55], v[148:151]
    v_mfma_f32_16x16x32_bf16 v[152:155], v[84:87], v[56:59], v[152:155]
    s_waitcnt vmcnt(4)
    s_barrier
    v_mfma_f32_16x16x32_bf16 v[156:159], v[84:87], v[60:63], v[156:159]
    ds_read_b64_tr_b16 v[32:33], v16 offset:32768
    s_waitcnt lgkmcnt(4)
    s_nop 0
    v_mfma_f32_16x16x32_bf16 v[160:163], v[64:67], v[48:51], v[160:163]
    ds_read_b128 v[80:83], v15 offset:12288
    ds_read_b64_tr_b16 v[34:35], v16 offset:33280
    v_mfma_f32_16x16x32_bf16 v[164:167], v[64:67], v[52:55], v[164:167]
    ds_read_b64_tr_b16 v[36:37], v17 offset:32768
    s_add_u32 s43, s45, 4
    s_and_b32 s43, s43, 7
    s_lshl_b32 s43, s43, 19
    s_add_u32 m0, s41, 0
    v_mfma_f32_16x16x32_bf16 v[168:171], v[64:67], v[56:59], v[168:171]
    ds_read_b64_tr_b16 v[38:39], v17 offset:33280
    v_mfma_f32_16x16x32_bf16 v[172:175], v[64:67], v[60:63], v[172:175]
    ds_read_b64_tr_b16 v[40:41], v18 offset:32768
    s_waitcnt lgkmcnt(8)
    s_nop 0
    v_mfma_f32_16x16x32_bf16 v[176:179], v[68:71], v[48:51], v[176:179]
    ds_read_b128 v[84:87], v15 offset:14336
    ds_read_b64_tr_b16 v[42:43], v18 offset:33280
    buffer_load_dwordx4 v8, s[16:19], s43 offen offset:0 lds
    v_mfma_f32_16x16x32_bf16 v[180:183], v[68:71], v[52:55], v[180:183]
    ds_read_b64_tr_b16 v[44:45], v19 offset:32768
    v_mfma_f32_16x16x32_bf16 v[184:187], v[68:71], v[56:59], v[184:187]
    ds_read_b64_tr_b16 v[46:47], v19 offset:33280
    v_mfma_f32_16x16x32_bf16 v[188:191], v[68:71], v[60:63], v[188:191]
    buffer_load_dwordx4 v9, s[16:19], s43 offen offset:1024 lds
    s_waitcnt lgkmcnt(11)
    s_nop 0
    v_mfma_f32_16x16x32_bf16 v[192:195], v[72:75], v[48:51], v[192:195]
    ds_read_b128 v[64:67], v12 offset:0
    v_mfma_f32_16x16x32_bf16 v[196:199], v[72:75], v[52:55], v[196:199]
    v_mfma_f32_16x16x32_bf16 v[200:203], v[72:75], v[56:59], v[200:203]
    s_add_u32 s42, s45, 4
    s_and_b32 s42, s42, 7
    s_lshl_b32 s42, s42, 7
    s_add_u32 m0, s40, 32768
    s_nop 0
    v_mfma_f32_16x16x32_bf16 v[204:207], v[72:75], v[60:63], v[204:207]
    s_waitcnt lgkmcnt(11)
    s_nop 0
    v_mfma_f32_16x16x32_bf16 v[208:211], v[76:79], v[48:51], v[208:211]
    ds_read_b128 v[68:71], v12 offset:2048
    v_mfma_f32_16x16x32_bf16 v[212:215], v[76:79], v[52:55], v[212:215]
    buffer_load_dwordx4 v6, s[12:15], s42 offen offset:2048 lds
    v_mfma_f32_16x16x32_bf16 v[216:219], v[76:79], v[56:59], v[216:219]
    v_mfma_f32_16x16x32_bf16 v[220:223], v[76:79], v[60:63], v[220:223]
    s_waitcnt lgkmcnt(10)
    s_nop 0
    v_mfma_f32_16x16x32_bf16 v[224:227], v[80:83], v[48:51], v[224:227]
    ds_read_b128 v[72:75], v12 offset:4096
    buffer_load_dwordx4 v7, s[12:15], s42 offen offset:3072 lds
    v_mfma_f32_16x16x32_bf16 v[228:231], v[80:83], v[52:55], v[228:231]
    v_mfma_f32_16x16x32_bf16 v[232:235], v[80:83], v[56:59], v[232:235]
    v_mfma_f32_16x16x32_bf16 v[236:239], v[80:83], v[60:63], v[236:239]
    s_waitcnt lgkmcnt(6)
    s_nop 0
    v_mfma_f32_16x16x32_bf16 v[240:243], v[84:87], v[48:51], v[240:243]
    ds_read_b128 v[76:79], v12 offset:6144
    v_mfma_f32_16x16x32_bf16 v[244:247], v[84:87], v[52:55], v[244:247]
    v_mfma_f32_16x16x32_bf16 v[248:251], v[84:87], v[56:59], v[248:251]
    v_mfma_f32_16x16x32_bf16 v[252:255], v[84:87], v[60:63], v[252:255]
    s_waitcnt lgkmcnt(3)
    s_nop 0
    v_mfma_f32_16x16x32_bf16 v[128:131], v[64:67], v[32:35], v[128:131]
    ds_read_b128 v[80:83], v12 offset:8192
    v_mfma_f32_16x16x32_bf16 v[132:135], v[64:67], v[36:39], v[132:135]
    v_mfma_f32_16x16x32_bf16 v[136:139], v[64:67], v[40:43], v[136:139]
    v_mfma_f32_16x16x32_bf16 v[140:143], v[64:67], v[44:47], v[140:143]
    s_waitcnt lgkmcnt(3)
    s_nop 0
    v_mfma_f32_16x16x32_bf16 v[144:147], v[68:71], v[32:35], v[144:147]
    ds_read_b128 v[84:87], v12 offset:10240
    v_mfma_f32_16x16x32_bf16 v[148:151], v[68:71], v[36:39], v[148:151]
    v_mfma_f32_16x16x32_bf16 v[152:155], v[68:71], v[40:43], v[152:155]
    s_waitcnt vmcnt(6)
    s_barrier
    v_mfma_f32_16x16x32_bf16 v[156:159], v[68:71], v[44:47], v[156:159]
    ds_read_b64_tr_b16 v[48:49], v16 offset:49152
    s_waitcnt lgkmcnt(4)
    s_nop 0
    v_mfma_f32_16x16x32_bf16 v[160:163], v[72:75], v[32:35], v[160:163]
    ds_read_b128 v[64:67], v12 offset:12288
    ds_read_b64_tr_b16 v[50:51], v16 offset:49664
    v_mfma_f32_16x16x32_bf16 v[164:167], v[72:75], v[36:39], v[164:167]
    ds_read_b64_tr_b16 v[52:53], v17 offset:49152
    s_add_u32 s43, s45, 4
    s_and_b32 s43, s43, 7
    s_lshl_b32 s43, s43, 19
    s_add_u32 s43, s43, 262144
    s_add_u32 m0, s41, 16384
    s_nop 0
    v_mfma_f32_16x16x32_bf16 v[168:171], v[72:75], v[40:43], v[168:171]
    ds_read_b64_tr_b16 v[54:55], v17 offset:49664
    v_mfma_f32_16x16x32_bf16 v[172:175], v[72:75], v[44:47], v[172:175]
    ds_read_b64_tr_b16 v[56:57], v18 offset:49152
    s_waitcnt lgkmcnt(8)
    s_nop 0
    v_mfma_f32_16x16x32_bf16 v[176:179], v[76:79], v[32:35], v[176:179]
    ds_read_b128 v[68:71], v12 offset:14336
    ds_read_b64_tr_b16 v[58:59], v18 offset:49664
    buffer_load_dwordx4 v8, s[16:19], s43 offen offset:0 lds
    v_mfma_f32_16x16x32_bf16 v[180:183], v[76:79], v[36:39], v[180:183]
    ds_read_b64_tr_b16 v[60:61], v19 offset:49152
    v_mfma_f32_16x16x32_bf16 v[184:187], v[76:79], v[40:43], v[184:187]
    ds_read_b64_tr_b16 v[62:63], v19 offset:49664
    v_mfma_f32_16x16x32_bf16 v[188:191], v[76:79], v[44:47], v[188:191]
    buffer_load_dwordx4 v9, s[16:19], s43 offen offset:1024 lds
    s_waitcnt lgkmcnt(11)
    s_nop 0
    v_mfma_f32_16x16x32_bf16 v[192:195], v[80:83], v[32:35], v[192:195]
    ds_read_b128 v[72:75], v14 offset:0
    v_mfma_f32_16x16x32_bf16 v[196:199], v[80:83], v[36:39], v[196:199]
    v_mfma_f32_16x16x32_bf16 v[200:203], v[80:83], v[40:43], v[200:203]
    s_add_u32 s42, s45, 5
    s_and_b32 s42, s42, 7
    s_lshl_b32 s42, s42, 7
    s_add_u32 m0, s40, 65536
    s_nop 0
    v_mfma_f32_16x16x32_bf16 v[204:207], v[80:83], v[44:47], v[204:207]
    s_waitcnt lgkmcnt(11)
    s_nop 0
    v_mfma_f32_16x16x32_bf16 v[208:211], v[84:87], v[32:35], v[208:211]
    ds_read_b128 v[76:79], v14 offset:2048
    v_mfma_f32_16x16x32_bf16 v[212:215], v[84:87], v[36:39], v[212:215]
    buffer_load_dwordx4 v4, s[12:15], s42 offen offset:0 lds
    v_mfma_f32_16x16x32_bf16 v[216:219], v[84:87], v[40:43], v[216:219]
    v_mfma_f32_16x16x32_bf16 v[220:223], v[84:87], v[44:47], v[220:223]
    s_waitcnt lgkmcnt(10)
    s_nop 0
    v_mfma_f32_16x16x32_bf16 v[224:227], v[64:67], v[32:35], v[224:227]
    ds_read_b128 v[80:83], v14 offset:4096
    buffer_load_dwordx4 v5, s[12:15], s42 offen offset:1024 lds
    v_mfma_f32_16x16x32_bf16 v[228:231], v[64:67], v[36:39], v[228:231]
    v_mfma_f32_16x16x32_bf16 v[232:235], v[64:67], v[40:43], v[232:235]
    v_mfma_f32_16x16x32_bf16 v[236:239], v[64:67], v[44:47], v[236:239]
    s_waitcnt lgkmcnt(6)
    s_nop 0
    v_mfma_f32_16x16x32_bf16 v[240:243], v[68:71], v[32:35], v[240:243]
    ds_read_b128 v[84:87], v14 offset:6144
    v_mfma_f32_16x16x32_bf16 v[244:247], v[68:71], v[36:39], v[244:247]
    v_mfma_f32_16x16x32_bf16 v[248:251], v[68:71], v[40:43], v[248:251]
    v_mfma_f32_16x16x32_bf16 v[252:255], v[68:71], v[44:47], v[252:255]
    s_waitcnt lgkmcnt(3)
    s_nop 0
    v_mfma_f32_16x16x32_bf16 v[128:131], v[72:75], v[48:51], v[128:131]
    ds_read_b128 v[64:67], v14 offset:8192
    v_mfma_f32_16x16x32_bf16 v[132:135], v[72:75], v[52:55], v[132:135]
    v_mfma_f32_16x16x32_bf16 v[136:139], v[72:75], v[56:59], v[136:139]
    v_mfma_f32_16x16x32_bf16 v[140:143], v[72:75], v[60:63], v[140:143]
    s_waitcnt lgkmcnt(3)
    s_nop 0
    v_mfma_f32_16x16x32_bf16 v[144:147], v[76:79], v[48:51], v[144:147]
    ds_read_b128 v[68:71], v14 offset:10240
    v_mfma_f32_16x16x32_bf16 v[148:151], v[76:79], v[52:55], v[148:151]
    v_mfma_f32_16x16x32_bf16 v[152:155], v[76:79], v[56:59], v[152:155]
    s_waitcnt vmcnt(4)
    s_barrier
    v_mfma_f32_16x16x32_bf16 v[156:159], v[76:79], v[60:63], v[156:159]
    ds_read_b64_tr_b16 v[32:33], v16 offset:0
    s_waitcnt lgkmcnt(4)
    s_nop 0
    v_mfma_f32_16x16x32_bf16 v[160:163], v[80:83], v[48:51], v[160:163]
    ds_read_b128 v[72:75], v14 offset:12288
    ds_read_b64_tr_b16 v[34:35], v16 offset:512
    v_mfma_f32_16x16x32_bf16 v[164:167], v[80:83], v[52:55], v[164:167]
    ds_read_b64_tr_b16 v[36:37], v17 offset:0
    s_add_u32 s43, s45, 5
    s_and_b32 s43, s43, 7
    s_lshl_b32 s43, s43, 19
    s_add_u32 m0, s41, 32768
    s_nop 0
    v_mfma_f32_16x16x32_bf16 v[168:171], v[80:83], v[56:59], v[168:171]
    ds_read_b64_tr_b16 v[38:39], v17 offset:512
    v_mfma_f32_16x16x32_bf16 v[172:175], v[80:83], v[60:63], v[172:175]
    ds_read_b64_tr_b16 v[40:41], v18 offset:0
    s_waitcnt lgkmcnt(8)
    s_nop 0
    v_mfma_f32_16x16x32_bf16 v[176:179], v[84:87], v[48:51], v[176:179]
    ds_read_b128 v[76:79], v14 offset:14336
    ds_read_b64_tr_b16 v[42:43], v18 offset:512
    buffer_load_dwordx4 v8, s[16:19], s43 offen offset:0 lds
    v_mfma_f32_16x16x32_bf16 v[180:183], v[84:87], v[52:55], v[180:183]
    ds_read_b64_tr_b16 v[44:45], v19 offset:0
    v_mfma_f32_16x16x32_bf16 v[184:187], v[84:87], v[56:59], v[184:187]
    ds_read_b64_tr_b16 v[46:47], v19 offset:512
    v_mfma_f32_16x16x32_bf16 v[188:191], v[84:87], v[60:63], v[188:191]
    buffer_load_dwordx4 v9, s[16:19], s43 offen offset:1024 lds
    s_waitcnt lgkmcnt(11)
    s_nop 0
    v_mfma_f32_16x16x32_bf16 v[192:195], v[64:67], v[48:51], v[192:195]
    ds_read_b128 v[80:83], v12 offset:32768
    v_mfma_f32_16x16x32_bf16 v[196:199], v[64:67], v[52:55], v[196:199]
    v_mfma_f32_16x16x32_bf16 v[200:203], v[64:67], v[56:59], v[200:203]
    s_add_u32 s42, s45, 5
    s_and_b32 s42, s42, 7
    s_lshl_b32 s42, s42, 7
    s_add_u32 m0, s40, 65536
    s_nop 0
    v_mfma_f32_16x16x32_bf16 v[204:207], v[64:67], v[60:63], v[204:207]
    s_waitcnt lgkmcnt(11)
    s_nop 0
    v_mfma_f32_16x16x32_bf16 v[208:211], v[68:71], v[48:51], v[208:211]
    ds_read_b128 v[84:87], v12 offset:34816
    v_mfma_f32_16x16x32_bf16 v[212:215], v[68:71], v[52:55], v[212:215]
    buffer_load_dwordx4 v6, s[12:15], s42 offen offset:2048 lds
    v_mfma_f32_16x16x32_bf16 v[216:219], v[68:71], v[56:59], v[216:219]
    v_mfma_f32_16x16x32_bf16 v[220:223], v[68:71], v[60:63], v[220:223]
    s_waitcnt lgkmcnt(10)
    s_nop 0
    v_mfma_f32_16x16x32_bf16 v[224:227], v[72:75], v[48:51], v[224:227]
    ds_read_b128 v[64:67], v12 offset:36864
    buffer_load_dwordx4 v7, s[12:15], s42 offen offset:3072 lds
    v_mfma_f32_16x16x32_bf16 v[228:231], v[72:75], v[52:55], v[228:231]
    v_mfma_f32_16x16x32_bf16 v[232:235], v[72:75], v[56:59], v[232:235]
    v_mfma_f32_16x16x32_bf16 v[236:239], v[72:75], v[60:63], v[236:239]
    s_waitcnt lgkmcnt(6)
    s_nop 0
    v_mfma_f32_16x16x32_bf16 v[240:243], v[76:79], v[48:51], v[240:243]
    ds_read_b128 v[68:71], v12 offset:38912
    v_mfma_f32_16x16x32_bf16 v[244:247], v[76:79], v[52:55], v[244:247]
    v_mfma_f32_16x16x32_bf16 v[248:251], v[76:79], v[56:59], v[248:251]
    v_mfma_f32_16x16x32_bf16 v[252:255], v[76:79], v[60:63], v[252:255]
    s_waitcnt lgkmcnt(3)
    s_nop 0
    v_mfma_f32_16x16x32_bf16 v[128:131], v[80:83], v[32:35], v[128:131]
    ds_read_b128 v[72:75], v12 offset:40960
    v_mfma_f32_16x16x32_bf16 v[132:135], v[80:83], v[36:39], v[132:135]
    v_mfma_f32_16x16x32_bf16 v[136:139], v[80:83], v[40:43], v[136:139]
    v_mfma_f32_16x16x32_bf16 v[140:143], v[80:83], v[44:47], v[140:143]
    s_waitcnt lgkmcnt(3)
    s_nop 0
    v_mfma_f32_16x16x32_bf16 v[144:147], v[84:87], v[32:35], v[144:147]
    ds_read_b128 v[76:79], v12 offset:43008
    v_mfma_f32_16x16x32_bf16 v[148:151], v[84:87], v[36:39], v[148:151]
    v_mfma_f32_16x16x32_bf16 v[152:155], v[84:87], v[40:43], v[152:155]
    s_waitcnt vmcnt(6)
    s_barrier
    v_mfma_f32_16x16x32_bf16 v[156:159], v[84:87], v[44:47], v[156:159]
    ds_read_b64_tr_b16 v[48:49], v16 offset:16384
    s_waitcnt lgkmcnt(4)
    s_nop 0
    v_mfma_f32_16x16x32_bf16 v[160:163], v[64:67], v[32:35], v[160:163]
    ds_read_b128 v[80:83], v12 offset:45056
    ds_read_b64_tr_b16 v[50:51], v16 offset:16896
    v_mfma_f32_16x16x32_bf16 v[164:167], v[64:67], v[36:39], v[164:167]
    ds_read_b64_tr_b16 v[52:53], v17 offset:16384
    s_add_u32 s43, s45, 5
    s_and_b32 s43, s43, 7
    s_lshl_b32 s43, s43, 19
    s_add_u32 s43, s43, 262144
    s_add_u32 m0, s41, 49152
    s_nop 0
    v_mfma_f32_16x16x32_bf16 v[168:171], v[64:67], v[40:43], v[168:171]
    ds_read_b64_tr_b16 v[54:55], v17 offset:16896
    v_mfma_f32_16x16x32_bf16 v[172:175], v[64:67], v[44:47], v[172:175]
    ds_read_b64_tr_b16 v[56:57], v18 offset:16384
    s_waitcnt lgkmcnt(8)
    s_nop 0
    v_mfma_f32_16x16x32_bf16 v[176:179], v[68:71], v[32:35], v[176:179]
    ds_read_b128 v[84:87], v12 offset:47104
    ds_read_b64_tr_b16 v[58:59], v18 offset:16896
    buffer_load_dwordx4 v8, s[16:19], s43 offen offset:0 lds
    v_mfma_f32_16x16x32_bf16 v[180:183], v[68:71], v[36:39], v[180:183]
    ds_read_b64_tr_b16 v[60:61], v19 offset:16384
    v_mfma_f32_16x16x32_bf16 v[184:187], v[68:71], v[40:43], v[184:187]
    ds_read_b64_tr_b16 v[62:63], v19 offset:16896
    v_mfma_f32_16x16x32_bf16 v[188:191], v[68:71], v[44:47], v[188:191]
    buffer_load_dwordx4 v9, s[16:19], s43 offen offset:1024 lds
    s_waitcnt lgkmcnt(11)
    s_nop 0
    v_mfma_f32_16x16x32_bf16 v[192:195], v[72:75], v[32:35], v[192:195]
    ds_read_b128 v[64:67], v14 offset:32768
    v_mfma_f32_16x16x32_bf16 v[196:199], v[72:75], v[36:39], v[196:199]
    v_mfma_f32_16x16x32_bf16 v[200:203], v[72:75], v[40:43], v[200:203]
    s_add_u32 s42, s45, 6
    s_and_b32 s42, s42, 7
    s_lshl_b32 s42, s42, 7
    s_add_u32 m0, s40, 0
    v_mfma_f32_16x16x32_bf16 v[204:207], v[72:75], v[44:47], v[204:207]
    s_waitcnt lgkmcnt(11)
    s_nop 0
    v_mfma_f32_16x16x32_bf16 v[208:211], v[76:79], v[32:35], v[208:211]
    ds_read_b128 v[68:71], v14 offset:34816
    v_mfma_f32_16x16x32_bf16 v[212:215], v[76:79], v[36:39], v[212:215]
    buffer_load_dwordx4 v4, s[12:15], s42 offen offset:0 lds
    v_mfma_f32_16x16x32_bf16 v[216:219], v[76:79], v[40:43], v[216:219]
    v_mfma_f32_16x16x32_bf16 v[220:223], v[76:79], v[44:47], v[220:223]
    s_waitcnt lgkmcnt(10)
    s_nop 0
    v_mfma_f32_16x16x32_bf16 v[224:227], v[80:83], v[32:35], v[224:227]
    ds_read_b128 v[72:75], v14 offset:36864
    buffer_load_dwordx4 v5, s[12:15], s42 offen offset:1024 lds
    v_mfma_f32_16x16x32_bf16 v[228:231], v[80:83], v[36:39], v[228:231]
    v_mfma_f32_16x16x32_bf16 v[232:235], v[80:83], v[40:43], v[232:235]
    v_mfma_f32_16x16x32_bf16 v[236:239], v[80:83], v[44:47], v[236:239]
    s_waitcnt lgkmcnt(6)
    s_nop 0
    v_mfma_f32_16x16x32_bf16 v[240:243], v[84:87], v[32:35], v[240:243]
    ds_read_b128 v[76:79], v14 offset:38912
    v_mfma_f32_16x16x32_bf16 v[244:247], v[84:87], v[36:39], v[244:247]
    v_mfma_f32_16x16x32_bf16 v[248:251], v[84:87], v[40:43], v[248:251]
    v_mfma_f32_16x16x32_bf16 v[252:255], v[84:87], v[44:47], v[252:255]
    s_waitcnt lgkmcnt(3)
    s_nop 0
    v_mfma_f32_16x16x32_bf16 v[128:131], v[64:67], v[48:51], v[128:131]
    ds_read_b128 v[80:83], v14 offset:40960
    v_mfma_f32_16x16x32_bf16 v[132:135], v[64:67], v[52:55], v[132:135]
    v_mfma_f32_16x16x32_bf16 v[136:139], v[64:67], v[56:59], v[136:139]
    v_mfma_f32_16x16x32_bf16 v[140:143], v[64:67], v[60:63], v[140:143]
    s_waitcnt lgkmcnt(3)
    s_nop 0
    v_mfma_f32_16x16x32_bf16 v[144:147], v[68:71], v[48:51], v[144:147]
    ds_read_b128 v[84:87], v14 offset:43008
    v_mfma_f32_16x16x32_bf16 v[148:151], v[68:71], v[52:55], v[148:151]
    v_mfma_f32_16x16x32_bf16 v[152:155], v[68:71], v[56:59], v[152:155]
    s_waitcnt vmcnt(4)
    s_barrier
    v_mfma_f32_16x16x32_bf16 v[156:159], v[68:71], v[60:63], v[156:159]
    ds_read_b64_tr_b16 v[32:33], v16 offset:32768
    s_waitcnt lgkmcnt(4)
    s_nop 0
    v_mfma_f32_16x16x32_bf16 v[160:163], v[72:75], v[48:51], v[160:163]
    ds_read_b128 v[64:67], v14 offset:45056
    ds_read_b64_tr_b16 v[34:35], v16 offset:33280
    v_mfma_f32_16x16x32_bf16 v[164:167], v[72:75], v[52:55], v[164:167]
    ds_read_b64_tr_b16 v[36:37], v17 offset:32768
    s_add_u32 s43, s45, 6
    s_and_b32 s43, s43, 7
    s_lshl_b32 s43, s43, 19
    s_add_u32 m0, s41, 0
    v_mfma_f32_16x16x32_bf16 v[168:171], v[72:75], v[56:59], v[168:171]
    ds_read_b64_tr_b16 v[38:39], v17 offset:33280
    v_mfma_f32_16x16x32_bf16 v[172:175], v[72:75], v[60:63], v[172:175]
    ds_read_b64_tr_b16 v[40:41], v18 offset:32768
    s_waitcnt lgkmcnt(8)
    s_nop 0
    v_mfma_f32_16x16x32_bf16 v[176:179], v[76:79], v[48:51], v[176:179]
    ds_read_b128 v[68:71], v14 offset:47104
    ds_read_b64_tr_b16 v[42:43], v18 offset:33280
    buffer_load_dwordx4 v8, s[16:19], s43 offen offset:0 lds
    v_mfma_f32_16x16x32_bf16 v[180:183], v[76:79], v[52:55], v[180:183]
    ds_read_b64_tr_b16 v[44:45], v19 offset:32768
    v_mfma_f32_16x16x32_bf16 v[184:187], v[76:79], v[56:59], v[184:187]
    ds_read_b64_tr_b16 v[46:47], v19 offset:33280
    v_mfma_f32_16x16x32_bf16 v[188:191], v[76:79], v[60:63], v[188:191]
    buffer_load_dwordx4 v9, s[16:19], s43 offen offset:1024 lds
    s_waitcnt lgkmcnt(11)
    s_nop 0
    v_mfma_f32_16x16x32_bf16 v[192:195], v[80:83], v[48:51], v[192:195]
    ds_read_b128 v[72:75], v13 offset:0
    v_mfma_f32_16x16x32_bf16 v[196:199], v[80:83], v[52:55], v[196:199]
    v_mfma_f32_16x16x32_bf16 v[200:203], v[80:83], v[56:59], v[200:203]
    s_add_u32 s42, s45, 6
    s_and_b32 s42, s42, 7
    s_lshl_b32 s42, s42, 7
    s_add_u32 m0, s40, 0
    v_mfma_f32_16x16x32_bf16 v[204:207], v[80:83], v[60:63], v[204:207]
    s_waitcnt lgkmcnt(11)
    s_nop 0
    v_mfma_f32_16x16x32_bf16 v[208:211], v[84:87], v[48:51], v[208:211]
    ds_read_b128 v[76:79], v13 offset:2048
    v_mfma_f32_16x16x32_bf16 v[212:215], v[84:87], v[52:55], v[212:215]
    buffer_load_dwordx4 v6, s[12:15], s42 offen offset:2048 lds
    v_mfma_f32_16x16x32_bf16 v[216:219], v[84:87], v[56:59], v[216:219]
    v_mfma_f32_16x16x32_bf16 v[220:223], v[84:87], v[60:63], v[220:223]
    s_waitcnt lgkmcnt(10)
    s_nop 0
    v_mfma_f32_16x16x32_bf16 v[224:227], v[64:67], v[48:51], v[224:227]
    ds_read_b128 v[80:83], v13 offset:4096
    buffer_load_dwordx4 v7, s[12:15], s42 offen offset:3072 lds
    v_mfma_f32_16x16x32_bf16 v[228:231], v[64:67], v[52:55], v[228:231]
    v_mfma_f32_16x16x32_bf16 v[232:235], v[64:67], v[56:59], v[232:235]
    v_mfma_f32_16x16x32_bf16 v[236:239], v[64:67], v[60:63], v[236:239]
    s_waitcnt lgkmcnt(6)
    s_nop 0
    v_mfma_f32_16x16x32_bf16 v[240:243], v[68:71], v[48:51], v[240:243]
    ds_read_b128 v[84:87], v13 offset:6144
    v_mfma_f32_16x16x32_bf16 v[244:247], v[68:71], v[52:55], v[244:247]
    v_mfma_f32_16x16x32_bf16 v[248:251], v[68:71], v[56:59], v[248:251]
    v_mfma_f32_16x16x32_bf16 v[252:255], v[68:71], v[60:63], v[252:255]
    s_waitcnt lgkmcnt(3)
    s_nop 0
    v_mfma_f32_16x16x32_bf16 v[128:131], v[72:75], v[32:35], v[128:131]
    ds_read_b128 v[64:67], v13 offset:8192
    v_mfma_f32_16x16x32_bf16 v[132:135], v[72:75], v[36:39], v[132:135]
    v_mfma_f32_16x16x32_bf16 v[136:139], v[72:75], v[40:43], v[136:139]
    v_mfma_f32_16x16x32_bf16 v[140:143], v[72:75], v[44:47], v[140:143]
    s_waitcnt lgkmcnt(3)
    s_nop 0
    v_mfma_f32_16x16x32_bf16 v[144:147], v[76:79], v[32:35], v[144:147]
    ds_read_b128 v[68:71], v13 offset:10240
    v_mfma_f32_16x16x32_bf16 v[148:151], v[76:79], v[36:39], v[148:151]
    v_mfma_f32_16x16x32_bf16 v[152:155], v[76:79], v[40:43], v[152:155]
    s_waitcnt vmcnt(6)
    s_barrier
    v_mfma_f32_16x16x32_bf16 v[156:159], v[76:79], v[44:47], v[156:159]
    ds_read_b64_tr_b16 v[48:49], v16 offset:49152
    s_waitcnt lgkmcnt(4)
    s_nop 0
    v_mfma_f32_16x16x32_bf16 v[160:163], v[80:83], v[32:35], v[160:163]
    ds_read_b128 v[72:75], v13 offset:12288
    ds_read_b64_tr_b16 v[50:51], v16 offset:49664
    v_mfma_f32_16x16x32_bf16 v[164:167], v[80:83], v[36:39], v[164:167]
    ds_read_b64_tr_b16 v[52:53], v17 offset:49152
    s_add_u32 s43, s45, 6
    s_and_b32 s43, s43, 7
    s_lshl_b32 s43, s43, 19
    s_add_u32 s43, s43, 262144
    s_add_u32 m0, s41, 16384
    s_nop 0
    v_mfma_f32_16x16x32_bf16 v[168:171], v[80:83], v[40:43], v[168:171]
    ds_read_b64_tr_b16 v[54:55], v17 offset:49664
    v_mfma_f32_16x16x32_bf16 v[172:175], v[80:83], v[44:47], v[172:175]
    ds_read_b64_tr_b16 v[56:57], v18 offset:49152
    s_waitcnt lgkmcnt(8)
    s_nop 0
    v_mfma_f32_16x16x32_bf16 v[176:179], v[84:87], v[32:35], v[176:179]
    ds_read_b128 v[76:79], v13 offset:14336
    ds_read_b64_tr_b16 v[58:59], v18 offset:49664
    buffer_load_dwordx4 v8, s[16:19], s43 offen offset:0 lds
    v_mfma_f32_16x16x32_bf16 v[180:183], v[84:87], v[36:39], v[180:183]
    ds_read_b64_tr_b16 v[60:61], v19 offset:49152
    v_mfma_f32_16x16x32_bf16 v[184:187], v[84:87], v[40:43], v[184:187]
    ds_read_b64_tr_b16 v[62:63], v19 offset:49664
    v_mfma_f32_16x16x32_bf16 v[188:191], v[84:87], v[44:47], v[188:191]
    buffer_load_dwordx4 v9, s[16:19], s43 offen offset:1024 lds
    s_waitcnt lgkmcnt(11)
    s_nop 0
    v_mfma_f32_16x16x32_bf16 v[192:195], v[64:67], v[32:35], v[192:195]
    ds_read_b128 v[80:83], v15 offset:0
    v_mfma_f32_16x16x32_bf16 v[196:199], v[64:67], v[36:39], v[196:199]
    v_mfma_f32_16x16x32_bf16 v[200:203], v[64:67], v[40:43], v[200:203]
    s_add_u32 s42, s45, 7
    s_and_b32 s42, s42, 7
    s_lshl_b32 s42, s42, 7
    s_add_u32 m0, s40, 32768
    s_nop 0
    v_mfma_f32_16x16x32_bf16 v[204:207], v[64:67], v[44:47], v[204:207]
    s_waitcnt lgkmcnt(11)
    s_nop 0
    v_mfma_f32_16x16x32_bf16 v[208:211], v[68:71], v[32:35], v[208:211]
    ds_read_b128 v[84:87], v15 offset:2048
    v_mfma_f32_16x16x32_bf16 v[212:215], v[68:71], v[36:39], v[212:215]
    buffer_load_dwordx4 v4, s[12:15], s42 offen offset:0 lds
    v_mfma_f32_16x16x32_bf16 v[216:219], v[68:71], v[40:43], v[216:219]
    v_mfma_f32_16x16x32_bf16 v[220:223], v[68:71], v[44:47], v[220:223]
    s_waitcnt lgkmcnt(10)
    s_nop 0
    v_mfma_f32_16x16x32_bf16 v[224:227], v[72:75], v[32:35], v[224:227]
    ds_read_b128 v[64:67], v15 offset:4096
    buffer_load_dwordx4 v5, s[12:15], s42 offen offset:1024 lds
    v_mfma_f32_16x16x32_bf16 v[228:231], v[72:75], v[36:39], v[228:231]
    v_mfma_f32_16x16x32_bf16 v[232:235], v[72:75], v[40:43], v[232:235]
    v_mfma_f32_16x16x32_bf16 v[236:239], v[72:75], v[44:47], v[236:239]
    s_waitcnt lgkmcnt(6)
    s_nop 0
    v_mfma_f32_16x16x32_bf16 v[240:243], v[76:79], v[32:35], v[240:243]
    ds_read_b128 v[68:71], v15 offset:6144
    v_mfma_f32_16x16x32_bf16 v[244:247], v[76:79], v[36:39], v[244:247]
    v_mfma_f32_16x16x32_bf16 v[248:251], v[76:79], v[40:43], v[248:251]
    v_mfma_f32_16x16x32_bf16 v[252:255], v[76:79], v[44:47], v[252:255]
    s_waitcnt lgkmcnt(3)
    s_nop 0
    v_mfma_f32_16x16x32_bf16 v[128:131], v[80:83], v[48:51], v[128:131]
    ds_read_b128 v[72:75], v15 offset:8192
    v_mfma_f32_16x16x32_bf16 v[132:135], v[80:83], v[52:55], v[132:135]
    v_mfma_f32_16x16x32_bf16 v[136:139], v[80:83], v[56:59], v[136:139]
    v_mfma_f32_16x16x32_bf16 v[140:143], v[80:83], v[60:63], v[140:143]
    s_waitcnt lgkmcnt(3)
    s_nop 0
    v_mfma_f32_16x16x32_bf16 v[144:147], v[84:87], v[48:51], v[144:147]
    ds_read_b128 v[76:79], v15 offset:10240
    v_mfma_f32_16x16x32_bf16 v[148:151], v[84:87], v[52:55], v[148:151]
    v_mfma_f32_16x16x32_bf16 v[152:155], v[84:87], v[56:59], v[152:155]
    s_waitcnt vmcnt(4)
    s_barrier
    v_mfma_f32_16x16x32_bf16 v[156:159], v[84:87], v[60:63], v[156:159]
    ds_read_b64_tr_b16 v[32:33], v16 offset:0
    s_waitcnt lgkmcnt(4)
    s_nop 0
    v_mfma_f32_16x16x32_bf16 v[160:163], v[64:67], v[48:51], v[160:163]
    ds_read_b128 v[80:83], v15 offset:12288
    ds_read_b64_tr_b16 v[34:35], v16 offset:512
    v_mfma_f32_16x16x32_bf16 v[164:167], v[64:67], v[52:55], v[164:167]
    ds_read_b64_tr_b16 v[36:37], v17 offset:0
    s_add_u32 s43, s45, 7
    s_and_b32 s43, s43, 7
    s_lshl_b32 s43, s43, 19
    s_add_u32 m0, s41, 32768
    s_nop 0
    v_mfma_f32_16x16x32_bf16 v[168:171], v[64:67], v[56:59], v[168:171]
    ds_read_b64_tr_b16 v[38:39], v17 offset:512
    v_mfma_f32_16x16x32_bf16 v[172:175], v[64:67], v[60:63], v[172:175]
    ds_read_b64_tr_b16 v[40:41], v18 offset:0
    s_waitcnt lgkmcnt(8)
    s_nop 0
    v_mfma_f32_16x16x32_bf16 v[176:179], v[68:71], v[48:51], v[176:179]
    ds_read_b128 v[84:87], v15 offset:14336
    ds_read_b64_tr_b16 v[42:43], v18 offset:512
    buffer_load_dwordx4 v8, s[16:19], s43 offen offset:0 lds
    v_mfma_f32_16x16x32_bf16 v[180:183], v[68:71], v[52:55], v[180:183]
    ds_read_b64_tr_b16 v[44:45], v19 offset:0
    v_mfma_f32_16x16x32_bf16 v[184:187], v[68:71], v[56:59], v[184:187]
    ds_read_b64_tr_b16 v[46:47], v19 offset:512
    v_mfma_f32_16x16x32_bf16 v[188:191], v[68:71], v[60:63], v[188:191]
    buffer_load_dwordx4 v9, s[16:19], s43 offen offset:1024 lds
    s_waitcnt lgkmcnt(11)
    s_nop 0
    v_mfma_f32_16x16x32_bf16 v[192:195], v[72:75], v[48:51], v[192:195]
    ds_read_b128 v[64:67], v12 offset:0
    v_mfma_f32_16x16x32_bf16 v[196:199], v[72:75], v[52:55], v[196:199]
    v_mfma_f32_16x16x32_bf16 v[200:203], v[72:75], v[56:59], v[200:203]
    s_add_u32 s42, s45, 7
    s_and_b32 s42, s42, 7
    s_lshl_b32 s42, s42, 7
    s_add_u32 m0, s40, 32768
    s_nop 0
    v_mfma_f32_16x16x32_bf16 v[204:207], v[72:75], v[60:63], v[204:207]
    s_waitcnt lgkmcnt(11)
    s_nop 0
    v_mfma_f32_16x16x32_bf16 v[208:211], v[76:79], v[48:51], v[208:211]
    ds_read_b128 v[68:71], v12 offset:2048
    v_mfma_f32_16x16x32_bf16 v[212:215], v[76:79], v[52:55], v[212:215]
    buffer_load_dwordx4 v6, s[12:15], s42 offen offset:2048 lds
    v_mfma_f32_16x16x32_bf16 v[216:219], v[76:79], v[56:59], v[216:219]
    v_mfma_f32_16x16x32_bf16 v[220:223], v[76:79], v[60:63], v[220:223]
    s_waitcnt lgkmcnt(10)
    s_nop 0
    v_mfma_f32_16x16x32_bf16 v[224:227], v[80:83], v[48:51], v[224:227]
    ds_read_b128 v[72:75], v12 offset:4096
    buffer_load_dwordx4 v7, s[12:15], s42 offen offset:3072 lds
    v_mfma_f32_16x16x32_bf16 v[228:231], v[80:83], v[52:55], v[228:231]
    v_mfma_f32_16x16x32_bf16 v[232:235], v[80:83], v[56:59], v[232:235]
    s_mov_b32 s4, 0x10000
    v_lshlrev_b32 v92, 2, v2
    s_cmp_lg_u32 s20, 0
    s_cbranch_scc1 main_kernel_pollud_15
main_kernel_pollu_14:
    buffer_load_dword v93, v92, s[60:63], 0 offen sc1
    s_waitcnt vmcnt(0)
    v_and_b32 v93, 0x01010101, v93
    v_cmp_ne_u32 vcc, 0x01010101, v93
    s_nop 0
    s_cbranch_vccz main_kernel_pollud_15
    s_sleep 12
    s_sub_u32 s4, s4, 1
    s_cmp_lg_u32 s4, 0
    s_cbranch_scc1 main_kernel_pollu_14
main_kernel_pollud_15:
    v_mfma_f32_16x16x32_bf16 v[236:239], v[80:83], v[60:63], v[236:239]
    s_waitcnt lgkmcnt(6)
    s_nop 0
    v_mfma_f32_16x16x32_bf16 v[240:243], v[84:87], v[48:51], v[240:243]
    ds_read_b128 v[76:79], v12 offset:6144
    v_mfma_f32_16x16x32_bf16 v[244:247], v[84:87], v[52:55], v[244:247]
    v_mfma_f32_16x16x32_bf16 v[248:251], v[84:87], v[56:59], v[248:251]
    v_mfma_f32_16x16x32_bf16 v[252:255], v[84:87], v[60:63], v[252:255]
    s_waitcnt lgkmcnt(3)
    s_nop 0
    v_mfma_f32_16x16x32_bf16 v[128:131], v[64:67], v[32:35], v[128:131]
    ds_read_b128 v[80:83], v12 offset:8192
    v_mfma_f32_16x16x32_bf16 v[132:135], v[64:67], v[36:39], v[132:135]
    v_mfma_f32_16x16x32_bf16 v[136:139], v[64:67], v[40:43], v[136:139]
    v_mfma_f32_16x16x32_bf16 v[140:143], v[64:67], v[44:47], v[140:143]
    s_waitcnt lgkmcnt(3)
    s_nop 0
    v_mfma_f32_16x16x32_bf16 v[144:147], v[68:71], v[32:35], v[144:147]
    ds_read_b128 v[84:87], v12 offset:10240
    v_mfma_f32_16x16x32_bf16 v[148:151], v[68:71], v[36:39], v[148:151]
    v_mfma_f32_16x16x32_bf16 v[152:155], v[68:71], v[40:43], v[152:155]
    s_waitcnt vmcnt(6)
    s_barrier
    v_mfma_f32_16x16x32_bf16 v[156:159], v[68:71], v[44:47], v[156:159]
    ds_read_b64_tr_b16 v[48:49], v16 offset:16384
    s_waitcnt lgkmcnt(4)
    s_nop 0
    v_mfma_f32_16x16x32_bf16 v[160:163], v[72:75], v[32:35], v[160:163]
    ds_read_b128 v[64:67], v12 offset:12288
    ds_read_b64_tr_b16 v[50:51], v16 offset:16896
    v_mfma_f32_16x16x32_bf16 v[164:167], v[72:75], v[36:39], v[164:167]
    ds_read_b64_tr_b16 v[52:53], v17 offset:16384
    s_add_u32 s43, s45, 7
    s_and_b32 s43, s43, 7
    s_lshl_b32 s43, s43, 19
    s_add_u32 s43, s43, 262144
    s_add_u32 m0, s41, 49152
    s_nop 0
    v_mfma_f32_16x16x32_bf16 v[168:171], v[72:75], v[40:43], v[168:171]
    ds_read_b64_tr_b16 v[54:55], v17 offset:16896
    v_mfma_f32_16x16x32_bf16 v[172:175], v[72:75], v[44:47], v[172:175]
    ds_read_b64_tr_b16 v[56:57], v18 offset:16384
    s_waitcnt lgkmcnt(8)
    s_nop 0
    v_mfma_f32_16x16x32_bf16 v[176:179], v[76:79], v[32:35], v[176:179]
    ds_read_b128 v[68:71], v12 offset:14336
    ds_read_b64_tr_b16 v[58:59], v18 offset:16896
    buffer_load_dwordx4 v8, s[16:19], s43 offen offset:0 lds
    v_mfma_f32_16x16x32_bf16 v[180:183], v[76:79], v[36:39], v[180:183]
    ds_read_b64_tr_b16 v[60:61], v19 offset:16384
    v_mfma_f32_16x16x32_bf16 v[184:187], v[76:79], v[40:43], v[184:187]
    ds_read_b64_tr_b16 v[62:63], v19 offset:16896
    v_mfma_f32_16x16x32_bf16 v[188:191], v[76:79], v[44:47], v[188:191]
    buffer_load_dwordx4 v9, s[16:19], s43 offen offset:1024 lds
    s_waitcnt lgkmcnt(11)
    s_nop 0
    v_mfma_f32_16x16x32_bf16 v[192:195], v[80:83], v[32:35], v[192:195]
    ds_read_b128 v[72:75], v14 offset:0
    v_mfma_f32_16x16x32_bf16 v[196:199], v[80:83], v[36:39], v[196:199]
    v_mfma_f32_16x16x32_bf16 v[200:203], v[80:83], v[40:43], v[200:203]
    s_add_u32 s42, s45, 0
    s_and_b32 s42, s42, 7
    s_lshl_b32 s42, s42, 7
    s_add_u32 m0, s40, 65536
    s_nop 0
    v_mfma_f32_16x16x32_bf16 v[204:207], v[80:83], v[44:47], v[204:207]
    s_waitcnt lgkmcnt(11)
    s_nop 0
    v_mfma_f32_16x16x32_bf16 v[208:211], v[84:87], v[32:35], v[208:211]
    ds_read_b128 v[76:79], v14 offset:2048
    v_mfma_f32_16x16x32_bf16 v[212:215], v[84:87], v[36:39], v[212:215]
    buffer_load_dwordx4 v4, s[68:71], s42 offen offset:0 lds
    v_mfma_f32_16x16x32_bf16 v[216:219], v[84:87], v[40:43], v[216:219]
    v_mfma_f32_16x16x32_bf16 v[220:223], v[84:87], v[44:47], v[220:223]
    s_waitcnt lgkmcnt(10)
    s_nop 0
    v_mfma_f32_16x16x32_bf16 v[224:227], v[64:67], v[32:35], v[224:227]
    ds_read_b128 v[80:83], v14 offset:4096
    buffer_load_dwordx4 v5, s[68:71], s42 offen offset:1024 lds
    v_mfma_f32_16x16x32_bf16 v[228:231], v[64:67], v[36:39], v[228:231]
    v_mfma_f32_16x16x32_bf16 v[232:235], v[64:67], v[40:43], v[232:235]
    s_lshl_b32 s3, s54, 12
    s_add_u32 s3, s3, 67108864
    v_lshlrev_b32 v92, 4, v0
    v_mfma_f32_16x16x32_bf16 v[236:239], v[64:67], v[44:47], v[236:239]
    buffer_load_dwordx4 v[88:91], v92, s[8:11], s3 offen
    s_waitcnt lgkmcnt(6)
    s_nop 0
    v_mfma_f32_16x16x32_bf16 v[240:243], v[68:71], v[32:35], v[240:243]
    ds_read_b128 v[84:87], v14 offset:6144
    v_mfma_f32_16x16x32_bf16 v[244:247], v[68:71], v[36:39], v[244:247]
    v_mfma_f32_16x16x32_bf16 v[248:251], v[68:71], v[40:43], v[248:251]
    v_mfma_f32_16x16x32_bf16 v[252:255], v[68:71], v[44:47], v[252:255]
    s_waitcnt lgkmcnt(3)
    s_nop 0
    v_mfma_f32_16x16x32_bf16 v[128:131], v[72:75], v[48:51], v[128:131]
    ds_read_b128 v[64:67], v14 offset:8192
    v_mfma_f32_16x16x32_bf16 v[132:135], v[72:75], v[52:55], v[132:135]
    v_mfma_f32_16x16x32_bf16 v[136:139], v[72:75], v[56:59], v[136:139]
    v_mfma_f32_16x16x32_bf16 v[140:143], v[72:75], v[60:63], v[140:143]
    s_waitcnt lgkmcnt(3)
    s_nop 0
    v_mfma_f32_16x16x32_bf16 v[144:147], v[76:79], v[48:51], v[144:147]
    ds_read_b128 v[68:71], v14 offset:10240
    v_mfma_f32_16x16x32_bf16 v[148:151], v[76:79], v[52:55], v[148:151]
    v_mfma_f32_16x16x32_bf16 v[152:155], v[76:79], v[56:59], v[152:155]
    s_waitcnt vmcnt(5)
    s_barrier
    v_mfma_f32_16x16x32_bf16 v[156:159], v[76:79], v[60:63], v[156:159]
    ds_read_b64_tr_b16 v[32:33], v16 offset:32768
    s_waitcnt lgkmcnt(4)
    s_nop 0
    v_mfma_f32_16x16x32_bf16 v[160:163], v[80:83], v[48:51], v[160:163]
    ds_read_b128 v[72:75], v14 offset:12288
    ds_read_b64_tr_b16 v[34:35], v16 offset:33280
    v_mfma_f32_16x16x32_bf16 v[164:167], v[80:83], v[52:55], v[164:167]
    ds_read_b64_tr_b16 v[36:37], v17 offset:32768
    s_add_u32 s43, s45, 0
    s_and_b32 s43, s43, 7
    s_lshl_b32 s43, s43, 19
    s_add_u32 m0, s41, 0
    v_mfma_f32_16x16x32_bf16 v[168:171], v[80:83], v[56:59], v[168:171]
    ds_read_b64_tr_b16 v[38:39], v17 offset:33280
    v_mfma_f32_16x16x32_bf16 v[172:175], v[80:83], v[60:63], v[172:175]
    ds_read_b64_tr_b16 v[40:41], v18 offset:32768
    s_waitcnt lgkmcnt(8)
    s_nop 0
    v_mfma_f32_16x16x32_bf16 v[176:179], v[84:87], v[48:51], v[176:179]
    ds_read_b128 v[76:79], v14 offset:14336
    ds_read_b64_tr_b16 v[42:43], v18 offset:33280
    buffer_load_dwordx4 v10, s[72:75], s43 offen offset:0 lds
    v_mfma_f32_16x16x32_bf16 v[180:183], v[84:87], v[52:55], v[180:183]
    ds_read_b64_tr_b16 v[44:45], v19 offset:32768
    v_mfma_f32_16x16x32_bf16 v[184:187], v[84:87], v[56:59], v[184:187]
    ds_read_b64_tr_b16 v[46:47], v19 offset:33280
    v_mfma_f32_16x16x32_bf16 v[188:191], v[84:87], v[60:63], v[188:191]
    buffer_load_dwordx4 v11, s[72:75], s43 offen offset:1024 lds
    s_waitcnt lgkmcnt(11)
    s_nop 0
    v_mfma_f32_16x16x32_bf16 v[192:195], v[64:67], v[48:51], v[192:195]
    ds_read_b128 v[80:83], v12 offset:32768
    v_mfma_f32_16x16x32_bf16 v[196:199], v[64:67], v[52:55], v[196:199]
    v_mfma_f32_16x16x32_bf16 v[200:203], v[64:67], v[56:59], v[200:203]
    s_add_u32 s42, s45, 0
    s_and_b32 s42, s42, 7
    s_lshl_b32 s42, s42, 7
    s_add_u32 m0, s40, 65536
    s_nop 0
    v_mfma_f32_16x16x32_bf16 v[204:207], v[64:67], v[60:63], v[204:207]
    s_waitcnt lgkmcnt(11)
    s_nop 0
    v_mfma_f32_16x16x32_bf16 v[208:211], v[68:71], v[48:51], v[208:211]
    ds_read_b128 v[84:87], v12 offset:34816
    v_mfma_f32_16x16x32_bf16 v[212:215], v[68:71], v[52:55], v[212:215]
    buffer_load_dwordx4 v6, s[68:71], s42 offen offset:2048 lds
    v_mfma_f32_16x16x32_bf16 v[216:219], v[68:71], v[56:59], v[216:219]
    v_mfma_f32_16x16x32_bf16 v[220:223], v[68:71], v[60:63], v[220:223]
    s_waitcnt lgkmcnt(10)
    s_nop 0
    v_mfma_f32_16x16x32_bf16 v[224:227], v[72:75], v[48:51], v[224:227]
    ds_read_b128 v[64:67], v12 offset:36864
    buffer_load_dwordx4 v7, s[68:71], s42 offen offset:3072 lds
    v_mfma_f32_16x16x32_bf16 v[228:231], v[72:75], v[52:55], v[228:231]
    v_mfma_f32_16x16x32_bf16 v[232:235], v[72:75], v[56:59], v[232:235]
    v_mfma_f32_16x16x32_bf16 v[236:239], v[72:75], v[60:63], v[236:239]
    s_waitcnt lgkmcnt(6)
    s_nop 0
    v_mfma_f32_16x16x32_bf16 v[240:243], v[76:79], v[48:51], v[240:243]
    ds_read_b128 v[68:71], v12 offset:38912
    v_mfma_f32_16x16x32_bf16 v[244:247], v[76:79], v[52:55], v[244:247]
    v_mfma_f32_16x16x32_bf16 v[248:251], v[76:79], v[56:59], v[248:251]
    v_mfma_f32_16x16x32_bf16 v[252:255], v[76:79], v[60:63], v[252:255]
    s_waitcnt lgkmcnt(3)
    s_nop 0
    v_mfma_f32_16x16x32_bf16 v[128:131], v[80:83], v[32:35], v[128:131]
    ds_read_b128 v[72:75], v12 offset:40960
    v_mfma_f32_16x16x32_bf16 v[132:135], v[80:83], v[36:39], v[132:135]
    v_mfma_f32_16x16x32_bf16 v[136:139], v[80:83], v[40:43], v[136:139]
    v_mfma_f32_16x16x32_bf16 v[140:143], v[80:83], v[44:47], v[140:143]
    s_waitcnt lgkmcnt(3)
    s_nop 0
    v_mfma_f32_16x16x32_bf16 v[144:147], v[84:87], v[32:35], v[144:147]
    ds_read_b128 v[76:79], v12 offset:43008
    v_mfma_f32_16x16x32_bf16 v[148:151], v[84:87], v[36:39], v[148:151]
    v_mfma_f32_16x16x32_bf16 v[152:155], v[84:87], v[40:43], v[152:155]
    s_waitcnt vmcnt(7)
    s_barrier
    v_mfma_f32_16x16x32_bf16 v[156:159], v[84:87], v[44:47], v[156:159]
    ds_read_b64_tr_b16 v[48:49], v16 offset:49152
    s_waitcnt lgkmcnt(4)
    s_nop 0
    v_mfma_f32_16x16x32_bf16 v[160:163], v[64:67], v[32:35], v[160:163]
    ds_read_b128 v[80:83], v12 offset:45056
    ds_read_b64_tr_b16 v[50:51], v16 offset:49664
    v_mfma_f32_16x16x32_bf16 v[164:167], v[64:67], v[36:39], v[164:167]
    ds_read_b64_tr_b16 v[52:53], v17 offset:49152
    s_add_u32 s43, s45, 1
    s_and_b32 s43, s43, 7
    s_lshl_b32 s43, s43, 19
    s_add_u32 m0, s41, 16384
    s_nop 0
    v_mfma_f32_16x16x32_bf16 v[168:171], v[64:67], v[40:43], v[168:171]
    ds_read_b64_tr_b16 v[54:55], v17 offset:49664
    v_mfma_f32_16x16x32_bf16 v[172:175], v[64:67], v[44:47], v[172:175]
    ds_read_b64_tr_b16 v[56:57], v18 offset:49152
    s_waitcnt lgkmcnt(8)
    s_nop 0
    v_mfma_f32_16x16x32_bf16 v[176:179], v[68:71], v[32:35], v[176:179]
    ds_read_b128 v[84:87], v12 offset:47104
    ds_read_b64_tr_b16 v[58:59], v18 offset:49664
    buffer_load_dwordx4 v10, s[72:75], s43 offen offset:0 lds
    v_mfma_f32_16x16x32_bf16 v[180:183], v[68:71], v[36:39], v[180:183]
    ds_read_b64_tr_b16 v[60:61], v19 offset:49152
    v_mfma_f32_16x16x32_bf16 v[184:187], v[68:71], v[40:43], v[184:187]
    ds_read_b64_tr_b16 v[62:63], v19 offset:49664
    v_mfma_f32_16x16x32_bf16 v[188:191], v[68:71], v[44:47], v[188:191]
    buffer_load_dwordx4 v11, s[72:75], s43 offen offset:1024 lds
    s_waitcnt lgkmcnt(11)
    s_nop 0
    v_mfma_f32_16x16x32_bf16 v[192:195], v[72:75], v[32:35], v[192:195]
    ds_read_b128 v[64:67], v14 offset:32768
    v_mfma_f32_16x16x32_bf16 v[196:199], v[72:75], v[36:39], v[196:199]
    v_mfma_f32_16x16x32_bf16 v[200:203], v[72:75], v[40:43], v[200:203]
    v_and_b32 v101, 255, v0
    v_lshlrev_b32 v92, 4, v101
    v_lshrrev_b32 v93, 8, v0
    v_mul_u32_u24 v102, 8704, v93
    v_add_u32 v92, v92, v102
    v_add_u32 v92, 0, v92
    v_mfma_f32_16x16x32_bf16 v[204:207], v[72:75], v[44:47], v[204:207]
    s_waitcnt lgkmcnt(11)
    s_nop 0
    v_mfma_f32_16x16x32_bf16 v[208:211], v[76:79], v[32:35], v[208:211]
    ds_read_b128 v[68:71], v14 offset:34816
    v_mfma_f32_16x16x32_bf16 v[212:215], v[76:79], v[36:39], v[212:215]
    s_waitcnt vmcnt(6)
    s_nop 0
    ds_write_b128 v92, v[88:91] offset:32
    v_alignbit_b32 v104, v89, v88, 16
    v_alignbit_b32 v105, v90, v89, 16
    v_alignbit_b32 v106, v91, v90, 16
    ds_write_b16 v92, v88 offset:4382
    ds_write_b64 v92, v[104:105] offset:4384
    ds_write_b32 v92, v106 offset:4392
    ds_write_b16_d16_hi v92, v91 offset:4396
    v_mfma_f32_16x16x32_bf16 v[216:219], v[76:79], v[40:43], v[216:219]
    v_mfma_f32_16x16x32_bf16 v[220:223], v[76:79], v[44:47], v[220:223]
    s_waitcnt lgkmcnt(15)
    s_nop 0
    v_mfma_f32_16x16x32_bf16 v[224:227], v[80:83], v[32:35], v[224:227]
    ds_read_b128 v[72:75], v14 offset:36864
    v_mov_b32 v24, v88
    v_mov_b32 v25, v89
    v_mov_b32 v26, v90
    v_mov_b32 v27, v91
    v_mfma_f32_16x16x32_bf16 v[228:231], v[80:83], v[36:39], v[228:231]
    v_mfma_f32_16x16x32_bf16 v[232:235], v[80:83], v[40:43], v[232:235]
    v_mfma_f32_16x16x32_bf16 v[236:239], v[80:83], v[44:47], v[236:239]
    v_mul_u32_u24 v93, 3072, v93
    v_lshl_add_u32 v93, v101, 2, v93
    ds_write_b32 v93, v28 offset:22016
    ds_write_b32 v93, v29 offset:23040
    ds_write_b32 v93, v30 offset:24064
    s_waitcnt lgkmcnt(14)
    s_nop 0
    v_mfma_f32_16x16x32_bf16 v[240:243], v[84:87], v[32:35], v[240:243]
    ds_read_b128 v[76:79], v14 offset:38912
    v_mfma_f32_16x16x32_bf16 v[244:247], v[84:87], v[36:39], v[244:247]
    v_mfma_f32_16x16x32_bf16 v[248:251], v[84:87], v[40:43], v[248:251]
    v_mfma_f32_16x16x32_bf16 v[252:255], v[84:87], v[44:47], v[252:255]
    s_waitcnt lgkmcnt(11)
    s_nop 0
    v_mfma_f32_16x16x32_bf16 v[128:131], v[64:67], v[48:51], v[128:131]
    ds_read_b128 v[80:83], v14 offset:40960
    v_mfma_f32_16x16x32_bf16 v[132:135], v[64:67], v[52:55], v[132:135]
    v_mfma_f32_16x16x32_bf16 v[136:139], v[64:67], v[56:59], v[136:139]
    v_mfma_f32_16x16x32_bf16 v[140:143], v[64:67], v[60:63], v[140:143]
    s_waitcnt lgkmcnt(11)
    s_nop 0
    v_mfma_f32_16x16x32_bf16 v[144:147], v[68:71], v[48:51], v[144:147]
    ds_read_b128 v[84:87], v14 offset:43008
    v_mfma_f32_16x16x32_bf16 v[148:151], v[68:71], v[52:55], v[148:151]
    v_mfma_f32_16x16x32_bf16 v[152:155], v[68:71], v[56:59], v[152:155]
    s_waitcnt vmcnt(2)
    s_barrier
    v_mfma_f32_16x16x32_bf16 v[156:159], v[68:71], v[60:63], v[156:159]
    s_waitcnt lgkmcnt(6)
    s_nop 0
    v_mfma_f32_16x16x32_bf16 v[160:163], v[72:75], v[48:51], v[160:163]
    ds_read_b128 v[64:67], v14 offset:45056
    v_mfma_f32_16x16x32_bf16 v[164:167], v[72:75], v[52:55], v[164:167]
    s_add_u32 s43, s45, 2
    s_and_b32 s43, s43, 7
    s_lshl_b32 s43, s43, 19
    s_add_u32 m0, s41, 32768
    s_nop 0
    v_mfma_f32_16x16x32_bf16 v[168:171], v[72:75], v[56:59], v[168:171]
    v_mfma_f32_16x16x32_bf16 v[172:175], v[72:75], v[60:63], v[172:175]
    s_waitcnt lgkmcnt(3)
    s_nop 0
    v_mfma_f32_16x16x32_bf16 v[176:179], v[76:79], v[48:51], v[176:179]
    ds_read_b128 v[68:71], v14 offset:47104
    buffer_load_dwordx4 v10, s[72:75], s43 offen offset:0 lds
    v_cvt_pk_bf16_f32 v88, v128, v129
    v_cvt_pk_bf16_f32 v89, v130, v131
    v_mfma_f32_16x16x32_bf16 v[180:183], v[76:79], v[52:55], v[180:183]
    v_cvt_pk_bf16_f32 v90, v144, v145
    v_cvt_pk_bf16_f32 v91, v146, v147
    v_cvt_pk_bf16_f32 v92, v132, v133
    v_cvt_pk_bf16_f32 v93, v134, v135
    v_mfma_f32_16x16x32_bf16 v[184:187], v[76:79], v[56:59], v[184:187]
    v_cvt_pk_bf16_f32 v94, v148, v149
    v_cvt_pk_bf16_f32 v95, v150, v151
    v_cvt_pk_bf16_f32 v96, v136, v137
    v_cvt_pk_bf16_f32 v97, v138, v139
    v_mfma_f32_16x16x32_bf16 v[188:191], v[76:79], v[60:63], v[188:191]
    buffer_load_dwordx4 v11, s[72:75], s43 offen offset:1024 lds
    v_cvt_pk_bf16_f32 v98, v152, v153
    v_cvt_pk_bf16_f32 v99, v154, v155
    v_cvt_pk_bf16_f32 v100, v140, v141
    v_cvt_pk_bf16_f32 v101, v142, v143
    s_waitcnt lgkmcnt(3)
    s_nop 0
    v_mfma_f32_16x16x32_bf16 v[192:195], v[80:83], v[48:51], v[192:195]
    v_cvt_pk_bf16_f32 v102, v156, v157
    v_cvt_pk_bf16_f32 v103, v158, v159
    v_mfma_f32_16x16x32_bf16 v[196:199], v[80:83], v[52:55], v[196:199]
    v_mfma_f32_16x16x32_bf16 v[200:203], v[80:83], v[56:59], v[200:203]
    v_mfma_f32_16x16x32_bf16 v[204:207], v[80:83], v[60:63], v[204:207]
    s_waitcnt lgkmcnt(2)
    s_nop 0
    v_mfma_f32_16x16x32_bf16 v[208:211], v[84:87], v[48:51], v[208:211]
    s_waitcnt lgkmcnt(0)
    s_barrier
    v_cvt_pk_bf16_f32 v104, v160, v161
    v_cvt_pk_bf16_f32 v105, v162, v163
    v_mfma_f32_16x16x32_bf16 v[212:215], v[84:87], v[52:55], v[212:215]
    s_add_u32 s42, s45, 1
    s_and_b32 s42, s42, 7
    s_lshl_b32 s42, s42, 7
    s_add_u32 m0, s40, 32768
    v_cvt_pk_bf16_f32 v106, v176, v177
    v_cvt_pk_bf16_f32 v107, v178, v179
    v_cvt_pk_bf16_f32 v108, v164, v165
    v_cvt_pk_bf16_f32 v109, v166, v167
    s_nop 0
    v_mfma_f32_16x16x32_bf16 v[216:219], v[84:87], v[56:59], v[216:219]
    buffer_load_dwordx4 v4, s[68:71], s42 offen offset:0 lds
    v_cvt_pk_bf16_f32 v110, v180, v181
    v_cvt_pk_bf16_f32 v111, v182, v183
    v_cvt_pk_bf16_f32 v112, v168, v169
    v_cvt_pk_bf16_f32 v113, v170, v171
    v_mfma_f32_16x16x32_bf16 v[220:223], v[84:87], v[60:63], v[220:223]
    buffer_load_dwordx4 v5, s[68:71], s42 offen offset:1024 lds
    v_cvt_pk_bf16_f32 v114, v184, v185
    v_cvt_pk_bf16_f32 v115, v186, v187
    v_cvt_pk_bf16_f32 v116, v172, v173
    v_cvt_pk_bf16_f32 v117, v174, v175
    v_mfma_f32_16x16x32_bf16 v[224:227], v[64:67], v[48:51], v[224:227]
    buffer_load_dwordx4 v6, s[68:71], s42 offen offset:2048 lds
    v_cvt_pk_bf16_f32 v118, v188, v189
    v_cvt_pk_bf16_f32 v119, v190, v191
    v_mfma_f32_16x16x32_bf16 v[228:231], v[64:67], v[52:55], v[228:231]
    buffer_load_dwordx4 v7, s[68:71], s42 offen offset:3072 lds
    v_mfma_f32_16x16x32_bf16 v[232:235], v[64:67], v[56:59], v[232:235]
    s_movk_i32 s53, 0
    buffer_store_dwordx4 v[88:91], v20, s[8:11], s53 offen offset:0 sc1
    s_nop 0
    v_mfma_f32_16x16x32_bf16 v[236:239], v[64:67], v[60:63], v[236:239]
    v_mfma_f32_16x16x32_bf16 v[240:243], v[68:71], v[48:51], v[240:243]
    v_cvt_pk_bf16_f32 v120, v192, v193
    v_cvt_pk_bf16_f32 v121, v194, v195
    s_movk_i32 s53, 0
    buffer_store_dwordx4 v[92:95], v20, s[8:11], s53 offen offset:1024 sc1
    s_nop 0
    v_mfma_f32_16x16x32_bf16 v[244:247], v[68:71], v[52:55], v[244:247]
    v_cvt_pk_bf16_f32 v122, v208, v209
    v_cvt_pk_bf16_f32 v123, v210, v211
    v_cvt_pk_bf16_f32 v124, v196, v197
    v_cvt_pk_bf16_f32 v125, v198, v199
    v_mfma_f32_16x16x32_bf16 v[248:251], v[68:71], v[56:59], v[248:251]
    v_cvt_pk_bf16_f32 v126, v212, v213
    v_cvt_pk_bf16_f32 v127, v214, v215
    s_movk_i32 s53, 0
    buffer_store_dwordx4 v[96:99], v31, s[8:11], s53 offen offset:0 sc1
    s_nop 0
    v_mfma_f32_16x16x32_bf16 v[252:255], v[68:71], v[60:63], v[252:255]
    v_cvt_pk_bf16_f32 v64, v200, v201
    v_cvt_pk_bf16_f32 v65, v202, v203
    v_cvt_pk_bf16_f32 v66, v216, v217
    v_cvt_pk_bf16_f32 v67, v218, v219
    v_cvt_pk_bf16_f32 v68, v204, v205
    v_cvt_pk_bf16_f32 v69, v206, v207
    v_cvt_pk_bf16_f32 v70, v220, v221
    v_cvt_pk_bf16_f32 v71, v222, v223
    v_cvt_pk_bf16_f32 v72, v224, v225
    v_cvt_pk_bf16_f32 v73, v226, v227
    v_cvt_pk_bf16_f32 v74, v240, v241
    v_cvt_pk_bf16_f32 v75, v242, v243
    v_cvt_pk_bf16_f32 v76, v228, v229
    v_cvt_pk_bf16_f32 v77, v230, v231
    v_cvt_pk_bf16_f32 v78, v244, v245
    v_cvt_pk_bf16_f32 v79, v246, v247
    v_cvt_pk_bf16_f32 v80, v232, v233
    v_cvt_pk_bf16_f32 v81, v234, v235
    v_cvt_pk_bf16_f32 v82, v248, v249
    v_cvt_pk_bf16_f32 v83, v250, v251
    v_cvt_pk_bf16_f32 v84, v236, v237
    v_cvt_pk_bf16_f32 v85, v238, v239
    v_cvt_pk_bf16_f32 v86, v252, v253
    v_cvt_pk_bf16_f32 v87, v254, v255
main_kernel_qphase_9:
    s_movk_i32 s53, 0
    buffer_store_dwordx4 v[100:103], v31, s[8:11], s53 offen offset:1024 sc1
    v_and_b32 v36, 255, v0
    v_and_b32 v37, 15, v2
    v_lshrrev_b32 v38, 4, v2
    s_lshr_b32 s5, s20, 2
    v_mov_b32 v48, 0
    v_mov_b32 v49, 0
    v_mov_b32 v50, 0
    v_mov_b32 v51, 0
    v_lshlrev_b32 v32, 1, v0
    v_add_u32 v32, 0, v32
    v_lshlrev_b32 v33, 4, v0
    v_add_u32 v34, 21504, v33
    v_add_u32 v33, 151552, v33
    v_cmp_gt_u32 vcc, 15, v0
    s_nop 0
    s_and_saveexec_b64 s[6:7], vcc
    ds_write_b16 v32, v48 offset:4352
    ds_write_b16 v32, v48 offset:13056
    s_mov_b64 exec, s[6:7]
    v_cmp_gt_u32 vcc, 16, v0
    s_nop 0
    s_and_saveexec_b64 s[6:7], vcc
    ds_write_b16 v32, v48
    ds_write_b16 v32, v48 offset:8704
    s_mov_b64 exec, s[6:7]
    v_cmp_gt_u32 vcc, 32, v0
    s_nop 0
    s_and_saveexec_b64 s[6:7], vcc
    ds_write_b128 v33, v[48:51]
    ds_write_b128 v33, v[48:51] offset:4608
    ds_write_b128 v33, v[48:51] offset:9216
    ds_write_b128 v34, v[48:51]
    s_mov_b64 exec, s[6:7]
    s_mul_i32 s3, s5, 3072
    s_add_u32 s3, s3, 22016
    v_or_b32 v204, 1, v36
    v_add_u32 v205, 1, v36
    v_ffbh_u32 v210, v205
    v_sub_u32 v210, 27, v210
    v_med3_i32 v210, v210, 0, 3
    v_lshrrev_b32 v207, 4, v205
    v_sub_u32 v211, 3, v210
    v_lshlrev_b32 v207, v211, v207
    v_lshl_add_u32 v207, v210, 3, v207
    v_and_b32 v211, 15, v205
    v_lshl_add_u32 v207, v207, 4, v211
    v_lshl_add_u32 v207, v207, 2, s3
    v_ffbh_u32 v208, v204
    v_sub_u32 v208, 27, v208
    v_med3_i32 v208, v208, 0, 3
    v_lshrrev_b32 v206, 4, v204
    v_sub_u32 v209, 3, v208
    v_lshlrev_b32 v206, v209, v206
    v_lshl_add_u32 v206, v208, 3, v206
    v_and_b32 v209, 15, v204
    v_lshl_add_u32 v206, v206, 4, v209
    v_lshl_add_u32 v206, v206, 2, s3
    v_and_b32 v209, 1, v36
    v_xor_b32 v204, 1, v209
    v_lshlrev_b32 v204, 2, v204
    v_sub_u32 v206, v206, v204
    v_mov_b32 v212, 0x76543210
    v_mov_b32 v213, 0
    v_mov_b32 v204, 0x03222100
    v_mov_b32 v205, 0x80
    v_cmp_eq_u32 vcc, 1, v208
    s_nop 1
    v_cndmask_b32 v212, v212, v204, vcc
    v_cndmask_b32 v213, v213, v205, vcc
    v_mov_b32 v204, 0x00111000
    v_mov_b32 v205, 0xc0
    v_cmp_eq_u32 vcc, 2, v208
    s_nop 1
    v_cndmask_b32 v212, v212, v204, vcc
    v_cndmask_b32 v213, v213, v205, vcc
    v_lshlrev_b32 v205, 4, v209
    v_or_b32 v205, 0xe0, v205
    v_cmp_eq_u32 vcc, 3, v208
    s_nop 1
    v_cndmask_b32 v212, v212, 0, vcc
    v_cndmask_b32 v213, v213, v205, vcc
    v_sub_u32 v207, v207, v206
    v_bfe_u32 v214, v212, 0, 4
    v_bfe_i32 v215, v213, 0, 1
    v_lshl_add_u32 v214, v214, 6, v206
    v_and_b32 v215, v215, v207
    v_add_u32 v40, v214, v215
    v_bfe_u32 v216, v212, 4, 4
    v_bfe_i32 v217, v213, 1, 1
    v_lshl_add_u32 v216, v216, 6, v206
    v_and_b32 v217, v217, v207
    v_add_u32 v41, v216, v217
    v_bfe_u32 v214, v212, 8, 4
    v_bfe_i32 v215, v213, 2, 1
    v_lshl_add_u32 v214, v214, 6, v206
    v_and_b32 v215, v215, v207
    v_add_u32 v42, v214, v215
    v_bfe_u32 v216, v212, 12, 4
    v_bfe_i32 v217, v213, 3, 1
    v_lshl_add_u32 v216, v216, 6, v206
    v_and_b32 v217, v217, v207
    v_add_u32 v43, v216, v217
    v_bfe_u32 v214, v212, 16, 4
    v_bfe_i32 v215, v213, 4, 1
    v_lshl_add_u32 v214, v214, 6, v206
    v_and_b32 v215, v215, v207
    v_add_u32 v44, v214, v215
    v_bfe_u32 v216, v212, 20, 4
    v_bfe_i32 v217, v213, 5, 1
    v_lshl_add_u32 v216, v216, 6, v206
    v_and_b32 v217, v217, v207
    v_add_u32 v45, v216, v217
    v_bfe_u32 v214, v212, 24, 4
    v_bfe_i32 v215, v213, 6, 1
    v_lshl_add_u32 v214, v214, 6, v206
    v_and_b32 v215, v215, v207
    v_add_u32 v46, v214, v215
    v_bfe_u32 v216, v212, 28, 4
    v_bfe_i32 v217, v213, 7, 1
    v_lshl_add_u32 v216, v216, 6, v206
    v_and_b32 v217, v217, v207
    v_add_u32 v47, v216, v217
    s_movk_i32 s53, 8192
    buffer_store_dwordx4 v[104:107], v20, s[8:11], s53 offen offset:0 sc1
    s_cmp_eq_u32 s5, 0
    s_mov_b32 s6, 156672
    s_cselect_b32 s6, 147456, s6
    s_mov_b32 s7, 17408
    s_cselect_b32 s7, 152064, s7
    s_waitcnt lgkmcnt(0)
    s_barrier
    s_nop 0
    ds_read_b32 v128, v40
    ds_read_b32 v132, v41
    ds_read_b32 v136, v42
    ds_read_b32 v140, v43
    ds_read_b32 v144, v44
    ds_read_b32 v148, v45
    ds_read_b32 v152, v46
    ds_read_b32 v156, v47
    v_add_u32 v32, 1, v37
    v_and_b32 v33, 1, v32
    v_sub_u32 v32, v32, v33
    v_lshlrev_b32 v32, 1, v32
    v_lshl_add_u32 v32, v38, 4, v32
    v_mul_u32_u24 v33, 4352, v33
    v_add_u32 v32, v32, v33
    s_and_b32 s4, s20, 3
    s_lshl_b32 s46, s4, 7
    s_mul_i32 s3, s5, 8704
    s_add_u32 s3, s3, 0
    s_add_u32 s3, s3, s46
    v_add_u32 v52, s3, v32
    v_lshlrev_b32 v32, 5, v37
    v_lshlrev_b32 v33, 4, v38
    v_sub_u32 v32, v33, v32
    v_add_u32 v32, 480, v32
    v_add_u32 v32, s46, v32
    v_add_u32 v53, s6, v32
    v_add_u32 v54, s7, v32
    s_waitcnt lgkmcnt(0)
    v_cvt_pk_bf16_f32 v160, v156, v152
    v_lshlrev_b32 v32, 16, v160
    v_and_b32 v33, 0xffff0000, v160
    v_sub_f32 v156, v156, v32
    v_sub_f32 v152, v152, v33
    v_cvt_pk_bf16_f32 v164, v156, v152
    v_cvt_pk_bf16_f32 v161, v148, v144
    v_lshlrev_b32 v32, 16, v161
    v_and_b32 v33, 0xffff0000, v161
    v_sub_f32 v148, v148, v32
    v_sub_f32 v144, v144, v33
    v_cvt_pk_bf16_f32 v165, v148, v144
    v_cvt_pk_bf16_f32 v162, v140, v136
    v_lshlrev_b32 v32, 16, v162
    v_and_b32 v33, 0xffff0000, v162
    v_sub_f32 v140, v140, v32
    v_sub_f32 v136, v136, v33
    v_cvt_pk_bf16_f32 v166, v140, v136
    v_cvt_pk_bf16_f32 v163, v132, v128
    v_lshlrev_b32 v32, 16, v163
    v_and_b32 v33, 0xffff0000, v163
    v_sub_f32 v132, v132, v32
    v_sub_f32 v128, v128, v33
    v_cvt_pk_bf16_f32 v167, v132, v128
    v_sub_u32 v32, 255, v36
    v_lshlrev_b32 v32, 4, v32
    v_add_u32 v33, s7, v32
    v_add_u32 v32, s6, v32
    ds_write_b128 v32, v[160:163]
    ds_write_b128 v33, v[164:167]
    ds_read_b32 v192, v52 offset:0
    ds_read_b32 v193, v52 offset:4
    ds_read_b32 v194, v52 offset:8
    ds_read_b32 v195, v52 offset:12
    ds_read_b32 v196, v52 offset:512
    ds_read_b32 v197, v52 offset:516
    ds_read_b32 v198, v52 offset:520
    ds_read_b32 v199, v52 offset:524
    ds_read_b32 v200, v52 offset:1024
    ds_read_b32 v201, v52 offset:1028
    ds_read_b32 v202, v52 offset:1032
    ds_read_b32 v203, v52 offset:1036
    ds_read_b32 v204, v52 offset:1536
    ds_read_b32 v205, v52 offset:1540
    ds_read_b32 v206, v52 offset:1544
    ds_read_b32 v207, v52 offset:1548
    ds_read_b32 v208, v52 offset:2048
    ds_read_b32 v209, v52 offset:2052
    ds_read_b32 v210, v52 offset:2056
    ds_read_b32 v211, v52 offset:2060
    ds_read_b32 v212, v52 offset:2560
    ds_read_b32 v213, v52 offset:2564
    ds_read_b32 v214, v52 offset:2568
    ds_read_b32 v215, v52 offset:2572
    ds_read_b32 v216, v52 offset:3072
    ds_read_b32 v217, v52 offset:3076
    ds_read_b32 v218, v52 offset:3080
    ds_read_b32 v219, v52 offset:3084
    ds_read_b32 v220, v52 offset:3584
    ds_read_b32 v221, v52 offset:3588
    ds_read_b32 v222, v52 offset:3592
    ds_read_b32 v223, v52 offset:3596
    s_movk_i32 s53, 8192
    buffer_store_dwordx4 v[108:111], v20, s[8:11], s53 offen offset:1024 sc1
    s_waitcnt lgkmcnt(0)
    s_barrier
    s_nop 0
    ds_read_b128 v[128:131], v53 offset:3584
    ds_read_b128 v[132:135], v54 offset:3584
    ds_read_b128 v[136:139], v53 offset:3072
    ds_read_b128 v[140:143], v54 offset:3072
    ds_read_b128 v[144:147], v53 offset:2560
    ds_read_b128 v[148:151], v54 offset:2560
    ds_read_b128 v[152:155], v53 offset:2048
    ds_read_b128 v[156:159], v54 offset:2048
    s_movk_i32 s53, 8192
    buffer_store_dwordx4 v[112:115], v31, s[8:11], s53 offen offset:0 sc1
    s_waitcnt lgkmcnt(6)
    v_mfma_f32_16x16x32_bf16 v[224:227], v[192:195], v[132:135], 0
    v_mfma_f32_16x16x32_bf16 v[228:231], v[196:199], v[132:135], 0
    v_mfma_f32_16x16x32_bf16 v[232:235], v[200:203], v[132:135], 0
    v_mfma_f32_16x16x32_bf16 v[236:239], v[204:207], v[132:135], 0
    v_mfma_f32_16x16x32_bf16 v[240:243], v[208:211], v[132:135], 0
    v_mfma_f32_16x16x32_bf16 v[244:247], v[212:215], v[132:135], 0
    v_mfma_f32_16x16x32_bf16 v[248:251], v[216:219], v[132:135], 0
    v_mfma_f32_16x16x32_bf16 v[252:255], v[220:223], v[132:135], 0
    v_mfma_f32_16x16x32_bf16 v[224:227], v[192:195], v[128:131], v[224:227]
    v_mfma_f32_16x16x32_bf16 v[228:231], v[196:199], v[128:131], v[228:231]
    v_mfma_f32_16x16x32_bf16 v[232:235], v[200:203], v[128:131], v[232:235]
    v_mfma_f32_16x16x32_bf16 v[236:239], v[204:207], v[128:131], v[236:239]
    v_mfma_f32_16x16x32_bf16 v[240:243], v[208:211], v[128:131], v[240:243]
    v_mfma_f32_16x16x32_bf16 v[244:247], v[212:215], v[128:131], v[244:247]
    v_mfma_f32_16x16x32_bf16 v[248:251], v[216:219], v[128:131], v[248:251]
    v_mfma_f32_16x16x32_bf16 v[252:255], v[220:223], v[128:131], v[252:255]
    ds_read_b128 v[128:131], v53 offset:1536
    ds_read_b128 v[132:135], v54 offset:1536
    s_movk_i32 s53, 8192
    buffer_store_dwordx4 v[116:119], v31, s[8:11], s53 offen offset:1024 sc1
    s_waitcnt lgkmcnt(6)
    v_mfma_f32_16x16x32_bf16 v[228:231], v[192:195], v[140:143], v[228:231]
    ds_read_b32 v160, v52 offset:64
    v_mfma_f32_16x16x32_bf16 v[232:235], v[196:199], v[140:143], v[232:235]
    ds_read_b32 v161, v52 offset:68
    v_mfma_f32_16x16x32_bf16 v[236:239], v[200:203], v[140:143], v[236:239]
    ds_read_b32 v162, v52 offset:72
    v_mfma_f32_16x16x32_bf16 v[240:243], v[204:207], v[140:143], v[240:243]
    ds_read_b32 v163, v52 offset:76
    v_mfma_f32_16x16x32_bf16 v[244:247], v[208:211], v[140:143], v[244:247]
    ds_read_b32 v164, v52 offset:576
    v_mfma_f32_16x16x32_bf16 v[248:251], v[212:215], v[140:143], v[248:251]
    ds_read_b32 v165, v52 offset:580
    v_mfma_f32_16x16x32_bf16 v[252:255], v[216:219], v[140:143], v[252:255]
    ds_read_b32 v166, v52 offset:584
    v_mfma_f32_16x16x32_bf16 v[228:231], v[192:195], v[136:139], v[228:231]
    ds_read_b32 v167, v52 offset:588
    v_mfma_f32_16x16x32_bf16 v[232:235], v[196:199], v[136:139], v[232:235]
    ds_read_b32 v168, v52 offset:1088
    v_mfma_f32_16x16x32_bf16 v[236:239], v[200:203], v[136:139], v[236:239]
    ds_read_b32 v169, v52 offset:1092
    v_mfma_f32_16x16x32_bf16 v[240:243], v[204:207], v[136:139], v[240:243]
    ds_read_b32 v170, v52 offset:1096
    v_mfma_f32_16x16x32_bf16 v[244:247], v[208:211], v[136:139], v[244:247]
    ds_read_b32 v171, v52 offset:1100
    v_mfma_f32_16x16x32_bf16 v[248:251], v[212:215], v[136:139], v[248:251]
    ds_read_b32 v172, v52 offset:1600
    v_mfma_f32_16x16x32_bf16 v[252:255], v[216:219], v[136:139], v[252:255]
    ds_read_b32 v173, v52 offset:1604
    ds_read_b128 v[136:139], v53 offset:1024
    ds_read_b128 v[140:143], v54 offset:1024
    s_movk_i32 s53, 16384
    buffer_store_dwordx4 v[120:123], v20, s[8:11], s53 offen offset:0 sc1
    s_waitcnt lgkmcnt(15)
    v_mfma_f32_16x16x32_bf16 v[232:235], v[192:195], v[148:151], v[232:235]
    ds_read_b32 v174, v52 offset:1608
    v_mfma_f32_16x16x32_bf16 v[236:239], v[196:199], v[148:151], v[236:239]
    ds_read_b32 v175, v52 offset:1612
    v_mfma_f32_16x16x32_bf16 v[240:243], v[200:203], v[148:151], v[240:243]
    ds_read_b32 v176, v52 offset:2112
    v_mfma_f32_16x16x32_bf16 v[244:247], v[204:207], v[148:151], v[244:247]
    ds_read_b32 v177, v52 offset:2116
    v_mfma_f32_16x16x32_bf16 v[248:251], v[208:211], v[148:151], v[248:251]
    ds_read_b32 v178, v52 offset:2120
    v_mfma_f32_16x16x32_bf16 v[252:255], v[212:215], v[148:151], v[252:255]
    ds_read_b32 v179, v52 offset:2124
    v_mfma_f32_16x16x32_bf16 v[232:235], v[192:195], v[144:147], v[232:235]
    ds_read_b32 v180, v52 offset:2624
    v_mfma_f32_16x16x32_bf16 v[236:239], v[196:199], v[144:147], v[236:239]
    ds_read_b32 v181, v52 offset:2628
    v_mfma_f32_16x16x32_bf16 v[240:243], v[200:203], v[144:147], v[240:243]
    ds_read_b32 v182, v52 offset:2632
    v_mfma_f32_16x16x32_bf16 v[244:247], v[204:207], v[144:147], v[244:247]
    ds_read_b32 v183, v52 offset:2636
    v_mfma_f32_16x16x32_bf16 v[248:251], v[208:211], v[144:147], v[248:251]
    ds_read_b32 v184, v52 offset:3136
    v_mfma_f32_16x16x32_bf16 v[252:255], v[212:215], v[144:147], v[252:255]
    ds_read_b32 v185, v52 offset:3140
    ds_read_b128 v[144:147], v53 offset:512
    ds_read_b128 v[148:151], v54 offset:512
    s_movk_i32 s53, 16384
    buffer_store_dwordx4 v[124:127], v20, s[8:11], s53 offen offset:1024 sc1
    s_waitcnt lgkmcnt(15)
    v_mfma_f32_16x16x32_bf16 v[236:239], v[192:195], v[156:159], v[236:239]
    ds_read_b32 v186, v52 offset:3144
    v_mfma_f32_16x16x32_bf16 v[240:243], v[196:199], v[156:159], v[240:243]
    ds_read_b32 v187, v52 offset:3148
    v_mfma_f32_16x16x32_bf16 v[244:247], v[200:203], v[156:159], v[244:247]
    ds_read_b32 v188, v52 offset:3648
    v_mfma_f32_16x16x32_bf16 v[248:251], v[204:207], v[156:159], v[248:251]
    ds_read_b32 v189, v52 offset:3652
    v_mfma_f32_16x16x32_bf16 v[252:255], v[208:211], v[156:159], v[252:255]
    ds_read_b32 v190, v52 offset:3656
    v_mfma_f32_16x16x32_bf16 v[236:239], v[192:195], v[152:155], v[236:239]
    ds_read_b32 v191, v52 offset:3660
    v_mfma_f32_16x16x32_bf16 v[240:243], v[196:199], v[152:155], v[240:243]
    v_mfma_f32_16x16x32_bf16 v[244:247], v[200:203], v[152:155], v[244:247]
    v_mfma_f32_16x16x32_bf16 v[248:251], v[204:207], v[152:155], v[248:251]
    v_mfma_f32_16x16x32_bf16 v[252:255], v[208:211], v[152:155], v[252:255]
    ds_read_b128 v[152:155], v53 offset:0
    ds_read_b128 v[156:159], v54 offset:0
    s_movk_i32 s53, 16384
    buffer_store_dwordx4 v[64:67], v31, s[8:11], s53 offen offset:0 sc1
    s_waitcnt lgkmcnt(15)
    v_mfma_f32_16x16x32_bf16 v[240:243], v[192:195], v[132:135], v[240:243]
    v_mfma_f32_16x16x32_bf16 v[244:247], v[196:199], v[132:135], v[244:247]
    v_mfma_f32_16x16x32_bf16 v[248:251], v[200:203], v[132:135], v[248:251]
    v_mfma_f32_16x16x32_bf16 v[252:255], v[204:207], v[132:135], v[252:255]
    v_mfma_f32_16x16x32_bf16 v[240:243], v[192:195], v[128:131], v[240:243]
    v_mfma_f32_16x16x32_bf16 v[244:247], v[196:199], v[128:131], v[244:247]
    v_mfma_f32_16x16x32_bf16 v[248:251], v[200:203], v[128:131], v[248:251]
    v_mfma_f32_16x16x32_bf16 v[252:255], v[204:207], v[128:131], v[252:255]
    ds_read_b128 v[128:131], v53 offset:3648
    ds_read_b128 v[132:135], v54 offset:3648
    s_movk_i32 s53, 16384
    buffer_store_dwordx4 v[68:71], v31, s[8:11], s53 offen offset:1024 sc1
    s_waitcnt lgkmcnt(15)
    v_mfma_f32_16x16x32_bf16 v[244:247], v[192:195], v[140:143], v[244:247]
    v_mfma_f32_16x16x32_bf16 v[248:251], v[196:199], v[140:143], v[248:251]
    v_mfma_f32_16x16x32_bf16 v[252:255], v[200:203], v[140:143], v[252:255]
    v_mfma_f32_16x16x32_bf16 v[244:247], v[192:195], v[136:139], v[244:247]
    v_mfma_f32_16x16x32_bf16 v[248:251], v[196:199], v[136:139], v[248:251]
    v_mfma_f32_16x16x32_bf16 v[252:255], v[200:203], v[136:139], v[252:255]
    ds_read_b128 v[136:139], v53 offset:3136
    ds_read_b128 v[140:143], v54 offset:3136
    s_movk_i32 s53, 24576
    buffer_store_dwordx4 v[72:75], v20, s[8:11], s53 offen offset:0 sc1
    s_waitcnt lgkmcnt(12)
    v_mfma_f32_16x16x32_bf16 v[248:251], v[192:195], v[148:151], v[248:251]
    v_mfma_f32_16x16x32_bf16 v[252:255], v[196:199], v[148:151], v[252:255]
    v_mfma_f32_16x16x32_bf16 v[248:251], v[192:195], v[144:147], v[248:251]
    v_mfma_f32_16x16x32_bf16 v[252:255], v[196:199], v[144:147], v[252:255]
    ds_read_b128 v[144:147], v53 offset:2624
    ds_read_b128 v[148:151], v54 offset:2624
    s_waitcnt lgkmcnt(6)
    s_nop 0
    v_mfma_f32_16x16x32_bf16 v[252:255], v[192:195], v[156:159], v[252:255]
    v_mfma_f32_16x16x32_bf16 v[252:255], v[192:195], v[152:155], v[252:255]
    ds_read_b128 v[152:155], v53 offset:2112
    ds_read_b128 v[156:159], v54 offset:2112
    s_movk_i32 s53, 24576
    buffer_store_dwordx4 v[76:79], v20, s[8:11], s53 offen offset:1024 sc1
    s_waitcnt lgkmcnt(6)
    v_mfma_f32_16x16x32_bf16 v[224:227], v[160:163], v[132:135], v[224:227]
    v_mfma_f32_16x16x32_bf16 v[228:231], v[164:167], v[132:135], v[228:231]
    v_mfma_f32_16x16x32_bf16 v[232:235], v[168:171], v[132:135], v[232:235]
    v_mfma_f32_16x16x32_bf16 v[236:239], v[172:175], v[132:135], v[236:239]
    v_mfma_f32_16x16x32_bf16 v[240:243], v[176:179], v[132:135], v[240:243]
    v_mfma_f32_16x16x32_bf16 v[244:247], v[180:183], v[132:135], v[244:247]
    v_mfma_f32_16x16x32_bf16 v[248:251], v[184:187], v[132:135], v[248:251]
    v_mfma_f32_16x16x32_bf16 v[252:255], v[188:191], v[132:135], v[252:255]
    v_mfma_f32_16x16x32_bf16 v[224:227], v[160:163], v[128:131], v[224:227]
    v_mfma_f32_16x16x32_bf16 v[228:231], v[164:167], v[128:131], v[228:231]
    v_mfma_f32_16x16x32_bf16 v[232:235], v[168:171], v[128:131], v[232:235]
    v_mfma_f32_16x16x32_bf16 v[236:239], v[172:175], v[128:131], v[236:239]
    v_mfma_f32_16x16x32_bf16 v[240:243], v[176:179], v[128:131], v[240:243]
    v_mfma_f32_16x16x32_bf16 v[244:247], v[180:183], v[128:131], v[244:247]
    v_mfma_f32_16x16x32_bf16 v[248:251], v[184:187], v[128:131], v[248:251]
    v_mfma_f32_16x16x32_bf16 v[252:255], v[188:191], v[128:131], v[252:255]
    ds_read_b128 v[128:131], v53 offset:1600
    ds_read_b128 v[132:135], v54 offset:1600
    s_movk_i32 s53, 24576
    buffer_store_dwordx4 v[80:83], v31, s[8:11], s53 offen offset:0 sc1
    s_waitcnt lgkmcnt(6)
    v_mfma_f32_16x16x32_bf16 v[228:231], v[160:163], v[140:143], v[228:231]
    v_mfma_f32_16x16x32_bf16 v[232:235], v[164:167], v[140:143], v[232:235]
    v_mfma_f32_16x16x32_bf16 v[236:239], v[168:171], v[140:143], v[236:239]
    v_mfma_f32_16x16x32_bf16 v[240:243], v[172:175], v[140:143], v[240:243]
    v_mfma_f32_16x16x32_bf16 v[244:247], v[176:179], v[140:143], v[244:247]
    v_mfma_f32_16x16x32_bf16 v[248:251], v[180:183], v[140:143], v[248:251]
    v_mfma_f32_16x16x32_bf16 v[252:255], v[184:187], v[140:143], v[252:255]
    v_mfma_f32_16x16x32_bf16 v[228:231], v[160:163], v[136:139], v[228:231]
    v_mfma_f32_16x16x32_bf16 v[232:235], v[164:167], v[136:139], v[232:235]
    v_mfma_f32_16x16x32_bf16 v[236:239], v[168:171], v[136:139], v[236:239]
    v_mfma_f32_16x16x32_bf16 v[240:243], v[172:175], v[136:139], v[240:243]
    v_mfma_f32_16x16x32_bf16 v[244:247], v[176:179], v[136:139], v[244:247]
    v_mfma_f32_16x16x32_bf16 v[248:251], v[180:183], v[136:139], v[248:251]
    v_mfma_f32_16x16x32_bf16 v[252:255], v[184:187], v[136:139], v[252:255]
    ds_read_b128 v[136:139], v53 offset:1088
    ds_read_b128 v[140:143], v54 offset:1088
    s_movk_i32 s53, 24576
    buffer_store_dwordx4 v[84:87], v31, s[8:11], s53 offen offset:1024 sc1
    s_waitcnt lgkmcnt(6)
    v_mfma_f32_16x16x32_bf16 v[232:235], v[160:163], v[148:151], v[232:235]
    v_mfma_f32_16x16x32_bf16 v[236:239], v[164:167], v[148:151], v[236:239]
    v_mfma_f32_16x16x32_bf16 v[240:243], v[168:171], v[148:151], v[240:243]
    v_mfma_f32_16x16x32_bf16 v[244:247], v[172:175], v[148:151], v[244:247]
    v_mfma_f32_16x16x32_bf16 v[248:251], v[176:179], v[148:151], v[248:251]
    v_mfma_f32_16x16x32_bf16 v[252:255], v[180:183], v[148:151], v[252:255]
    v_mfma_f32_16x16x32_bf16 v[232:235], v[160:163], v[144:147], v[232:235]
    v_mfma_f32_16x16x32_bf16 v[236:239], v[164:167], v[144:147], v[236:239]
    v_mfma_f32_16x16x32_bf16 v[240:243], v[168:171], v[144:147], v[240:243]
    v_mfma_f32_16x16x32_bf16 v[244:247], v[172:175], v[144:147], v[244:247]
    v_mfma_f32_16x16x32_bf16 v[248:251], v[176:179], v[144:147], v[248:251]
    v_mfma_f32_16x16x32_bf16 v[252:255], v[180:183], v[144:147], v[252:255]
    ds_read_b128 v[144:147], v53 offset:576
    ds_read_b128 v[148:151], v54 offset:576
    s_waitcnt lgkmcnt(6)
    s_nop 0
    v_mfma_f32_16x16x32_bf16 v[236:239], v[160:163], v[156:159], v[236:239]
    v_mfma_f32_16x16x32_bf16 v[240:243], v[164:167], v[156:159], v[240:243]
    v_mfma_f32_16x16x32_bf16 v[244:247], v[168:171], v[156:159], v[244:247]
    v_mfma_f32_16x16x32_bf16 v[248:251], v[172:175], v[156:159], v[248:251]
    v_mfma_f32_16x16x32_bf16 v[252:255], v[176:179], v[156:159], v[252:255]
    v_mfma_f32_16x16x32_bf16 v[236:239], v[160:163], v[152:155], v[236:239]
    v_mfma_f32_16x16x32_bf16 v[240:243], v[164:167], v[152:155], v[240:243]
    v_mfma_f32_16x16x32_bf16 v[244:247], v[168:171], v[152:155], v[244:247]
    v_mfma_f32_16x16x32_bf16 v[248:251], v[172:175], v[152:155], v[248:251]
    v_mfma_f32_16x16x32_bf16 v[252:255], v[176:179], v[152:155], v[252:255]
    ds_read_b128 v[152:155], v53 offset:64
    ds_read_b128 v[156:159], v54 offset:64
    s_waitcnt lgkmcnt(6)
    s_nop 0
    v_mfma_f32_16x16x32_bf16 v[240:243], v[160:163], v[132:135], v[240:243]
    v_mfma_f32_16x16x32_bf16 v[244:247], v[164:167], v[132:135], v[244:247]
    v_mfma_f32_16x16x32_bf16 v[248:251], v[168:171], v[132:135], v[248:251]
    v_mfma_f32_16x16x32_bf16 v[252:255], v[172:175], v[132:135], v[252:255]
    v_mfma_f32_16x16x32_bf16 v[240:243], v[160:163], v[128:131], v[240:243]
    v_mfma_f32_16x16x32_bf16 v[244:247], v[164:167], v[128:131], v[244:247]
    v_mfma_f32_16x16x32_bf16 v[248:251], v[168:171], v[128:131], v[248:251]
    v_mfma_f32_16x16x32_bf16 v[252:255], v[172:175], v[128:131], v[252:255]
    s_waitcnt lgkmcnt(4)
    s_nop 0
    v_mfma_f32_16x16x32_bf16 v[244:247], v[160:163], v[140:143], v[244:247]
    v_mfma_f32_16x16x32_bf16 v[248:251], v[164:167], v[140:143], v[248:251]
    v_mfma_f32_16x16x32_bf16 v[252:255], v[168:171], v[140:143], v[252:255]
    v_mfma_f32_16x16x32_bf16 v[244:247], v[160:163], v[136:139], v[244:247]
    v_mfma_f32_16x16x32_bf16 v[248:251], v[164:167], v[136:139], v[248:251]
    v_mfma_f32_16x16x32_bf16 v[252:255], v[168:171], v[136:139], v[252:255]
    s_waitcnt lgkmcnt(2)
    s_nop 0
    v_mfma_f32_16x16x32_bf16 v[248:251], v[160:163], v[148:151], v[248:251]
    v_mfma_f32_16x16x32_bf16 v[252:255], v[164:167], v[148:151], v[252:255]
    v_mfma_f32_16x16x32_bf16 v[248:251], v[160:163], v[144:147], v[248:251]
    v_mfma_f32_16x16x32_bf16 v[252:255], v[164:167], v[144:147], v[252:255]
    s_waitcnt lgkmcnt(0)
    s_nop 0
    v_mfma_f32_16x16x32_bf16 v[252:255], v[160:163], v[156:159], v[252:255]
    v_mfma_f32_16x16x32_bf16 v[252:255], v[160:163], v[152:155], v[252:255]
    s_and_b32 s46, s4, 1
    s_lshl_b32 s47, s5, 1
    s_add_u32 s46, s46, s47
    s_lshl_b32 s46, s46, 13
    s_add_u32 s46, s46, 0
    v_bfe_u32 v33, v37, 1, 2
    v_xor_b32 v33, v33, v38
    v_lshlrev_b32 v32, 6, v37
    v_lshl_add_u32 v32, v33, 4, v32
    v_add_u32_e64 v32, s46, v32
    s_barrier
    s_cmp_lt_u32 s4, 2
    s_cbranch_scc1 main_kernel_rlow_16
    ds_write_b128 v32, v[224:227] offset:0
    ds_write_b128 v32, v[228:231] offset:1024
    ds_write_b128 v32, v[232:235] offset:2048
    ds_write_b128 v32, v[236:239] offset:3072
    ds_write_b128 v32, v[240:243] offset:4096
    ds_write_b128 v32, v[244:247] offset:5120
    ds_write_b128 v32, v[248:251] offset:6144
    ds_write_b128 v32, v[252:255] offset:7168
    s_waitcnt lgkmcnt(0)
    s_barrier
    s_branch main_kernel_rjoin_17
main_kernel_rlow_16:
    s_barrier
    ds_read_b128 v[128:131], v32 offset:0
    ds_read_b128 v[132:135], v32 offset:1024
    ds_read_b128 v[136:139], v32 offset:2048
    ds_read_b128 v[140:143], v32 offset:3072
    ds_read_b128 v[144:147], v32 offset:4096
    ds_read_b128 v[148:151], v32 offset:5120
    ds_read_b128 v[152:155], v32 offset:6144
    ds_read_b128 v[156:159], v32 offset:7168
    s_waitcnt lgkmcnt(7)
    v_add_f32 v224, v224, v128
    v_add_f32 v225, v225, v129
    v_add_f32 v226, v226, v130
    v_add_f32_e64 v227, v227, v131
    ds_write_b128 v32, v[224:227] offset:0
    s_waitcnt lgkmcnt(7)
    v_add_f32 v228, v228, v132
    v_add_f32 v229, v229, v133
    v_add_f32 v230, v230, v134
    v_add_f32_e64 v231, v231, v135
    ds_write_b128 v32, v[228:231] offset:1024
    s_waitcnt lgkmcnt(7)
    v_add_f32 v232, v232, v136
    v_add_f32 v233, v233, v137
    v_add_f32 v234, v234, v138
    v_add_f32_e64 v235, v235, v139
    ds_write_b128 v32, v[232:235] offset:2048
    s_waitcnt lgkmcnt(7)
    v_add_f32 v236, v236, v140
    v_add_f32 v237, v237, v141
    v_add_f32 v238, v238, v142
    v_add_f32_e64 v239, v239, v143
    ds_write_b128 v32, v[236:239] offset:3072
    s_waitcnt lgkmcnt(7)
    v_add_f32 v240, v240, v144
    v_add_f32 v241, v241, v145
    v_add_f32 v242, v242, v146
    v_add_f32_e64 v243, v243, v147
    ds_write_b128 v32, v[240:243] offset:4096
    s_waitcnt lgkmcnt(7)
    v_add_f32 v244, v244, v148
    v_add_f32 v245, v245, v149
    v_add_f32 v246, v246, v150
    v_add_f32_e64 v247, v247, v151
    ds_write_b128 v32, v[244:247] offset:5120
    s_waitcnt lgkmcnt(7)
    v_add_f32 v248, v248, v152
    v_add_f32 v249, v249, v153
    v_add_f32 v250, v250, v154
    v_add_f32_e64 v251, v251, v155
    ds_write_b128 v32, v[248:251] offset:6144
    s_waitcnt lgkmcnt(7)
    v_add_f32 v252, v252, v156
    v_add_f32 v253, v253, v157
    v_add_f32 v254, v254, v158
    v_add_f32_e64 v255, v255, v159
    ds_write_b128 v32, v[252:255] offset:7168
main_kernel_rjoin_17:
    s_lshl_b32 s46, s47, 13
    s_add_u32 s46, s46, 0
    v_lshrrev_b32 v32, 1, v36
    v_lshlrev_b32 v32, 6, v32
    v_add_u32 v32, s46, v32
    v_bfe_u32 v34, v36, 2, 2
    v_and_b32 v35, 1, v36
    v_lshlrev_b32 v35, 1, v35
    v_xor_b32 v34, v34, v35
    v_xor_b32 v35, 1, v34
    v_lshl_add_u32 v35, v35, 4, v32
    v_lshl_add_u32 v32, v34, 4, v32
    s_lshr_b32 s48, s55, 16
    s_cmp_eq_u32 s5, 0
    s_cselect_b32 s48, s55, s48
    s_lshl_b32 s48, s48, 16
    s_lshl_b32 s49, s54, 12
    s_add_u32 s49, s49, 69206016
    v_lshlrev_b32_e64 v33, 4, v0
    s_waitcnt lgkmcnt(0)
    s_barrier
    ds_read_b128 v[128:131], v32 offset:0
    ds_read_b128 v[132:135], v35 offset:0
    ds_read_b128 v[136:139], v32 offset:8192
    ds_read_b128 v[140:143], v35 offset:8192
    v_lshlrev_b32 v44, 16, v24
    v_and_b32 v46, 0xffff0000, v24
    v_lshlrev_b32 v48, 16, v25
    v_and_b32 v50, 0xffff0000, v25
    v_lshlrev_b32 v52, 16, v26
    v_and_b32 v54, 0xffff0000, v26
    v_lshlrev_b32 v56, 16, v27
    v_and_b32 v58, 0xffff0000, v27
    v_mul_f32 v44, s48, v44
    v_mul_f32 v46, s48, v46
    v_mul_f32 v48, s48, v48
    v_mul_f32 v50, s48, v50
    v_mul_f32 v52, s48, v52
    v_mul_f32 v54, s48, v54
    v_mul_f32 v56, s48, v56
    v_mul_f32 v58, s48, v58
    s_waitcnt lgkmcnt(1)
    v_add_f32 v128, v128, v136
    v_add_f32 v129, v129, v137
    v_add_f32 v130, v130, v138
    v_add_f32 v131, v131, v139
    s_waitcnt lgkmcnt(0)
    v_add_f32 v132, v132, v140
    v_add_f32 v133, v133, v141
    v_add_f32 v134, v134, v142
    v_add_f32 v135, v135, v143
    v_cvt_pk_bf16_f32 v44, v44, v128
    v_cvt_pk_bf16_f32 v46, v46, v129
    v_cvt_pk_bf16_f32 v48, v48, v130
    v_cvt_pk_bf16_f32 v50, v50, v131
    v_cvt_pk_bf16_f32 v52, v52, v132
    v_cvt_pk_bf16_f32 v54, v54, v133
    v_cvt_pk_bf16_f32 v56, v56, v134
    v_cvt_pk_bf16_f32 v58, v58, v135
    v_lshlrev_b32 v45, 16, v44
    v_lshlrev_b32 v47, 16, v46
    v_lshlrev_b32 v49, 16, v48
    v_lshlrev_b32 v51, 16, v50
    v_lshlrev_b32 v53, 16, v52
    v_lshlrev_b32 v55, 16, v54
    v_lshlrev_b32 v57, 16, v56
    v_lshlrev_b32 v59, 16, v58
    v_and_b32 v44, 0xffff0000, v44
    v_and_b32 v46, 0xffff0000, v46
    v_and_b32 v48, 0xffff0000, v48
    v_and_b32 v50, 0xffff0000, v50
    v_and_b32 v52, 0xffff0000, v52
    v_and_b32 v54, 0xffff0000, v54
    v_and_b32 v56, 0xffff0000, v56
    v_and_b32 v58, 0xffff0000, v58
    v_add_f32 v128, v44, v45
    v_add_f32 v129, v46, v47
    v_add_f32 v130, v48, v49
    v_add_f32 v131, v50, v51
    v_add_f32 v132, v52, v53
    v_add_f32 v133, v54, v55
    v_add_f32 v134, v56, v57
    v_add_f32 v135, v58, v59
    v_cvt_pk_bf16_f32 v40, v128, v129
    v_cvt_pk_bf16_f32 v41, v130, v131
    v_cvt_pk_bf16_f32 v42, v132, v133
    v_cvt_pk_bf16_f32 v43, v134, v135
    buffer_store_dwordx4 v[40:43], v33, s[8:11], s49 offen sc1
    s_waitcnt lgkmcnt(0)
    s_barrier
    s_mov_b32 s53, 1040356334
    s_lshr_b32 s46, s20, 1
    s_lshl_b32 s46, s46, 13
    s_and_b32 s47, s20, 1
    s_lshl_b32 s47, s47, 13
    v_lshrrev_b32 v23, 4, v2
    v_and_b32 v24, 15, v2
    v_lshrrev_b32 v25, 1, v24
    v_xor_b32 v25, v25, v23
    v_lshlrev_b32 v24, 7, v24
    v_add_u32 v24, s46, v24
    v_xor_b32 v26, 0, v25
    v_lshlrev_b32 v26, 4, v26
    v_add_u32 v12, v24, v26
    v_add_u32 v13, 0x10000, v12
    v_xor_b32 v26, 4, v25
    v_lshlrev_b32 v26, 4, v26
    v_add_u32 v14, v24, v26
    v_add_u32 v15, 0x10000, v14
    v_and_b32 v24, 15, v2
    v_lshrrev_b32 v25, 2, v24
    v_and_b32 v24, 3, v24
    v_lshlrev_b32 v24, 3, v24
    v_lshlrev_b32 v26, 7, v25
    v_add_u32 v24, v24, v26
    v_lshlrev_b32 v26, 10, v23
    v_add_u32 v24, v24, v26
    v_lshrrev_b32 v25, 1, v25
    v_and_b32 v26, 1, v23
    v_lshlrev_b32 v26, 1, v26
    v_or_b32 v25, v25, v26
    v_add_u32 v24, s47, v24
    v_add_u32 v24, 98304, v24
    v_xor_b32 v26, 0, v25
    v_lshlrev_b32 v26, 5, v26
    v_add_u32 v16, v24, v26
    v_xor_b32 v26, 1, v25
    v_lshlrev_b32 v26, 5, v26
    v_add_u32 v17, v24, v26
    v_xor_b32 v26, 2, v25
    v_lshlrev_b32 v26, 5, v26
    v_add_u32 v18, v24, v26
    v_xor_b32 v26, 3, v25
    v_lshlrev_b32 v26, 5, v26
    v_add_u32 v19, v24, v26
    s_add_u32 s42, s45, 2
    s_and_b32 s42, s42, 7
    s_lshl_b32 s42, s42, 7
    s_add_u32 m0, s40, 0
    s_nop 0
    buffer_load_dwordx4 v4, s[68:71], s42 offen offset:0 lds
    buffer_load_dwordx4 v5, s[68:71], s42 offen offset:1024 lds
    buffer_load_dwordx4 v6, s[68:71], s42 offen offset:2048 lds
    buffer_load_dwordx4 v7, s[68:71], s42 offen offset:3072 lds
    ds_read_b64_tr_b16 v[144:145], v16 offset:0
    ds_read_b64_tr_b16 v[146:147], v16 offset:512
    ds_read_b128 v[128:131], v13 offset:0
    ds_read_b64_tr_b16 v[148:149], v17 offset:0
    ds_read_b64_tr_b16 v[150:151], v17 offset:512
    ds_read_b128 v[132:135], v13 offset:2048
    ds_read_b64_tr_b16 v[152:153], v18 offset:0
    ds_read_b64_tr_b16 v[154:155], v18 offset:512
    ds_read_b128 v[136:139], v13 offset:4096
    ds_read_b64_tr_b16 v[156:157], v19 offset:0
    ds_read_b64_tr_b16 v[158:159], v19 offset:512
    ds_read_b128 v[140:143], v13 offset:6144
    s_waitcnt lgkmcnt(9)
    s_nop 0
    v_mfma_f32_16x16x32_bf16 v[192:195], v[144:147], v[128:131], 0
    ds_read_b64_tr_b16 v[176:177], v16 offset:4096
    ds_read_b64_tr_b16 v[178:179], v16 offset:4608
    s_waitcnt lgkmcnt(9)
    s_nop 0
    v_mfma_f32_16x16x32_bf16 v[196:199], v[148:151], v[128:131], 0
    ds_read_b128 v[160:163], v15 offset:0
    s_waitcnt lgkmcnt(7)
    s_nop 0
    v_mfma_f32_16x16x32_bf16 v[200:203], v[152:155], v[128:131], 0
    ds_read_b64_tr_b16 v[180:181], v17 offset:4096
    ds_read_b64_tr_b16 v[182:183], v17 offset:4608
    s_waitcnt lgkmcnt(6)
    s_nop 0
    v_mfma_f32_16x16x32_bf16 v[204:207], v[156:159], v[128:131], 0
    ds_read_b128 v[164:167], v15 offset:2048
    v_mfma_f32_16x16x32_bf16 v[208:211], v[144:147], v[132:135], 0
    ds_read_b64_tr_b16 v[184:185], v18 offset:4096
    ds_read_b64_tr_b16 v[186:187], v18 offset:4608
    v_mfma_f32_16x16x32_bf16 v[212:215], v[148:151], v[132:135], 0
    ds_read_b128 v[168:171], v15 offset:4096
    v_mfma_f32_16x16x32_bf16 v[216:219], v[152:155], v[132:135], 0
    ds_read_b64_tr_b16 v[188:189], v19 offset:4096
    ds_read_b64_tr_b16 v[190:191], v19 offset:4608
    v_mfma_f32_16x16x32_bf16 v[220:223], v[156:159], v[132:135], 0
    ds_read_b128 v[172:175], v15 offset:6144
    v_mfma_f32_16x16x32_bf16 v[224:227], v[144:147], v[136:139], 0
    v_mfma_f32_16x16x32_bf16 v[228:231], v[148:151], v[136:139], 0
    v_mfma_f32_16x16x32_bf16 v[232:235], v[152:155], v[136:139], 0
    v_mfma_f32_16x16x32_bf16 v[236:239], v[156:159], v[136:139], 0
    s_waitcnt lgkmcnt(12)
    s_nop 0
    v_mfma_f32_16x16x32_bf16 v[240:243], v[144:147], v[140:143], 0
    v_mfma_f32_16x16x32_bf16 v[244:247], v[148:151], v[140:143], 0
    v_mfma_f32_16x16x32_bf16 v[248:251], v[152:155], v[140:143], 0
    v_mfma_f32_16x16x32_bf16 v[252:255], v[156:159], v[140:143], 0
    s_waitcnt lgkmcnt(9)
    s_nop 0
    v_mfma_f32_16x16x32_bf16 v[192:195], v[176:179], v[160:163], v[192:195]
    s_waitcnt lgkmcnt(7)
    s_nop 0
    v_mfma_f32_16x16x32_bf16 v[196:199], v[180:183], v[160:163], v[196:199]
    s_waitcnt vmcnt(21) lgkmcnt(0)
    s_barrier
    ds_read_b64_tr_b16 v[144:145], v16 offset:16384
    ds_read_b64_tr_b16 v[146:147], v16 offset:16896
    v_mfma_f32_16x16x32_bf16 v[200:203], v[184:187], v[160:163], v[200:203]
    ds_read_b128 v[128:131], v12 offset:32768
    v_mfma_f32_16x16x32_bf16 v[204:207], v[188:191], v[160:163], v[204:207]
    ds_read_b64_tr_b16 v[148:149], v17 offset:16384
    ds_read_b64_tr_b16 v[150:151], v17 offset:16896
    s_add_u32 s43, s45, 3
    s_and_b32 s43, s43, 7
    s_lshl_b32 s43, s43, 19
    s_add_u32 m0, s41, 49152
    s_nop 0
    v_mfma_f32_16x16x32_bf16 v[208:211], v[176:179], v[164:167], v[208:211]
    ds_read_b128 v[132:135], v12 offset:34816
    buffer_load_dwordx4 v10, s[72:75], s43 offen offset:0 lds
    v_mfma_f32_16x16x32_bf16 v[212:215], v[180:183], v[164:167], v[212:215]
    ds_read_b64_tr_b16 v[152:153], v18 offset:16384
    ds_read_b64_tr_b16 v[154:155], v18 offset:16896
    v_mfma_f32_16x16x32_bf16 v[216:219], v[184:187], v[164:167], v[216:219]
    ds_read_b128 v[136:139], v12 offset:36864
    buffer_load_dwordx4 v11, s[72:75], s43 offen offset:1024 lds
    v_mfma_f32_16x16x32_bf16 v[220:223], v[188:191], v[164:167], v[220:223]
    ds_read_b64_tr_b16 v[156:157], v19 offset:16384
    ds_read_b64_tr_b16 v[158:159], v19 offset:16896
    s_add_u32 s42, s45, 3
    s_and_b32 s42, s42, 7
    s_lshl_b32 s42, s42, 7
    s_add_u32 m0, s40, 65536
    s_nop 0
    v_mfma_f32_16x16x32_bf16 v[224:227], v[176:179], v[168:171], v[224:227]
    ds_read_b128 v[140:143], v12 offset:38912
    v_mfma_f32_16x16x32_bf16 v[228:231], v[180:183], v[168:171], v[228:231]
    buffer_load_dwordx4 v4, s[68:71], s42 offen offset:0 lds
    v_mfma_f32_16x16x32_bf16 v[232:235], v[184:187], v[168:171], v[232:235]
    buffer_load_dwordx4 v5, s[68:71], s42 offen offset:1024 lds
    v_mfma_f32_16x16x32_bf16 v[236:239], v[188:191], v[168:171], v[236:239]
    v_mfma_f32_16x16x32_bf16 v[240:243], v[176:179], v[172:175], v[240:243]
    buffer_load_dwordx4 v6, s[68:71], s42 offen offset:2048 lds
    v_mfma_f32_16x16x32_bf16 v[244:247], v[180:183], v[172:175], v[244:247]
    buffer_load_dwordx4 v7, s[68:71], s42 offen offset:3072 lds
    v_mfma_f32_16x16x32_bf16 v[248:251], v[184:187], v[172:175], v[248:251]
    v_mfma_f32_16x16x32_bf16 v[252:255], v[188:191], v[172:175], v[252:255]
    s_waitcnt lgkmcnt(9)
    s_nop 0
    v_mfma_f32_16x16x32_bf16 v[192:195], v[144:147], v[128:131], v[192:195]
    ds_read_b64_tr_b16 v[176:177], v16 offset:20480
    ds_read_b64_tr_b16 v[178:179], v16 offset:20992
    s_waitcnt lgkmcnt(9)
    s_nop 0
    v_mfma_f32_16x16x32_bf16 v[196:199], v[148:151], v[128:131], v[196:199]
    ds_read_b128 v[160:163], v14 offset:32768
    s_waitcnt lgkmcnt(7)
    s_nop 0
    v_mfma_f32_16x16x32_bf16 v[200:203], v[152:155], v[128:131], v[200:203]
    ds_read_b64_tr_b16 v[180:181], v17 offset:20480
    ds_read_b64_tr_b16 v[182:183], v17 offset:20992
    s_waitcnt lgkmcnt(6)
    s_nop 0
    v_mfma_f32_16x16x32_bf16 v[204:207], v[156:159], v[128:131], v[204:207]
    ds_read_b128 v[164:167], v14 offset:34816
    v_mfma_f32_16x16x32_bf16 v[208:211], v[144:147], v[132:135], v[208:211]
    ds_read_b64_tr_b16 v[184:185], v18 offset:20480
    ds_read_b64_tr_b16 v[186:187], v18 offset:20992
    v_mfma_f32_16x16x32_bf16 v[212:215], v[148:151], v[132:135], v[212:215]
    ds_read_b128 v[168:171], v14 offset:36864
    v_mfma_f32_16x16x32_bf16 v[216:219], v[152:155], v[132:135], v[216:219]
    ds_read_b64_tr_b16 v[188:189], v19 offset:20480
    ds_read_b64_tr_b16 v[190:191], v19 offset:20992
    v_mfma_f32_16x16x32_bf16 v[220:223], v[156:159], v[132:135], v[220:223]
    ds_read_b128 v[172:175], v14 offset:38912
    v_mfma_f32_16x16x32_bf16 v[224:227], v[144:147], v[136:139], v[224:227]
    v_mfma_f32_16x16x32_bf16 v[228:231], v[148:151], v[136:139], v[228:231]
    v_mfma_f32_16x16x32_bf16 v[232:235], v[152:155], v[136:139], v[232:235]
    v_mfma_f32_16x16x32_bf16 v[236:239], v[156:159], v[136:139], v[236:239]
    s_waitcnt lgkmcnt(12)
    s_nop 0
    v_mfma_f32_16x16x32_bf16 v[240:243], v[144:147], v[140:143], v[240:243]
    v_mfma_f32_16x16x32_bf16 v[244:247], v[148:151], v[140:143], v[244:247]
    v_mfma_f32_16x16x32_bf16 v[248:251], v[152:155], v[140:143], v[248:251]
    v_mfma_f32_16x16x32_bf16 v[252:255], v[156:159], v[140:143], v[252:255]
    s_waitcnt lgkmcnt(9)
    s_nop 0
    v_mfma_f32_16x16x32_bf16 v[192:195], v[176:179], v[160:163], v[192:195]
    s_waitcnt lgkmcnt(7)
    s_nop 0
    v_mfma_f32_16x16x32_bf16 v[196:199], v[180:183], v[160:163], v[196:199]
    s_waitcnt vmcnt(6) lgkmcnt(0)
    s_barrier
    s_cmp_lg_u32 s20, 0
    s_cbranch_scc1 main_kernel_nkv_21
    s_lshl_b32 s3, s21, 3
    v_add_u32 v21, s3, v2
    v_lshlrev_b32 v21, 7, v21
    v_add_u32 v21, s22, v21
    s_add_u32 s4, s3, s22
    s_and_b32 s5, s4, 31
    s_add_u32 s5, s5, 64
    s_andn2_b32 s4, s4, 31
    s_sub_u32 s4, s4, 32
    v_add_u32 v22, s4, v2
    v_lshlrev_b32 v22, 7, v22
    v_add_u32 v22, s5, v22
    v_cmp_gt_u32 vcc, 32, v2
    s_nop 1
    v_cndmask_b32 v21, v22, v21, vcc
    v_mov_b32 v22, 1
    s_mov_b32 s3, 71303168
    s_mov_b32 exec_lo, 0xff
    buffer_store_byte v22, v21, s[8:11], s3 offen sc1
    s_mov_b32 exec_lo, -1
main_kernel_nkv_21:
    s_nop 0
    ds_read_b64_tr_b16 v[144:145], v16 offset:32768
    ds_read_b64_tr_b16 v[146:147], v16 offset:33280
    v_mfma_f32_16x16x32_bf16 v[200:203], v[184:187], v[160:163], v[200:203]
    ds_read_b128 v[128:131], v12 offset:0
    v_mfma_f32_16x16x32_bf16 v[204:207], v[188:191], v[160:163], v[204:207]
    ds_read_b64_tr_b16 v[148:149], v17 offset:32768
    ds_read_b64_tr_b16 v[150:151], v17 offset:33280
    s_add_u32 s43, s45, 4
    s_and_b32 s43, s43, 7
    s_lshl_b32 s43, s43, 19
    s_add_u32 m0, s41, 0
    v_mfma_f32_16x16x32_bf16 v[208:211], v[176:179], v[164:167], v[208:211]
    ds_read_b128 v[132:135], v12 offset:2048
    buffer_load_dwordx4 v10, s[72:75], s43 offen offset:0 lds
    v_mfma_f32_16x16x32_bf16 v[212:215], v[180:183], v[164:167], v[212:215]
    ds_read_b64_tr_b16 v[152:153], v18 offset:32768
    ds_read_b64_tr_b16 v[154:155], v18 offset:33280
    v_mfma_f32_16x16x32_bf16 v[216:219], v[184:187], v[164:167], v[216:219]
    ds_read_b128 v[136:139], v12 offset:4096
    buffer_load_dwordx4 v11, s[72:75], s43 offen offset:1024 lds
    v_mfma_f32_16x16x32_bf16 v[220:223], v[188:191], v[164:167], v[220:223]
    ds_read_b64_tr_b16 v[156:157], v19 offset:32768
    ds_read_b64_tr_b16 v[158:159], v19 offset:33280
    s_add_u32 s42, s45, 4
    s_and_b32 s42, s42, 7
    s_lshl_b32 s42, s42, 7
    s_add_u32 m0, s40, 32768
    s_nop 0
    v_mfma_f32_16x16x32_bf16 v[224:227], v[176:179], v[168:171], v[224:227]
    ds_read_b128 v[140:143], v12 offset:6144
    v_mfma_f32_16x16x32_bf16 v[228:231], v[180:183], v[168:171], v[228:231]
    buffer_load_dwordx4 v4, s[68:71], s42 offen offset:0 lds
    v_mfma_f32_16x16x32_bf16 v[232:235], v[184:187], v[168:171], v[232:235]
    buffer_load_dwordx4 v5, s[68:71], s42 offen offset:1024 lds
    v_mfma_f32_16x16x32_bf16 v[236:239], v[188:191], v[168:171], v[236:239]
    v_mfma_f32_16x16x32_bf16 v[240:243], v[176:179], v[172:175], v[240:243]
    buffer_load_dwordx4 v6, s[68:71], s42 offen offset:2048 lds
    v_mfma_f32_16x16x32_bf16 v[244:247], v[180:183], v[172:175], v[244:247]
    buffer_load_dwordx4 v7, s[68:71], s42 offen offset:3072 lds
    v_mfma_f32_16x16x32_bf16 v[248:251], v[184:187], v[172:175], v[248:251]
    v_mfma_f32_16x16x32_bf16 v[252:255], v[188:191], v[172:175], v[252:255]
    s_waitcnt lgkmcnt(9)
    s_nop 0
    v_mfma_f32_16x16x32_bf16 v[192:195], v[144:147], v[128:131], v[192:195]
    ds_read_b64_tr_b16 v[176:177], v16 offset:36864
    ds_read_b64_tr_b16 v[178:179], v16 offset:37376
    s_waitcnt lgkmcnt(9)
    s_nop 0
    v_mfma_f32_16x16x32_bf16 v[196:199], v[148:151], v[128:131], v[196:199]
    ds_read_b128 v[160:163], v14 offset:0
    s_waitcnt lgkmcnt(7)
    s_nop 0
    v_mfma_f32_16x16x32_bf16 v[200:203], v[152:155], v[128:131], v[200:203]
    ds_read_b64_tr_b16 v[180:181], v17 offset:36864
    ds_read_b64_tr_b16 v[182:183], v17 offset:37376
    s_waitcnt lgkmcnt(6)
    s_nop 0
    v_mfma_f32_16x16x32_bf16 v[204:207], v[156:159], v[128:131], v[204:207]
    ds_read_b128 v[164:167], v14 offset:2048
    v_mfma_f32_16x16x32_bf16 v[208:211], v[144:147], v[132:135], v[208:211]
    ds_read_b64_tr_b16 v[184:185], v18 offset:36864
    ds_read_b64_tr_b16 v[186:187], v18 offset:37376
    v_mfma_f32_16x16x32_bf16 v[212:215], v[148:151], v[132:135], v[212:215]
    ds_read_b128 v[168:171], v14 offset:4096
    v_mfma_f32_16x16x32_bf16 v[216:219], v[152:155], v[132:135], v[216:219]
    ds_read_b64_tr_b16 v[188:189], v19 offset:36864
    ds_read_b64_tr_b16 v[190:191], v19 offset:37376
    v_mfma_f32_16x16x32_bf16 v[220:223], v[156:159], v[132:135], v[220:223]
    ds_read_b128 v[172:175], v14 offset:6144
    v_mfma_f32_16x16x32_bf16 v[224:227], v[144:147], v[136:139], v[224:227]
    v_mfma_f32_16x16x32_bf16 v[228:231], v[148:151], v[136:139], v[228:231]
    v_mfma_f32_16x16x32_bf16 v[232:235], v[152:155], v[136:139], v[232:235]
    v_mfma_f32_16x16x32_bf16 v[236:239], v[156:159], v[136:139], v[236:239]
    s_waitcnt lgkmcnt(12)
    s_nop 0
    v_mfma_f32_16x16x32_bf16 v[240:243], v[144:147], v[140:143], v[240:243]
    v_mfma_f32_16x16x32_bf16 v[244:247], v[148:151], v[140:143], v[244:247]
    v_mfma_f32_16x16x32_bf16 v[248:251], v[152:155], v[140:143], v[248:251]
    v_mfma_f32_16x16x32_bf16 v[252:255], v[156:159], v[140:143], v[252:255]
    s_waitcnt lgkmcnt(9)
    s_nop 0
    v_mfma_f32_16x16x32_bf16 v[192:195], v[176:179], v[160:163], v[192:195]
    s_waitcnt lgkmcnt(7)
    s_nop 0
    v_mfma_f32_16x16x32_bf16 v[196:199], v[180:183], v[160:163], v[196:199]
    s_waitcnt vmcnt(6) lgkmcnt(0)
    s_barrier
    ds_read_b64_tr_b16 v[144:145], v16 offset:49152
    ds_read_b64_tr_b16 v[146:147], v16 offset:49664
    v_mfma_f32_16x16x32_bf16 v[200:203], v[184:187], v[160:163], v[200:203]
    ds_read_b128 v[128:131], v13 offset:0
    v_mfma_f32_16x16x32_bf16 v[204:207], v[188:191], v[160:163], v[204:207]
    ds_read_b64_tr_b16 v[148:149], v17 offset:49152
    ds_read_b64_tr_b16 v[150:151], v17 offset:49664
    s_add_u32 s43, s45, 5
    s_and_b32 s43, s43, 7
    s_lshl_b32 s43, s43, 19
    s_add_u32 m0, s41, 16384
    s_nop 0
    v_mfma_f32_16x16x32_bf16 v[208:211], v[176:179], v[164:167], v[208:211]
    ds_read_b128 v[132:135], v13 offset:2048
    buffer_load_dwordx4 v10, s[72:75], s43 offen offset:0 lds
    v_mfma_f32_16x16x32_bf16 v[212:215], v[180:183], v[164:167], v[212:215]
    ds_read_b64_tr_b16 v[152:153], v18 offset:49152
    ds_read_b64_tr_b16 v[154:155], v18 offset:49664
    v_mfma_f32_16x16x32_bf16 v[216:219], v[184:187], v[164:167], v[216:219]
    ds_read_b128 v[136:139], v13 offset:4096
    buffer_load_dwordx4 v11, s[72:75], s43 offen offset:1024 lds
    v_mfma_f32_16x16x32_bf16 v[220:223], v[188:191], v[164:167], v[220:223]
    ds_read_b64_tr_b16 v[156:157], v19 offset:49152
    ds_read_b64_tr_b16 v[158:159], v19 offset:49664
    s_add_u32 s42, s45, 5
    s_and_b32 s42, s42, 7
    s_lshl_b32 s42, s42, 7
    s_add_u32 m0, s40, 0
    v_mfma_f32_16x16x32_bf16 v[224:227], v[176:179], v[168:171], v[224:227]
    ds_read_b128 v[140:143], v13 offset:6144
    v_mfma_f32_16x16x32_bf16 v[228:231], v[180:183], v[168:171], v[228:231]
    buffer_load_dwordx4 v4, s[68:71], s42 offen offset:0 lds
    v_mfma_f32_16x16x32_bf16 v[232:235], v[184:187], v[168:171], v[232:235]
    buffer_load_dwordx4 v5, s[68:71], s42 offen offset:1024 lds
    v_mfma_f32_16x16x32_bf16 v[236:239], v[188:191], v[168:171], v[236:239]
    v_mfma_f32_16x16x32_bf16 v[240:243], v[176:179], v[172:175], v[240:243]
    buffer_load_dwordx4 v6, s[68:71], s42 offen offset:2048 lds
    v_mfma_f32_16x16x32_bf16 v[244:247], v[180:183], v[172:175], v[244:247]
    buffer_load_dwordx4 v7, s[68:71], s42 offen offset:3072 lds
    v_mfma_f32_16x16x32_bf16 v[248:251], v[184:187], v[172:175], v[248:251]
    v_mfma_f32_16x16x32_bf16 v[252:255], v[188:191], v[172:175], v[252:255]
    s_waitcnt lgkmcnt(9)
    s_nop 0
    v_mfma_f32_16x16x32_bf16 v[192:195], v[144:147], v[128:131], v[192:195]
    ds_read_b64_tr_b16 v[176:177], v16 offset:53248
    ds_read_b64_tr_b16 v[178:179], v16 offset:53760
    s_waitcnt lgkmcnt(9)
    s_nop 0
    v_mfma_f32_16x16x32_bf16 v[196:199], v[148:151], v[128:131], v[196:199]
    ds_read_b128 v[160:163], v15 offset:0
    s_waitcnt lgkmcnt(7)
    s_nop 0
    v_mfma_f32_16x16x32_bf16 v[200:203], v[152:155], v[128:131], v[200:203]
    ds_read_b64_tr_b16 v[180:181], v17 offset:53248
    ds_read_b64_tr_b16 v[182:183], v17 offset:53760
    s_waitcnt lgkmcnt(6)
    s_nop 0
    v_mfma_f32_16x16x32_bf16 v[204:207], v[156:159], v[128:131], v[204:207]
    ds_read_b128 v[164:167], v15 offset:2048
    v_mfma_f32_16x16x32_bf16 v[208:211], v[144:147], v[132:135], v[208:211]
    ds_read_b64_tr_b16 v[184:185], v18 offset:53248
    ds_read_b64_tr_b16 v[186:187], v18 offset:53760
    v_mfma_f32_16x16x32_bf16 v[212:215], v[148:151], v[132:135], v[212:215]
    ds_read_b128 v[168:171], v15 offset:4096
    v_mfma_f32_16x16x32_bf16 v[216:219], v[152:155], v[132:135], v[216:219]
    ds_read_b64_tr_b16 v[188:189], v19 offset:53248
    ds_read_b64_tr_b16 v[190:191], v19 offset:53760
    v_mfma_f32_16x16x32_bf16 v[220:223], v[156:159], v[132:135], v[220:223]
    ds_read_b128 v[172:175], v15 offset:6144
    v_mfma_f32_16x16x32_bf16 v[224:227], v[144:147], v[136:139], v[224:227]
    v_mfma_f32_16x16x32_bf16 v[228:231], v[148:151], v[136:139], v[228:231]
    v_mfma_f32_16x16x32_bf16 v[232:235], v[152:155], v[136:139], v[232:235]
    v_mfma_f32_16x16x32_bf16 v[236:239], v[156:159], v[136:139], v[236:239]
    s_waitcnt lgkmcnt(12)
    s_nop 0
    v_mfma_f32_16x16x32_bf16 v[240:243], v[144:147], v[140:143], v[240:243]
    v_mfma_f32_16x16x32_bf16 v[244:247], v[148:151], v[140:143], v[244:247]
    v_mfma_f32_16x16x32_bf16 v[248:251], v[152:155], v[140:143], v[248:251]
    v_mfma_f32_16x16x32_bf16 v[252:255], v[156:159], v[140:143], v[252:255]
    s_waitcnt lgkmcnt(9)
    s_nop 0
    v_mfma_f32_16x16x32_bf16 v[192:195], v[176:179], v[160:163], v[192:195]
    s_waitcnt lgkmcnt(7)
    s_nop 0
    v_mfma_f32_16x16x32_bf16 v[196:199], v[180:183], v[160:163], v[196:199]
    s_waitcnt vmcnt(6) lgkmcnt(0)
    s_barrier
    ds_read_b64_tr_b16 v[144:145], v16 offset:0
    ds_read_b64_tr_b16 v[146:147], v16 offset:512
    v_mfma_f32_16x16x32_bf16 v[200:203], v[184:187], v[160:163], v[200:203]
    ds_read_b128 v[128:131], v12 offset:32768
    v_mfma_f32_16x16x32_bf16 v[204:207], v[188:191], v[160:163], v[204:207]
    ds_read_b64_tr_b16 v[148:149], v17 offset:0
    ds_read_b64_tr_b16 v[150:151], v17 offset:512
    s_add_u32 s43, s45, 6
    s_and_b32 s43, s43, 7
    s_lshl_b32 s43, s43, 19
    s_add_u32 m0, s41, 32768
    s_nop 0
    v_mfma_f32_16x16x32_bf16 v[208:211], v[176:179], v[164:167], v[208:211]
    ds_read_b128 v[132:135], v12 offset:34816
    buffer_load_dwordx4 v10, s[72:75], s43 offen offset:0 lds
    v_mfma_f32_16x16x32_bf16 v[212:215], v[180:183], v[164:167], v[212:215]
    ds_read_b64_tr_b16 v[152:153], v18 offset:0
    ds_read_b64_tr_b16 v[154:155], v18 offset:512
    v_mfma_f32_16x16x32_bf16 v[216:219], v[184:187], v[164:167], v[216:219]
    ds_read_b128 v[136:139], v12 offset:36864
    buffer_load_dwordx4 v11, s[72:75], s43 offen offset:1024 lds
    v_mfma_f32_16x16x32_bf16 v[220:223], v[188:191], v[164:167], v[220:223]
    ds_read_b64_tr_b16 v[156:157], v19 offset:0
    ds_read_b64_tr_b16 v[158:159], v19 offset:512
    s_add_u32 s42, s45, 6
    s_and_b32 s42, s42, 7
    s_lshl_b32 s42, s42, 7
    s_add_u32 m0, s40, 65536
    s_nop 0
    v_mfma_f32_16x16x32_bf16 v[224:227], v[176:179], v[168:171], v[224:227]
    ds_read_b128 v[140:143], v12 offset:38912
    v_mfma_f32_16x16x32_bf16 v[228:231], v[180:183], v[168:171], v[228:231]
    buffer_load_dwordx4 v4, s[68:71], s42 offen offset:0 lds
    v_mfma_f32_16x16x32_bf16 v[232:235], v[184:187], v[168:171], v[232:235]
    buffer_load_dwordx4 v5, s[68:71], s42 offen offset:1024 lds
    v_mfma_f32_16x16x32_bf16 v[236:239], v[188:191], v[168:171], v[236:239]
    v_mfma_f32_16x16x32_bf16 v[240:243], v[176:179], v[172:175], v[240:243]
    buffer_load_dwordx4 v6, s[68:71], s42 offen offset:2048 lds
    v_mfma_f32_16x16x32_bf16 v[244:247], v[180:183], v[172:175], v[244:247]
    buffer_load_dwordx4 v7, s[68:71], s42 offen offset:3072 lds
    v_mfma_f32_16x16x32_bf16 v[248:251], v[184:187], v[172:175], v[248:251]
    v_mfma_f32_16x16x32_bf16 v[252:255], v[188:191], v[172:175], v[252:255]
    s_waitcnt lgkmcnt(9)
    s_nop 0
    v_mfma_f32_16x16x32_bf16 v[192:195], v[144:147], v[128:131], v[192:195]
    ds_read_b64_tr_b16 v[176:177], v16 offset:4096
    ds_read_b64_tr_b16 v[178:179], v16 offset:4608
    s_waitcnt lgkmcnt(9)
    s_nop 0
    v_mfma_f32_16x16x32_bf16 v[196:199], v[148:151], v[128:131], v[196:199]
    ds_read_b128 v[160:163], v14 offset:32768
    s_waitcnt lgkmcnt(7)
    s_nop 0
    v_mfma_f32_16x16x32_bf16 v[200:203], v[152:155], v[128:131], v[200:203]
    ds_read_b64_tr_b16 v[180:181], v17 offset:4096
    ds_read_b64_tr_b16 v[182:183], v17 offset:4608
    s_waitcnt lgkmcnt(6)
    s_nop 0
    v_mfma_f32_16x16x32_bf16 v[204:207], v[156:159], v[128:131], v[204:207]
    ds_read_b128 v[164:167], v14 offset:34816
    v_mfma_f32_16x16x32_bf16 v[208:211], v[144:147], v[132:135], v[208:211]
    ds_read_b64_tr_b16 v[184:185], v18 offset:4096
    ds_read_b64_tr_b16 v[186:187], v18 offset:4608
    v_mfma_f32_16x16x32_bf16 v[212:215], v[148:151], v[132:135], v[212:215]
    ds_read_b128 v[168:171], v14 offset:36864
    v_mfma_f32_16x16x32_bf16 v[216:219], v[152:155], v[132:135], v[216:219]
    ds_read_b64_tr_b16 v[188:189], v19 offset:4096
    ds_read_b64_tr_b16 v[190:191], v19 offset:4608
    v_mfma_f32_16x16x32_bf16 v[220:223], v[156:159], v[132:135], v[220:223]
    ds_read_b128 v[172:175], v14 offset:38912
    v_mfma_f32_16x16x32_bf16 v[224:227], v[144:147], v[136:139], v[224:227]
    v_mfma_f32_16x16x32_bf16 v[228:231], v[148:151], v[136:139], v[228:231]
    v_mfma_f32_16x16x32_bf16 v[232:235], v[152:155], v[136:139], v[232:235]
    v_mfma_f32_16x16x32_bf16 v[236:239], v[156:159], v[136:139], v[236:239]
    s_waitcnt lgkmcnt(12)
    s_nop 0
    v_mfma_f32_16x16x32_bf16 v[240:243], v[144:147], v[140:143], v[240:243]
    v_mfma_f32_16x16x32_bf16 v[244:247], v[148:151], v[140:143], v[244:247]
    v_mfma_f32_16x16x32_bf16 v[248:251], v[152:155], v[140:143], v[248:251]
    v_mfma_f32_16x16x32_bf16 v[252:255], v[156:159], v[140:143], v[252:255]
    s_waitcnt lgkmcnt(9)
    s_nop 0
    v_mfma_f32_16x16x32_bf16 v[192:195], v[176:179], v[160:163], v[192:195]
    s_waitcnt lgkmcnt(7)
    s_nop 0
    v_mfma_f32_16x16x32_bf16 v[196:199], v[180:183], v[160:163], v[196:199]
    s_waitcnt vmcnt(6) lgkmcnt(0)
    s_barrier
    s_lshl_b32 s54, s21, 3
    s_add_u32 s54, s54, s22
    s_lshl_b32 s54, s54, 7
    s_add_u32 s54, s54, 71303168
    v_mov_b32 v30, s54
    s_cmp_lg_u32 s20, 0
    s_cbranch_scc1 main_kernel_p3_20
    buffer_load_dwordx2 v[28:29], v30, s[8:11], 0 offen sc1
main_kernel_p3_20:
    ds_read_b64_tr_b16 v[144:145], v16 offset:16384
    ds_read_b64_tr_b16 v[146:147], v16 offset:16896
    v_mfma_f32_16x16x32_bf16 v[200:203], v[184:187], v[160:163], v[200:203]
    ds_read_b128 v[128:131], v12 offset:0
    v_mfma_f32_16x16x32_bf16 v[204:207], v[188:191], v[160:163], v[204:207]
    ds_read_b64_tr_b16 v[148:149], v17 offset:16384
    ds_read_b64_tr_b16 v[150:151], v17 offset:16896
    s_add_u32 s43, s45, 7
    s_and_b32 s43, s43, 7
    s_lshl_b32 s43, s43, 19
    s_add_u32 m0, s41, 49152
    s_nop 0
    v_mfma_f32_16x16x32_bf16 v[208:211], v[176:179], v[164:167], v[208:211]
    ds_read_b128 v[132:135], v12 offset:2048
    buffer_load_dwordx4 v10, s[72:75], s43 offen offset:0 lds
    v_mfma_f32_16x16x32_bf16 v[212:215], v[180:183], v[164:167], v[212:215]
    ds_read_b64_tr_b16 v[152:153], v18 offset:16384
    ds_read_b64_tr_b16 v[154:155], v18 offset:16896
    v_mfma_f32_16x16x32_bf16 v[216:219], v[184:187], v[164:167], v[216:219]
    ds_read_b128 v[136:139], v12 offset:4096
    buffer_load_dwordx4 v11, s[72:75], s43 offen offset:1024 lds
    v_mfma_f32_16x16x32_bf16 v[220:223], v[188:191], v[164:167], v[220:223]
    ds_read_b64_tr_b16 v[156:157], v19 offset:16384
    ds_read_b64_tr_b16 v[158:159], v19 offset:16896
    s_add_u32 s42, s45, 7
    s_and_b32 s42, s42, 7
    s_lshl_b32 s42, s42, 7
    s_add_u32 m0, s40, 32768
    s_nop 0
    v_mfma_f32_16x16x32_bf16 v[224:227], v[176:179], v[168:171], v[224:227]
    ds_read_b128 v[140:143], v12 offset:6144
    v_mfma_f32_16x16x32_bf16 v[228:231], v[180:183], v[168:171], v[228:231]
    buffer_load_dwordx4 v4, s[68:71], s42 offen offset:0 lds
    v_mfma_f32_16x16x32_bf16 v[232:235], v[184:187], v[168:171], v[232:235]
    buffer_load_dwordx4 v5, s[68:71], s42 offen offset:1024 lds
    v_mfma_f32_16x16x32_bf16 v[236:239], v[188:191], v[168:171], v[236:239]
    v_mfma_f32_16x16x32_bf16 v[240:243], v[176:179], v[172:175], v[240:243]
    buffer_load_dwordx4 v6, s[68:71], s42 offen offset:2048 lds
    v_mfma_f32_16x16x32_bf16 v[244:247], v[180:183], v[172:175], v[244:247]
    buffer_load_dwordx4 v7, s[68:71], s42 offen offset:3072 lds
    v_mfma_f32_16x16x32_bf16 v[248:251], v[184:187], v[172:175], v[248:251]
    v_mfma_f32_16x16x32_bf16 v[252:255], v[188:191], v[172:175], v[252:255]
    s_waitcnt lgkmcnt(9)
    s_nop 0
    v_mfma_f32_16x16x32_bf16 v[192:195], v[144:147], v[128:131], v[192:195]
    ds_read_b64_tr_b16 v[176:177], v16 offset:20480
    ds_read_b64_tr_b16 v[178:179], v16 offset:20992
    s_waitcnt lgkmcnt(9)
    s_nop 0
    v_mfma_f32_16x16x32_bf16 v[196:199], v[148:151], v[128:131], v[196:199]
    ds_read_b128 v[160:163], v14 offset:0
    s_waitcnt lgkmcnt(7)
    s_nop 0
    v_mfma_f32_16x16x32_bf16 v[200:203], v[152:155], v[128:131], v[200:203]
    ds_read_b64_tr_b16 v[180:181], v17 offset:20480
    ds_read_b64_tr_b16 v[182:183], v17 offset:20992
    s_waitcnt lgkmcnt(6)
    s_nop 0
    v_mfma_f32_16x16x32_bf16 v[204:207], v[156:159], v[128:131], v[204:207]
    ds_read_b128 v[164:167], v14 offset:2048
    v_mfma_f32_16x16x32_bf16 v[208:211], v[144:147], v[132:135], v[208:211]
    ds_read_b64_tr_b16 v[184:185], v18 offset:20480
    ds_read_b64_tr_b16 v[186:187], v18 offset:20992
    v_mfma_f32_16x16x32_bf16 v[212:215], v[148:151], v[132:135], v[212:215]
    ds_read_b128 v[168:171], v14 offset:4096
    v_mfma_f32_16x16x32_bf16 v[216:219], v[152:155], v[132:135], v[216:219]
    ds_read_b64_tr_b16 v[188:189], v19 offset:20480
    ds_read_b64_tr_b16 v[190:191], v19 offset:20992
    v_mfma_f32_16x16x32_bf16 v[220:223], v[156:159], v[132:135], v[220:223]
    ds_read_b128 v[172:175], v14 offset:6144
    v_mfma_f32_16x16x32_bf16 v[224:227], v[144:147], v[136:139], v[224:227]
    v_mfma_f32_16x16x32_bf16 v[228:231], v[148:151], v[136:139], v[228:231]
    v_mfma_f32_16x16x32_bf16 v[232:235], v[152:155], v[136:139], v[232:235]
    v_mfma_f32_16x16x32_bf16 v[236:239], v[156:159], v[136:139], v[236:239]
    s_waitcnt lgkmcnt(12)
    s_nop 0
    v_mfma_f32_16x16x32_bf16 v[240:243], v[144:147], v[140:143], v[240:243]
    v_mfma_f32_16x16x32_bf16 v[244:247], v[148:151], v[140:143], v[244:247]
    v_mfma_f32_16x16x32_bf16 v[248:251], v[152:155], v[140:143], v[248:251]
    v_mfma_f32_16x16x32_bf16 v[252:255], v[156:159], v[140:143], v[252:255]
    s_waitcnt lgkmcnt(9)
    s_nop 0
    v_mfma_f32_16x16x32_bf16 v[192:195], v[176:179], v[160:163], v[192:195]
    s_waitcnt lgkmcnt(7)
    s_nop 0
    v_mfma_f32_16x16x32_bf16 v[196:199], v[180:183], v[160:163], v[196:199]
    s_waitcnt vmcnt(6) lgkmcnt(0)
    s_barrier
    s_cmp_lg_u32 s20, 0
    s_cbranch_scc1 main_kernel_polled_19
    s_mov_b32 s55, 0x10000
main_kernel_poll_18:
    v_and_b32 v28, v28, v29
    s_nop 0
    v_readfirstlane_b32 s54, v28
    s_nop 0
    s_cmp_eq_u32 s54, 0x01010101
    s_cbranch_scc1 main_kernel_polled_19
    s_sleep 4
    buffer_load_dwordx2 v[28:29], v30, s[8:11], 0 offen sc1
    s_waitcnt vmcnt(0)
    s_sub_u32 s55, s55, 1
    s_cmp_lg_u32 s55, 0
    s_cbranch_scc1 main_kernel_poll_18
main_kernel_polled_19:
    ds_read_b64_tr_b16 v[144:145], v16 offset:32768
    ds_read_b64_tr_b16 v[146:147], v16 offset:33280
    v_mfma_f32_16x16x32_bf16 v[200:203], v[184:187], v[160:163], v[200:203]
    ds_read_b128 v[128:131], v13 offset:0
    v_mfma_f32_16x16x32_bf16 v[204:207], v[188:191], v[160:163], v[204:207]
    ds_read_b64_tr_b16 v[148:149], v17 offset:32768
    ds_read_b64_tr_b16 v[150:151], v17 offset:33280
    v_mfma_f32_16x16x32_bf16 v[208:211], v[176:179], v[164:167], v[208:211]
    ds_read_b128 v[132:135], v13 offset:2048
    v_mfma_f32_16x16x32_bf16 v[212:215], v[180:183], v[164:167], v[212:215]
    ds_read_b64_tr_b16 v[152:153], v18 offset:32768
    ds_read_b64_tr_b16 v[154:155], v18 offset:33280
    v_mfma_f32_16x16x32_bf16 v[216:219], v[184:187], v[164:167], v[216:219]
    ds_read_b128 v[136:139], v13 offset:4096
    v_mfma_f32_16x16x32_bf16 v[220:223], v[188:191], v[164:167], v[220:223]
    ds_read_b64_tr_b16 v[156:157], v19 offset:32768
    ds_read_b64_tr_b16 v[158:159], v19 offset:33280
    v_mfma_f32_16x16x32_bf16 v[224:227], v[176:179], v[168:171], v[224:227]
    ds_read_b128 v[140:143], v13 offset:6144
    v_mfma_f32_16x16x32_bf16 v[228:231], v[180:183], v[168:171], v[228:231]
    v_mfma_f32_16x16x32_bf16 v[232:235], v[184:187], v[168:171], v[232:235]
    v_mfma_f32_16x16x32_bf16 v[236:239], v[188:191], v[168:171], v[236:239]
    v_mfma_f32_16x16x32_bf16 v[240:243], v[176:179], v[172:175], v[240:243]
    v_mfma_f32_16x16x32_bf16 v[244:247], v[180:183], v[172:175], v[244:247]
    v_mfma_f32_16x16x32_bf16 v[248:251], v[184:187], v[172:175], v[248:251]
    v_mfma_f32_16x16x32_bf16 v[252:255], v[188:191], v[172:175], v[252:255]
    s_waitcnt lgkmcnt(9)
    s_nop 0
    v_mfma_f32_16x16x32_bf16 v[192:195], v[144:147], v[128:131], v[192:195]
    ds_read_b64_tr_b16 v[176:177], v16 offset:36864
    ds_read_b64_tr_b16 v[178:179], v16 offset:37376
    s_waitcnt lgkmcnt(9)
    s_nop 0
    v_mfma_f32_16x16x32_bf16 v[196:199], v[148:151], v[128:131], v[196:199]
    ds_read_b128 v[160:163], v15 offset:0
    s_waitcnt lgkmcnt(7)
    s_nop 0
    v_mfma_f32_16x16x32_bf16 v[200:203], v[152:155], v[128:131], v[200:203]
    ds_read_b64_tr_b16 v[180:181], v17 offset:36864
    ds_read_b64_tr_b16 v[182:183], v17 offset:37376
    s_waitcnt lgkmcnt(6)
    s_nop 0
    v_mfma_f32_16x16x32_bf16 v[204:207], v[156:159], v[128:131], v[204:207]
    ds_read_b128 v[164:167], v15 offset:2048
    v_mfma_f32_16x16x32_bf16 v[208:211], v[144:147], v[132:135], v[208:211]
    ds_read_b64_tr_b16 v[184:185], v18 offset:36864
    ds_read_b64_tr_b16 v[186:187], v18 offset:37376
    v_mfma_f32_16x16x32_bf16 v[212:215], v[148:151], v[132:135], v[212:215]
    ds_read_b128 v[168:171], v15 offset:4096
    v_mfma_f32_16x16x32_bf16 v[216:219], v[152:155], v[132:135], v[216:219]
    ds_read_b64_tr_b16 v[188:189], v19 offset:36864
    ds_read_b64_tr_b16 v[190:191], v19 offset:37376
    v_mfma_f32_16x16x32_bf16 v[220:223], v[156:159], v[132:135], v[220:223]
    ds_read_b128 v[172:175], v15 offset:6144
    v_mfma_f32_16x16x32_bf16 v[224:227], v[144:147], v[136:139], v[224:227]
    v_mfma_f32_16x16x32_bf16 v[228:231], v[148:151], v[136:139], v[228:231]
    v_mfma_f32_16x16x32_bf16 v[232:235], v[152:155], v[136:139], v[232:235]
    v_mfma_f32_16x16x32_bf16 v[236:239], v[156:159], v[136:139], v[236:239]
    s_waitcnt lgkmcnt(12)
    s_nop 0
    v_mfma_f32_16x16x32_bf16 v[240:243], v[144:147], v[140:143], v[240:243]
    v_mfma_f32_16x16x32_bf16 v[244:247], v[148:151], v[140:143], v[244:247]
    v_mfma_f32_16x16x32_bf16 v[248:251], v[152:155], v[140:143], v[248:251]
    v_mfma_f32_16x16x32_bf16 v[252:255], v[156:159], v[140:143], v[252:255]
    s_waitcnt lgkmcnt(9)
    s_nop 0
    v_mfma_f32_16x16x32_bf16 v[192:195], v[176:179], v[160:163], v[192:195]
    s_waitcnt lgkmcnt(7)
    s_nop 0
    v_mfma_f32_16x16x32_bf16 v[196:199], v[180:183], v[160:163], v[196:199]
    s_waitcnt vmcnt(0) lgkmcnt(0)
    s_barrier
    s_cmp_eq_u32 s23, 0
    s_cbranch_scc1 main_kernel_edma_22
    s_add_u32 s33, s25, 0
    s_min_u32 s33, s33, 15
    s_lshl_b32 s33, s33, 15
    s_add_u32 s33, s33, s32
    s_mov_b32 s34, 0
    s_add_u32 s34, s34, s39
    s_add_u32 m0, s34, 0
    s_nop 0
    buffer_load_dwordx4 v3, s[8:11], s33 offen offset:0 lds
    buffer_load_dwordx4 v3, s[8:11], s33 offen offset:1024 lds
    buffer_load_dwordx4 v3, s[8:11], s33 offen offset:2048 lds
    buffer_load_dwordx4 v3, s[8:11], s33 offen offset:3072 lds
    s_add_u32 m0, s34, 4096
    s_add_u32 s33, s33, 4096
    buffer_load_dwordx4 v3, s[8:11], s33 offen offset:0 lds
    buffer_load_dwordx4 v3, s[8:11], s33 offen offset:1024 lds
    buffer_load_dwordx4 v3, s[8:11], s33 offen offset:2048 lds
    buffer_load_dwordx4 v3, s[8:11], s33 offen offset:3072 lds
main_kernel_edma_22:
    s_cmp_eq_u32 s23, 0
    s_cbranch_scc1 main_kernel_edma_23
    s_add_u32 s33, s28, 0
    s_min_u32 s33, s33, 15
    s_lshl_b32 s33, s33, 15
    s_add_u32 s33, s33, s32
    s_add_u32 s33, s33, 16777216
    s_mov_b32 s34, 65536
    s_add_u32 s34, s34, s39
    s_add_u32 m0, s34, 0
    s_nop 0
    buffer_load_dwordx4 v3, s[8:11], s33 offen offset:0 lds
    buffer_load_dwordx4 v3, s[8:11], s33 offen offset:1024 lds
    buffer_load_dwordx4 v3, s[8:11], s33 offen offset:2048 lds
    buffer_load_dwordx4 v3, s[8:11], s33 offen offset:3072 lds
    s_add_u32 m0, s34, 4096
    s_add_u32 s33, s33, 4096
    buffer_load_dwordx4 v3, s[8:11], s33 offen offset:0 lds
    buffer_load_dwordx4 v3, s[8:11], s33 offen offset:1024 lds
    buffer_load_dwordx4 v3, s[8:11], s33 offen offset:2048 lds
    buffer_load_dwordx4 v3, s[8:11], s33 offen offset:3072 lds
main_kernel_edma_23:
    s_nop 0
    ds_read_b64_tr_b16 v[144:145], v16 offset:49152
    ds_read_b64_tr_b16 v[146:147], v16 offset:49664
    v_mfma_f32_16x16x32_bf16 v[200:203], v[184:187], v[160:163], v[200:203]
    ds_read_b128 v[128:131], v12 offset:32768
    v_mfma_f32_16x16x32_bf16 v[204:207], v[188:191], v[160:163], v[204:207]
    ds_read_b64_tr_b16 v[148:149], v17 offset:49152
    ds_read_b64_tr_b16 v[150:151], v17 offset:49664
    v_mfma_f32_16x16x32_bf16 v[208:211], v[176:179], v[164:167], v[208:211]
    ds_read_b128 v[132:135], v12 offset:34816
    v_mfma_f32_16x16x32_bf16 v[212:215], v[180:183], v[164:167], v[212:215]
    ds_read_b64_tr_b16 v[152:153], v18 offset:49152
    ds_read_b64_tr_b16 v[154:155], v18 offset:49664
    v_mfma_f32_16x16x32_bf16 v[216:219], v[184:187], v[164:167], v[216:219]
    ds_read_b128 v[136:139], v12 offset:36864
    v_mfma_f32_16x16x32_bf16 v[220:223], v[188:191], v[164:167], v[220:223]
    ds_read_b64_tr_b16 v[156:157], v19 offset:49152
    ds_read_b64_tr_b16 v[158:159], v19 offset:49664
    v_mfma_f32_16x16x32_bf16 v[224:227], v[176:179], v[168:171], v[224:227]
    ds_read_b128 v[140:143], v12 offset:38912
    v_mfma_f32_16x16x32_bf16 v[228:231], v[180:183], v[168:171], v[228:231]
    v_mfma_f32_16x16x32_bf16 v[232:235], v[184:187], v[168:171], v[232:235]
    v_mfma_f32_16x16x32_bf16 v[236:239], v[188:191], v[168:171], v[236:239]
    v_mfma_f32_16x16x32_bf16 v[240:243], v[176:179], v[172:175], v[240:243]
    v_mfma_f32_16x16x32_bf16 v[244:247], v[180:183], v[172:175], v[244:247]
    v_mfma_f32_16x16x32_bf16 v[248:251], v[184:187], v[172:175], v[248:251]
    v_mfma_f32_16x16x32_bf16 v[252:255], v[188:191], v[172:175], v[252:255]
    s_waitcnt lgkmcnt(9)
    s_nop 0
    v_mfma_f32_16x16x32_bf16 v[192:195], v[144:147], v[128:131], v[192:195]
    ds_read_b64_tr_b16 v[176:177], v16 offset:53248
    ds_read_b64_tr_b16 v[178:179], v16 offset:53760
    s_waitcnt lgkmcnt(9)
    s_nop 0
    v_mfma_f32_16x16x32_bf16 v[196:199], v[148:151], v[128:131], v[196:199]
    ds_read_b128 v[160:163], v14 offset:32768
    s_waitcnt lgkmcnt(7)
    s_nop 0
    v_mfma_f32_16x16x32_bf16 v[200:203], v[152:155], v[128:131], v[200:203]
    ds_read_b64_tr_b16 v[180:181], v17 offset:53248
    ds_read_b64_tr_b16 v[182:183], v17 offset:53760
    s_waitcnt lgkmcnt(6)
    s_nop 0
    v_mfma_f32_16x16x32_bf16 v[204:207], v[156:159], v[128:131], v[204:207]
    ds_read_b128 v[164:167], v14 offset:34816
    v_mfma_f32_16x16x32_bf16 v[208:211], v[144:147], v[132:135], v[208:211]
    ds_read_b64_tr_b16 v[184:185], v18 offset:53248
    ds_read_b64_tr_b16 v[186:187], v18 offset:53760
    v_mfma_f32_16x16x32_bf16 v[212:215], v[148:151], v[132:135], v[212:215]
    ds_read_b128 v[168:171], v14 offset:36864
    v_mfma_f32_16x16x32_bf16 v[216:219], v[152:155], v[132:135], v[216:219]
    ds_read_b64_tr_b16 v[188:189], v19 offset:53248
    ds_read_b64_tr_b16 v[190:191], v19 offset:53760
    v_mfma_f32_16x16x32_bf16 v[220:223], v[156:159], v[132:135], v[220:223]
    ds_read_b128 v[172:175], v14 offset:38912
    v_mfma_f32_16x16x32_bf16 v[224:227], v[144:147], v[136:139], v[224:227]
    v_mfma_f32_16x16x32_bf16 v[228:231], v[148:151], v[136:139], v[228:231]
    v_mfma_f32_16x16x32_bf16 v[232:235], v[152:155], v[136:139], v[232:235]
    v_mfma_f32_16x16x32_bf16 v[236:239], v[156:159], v[136:139], v[236:239]
    s_waitcnt lgkmcnt(12)
    s_nop 0
    v_mfma_f32_16x16x32_bf16 v[240:243], v[144:147], v[140:143], v[240:243]
    v_mfma_f32_16x16x32_bf16 v[244:247], v[148:151], v[140:143], v[244:247]
    v_mfma_f32_16x16x32_bf16 v[248:251], v[152:155], v[140:143], v[248:251]
    v_mfma_f32_16x16x32_bf16 v[252:255], v[156:159], v[140:143], v[252:255]
    s_waitcnt lgkmcnt(9)
    s_nop 0
    v_mfma_f32_16x16x32_bf16 v[192:195], v[176:179], v[160:163], v[192:195]
    s_waitcnt lgkmcnt(0)
    s_barrier
    v_mfma_f32_16x16x32_bf16 v[196:199], v[180:183], v[160:163], v[196:199]
    s_cmp_eq_u32 s23, 0
    s_cbranch_scc1 main_kernel_edma_24
    s_add_u32 s33, s25, 1
    s_min_u32 s33, s33, 15
    s_lshl_b32 s33, s33, 15
    s_add_u32 s33, s33, s32
    s_mov_b32 s34, 32768
    s_add_u32 s34, s34, s39
    s_add_u32 m0, s34, 0
    s_nop 0
    buffer_load_dwordx4 v3, s[8:11], s33 offen offset:0 lds
    buffer_load_dwordx4 v3, s[8:11], s33 offen offset:1024 lds
    buffer_load_dwordx4 v3, s[8:11], s33 offen offset:2048 lds
    buffer_load_dwordx4 v3, s[8:11], s33 offen offset:3072 lds
    s_add_u32 m0, s34, 4096
    s_add_u32 s33, s33, 4096
    buffer_load_dwordx4 v3, s[8:11], s33 offen offset:0 lds
    buffer_load_dwordx4 v3, s[8:11], s33 offen offset:1024 lds
    buffer_load_dwordx4 v3, s[8:11], s33 offen offset:2048 lds
    buffer_load_dwordx4 v3, s[8:11], s33 offen offset:3072 lds
main_kernel_edma_24:
    s_nop 0
    v_mfma_f32_16x16x32_bf16 v[200:203], v[184:187], v[160:163], v[200:203]
    v_mfma_f32_16x16x32_bf16 v[204:207], v[188:191], v[160:163], v[204:207]
    v_mfma_f32_16x16x32_bf16 v[208:211], v[176:179], v[164:167], v[208:211]
    v_mfma_f32_16x16x32_bf16 v[212:215], v[180:183], v[164:167], v[212:215]
    v_mfma_f32_16x16x32_bf16 v[216:219], v[184:187], v[164:167], v[216:219]
    v_mfma_f32_16x16x32_bf16 v[220:223], v[188:191], v[164:167], v[220:223]
    v_mfma_f32_16x16x32_bf16 v[224:227], v[176:179], v[168:171], v[224:227]
    v_mfma_f32_16x16x32_bf16 v[228:231], v[180:183], v[168:171], v[228:231]
    v_mfma_f32_16x16x32_bf16 v[232:235], v[184:187], v[168:171], v[232:235]
    v_mfma_f32_16x16x32_bf16 v[236:239], v[188:191], v[168:171], v[236:239]
    v_mfma_f32_16x16x32_bf16 v[240:243], v[176:179], v[172:175], v[240:243]
    v_mfma_f32_16x16x32_bf16 v[244:247], v[180:183], v[172:175], v[244:247]
    v_mfma_f32_16x16x32_bf16 v[248:251], v[184:187], v[172:175], v[248:251]
    v_mfma_f32_16x16x32_bf16 v[252:255], v[188:191], v[172:175], v[252:255]
    v_pk_mul_f32 v[192:193], v[192:193], s[52:53] op_sel:[0,1] op_sel_hi:[1,1]
    v_pk_mul_f32 v[194:195], v[194:195], s[52:53] op_sel:[0,1] op_sel_hi:[1,1]
    v_cvt_pk_bf16_f32 v32, v192, v193
    v_cvt_pk_bf16_f32 v33, v194, v195
    v_pk_mul_f32 v[196:197], v[196:197], s[52:53] op_sel:[0,1] op_sel_hi:[1,1]
    v_pk_mul_f32 v[198:199], v[198:199], s[52:53] op_sel:[0,1] op_sel_hi:[1,1]
    v_cvt_pk_bf16_f32 v34, v196, v197
    v_cvt_pk_bf16_f32 v35, v198, v199
    v_pk_mul_f32 v[200:201], v[200:201], s[52:53] op_sel:[0,1] op_sel_hi:[1,1]
    v_pk_mul_f32 v[202:203], v[202:203], s[52:53] op_sel:[0,1] op_sel_hi:[1,1]
    v_cvt_pk_bf16_f32 v36, v200, v201
    v_cvt_pk_bf16_f32 v37, v202, v203
    v_pk_mul_f32 v[204:205], v[204:205], s[52:53] op_sel:[0,1] op_sel_hi:[1,1]
    v_pk_mul_f32 v[206:207], v[206:207], s[52:53] op_sel:[0,1] op_sel_hi:[1,1]
    v_cvt_pk_bf16_f32 v38, v204, v205
    v_cvt_pk_bf16_f32 v39, v206, v207
    v_pk_mul_f32 v[208:209], v[208:209], s[52:53] op_sel:[0,1] op_sel_hi:[1,1]
    v_pk_mul_f32 v[210:211], v[210:211], s[52:53] op_sel:[0,1] op_sel_hi:[1,1]
    v_cvt_pk_bf16_f32 v40, v208, v209
    v_cvt_pk_bf16_f32 v41, v210, v211
    v_pk_mul_f32 v[212:213], v[212:213], s[52:53] op_sel:[0,1] op_sel_hi:[1,1]
    v_pk_mul_f32 v[214:215], v[214:215], s[52:53] op_sel:[0,1] op_sel_hi:[1,1]
    v_cvt_pk_bf16_f32 v42, v212, v213
    v_cvt_pk_bf16_f32 v43, v214, v215
    v_pk_mul_f32 v[216:217], v[216:217], s[52:53] op_sel:[0,1] op_sel_hi:[1,1]
    v_pk_mul_f32 v[218:219], v[218:219], s[52:53] op_sel:[0,1] op_sel_hi:[1,1]
    v_cvt_pk_bf16_f32 v44, v216, v217
    v_cvt_pk_bf16_f32 v45, v218, v219
    v_pk_mul_f32 v[220:221], v[220:221], s[52:53] op_sel:[0,1] op_sel_hi:[1,1]
    v_pk_mul_f32 v[222:223], v[222:223], s[52:53] op_sel:[0,1] op_sel_hi:[1,1]
    v_cvt_pk_bf16_f32 v46, v220, v221
    v_cvt_pk_bf16_f32 v47, v222, v223
    v_pk_mul_f32 v[224:225], v[224:225], s[52:53] op_sel:[0,1] op_sel_hi:[1,1]
    v_pk_mul_f32 v[226:227], v[226:227], s[52:53] op_sel:[0,1] op_sel_hi:[1,1]
    v_cvt_pk_bf16_f32 v48, v224, v225
    v_cvt_pk_bf16_f32 v49, v226, v227
    v_pk_mul_f32 v[228:229], v[228:229], s[52:53] op_sel:[0,1] op_sel_hi:[1,1]
    v_pk_mul_f32 v[230:231], v[230:231], s[52:53] op_sel:[0,1] op_sel_hi:[1,1]
    v_cvt_pk_bf16_f32 v50, v228, v229
    v_cvt_pk_bf16_f32 v51, v230, v231
    v_pk_mul_f32 v[232:233], v[232:233], s[52:53] op_sel:[0,1] op_sel_hi:[1,1]
    v_pk_mul_f32 v[234:235], v[234:235], s[52:53] op_sel:[0,1] op_sel_hi:[1,1]
    v_cvt_pk_bf16_f32 v52, v232, v233
    v_cvt_pk_bf16_f32 v53, v234, v235
    v_pk_mul_f32 v[236:237], v[236:237], s[52:53] op_sel:[0,1] op_sel_hi:[1,1]
    v_pk_mul_f32 v[238:239], v[238:239], s[52:53] op_sel:[0,1] op_sel_hi:[1,1]
    v_cvt_pk_bf16_f32 v54, v236, v237
    v_cvt_pk_bf16_f32 v55, v238, v239
    v_pk_mul_f32 v[240:241], v[240:241], s[52:53] op_sel:[0,1] op_sel_hi:[1,1]
    v_pk_mul_f32 v[242:243], v[242:243], s[52:53] op_sel:[0,1] op_sel_hi:[1,1]
    v_cvt_pk_bf16_f32 v56, v240, v241
    v_cvt_pk_bf16_f32 v57, v242, v243
    v_pk_mul_f32 v[244:245], v[244:245], s[52:53] op_sel:[0,1] op_sel_hi:[1,1]
    v_pk_mul_f32 v[246:247], v[246:247], s[52:53] op_sel:[0,1] op_sel_hi:[1,1]
    v_cvt_pk_bf16_f32 v58, v244, v245
    v_cvt_pk_bf16_f32 v59, v246, v247
    v_pk_mul_f32 v[248:249], v[248:249], s[52:53] op_sel:[0,1] op_sel_hi:[1,1]
    v_pk_mul_f32 v[250:251], v[250:251], s[52:53] op_sel:[0,1] op_sel_hi:[1,1]
    v_cvt_pk_bf16_f32 v60, v248, v249
    v_cvt_pk_bf16_f32 v61, v250, v251
    v_pk_mul_f32 v[252:253], v[252:253], s[52:53] op_sel:[0,1] op_sel_hi:[1,1]
    v_pk_mul_f32 v[254:255], v[254:255], s[52:53] op_sel:[0,1] op_sel_hi:[1,1]
    v_cvt_pk_bf16_f32 v62, v252, v253
    v_cvt_pk_bf16_f32 v63, v254, v255
    s_lshr_b32 s46, s20, 1
    s_xor_b32 s46, s46, 2
    s_lshl_b32 s46, s46, 14
    s_and_b32 s47, s20, 1
    s_lshl_b32 s47, s47, 11
    s_add_u32 s46, s46, s47
    s_add_u32 s46, s46, 98304
    v_lshlrev_b32 v21, 4, v2
    v_add_u32 v21, s46, v21
    ds_write_b128 v21, v[32:35] offset:0
    ds_write_b128 v21, v[36:39] offset:1024
    ds_write_b128 v21, v[40:43] offset:4096
    ds_write_b128 v21, v[44:47] offset:5120
    ds_write_b128 v21, v[48:51] offset:8192
    ds_write_b128 v21, v[52:55] offset:9216
    ds_write_b128 v21, v[56:59] offset:12288
    ds_write_b128 v21, v[60:63] offset:13312
    s_load_dwordx4 s[64:67], s[0:1], 96
    s_waitcnt lgkmcnt(0)
    s_mov_b32 s12, s64
    s_and_b32 s13, s65, 0xffff
    s_mov_b32 s14, 4194304
    s_mov_b32 s15, 0x00020000
    s_mov_b32 s16, s66
    s_and_b32 s17, s67, 0xffff
    s_mov_b32 s18, 4194304
    s_mov_b32 s19, 0x00020000
    v_lshlrev_b32 v7, 4, v2
    v_and_b32 v6, 15, v2
    v_lshrrev_b32 v1, 4, v2
    v_lshlrev_b32 v1, 2, v1
    v_sub_u32 v6, v6, v1
    s_cmp_eq_u32 s23, 0
    s_cselect_b32 s37, s35, s22
    s_lshl_b32 s37, s37, 2
    s_add_u32 s37, s37, s24
    s_add_u32 s25, s32, 65536
    s_lshl_b32 s3, s20, 12
    s_mov_b32 s4, s3
    v_add_u32 v10, s3, v7
    s_mov_b32 s26, s4
    s_add_u32 s28, s32, 16809984
    s_add_u32 s29, s4, 98304
    s_add_u32 s30, s35, 1
    s_lshl_b32 s30, s30, 15
    s_add_u32 s30, s30, s32
    s_add_u32 s43, s30, 16777216
    s_mov_b32 s27, 0
    s_mov_b32 s38, 0
    s_add_u32 s31, s22, 1
    v_mov_b32 v4, v7
    v_add_u32 v5, 98304, v7
    s_waitcnt vmcnt(8) lgkmcnt(0)
    s_barrier
    s_cmp_eq_u32 s23, 0
    s_cbranch_scc1 main_kernel_q1_25
    s_lshl_b32 s34, s24, 13
    s_add_u32 s34, s34, 98304
    v_add_u32_e64 v1, s34, v7
    ds_read_b128 v[40:43], v1 offset:0
    ds_read_b128 v[44:47], v1 offset:1024
    ds_read_b128 v[48:51], v1 offset:2048
    ds_read_b128 v[52:55], v1 offset:3072
    ds_read_b128 v[56:59], v1 offset:4096
    ds_read_b128 v[60:63], v1 offset:5120
    ds_read_b128 v[64:67], v1 offset:6144
    ds_read_b128 v[68:71], v1 offset:7168
    s_branch main_kernel_q2_26
main_kernel_q1_25:
    s_lshl_b32 s34, s24, 13
    s_add_u32 s34, s34, 131072
    v_add_u32_e64 v1, s34, v7
    ds_read_b128 v[40:43], v1 offset:0
    ds_read_b128 v[44:47], v1 offset:1024
    ds_read_b128 v[48:51], v1 offset:2048
    ds_read_b128 v[52:55], v1 offset:3072
    ds_read_b128 v[56:59], v1 offset:4096
    ds_read_b128 v[60:63], v1 offset:5120
    ds_read_b128 v[64:67], v1 offset:6144
    ds_read_b128 v[68:71], v1 offset:7168
main_kernel_q2_26:
    v_mov_b32 v28, 0x3f803f80
    v_mov_b32 v29, 0x3f803f80
    v_mov_b32 v30, 0x3f803f80
    v_mov_b32 v31, 0x3f803f80
    v_mov_b64 v[32:33], 0
    v_mov_b64 v[248:249], 0
    v_mov_b64 v[34:35], 0
    v_mov_b64 v[250:251], 0
    v_mov_b64 v[36:37], 0
    v_mov_b64 v[252:253], 0
    v_mov_b64 v[38:39], 0
    v_mov_b64 v[254:255], 0
    v_mov_b64 v[152:153], 0
    v_mov_b64 v[154:155], 0
    v_mov_b64 v[156:157], 0
    v_mov_b64 v[158:159], 0
    v_mov_b64 v[160:161], 0
    v_mov_b64 v[162:163], 0
    v_mov_b64 v[164:165], 0
    v_mov_b64 v[166:167], 0
    v_mov_b64 v[168:169], 0
    v_mov_b64 v[170:171], 0
    v_mov_b64 v[172:173], 0
    v_mov_b64 v[174:175], 0
    v_mov_b64 v[176:177], 0
    v_mov_b64 v[178:179], 0
    v_mov_b64 v[180:181], 0
    v_mov_b64 v[182:183], 0
    v_mov_b64 v[184:185], 0
    v_mov_b64 v[186:187], 0
    v_mov_b64 v[188:189], 0
    v_mov_b64 v[190:191], 0
    v_mov_b64 v[192:193], 0
    v_mov_b64 v[194:195], 0
    v_mov_b64 v[196:197], 0
    v_mov_b64 v[198:199], 0
    v_mov_b64 v[200:201], 0
    v_mov_b64 v[202:203], 0
    v_mov_b64 v[204:205], 0
    v_mov_b64 v[206:207], 0
    v_mov_b64 v[208:209], 0
    v_mov_b64 v[210:211], 0
    v_mov_b64 v[212:213], 0
    v_mov_b64 v[214:215], 0
    s_cmp_eq_u32 s23, 1
    s_cbranch_scc1 main_kernel_grp1_27
    s_mov_b32 s41, 1
    s_mov_b32 s56, 1
    s_sub_u32 s25, s25, 32768
    s_xor_b32 s26, s26, 32768
    ds_read_b128 v[96:99], v4 offset:0
    ds_read_b128 v[100:103], v4 offset:1024
    ds_read_b128 v[104:107], v4 offset:2048
    ds_read_b128 v[108:111], v4 offset:3072
    ds_read_b128 v[112:115], v4 offset:4096
    ds_read_b128 v[116:119], v4 offset:5120
    s_setprio 1
    s_waitcnt lgkmcnt(4)
    v_mfma_f32_16x16x32_bf16 v[72:75], v[96:99], v[40:43], v[32:35]
    ds_read_b128 v[120:123], v4 offset:6144
    v_mfma_f32_16x16x32_bf16 v[76:79], v[96:99], v[56:59], v[36:39]
    v_mfma_f32_16x16x32_bf16 v[72:75], v[100:103], v[44:47], v[72:75]
    ds_read_b128 v[124:127], v4 offset:7168
    v_mfma_f32_16x16x32_bf16 v[76:79], v[100:103], v[60:63], v[76:79]
    s_waitcnt lgkmcnt(4)
    s_nop 0
    v_mfma_f32_16x16x32_bf16 v[72:75], v[104:107], v[48:51], v[72:75]
    v_mfma_f32_16x16x32_bf16 v[76:79], v[104:107], v[64:67], v[76:79]
    v_mfma_f32_16x16x32_bf16 v[72:75], v[108:111], v[52:55], v[72:75]
    v_mfma_f32_16x16x32_bf16 v[76:79], v[108:111], v[68:71], v[76:79]
    s_waitcnt lgkmcnt(2)
    s_nop 0
    v_mfma_f32_16x16x32_bf16 v[80:83], v[112:115], v[40:43], v[32:35]
    v_mfma_f32_16x16x32_bf16 v[84:87], v[112:115], v[56:59], v[36:39]
    v_mfma_f32_16x16x32_bf16 v[80:83], v[116:119], v[44:47], v[80:83]
    v_mfma_f32_16x16x32_bf16 v[84:87], v[116:119], v[60:63], v[84:87]
    s_waitcnt lgkmcnt(0)
    s_nop 0
    v_mfma_f32_16x16x32_bf16 v[80:83], v[120:123], v[48:51], v[80:83]
    v_mfma_f32_16x16x32_bf16 v[84:87], v[120:123], v[64:67], v[84:87]
    v_mfma_f32_16x16x32_bf16 v[80:83], v[124:127], v[52:55], v[80:83]
    v_mfma_f32_16x16x32_bf16 v[84:87], v[124:127], v[68:71], v[84:87]
    s_setprio 3
    .p2align 6
main_kernel_la0_29:
    s_cmp_ge_u32 s27, s38
    s_cbranch_scc1 main_kernel_spec_33
main_kernel_exp_34:
    v_exp_f32 v16, v72
    v_exp_f32 v17, v73
    v_exp_f32 v18, v76
    v_exp_f32 v19, v77
    s_cmp_lt_u32 s25, s30
    s_cselect_b32 s42, s25, 0xf0000000
    s_mov_b32 m0, s26
    s_add_u32 s25, s25, 32768
    buffer_load_dwordx4 v10, s[8:11], s42 offen offset:0 lds
    v_cvt_pk_bf16_f32 v88, v16, v17
    v_cvt_pk_bf16_f32 v92, v18, v19
    v_exp_f32 v20, v74
    v_exp_f32 v21, v75
    v_exp_f32 v22, v78
    buffer_load_dwordx4 v10, s[8:11], s42 offen offset:1024 lds
    v_exp_f32 v23, v79
    v_cvt_pk_bf16_f32 v89, v20, v21
    v_cvt_pk_bf16_f32 v93, v22, v23
    v_exp_f32 v16, v80
    v_exp_f32 v17, v81
    buffer_load_dwordx4 v10, s[8:11], s42 offen offset:2048 lds
    v_exp_f32 v18, v84
    v_exp_f32 v19, v85
    v_cvt_pk_bf16_f32 v90, v16, v17
    v_cvt_pk_bf16_f32 v94, v18, v19
    v_exp_f32 v20, v82
    buffer_load_dwordx4 v10, s[8:11], s42 offen offset:3072 lds
    s_xor_b32 s26, s26, 32768
    v_exp_f32 v21, v83
    v_exp_f32 v22, v86
    v_exp_f32 v23, v87
    v_cvt_pk_bf16_f32 v91, v20, v21
    v_cvt_pk_bf16_f32 v95, v22, v23
    v_or3_b32 v8, v88, v92, v89
    v_or3_b32 v9, v93, v90, v94
    v_or3_b32 v8, v8, v91, v95
    v_or_b32 v8, v8, v9
    v_and_b32 v12, s36, v8
    v_xor_b32 v5, 0x8000, v5
    v_cmp_ne_u32 vcc, 0, v12
    s_add_u32 s27, s27, 1
    s_cbranch_vccnz main_kernel_rare_35
main_kernel_chk_36:
    s_waitcnt vmcnt(4)
    s_barrier
    s_waitcnt lgkmcnt(1)
    ds_read_b128 v[96:99], v4 offset:8192
    s_waitcnt lgkmcnt(1)
    s_nop 0
    ds_read_b128 v[100:103], v4 offset:9216
    ds_read_b128 v[104:107], v4 offset:10240
    ds_read_b128 v[108:111], v4 offset:11264
    ds_read_b128 v[112:115], v4 offset:12288
    ds_read_b128 v[116:119], v4 offset:13312
    s_mov_b32 s57, s56
    s_cmp_le_u32 s27, s37
    s_cselect_b32 s56, 1, 0
    s_cmp_eq_u32 s56, 0
    s_cbranch_scc1 main_kernel_sq_37
    s_setprio 1
    s_waitcnt lgkmcnt(4)
    s_nop 0
    v_mfma_f32_16x16x32_bf16 v[72:75], v[96:99], v[40:43], v[32:35]
    ds_read_b128 v[120:123], v4 offset:14336
    v_mfma_f32_16x16x32_bf16 v[76:79], v[96:99], v[56:59], v[36:39]
    v_mfma_f32_16x16x32_bf16 v[72:75], v[100:103], v[44:47], v[72:75]
    ds_read_b128 v[124:127], v4 offset:15360
    v_mfma_f32_16x16x32_bf16 v[76:79], v[100:103], v[60:63], v[76:79]
    s_waitcnt lgkmcnt(4)
    s_nop 0
    v_mfma_f32_16x16x32_bf16 v[72:75], v[104:107], v[48:51], v[72:75]
    ds_read_b128 v[128:131], v5 offset:0
    v_mfma_f32_16x16x32_bf16 v[76:79], v[104:107], v[64:67], v[76:79]
    v_mfma_f32_16x16x32_bf16 v[72:75], v[108:111], v[52:55], v[72:75]
    ds_read_b128 v[132:135], v5 offset:1024
    v_mfma_f32_16x16x32_bf16 v[76:79], v[108:111], v[68:71], v[76:79]
    s_waitcnt lgkmcnt(4)
    s_nop 0
    v_mfma_f32_16x16x32_bf16 v[80:83], v[112:115], v[40:43], v[32:35]
    ds_read_b128 v[136:139], v5 offset:2048
    v_mfma_f32_16x16x32_bf16 v[84:87], v[112:115], v[56:59], v[36:39]
    v_mfma_f32_16x16x32_bf16 v[80:83], v[116:119], v[44:47], v[80:83]
    ds_read_b128 v[140:143], v5 offset:3072
    v_mfma_f32_16x16x32_bf16 v[84:87], v[116:119], v[60:63], v[84:87]
    s_waitcnt lgkmcnt(4)
    s_nop 0
    v_mfma_f32_16x16x32_bf16 v[80:83], v[120:123], v[48:51], v[80:83]
    ds_read_b128 v[96:99], v5 offset:4096
    v_mfma_f32_16x16x32_bf16 v[84:87], v[120:123], v[64:67], v[84:87]
    v_mfma_f32_16x16x32_bf16 v[80:83], v[124:127], v[52:55], v[80:83]
    ds_read_b128 v[100:103], v5 offset:5120
    v_mfma_f32_16x16x32_bf16 v[84:87], v[124:127], v[68:71], v[84:87]
main_kernel_pv_38:
    s_cmp_eq_u32 s57, 0
    s_cbranch_scc1 main_kernel_sp_39
    s_waitcnt lgkmcnt(4)
    s_nop 0
    v_mfma_f32_16x16x32_bf16 v[152:155], v[128:131], v[88:91], v[152:155]
    ds_read_b128 v[104:107], v5 offset:6144
    v_mfma_f32_16x16x32_bf16 v[156:159], v[128:131], v[92:95], v[156:159]
    v_mfma_f32_16x16x32_bf16 v[160:163], v[132:135], v[88:91], v[160:163]
    ds_read_b128 v[108:111], v5 offset:7168
    v_mfma_f32_16x16x32_bf16 v[164:167], v[132:135], v[92:95], v[164:167]
    s_waitcnt lgkmcnt(4)
    s_nop 0
    v_mfma_f32_16x16x32_bf16 v[168:171], v[136:139], v[88:91], v[168:171]
    v_mfma_f32_16x16x32_bf16 v[172:175], v[136:139], v[92:95], v[172:175]
    v_mfma_f32_16x16x32_bf16 v[176:179], v[140:143], v[88:91], v[176:179]
    v_mfma_f32_16x16x32_bf16 v[180:183], v[140:143], v[92:95], v[180:183]
    s_waitcnt lgkmcnt(2)
    s_nop 0
    v_mfma_f32_16x16x32_bf16 v[184:187], v[96:99], v[88:91], v[184:187]
    v_mfma_f32_16x16x32_bf16 v[188:191], v[96:99], v[92:95], v[188:191]
    v_mfma_f32_16x16x32_bf16 v[192:195], v[100:103], v[88:91], v[192:195]
    v_mfma_f32_16x16x32_bf16 v[196:199], v[100:103], v[92:95], v[196:199]
    s_waitcnt lgkmcnt(0)
    s_nop 0
    v_mfma_f32_16x16x32_bf16 v[200:203], v[104:107], v[88:91], v[200:203]
    v_mfma_f32_16x16x32_bf16 v[204:207], v[104:107], v[92:95], v[204:207]
    v_mfma_f32_16x16x32_bf16 v[248:251], v[28:31], v[88:91], v[248:251]
    v_mfma_f32_16x16x32_bf16 v[208:211], v[108:111], v[88:91], v[208:211]
    v_mfma_f32_16x16x32_bf16 v[212:215], v[108:111], v[92:95], v[212:215]
    v_mfma_f32_16x16x32_bf16 v[252:255], v[28:31], v[92:95], v[252:255]
main_kernel_me_40:
    s_setprio 3
    s_cmp_ge_u32 s27, s38
    s_cbranch_scc1 main_kernel_spec_41
main_kernel_exp_42:
    v_exp_f32 v16, v72
    v_exp_f32 v17, v73
    v_exp_f32 v18, v76
    v_exp_f32 v19, v77
    s_cmp_lt_u32 s28, s43
    s_cselect_b32 s42, s28, 0xf0000000
    s_mov_b32 m0, s29
    s_add_u32 s28, s28, 32768
    buffer_load_dwordx4 v10, s[8:11], s42 offen offset:0 lds
    v_cvt_pk_bf16_f32 v88, v16, v17
    v_cvt_pk_bf16_f32 v92, v18, v19
    v_exp_f32 v20, v74
    v_exp_f32 v21, v75
    v_exp_f32 v22, v78
    buffer_load_dwordx4 v10, s[8:11], s42 offen offset:1024 lds
    v_exp_f32 v23, v79
    v_cvt_pk_bf16_f32 v89, v20, v21
    v_cvt_pk_bf16_f32 v93, v22, v23
    v_exp_f32 v16, v80
    v_exp_f32 v17, v81
    buffer_load_dwordx4 v10, s[8:11], s42 offen offset:2048 lds
    v_exp_f32 v18, v84
    v_exp_f32 v19, v85
    v_cvt_pk_bf16_f32 v90, v16, v17
    v_cvt_pk_bf16_f32 v94, v18, v19
    v_exp_f32 v20, v82
    buffer_load_dwordx4 v10, s[8:11], s42 offen offset:3072 lds
    s_xor_b32 s29, s29, 32768
    v_exp_f32 v21, v83
    v_exp_f32 v22, v86
    v_exp_f32 v23, v87
    v_cvt_pk_bf16_f32 v91, v20, v21
    v_cvt_pk_bf16_f32 v95, v22, v23
    v_or3_b32 v8, v88, v92, v89
    v_or3_b32 v9, v93, v90, v94
    v_or3_b32 v8, v8, v91, v95
    v_or_b32 v8, v8, v9
    v_and_b32_e64 v12, s36, v8
    v_cmp_ne_u32 vcc, 0, v12
    s_add_u32 s27, s27, 1
    s_cbranch_vccnz main_kernel_rare_43
main_kernel_chk_44:
    s_waitcnt vmcnt(4)
    s_barrier
    s_waitcnt lgkmcnt(1)
    ds_read_b128 v[96:99], v4 offset:16384
    s_waitcnt lgkmcnt(1)
    s_nop 0
    ds_read_b128 v[100:103], v4 offset:17408
    ds_read_b128 v[104:107], v4 offset:18432
    ds_read_b128 v[108:111], v4 offset:19456
    ds_read_b128 v[112:115], v4 offset:20480
    ds_read_b128 v[116:119], v4 offset:21504
    s_mov_b32 s57, s56
    s_cmp_le_u32 s27, s37
    s_cselect_b32 s56, 1, 0
    s_cmp_eq_u32 s56, 0
    s_cbranch_scc1 main_kernel_sq_45
    s_setprio 1
    s_waitcnt lgkmcnt(4)
    s_nop 0
    v_mfma_f32_16x16x32_bf16 v[72:75], v[96:99], v[40:43], v[32:35]
    ds_read_b128 v[120:123], v4 offset:22528
    v_mfma_f32_16x16x32_bf16 v[76:79], v[96:99], v[56:59], v[36:39]
    v_mfma_f32_16x16x32_bf16 v[72:75], v[100:103], v[44:47], v[72:75]
    ds_read_b128 v[124:127], v4 offset:23552
    v_mfma_f32_16x16x32_bf16 v[76:79], v[100:103], v[60:63], v[76:79]
    s_waitcnt lgkmcnt(4)
    s_nop 0
    v_mfma_f32_16x16x32_bf16 v[72:75], v[104:107], v[48:51], v[72:75]
    ds_read_b128 v[128:131], v5 offset:8192
    v_mfma_f32_16x16x32_bf16 v[76:79], v[104:107], v[64:67], v[76:79]
    v_mfma_f32_16x16x32_bf16 v[72:75], v[108:111], v[52:55], v[72:75]
    ds_read_b128 v[132:135], v5 offset:9216
    v_mfma_f32_16x16x32_bf16 v[76:79], v[108:111], v[68:71], v[76:79]
    s_waitcnt lgkmcnt(4)
    s_nop 0
    v_mfma_f32_16x16x32_bf16 v[80:83], v[112:115], v[40:43], v[32:35]
    ds_read_b128 v[136:139], v5 offset:10240
    v_mfma_f32_16x16x32_bf16 v[84:87], v[112:115], v[56:59], v[36:39]
    v_mfma_f32_16x16x32_bf16 v[80:83], v[116:119], v[44:47], v[80:83]
    ds_read_b128 v[140:143], v5 offset:11264
    v_mfma_f32_16x16x32_bf16 v[84:87], v[116:119], v[60:63], v[84:87]
    s_waitcnt lgkmcnt(4)
    s_nop 0
    v_mfma_f32_16x16x32_bf16 v[80:83], v[120:123], v[48:51], v[80:83]
    ds_read_b128 v[96:99], v5 offset:12288
    v_mfma_f32_16x16x32_bf16 v[84:87], v[120:123], v[64:67], v[84:87]
    v_mfma_f32_16x16x32_bf16 v[80:83], v[124:127], v[52:55], v[80:83]
    ds_read_b128 v[100:103], v5 offset:13312
    v_mfma_f32_16x16x32_bf16 v[84:87], v[124:127], v[68:71], v[84:87]
main_kernel_pv_46:
    s_cmp_eq_u32 s57, 0
    s_cbranch_scc1 main_kernel_sp_47
    s_waitcnt lgkmcnt(4)
    s_nop 0
    v_mfma_f32_16x16x32_bf16 v[152:155], v[128:131], v[88:91], v[152:155]
    ds_read_b128 v[104:107], v5 offset:14336
    v_mfma_f32_16x16x32_bf16 v[156:159], v[128:131], v[92:95], v[156:159]
    v_mfma_f32_16x16x32_bf16 v[160:163], v[132:135], v[88:91], v[160:163]
    ds_read_b128 v[108:111], v5 offset:15360
    v_mfma_f32_16x16x32_bf16 v[164:167], v[132:135], v[92:95], v[164:167]
    s_waitcnt lgkmcnt(4)
    s_nop 0
    v_mfma_f32_16x16x32_bf16 v[168:171], v[136:139], v[88:91], v[168:171]
    v_mfma_f32_16x16x32_bf16 v[172:175], v[136:139], v[92:95], v[172:175]
    v_mfma_f32_16x16x32_bf16 v[176:179], v[140:143], v[88:91], v[176:179]
    v_mfma_f32_16x16x32_bf16 v[180:183], v[140:143], v[92:95], v[180:183]
    s_waitcnt lgkmcnt(2)
    s_nop 0
    v_mfma_f32_16x16x32_bf16 v[184:187], v[96:99], v[88:91], v[184:187]
    v_mfma_f32_16x16x32_bf16 v[188:191], v[96:99], v[92:95], v[188:191]
    v_mfma_f32_16x16x32_bf16 v[192:195], v[100:103], v[88:91], v[192:195]
    v_mfma_f32_16x16x32_bf16 v[196:199], v[100:103], v[92:95], v[196:199]
    s_waitcnt lgkmcnt(0)
    s_nop 0
    v_mfma_f32_16x16x32_bf16 v[200:203], v[104:107], v[88:91], v[200:203]
    v_mfma_f32_16x16x32_bf16 v[204:207], v[104:107], v[92:95], v[204:207]
    v_mfma_f32_16x16x32_bf16 v[248:251], v[28:31], v[88:91], v[248:251]
    v_mfma_f32_16x16x32_bf16 v[208:211], v[108:111], v[88:91], v[208:211]
    v_mfma_f32_16x16x32_bf16 v[212:215], v[108:111], v[92:95], v[212:215]
    v_mfma_f32_16x16x32_bf16 v[252:255], v[28:31], v[92:95], v[252:255]
main_kernel_me_48:
    s_setprio 3
    s_cmp_ge_u32 s27, s38
    s_cbranch_scc1 main_kernel_spec_49
main_kernel_exp_50:
    v_exp_f32 v16, v72
    v_exp_f32 v17, v73
    v_exp_f32 v18, v76
    v_exp_f32 v19, v77
    v_cvt_pk_bf16_f32 v88, v16, v17
    v_cvt_pk_bf16_f32 v92, v18, v19
    v_exp_f32 v20, v74
    v_exp_f32 v21, v75
    v_exp_f32 v22, v78
    v_exp_f32 v23, v79
    v_cvt_pk_bf16_f32 v89, v20, v21
    v_cvt_pk_bf16_f32 v93, v22, v23
    v_exp_f32 v16, v80
    v_exp_f32 v17, v81
    v_exp_f32 v18, v84
    v_exp_f32 v19, v85
    v_cvt_pk_bf16_f32 v90, v16, v17
    v_cvt_pk_bf16_f32 v94, v18, v19
    v_exp_f32 v20, v82
    v_exp_f32 v21, v83
    v_exp_f32 v22, v86
    v_exp_f32 v23, v87
    v_cvt_pk_bf16_f32 v91, v20, v21
    v_cvt_pk_bf16_f32 v95, v22, v23
    v_or3_b32 v8, v88, v92, v89
    v_or3_b32 v9, v93, v90, v94
    v_or3_b32 v8, v8, v91, v95
    v_or_b32 v8, v8, v9
    v_and_b32_e64 v12, s36, v8
    v_cmp_ne_u32 vcc, 0, v12
    s_add_u32 s27, s27, 1
    s_cbranch_vccnz main_kernel_rare_51
main_kernel_chk_52:
    s_waitcnt vmcnt(0)
    s_barrier
    s_waitcnt lgkmcnt(1)
    ds_read_b128 v[96:99], v4 offset:24576
    s_waitcnt lgkmcnt(1)
    s_nop 0
    ds_read_b128 v[100:103], v4 offset:25600
    ds_read_b128 v[104:107], v4 offset:26624
    ds_read_b128 v[108:111], v4 offset:27648
    ds_read_b128 v[112:115], v4 offset:28672
    ds_read_b128 v[116:119], v4 offset:29696
    s_mov_b32 s57, s56
    s_cmp_le_u32 s27, s37
    s_cselect_b32 s56, 1, 0
    s_cmp_eq_u32 s56, 0
    s_cbranch_scc1 main_kernel_sq_53
    s_setprio 1
    s_waitcnt lgkmcnt(4)
    s_nop 0
    v_mfma_f32_16x16x32_bf16 v[72:75], v[96:99], v[40:43], v[32:35]
    ds_read_b128 v[120:123], v4 offset:30720
    v_mfma_f32_16x16x32_bf16 v[76:79], v[96:99], v[56:59], v[36:39]
    v_mfma_f32_16x16x32_bf16 v[72:75], v[100:103], v[44:47], v[72:75]
    ds_read_b128 v[124:127], v4 offset:31744
    v_mfma_f32_16x16x32_bf16 v[76:79], v[100:103], v[60:63], v[76:79]
    s_waitcnt lgkmcnt(4)
    s_nop 0
    v_mfma_f32_16x16x32_bf16 v[72:75], v[104:107], v[48:51], v[72:75]
    ds_read_b128 v[128:131], v5 offset:16384
    v_mfma_f32_16x16x32_bf16 v[76:79], v[104:107], v[64:67], v[76:79]
    v_mfma_f32_16x16x32_bf16 v[72:75], v[108:111], v[52:55], v[72:75]
    ds_read_b128 v[132:135], v5 offset:17408
    v_mfma_f32_16x16x32_bf16 v[76:79], v[108:111], v[68:71], v[76:79]
    s_waitcnt lgkmcnt(4)
    s_nop 0
    v_mfma_f32_16x16x32_bf16 v[80:83], v[112:115], v[40:43], v[32:35]
    ds_read_b128 v[136:139], v5 offset:18432
    v_mfma_f32_16x16x32_bf16 v[84:87], v[112:115], v[56:59], v[36:39]
    v_mfma_f32_16x16x32_bf16 v[80:83], v[116:119], v[44:47], v[80:83]
    ds_read_b128 v[140:143], v5 offset:19456
    v_mfma_f32_16x16x32_bf16 v[84:87], v[116:119], v[60:63], v[84:87]
    s_waitcnt lgkmcnt(4)
    s_nop 0
    v_mfma_f32_16x16x32_bf16 v[80:83], v[120:123], v[48:51], v[80:83]
    ds_read_b128 v[96:99], v5 offset:20480
    v_mfma_f32_16x16x32_bf16 v[84:87], v[120:123], v[64:67], v[84:87]
    v_mfma_f32_16x16x32_bf16 v[80:83], v[124:127], v[52:55], v[80:83]
    ds_read_b128 v[100:103], v5 offset:21504
    v_mfma_f32_16x16x32_bf16 v[84:87], v[124:127], v[68:71], v[84:87]
main_kernel_pv_54:
    s_cmp_eq_u32 s57, 0
    s_cbranch_scc1 main_kernel_sp_55
    s_waitcnt lgkmcnt(4)
    s_nop 0
    v_mfma_f32_16x16x32_bf16 v[152:155], v[128:131], v[88:91], v[152:155]
    ds_read_b128 v[104:107], v5 offset:22528
    v_mfma_f32_16x16x32_bf16 v[156:159], v[128:131], v[92:95], v[156:159]
    v_mfma_f32_16x16x32_bf16 v[160:163], v[132:135], v[88:91], v[160:163]
    ds_read_b128 v[108:111], v5 offset:23552
    v_mfma_f32_16x16x32_bf16 v[164:167], v[132:135], v[92:95], v[164:167]
    s_waitcnt lgkmcnt(4)
    s_nop 0
    v_mfma_f32_16x16x32_bf16 v[168:171], v[136:139], v[88:91], v[168:171]
    v_mfma_f32_16x16x32_bf16 v[172:175], v[136:139], v[92:95], v[172:175]
    v_mfma_f32_16x16x32_bf16 v[176:179], v[140:143], v[88:91], v[176:179]
    v_mfma_f32_16x16x32_bf16 v[180:183], v[140:143], v[92:95], v[180:183]
    s_waitcnt lgkmcnt(2)
    s_nop 0
    v_mfma_f32_16x16x32_bf16 v[184:187], v[96:99], v[88:91], v[184:187]
    v_mfma_f32_16x16x32_bf16 v[188:191], v[96:99], v[92:95], v[188:191]
    v_mfma_f32_16x16x32_bf16 v[192:195], v[100:103], v[88:91], v[192:195]
    v_mfma_f32_16x16x32_bf16 v[196:199], v[100:103], v[92:95], v[196:199]
    s_waitcnt lgkmcnt(0)
    s_nop 0
    v_mfma_f32_16x16x32_bf16 v[200:203], v[104:107], v[88:91], v[200:203]
    v_mfma_f32_16x16x32_bf16 v[204:207], v[104:107], v[92:95], v[204:207]
    v_mfma_f32_16x16x32_bf16 v[248:251], v[28:31], v[88:91], v[248:251]
    v_mfma_f32_16x16x32_bf16 v[208:211], v[108:111], v[88:91], v[208:211]
    v_mfma_f32_16x16x32_bf16 v[212:215], v[108:111], v[92:95], v[212:215]
    v_mfma_f32_16x16x32_bf16 v[252:255], v[28:31], v[92:95], v[252:255]
main_kernel_me_56:
    s_setprio 3
    s_cmp_ge_u32 s27, s38
    s_cbranch_scc1 main_kernel_spec_57
main_kernel_exp_58:
    v_exp_f32 v16, v72
    v_exp_f32 v17, v73
    v_exp_f32 v18, v76
    v_exp_f32 v19, v77
    v_cvt_pk_bf16_f32 v88, v16, v17
    v_cvt_pk_bf16_f32 v92, v18, v19
    v_exp_f32 v20, v74
    v_exp_f32 v21, v75
    v_exp_f32 v22, v78
    v_exp_f32 v23, v79
    v_cvt_pk_bf16_f32 v89, v20, v21
    v_cvt_pk_bf16_f32 v93, v22, v23
    v_exp_f32 v16, v80
    v_exp_f32 v17, v81
    v_exp_f32 v18, v84
    v_exp_f32 v19, v85
    v_cvt_pk_bf16_f32 v90, v16, v17
    v_cvt_pk_bf16_f32 v94, v18, v19
    v_exp_f32 v20, v82
    v_exp_f32 v21, v83
    v_exp_f32 v22, v86
    v_exp_f32 v23, v87
    v_cvt_pk_bf16_f32 v91, v20, v21
    v_cvt_pk_bf16_f32 v95, v22, v23
    v_or3_b32 v8, v88, v92, v89
    v_or3_b32 v9, v93, v90, v94
    v_or3_b32 v8, v8, v91, v95
    v_or_b32 v8, v8, v9
    v_and_b32 v12, s36, v8
    v_xor_b32 v4, 0x8000, v4
    v_cmp_ne_u32 vcc, 0, v12
    s_add_u32 s27, s27, 1
    s_cbranch_vccnz main_kernel_rare_59
main_kernel_chk_60:
    s_waitcnt vmcnt(0)
    s_sub_u32 s31, s31, 1
    s_cmp_eq_u32 s31, 0
    s_cbranch_scc1 main_kernel_ab0_32
    s_barrier
    s_waitcnt lgkmcnt(1)
    ds_read_b128 v[96:99], v4 offset:0
    s_waitcnt lgkmcnt(1)
    s_nop 0
    ds_read_b128 v[100:103], v4 offset:1024
    ds_read_b128 v[104:107], v4 offset:2048
    ds_read_b128 v[108:111], v4 offset:3072
    ds_read_b128 v[112:115], v4 offset:4096
    ds_read_b128 v[116:119], v4 offset:5120
    s_mov_b32 s57, s56
    s_cmp_le_u32 s27, s37
    s_cselect_b32 s56, 1, 0
    s_cmp_eq_u32 s56, 0
    s_cbranch_scc1 main_kernel_sq_61
    s_setprio 1
    s_waitcnt lgkmcnt(4)
    s_nop 0
    v_mfma_f32_16x16x32_bf16 v[72:75], v[96:99], v[40:43], v[32:35]
    ds_read_b128 v[120:123], v4 offset:6144
    v_mfma_f32_16x16x32_bf16 v[76:79], v[96:99], v[56:59], v[36:39]
    v_mfma_f32_16x16x32_bf16 v[72:75], v[100:103], v[44:47], v[72:75]
    ds_read_b128 v[124:127], v4 offset:7168
    v_mfma_f32_16x16x32_bf16 v[76:79], v[100:103], v[60:63], v[76:79]
    s_waitcnt lgkmcnt(4)
    s_nop 0
    v_mfma_f32_16x16x32_bf16 v[72:75], v[104:107], v[48:51], v[72:75]
    ds_read_b128 v[128:131], v5 offset:24576
    v_mfma_f32_16x16x32_bf16 v[76:79], v[104:107], v[64:67], v[76:79]
    v_mfma_f32_16x16x32_bf16 v[72:75], v[108:111], v[52:55], v[72:75]
    ds_read_b128 v[132:135], v5 offset:25600
    v_mfma_f32_16x16x32_bf16 v[76:79], v[108:111], v[68:71], v[76:79]
    s_waitcnt lgkmcnt(4)
    s_nop 0
    v_mfma_f32_16x16x32_bf16 v[80:83], v[112:115], v[40:43], v[32:35]
    ds_read_b128 v[136:139], v5 offset:26624
    v_mfma_f32_16x16x32_bf16 v[84:87], v[112:115], v[56:59], v[36:39]
    v_mfma_f32_16x16x32_bf16 v[80:83], v[116:119], v[44:47], v[80:83]
    ds_read_b128 v[140:143], v5 offset:27648
    v_mfma_f32_16x16x32_bf16 v[84:87], v[116:119], v[60:63], v[84:87]
    s_waitcnt lgkmcnt(4)
    s_nop 0
    v_mfma_f32_16x16x32_bf16 v[80:83], v[120:123], v[48:51], v[80:83]
    ds_read_b128 v[96:99], v5 offset:28672
    v_mfma_f32_16x16x32_bf16 v[84:87], v[120:123], v[64:67], v[84:87]
    v_mfma_f32_16x16x32_bf16 v[80:83], v[124:127], v[52:55], v[80:83]
    ds_read_b128 v[100:103], v5 offset:29696
    v_mfma_f32_16x16x32_bf16 v[84:87], v[124:127], v[68:71], v[84:87]
main_kernel_pv_62:
    s_cmp_eq_u32 s57, 0
    s_cbranch_scc1 main_kernel_sp_63
    s_waitcnt lgkmcnt(4)
    s_nop 0
    v_mfma_f32_16x16x32_bf16 v[152:155], v[128:131], v[88:91], v[152:155]
    ds_read_b128 v[104:107], v5 offset:30720
    v_mfma_f32_16x16x32_bf16 v[156:159], v[128:131], v[92:95], v[156:159]
    v_mfma_f32_16x16x32_bf16 v[160:163], v[132:135], v[88:91], v[160:163]
    ds_read_b128 v[108:111], v5 offset:31744
    v_mfma_f32_16x16x32_bf16 v[164:167], v[132:135], v[92:95], v[164:167]
    s_waitcnt lgkmcnt(4)
    s_nop 0
    v_mfma_f32_16x16x32_bf16 v[168:171], v[136:139], v[88:91], v[168:171]
    v_mfma_f32_16x16x32_bf16 v[172:175], v[136:139], v[92:95], v[172:175]
    v_mfma_f32_16x16x32_bf16 v[176:179], v[140:143], v[88:91], v[176:179]
    v_mfma_f32_16x16x32_bf16 v[180:183], v[140:143], v[92:95], v[180:183]
    s_waitcnt lgkmcnt(2)
    s_nop 0
    v_mfma_f32_16x16x32_bf16 v[184:187], v[96:99], v[88:91], v[184:187]
    v_mfma_f32_16x16x32_bf16 v[188:191], v[96:99], v[92:95], v[188:191]
    v_mfma_f32_16x16x32_bf16 v[192:195], v[100:103], v[88:91], v[192:195]
    v_mfma_f32_16x16x32_bf16 v[196:199], v[100:103], v[92:95], v[196:199]
    s_waitcnt lgkmcnt(0)
    s_nop 0
    v_mfma_f32_16x16x32_bf16 v[200:203], v[104:107], v[88:91], v[200:203]
    v_mfma_f32_16x16x32_bf16 v[204:207], v[104:107], v[92:95], v[204:207]
    v_mfma_f32_16x16x32_bf16 v[248:251], v[28:31], v[88:91], v[248:251]
    v_mfma_f32_16x16x32_bf16 v[208:211], v[108:111], v[88:91], v[208:211]
    v_mfma_f32_16x16x32_bf16 v[212:215], v[108:111], v[92:95], v[212:215]
    v_mfma_f32_16x16x32_bf16 v[252:255], v[28:31], v[92:95], v[252:255]
main_kernel_me_64:
    s_setprio 3
    s_branch main_kernel_la0_29
main_kernel_ab0_32:
    s_lshl_b32 s31, s22, 1
    s_sub_u32 s31, 15, s31
    s_barrier
    s_waitcnt lgkmcnt(1)
    ds_read_b128 v[96:99], v4 offset:0
    s_waitcnt lgkmcnt(1)
    s_nop 0
    ds_read_b128 v[100:103], v4 offset:1024
    ds_read_b128 v[104:107], v4 offset:2048
    ds_read_b128 v[108:111], v4 offset:3072
    ds_read_b128 v[112:115], v4 offset:4096
    ds_read_b128 v[116:119], v4 offset:5120
    s_mov_b32 s57, s56
    s_cmp_le_u32 s27, s37
    s_cselect_b32 s56, 1, 0
    s_cmp_eq_u32 s56, 0
    s_cbranch_scc1 main_kernel_sq_65
    s_setprio 1
    s_waitcnt lgkmcnt(4)
    s_nop 0
    v_mfma_f32_16x16x32_bf16 v[72:75], v[96:99], v[40:43], v[32:35]
    ds_read_b128 v[120:123], v4 offset:6144
    v_mfma_f32_16x16x32_bf16 v[76:79], v[96:99], v[56:59], v[36:39]
    v_mfma_f32_16x16x32_bf16 v[72:75], v[100:103], v[44:47], v[72:75]
    ds_read_b128 v[124:127], v4 offset:7168
    v_mfma_f32_16x16x32_bf16 v[76:79], v[100:103], v[60:63], v[76:79]
    s_waitcnt lgkmcnt(4)
    s_nop 0
    v_mfma_f32_16x16x32_bf16 v[72:75], v[104:107], v[48:51], v[72:75]
    ds_read_b128 v[128:131], v5 offset:24576
    v_mfma_f32_16x16x32_bf16 v[76:79], v[104:107], v[64:67], v[76:79]
    v_mfma_f32_16x16x32_bf16 v[72:75], v[108:111], v[52:55], v[72:75]
    ds_read_b128 v[132:135], v5 offset:25600
    v_mfma_f32_16x16x32_bf16 v[76:79], v[108:111], v[68:71], v[76:79]
    s_waitcnt lgkmcnt(4)
    s_nop 0
    v_mfma_f32_16x16x32_bf16 v[80:83], v[112:115], v[40:43], v[32:35]
    ds_read_b128 v[136:139], v5 offset:26624
    v_mfma_f32_16x16x32_bf16 v[84:87], v[112:115], v[56:59], v[36:39]
    v_mfma_f32_16x16x32_bf16 v[80:83], v[116:119], v[44:47], v[80:83]
    ds_read_b128 v[140:143], v5 offset:27648
    v_mfma_f32_16x16x32_bf16 v[84:87], v[116:119], v[60:63], v[84:87]
    s_waitcnt lgkmcnt(4)
    s_nop 0
    v_mfma_f32_16x16x32_bf16 v[80:83], v[120:123], v[48:51], v[80:83]
    ds_read_b128 v[96:99], v5 offset:28672
    v_mfma_f32_16x16x32_bf16 v[84:87], v[120:123], v[64:67], v[84:87]
    v_mfma_f32_16x16x32_bf16 v[80:83], v[124:127], v[52:55], v[80:83]
    ds_read_b128 v[100:103], v5 offset:29696
    v_mfma_f32_16x16x32_bf16 v[84:87], v[124:127], v[68:71], v[84:87]
main_kernel_pv_66:
    s_cmp_eq_u32 s57, 0
    s_cbranch_scc1 main_kernel_sp_67
    s_waitcnt lgkmcnt(4)
    s_nop 0
    v_mfma_f32_16x16x32_bf16 v[152:155], v[128:131], v[88:91], v[152:155]
    ds_read_b128 v[104:107], v5 offset:30720
    v_mfma_f32_16x16x32_bf16 v[156:159], v[128:131], v[92:95], v[156:159]
    v_mfma_f32_16x16x32_bf16 v[160:163], v[132:135], v[88:91], v[160:163]
    ds_read_b128 v[108:111], v5 offset:31744
    v_mfma_f32_16x16x32_bf16 v[164:167], v[132:135], v[92:95], v[164:167]
    s_waitcnt lgkmcnt(4)
    s_nop 0
    v_mfma_f32_16x16x32_bf16 v[168:171], v[136:139], v[88:91], v[168:171]
    v_mfma_f32_16x16x32_bf16 v[172:175], v[136:139], v[92:95], v[172:175]
    v_mfma_f32_16x16x32_bf16 v[176:179], v[140:143], v[88:91], v[176:179]
    v_mfma_f32_16x16x32_bf16 v[180:183], v[140:143], v[92:95], v[180:183]
    s_waitcnt lgkmcnt(2)
    s_nop 0
    v_mfma_f32_16x16x32_bf16 v[184:187], v[96:99], v[88:91], v[184:187]
    v_mfma_f32_16x16x32_bf16 v[188:191], v[96:99], v[92:95], v[188:191]
    v_mfma_f32_16x16x32_bf16 v[192:195], v[100:103], v[88:91], v[192:195]
    v_mfma_f32_16x16x32_bf16 v[196:199], v[100:103], v[92:95], v[196:199]
    s_waitcnt lgkmcnt(0)
    s_nop 0
    v_mfma_f32_16x16x32_bf16 v[200:203], v[104:107], v[88:91], v[200:203]
    v_mfma_f32_16x16x32_bf16 v[204:207], v[104:107], v[92:95], v[204:207]
    v_mfma_f32_16x16x32_bf16 v[248:251], v[28:31], v[88:91], v[248:251]
    v_mfma_f32_16x16x32_bf16 v[208:211], v[108:111], v[88:91], v[208:211]
    v_mfma_f32_16x16x32_bf16 v[212:215], v[108:111], v[92:95], v[212:215]
    v_mfma_f32_16x16x32_bf16 v[252:255], v[28:31], v[92:95], v[252:255]
main_kernel_me_68:
    s_setprio 3
    .p2align 6
main_kernel_lb0_30:
    s_cmp_ge_u32 s27, s38
    s_cbranch_scc1 main_kernel_spec_69
main_kernel_exp_70:
    v_exp_f32 v16, v72
    v_exp_f32 v17, v73
    v_exp_f32 v18, v76
    v_exp_f32 v19, v77
    s_cmp_lt_u32 s25, s30
    s_cselect_b32 s42, s25, 0xf0000000
    s_mov_b32 m0, s26
    s_add_u32 s25, s25, 32768
    buffer_load_dwordx4 v10, s[8:11], s42 offen offset:0 lds
    v_cvt_pk_bf16_f32 v88, v16, v17
    v_cvt_pk_bf16_f32 v92, v18, v19
    v_exp_f32 v20, v74
    v_exp_f32 v21, v75
    v_exp_f32 v22, v78
    buffer_load_dwordx4 v10, s[8:11], s42 offen offset:1024 lds
    v_exp_f32 v23, v79
    v_cvt_pk_bf16_f32 v89, v20, v21
    v_cvt_pk_bf16_f32 v93, v22, v23
    v_exp_f32 v16, v80
    v_exp_f32 v17, v81
    buffer_load_dwordx4 v10, s[8:11], s42 offen offset:2048 lds
    v_exp_f32 v18, v84
    v_exp_f32 v19, v85
    v_cvt_pk_bf16_f32 v90, v16, v17
    v_cvt_pk_bf16_f32 v94, v18, v19
    v_exp_f32 v20, v82
    buffer_load_dwordx4 v10, s[8:11], s42 offen offset:3072 lds
    s_xor_b32 s26, s26, 32768
    v_exp_f32 v21, v83
    v_exp_f32 v22, v86
    v_exp_f32 v23, v87
    v_cvt_pk_bf16_f32 v91, v20, v21
    v_cvt_pk_bf16_f32 v95, v22, v23
    v_or3_b32 v8, v88, v92, v89
    v_or3_b32 v9, v93, v90, v94
    v_or3_b32 v8, v8, v91, v95
    v_or_b32 v8, v8, v9
    v_and_b32 v12, s36, v8
    v_xor_b32 v5, 0x8000, v5
    v_cmp_ne_u32 vcc, 0, v12
    s_add_u32 s27, s27, 1
    s_cbranch_vccnz main_kernel_rare_71
main_kernel_chk_72:
    s_waitcnt vmcnt(4)
    s_barrier
    s_waitcnt lgkmcnt(1)
    ds_read_b128 v[96:99], v4 offset:8192
    s_waitcnt lgkmcnt(1)
    s_nop 0
    ds_read_b128 v[100:103], v4 offset:9216
    ds_read_b128 v[104:107], v4 offset:10240
    ds_read_b128 v[108:111], v4 offset:11264
    ds_read_b128 v[112:115], v4 offset:12288
    ds_read_b128 v[116:119], v4 offset:13312
    s_mov_b32 s57, s56
    s_cmp_le_u32 s27, s37
    s_cselect_b32 s56, 1, 0
    s_cmp_eq_u32 s56, 0
    s_cbranch_scc1 main_kernel_sq_73
    s_setprio 1
    s_waitcnt lgkmcnt(4)
    s_nop 0
    v_mfma_f32_16x16x32_bf16 v[72:75], v[96:99], v[40:43], v[32:35]
    ds_read_b128 v[120:123], v4 offset:14336
    v_mfma_f32_16x16x32_bf16 v[76:79], v[96:99], v[56:59], v[36:39]
    v_mfma_f32_16x16x32_bf16 v[72:75], v[100:103], v[44:47], v[72:75]
    ds_read_b128 v[124:127], v4 offset:15360
    v_mfma_f32_16x16x32_bf16 v[76:79], v[100:103], v[60:63], v[76:79]
    s_waitcnt lgkmcnt(4)
    s_nop 0
    v_mfma_f32_16x16x32_bf16 v[72:75], v[104:107], v[48:51], v[72:75]
    ds_read_b128 v[128:131], v5 offset:0
    v_mfma_f32_16x16x32_bf16 v[76:79], v[104:107], v[64:67], v[76:79]
    v_mfma_f32_16x16x32_bf16 v[72:75], v[108:111], v[52:55], v[72:75]
    ds_read_b128 v[132:135], v5 offset:1024
    v_mfma_f32_16x16x32_bf16 v[76:79], v[108:111], v[68:71], v[76:79]
    s_waitcnt lgkmcnt(4)
    s_nop 0
    v_mfma_f32_16x16x32_bf16 v[80:83], v[112:115], v[40:43], v[32:35]
    ds_read_b128 v[136:139], v5 offset:2048
    v_mfma_f32_16x16x32_bf16 v[84:87], v[112:115], v[56:59], v[36:39]
    v_mfma_f32_16x16x32_bf16 v[80:83], v[116:119], v[44:47], v[80:83]
    ds_read_b128 v[140:143], v5 offset:3072
    v_mfma_f32_16x16x32_bf16 v[84:87], v[116:119], v[60:63], v[84:87]
    s_waitcnt lgkmcnt(4)
    s_nop 0
    v_mfma_f32_16x16x32_bf16 v[80:83], v[120:123], v[48:51], v[80:83]
    ds_read_b128 v[96:99], v5 offset:4096
    v_mfma_f32_16x16x32_bf16 v[84:87], v[120:123], v[64:67], v[84:87]
    v_mfma_f32_16x16x32_bf16 v[80:83], v[124:127], v[52:55], v[80:83]
    ds_read_b128 v[100:103], v5 offset:5120
    v_mfma_f32_16x16x32_bf16 v[84:87], v[124:127], v[68:71], v[84:87]
main_kernel_pv_74:
    s_cmp_eq_u32 s57, 0
    s_cbranch_scc1 main_kernel_sp_75
    s_waitcnt lgkmcnt(4)
    s_nop 0
    v_mfma_f32_16x16x32_bf16 v[152:155], v[128:131], v[88:91], v[152:155]
    ds_read_b128 v[104:107], v5 offset:6144
    v_mfma_f32_16x16x32_bf16 v[156:159], v[128:131], v[92:95], v[156:159]
    v_mfma_f32_16x16x32_bf16 v[160:163], v[132:135], v[88:91], v[160:163]
    ds_read_b128 v[108:111], v5 offset:7168
    v_mfma_f32_16x16x32_bf16 v[164:167], v[132:135], v[92:95], v[164:167]
    s_waitcnt lgkmcnt(4)
    s_nop 0
    v_mfma_f32_16x16x32_bf16 v[168:171], v[136:139], v[88:91], v[168:171]
    v_mfma_f32_16x16x32_bf16 v[172:175], v[136:139], v[92:95], v[172:175]
    v_mfma_f32_16x16x32_bf16 v[176:179], v[140:143], v[88:91], v[176:179]
    v_mfma_f32_16x16x32_bf16 v[180:183], v[140:143], v[92:95], v[180:183]
    s_waitcnt lgkmcnt(2)
    s_nop 0
    v_mfma_f32_16x16x32_bf16 v[184:187], v[96:99], v[88:91], v[184:187]
    v_mfma_f32_16x16x32_bf16 v[188:191], v[96:99], v[92:95], v[188:191]
    v_mfma_f32_16x16x32_bf16 v[192:195], v[100:103], v[88:91], v[192:195]
    v_mfma_f32_16x16x32_bf16 v[196:199], v[100:103], v[92:95], v[196:199]
    s_waitcnt lgkmcnt(0)
    s_nop 0
    v_mfma_f32_16x16x32_bf16 v[200:203], v[104:107], v[88:91], v[200:203]
    v_mfma_f32_16x16x32_bf16 v[204:207], v[104:107], v[92:95], v[204:207]
    v_mfma_f32_16x16x32_bf16 v[248:251], v[28:31], v[88:91], v[248:251]
    v_mfma_f32_16x16x32_bf16 v[208:211], v[108:111], v[88:91], v[208:211]
    v_mfma_f32_16x16x32_bf16 v[212:215], v[108:111], v[92:95], v[212:215]
    v_mfma_f32_16x16x32_bf16 v[252:255], v[28:31], v[92:95], v[252:255]
main_kernel_me_76:
    s_setprio 3
    s_cmp_ge_u32 s27, s38
    s_cbranch_scc1 main_kernel_spec_77
main_kernel_exp_78:
    v_exp_f32 v16, v72
    v_exp_f32 v17, v73
    v_exp_f32 v18, v76
    v_exp_f32 v19, v77
    s_cmp_lt_u32 s28, s43
    s_cselect_b32 s42, s28, 0xf0000000
    s_mov_b32 m0, s29
    s_add_u32 s28, s28, 32768
    buffer_load_dwordx4 v10, s[8:11], s42 offen offset:0 lds
    v_cvt_pk_bf16_f32 v88, v16, v17
    v_cvt_pk_bf16_f32 v92, v18, v19
    v_exp_f32 v20, v74
    v_exp_f32 v21, v75
    v_exp_f32 v22, v78
    buffer_load_dwordx4 v10, s[8:11], s42 offen offset:1024 lds
    v_exp_f32 v23, v79
    v_cvt_pk_bf16_f32 v89, v20, v21
    v_cvt_pk_bf16_f32 v93, v22, v23
    v_exp_f32 v16, v80
    v_exp_f32 v17, v81
    buffer_load_dwordx4 v10, s[8:11], s42 offen offset:2048 lds
    v_exp_f32 v18, v84
    v_exp_f32 v19, v85
    v_cvt_pk_bf16_f32 v90, v16, v17
    v_cvt_pk_bf16_f32 v94, v18, v19
    v_exp_f32 v20, v82
    buffer_load_dwordx4 v10, s[8:11], s42 offen offset:3072 lds
    s_xor_b32 s29, s29, 32768
    v_exp_f32 v21, v83
    v_exp_f32 v22, v86
    v_exp_f32 v23, v87
    v_cvt_pk_bf16_f32 v91, v20, v21
    v_cvt_pk_bf16_f32 v95, v22, v23
    v_or3_b32 v8, v88, v92, v89
    v_or3_b32 v9, v93, v90, v94
    v_or3_b32 v8, v8, v91, v95
    v_or_b32 v8, v8, v9
    v_and_b32 v12, s36, v8
    v_xor_b32 v4, 0x8000, v4
    v_cmp_ne_u32 vcc, 0, v12
    s_add_u32 s27, s27, 3
    s_cbranch_vccnz main_kernel_rare_79
main_kernel_chk_80:
    s_waitcnt vmcnt(4)
    s_barrier
    s_sub_u32 s31, s31, 1
    s_cmp_eq_u32 s31, 0
    s_cbranch_scc1 main_kernel_last0_31
    s_waitcnt lgkmcnt(1)
    ds_read_b128 v[96:99], v4 offset:0
    s_waitcnt lgkmcnt(1)
    s_nop 0
    ds_read_b128 v[100:103], v4 offset:1024
    ds_read_b128 v[104:107], v4 offset:2048
    ds_read_b128 v[108:111], v4 offset:3072
    ds_read_b128 v[112:115], v4 offset:4096
    ds_read_b128 v[116:119], v4 offset:5120
    s_mov_b32 s57, s56
    s_cmp_le_u32 s27, s37
    s_cselect_b32 s56, 1, 0
    s_cmp_eq_u32 s56, 0
    s_cbranch_scc1 main_kernel_sq_81
    s_setprio 1
    s_waitcnt lgkmcnt(4)
    s_nop 0
    v_mfma_f32_16x16x32_bf16 v[72:75], v[96:99], v[40:43], v[32:35]
    ds_read_b128 v[120:123], v4 offset:6144
    v_mfma_f32_16x16x32_bf16 v[76:79], v[96:99], v[56:59], v[36:39]
    v_mfma_f32_16x16x32_bf16 v[72:75], v[100:103], v[44:47], v[72:75]
    ds_read_b128 v[124:127], v4 offset:7168
    v_mfma_f32_16x16x32_bf16 v[76:79], v[100:103], v[60:63], v[76:79]
    s_waitcnt lgkmcnt(4)
    s_nop 0
    v_mfma_f32_16x16x32_bf16 v[72:75], v[104:107], v[48:51], v[72:75]
    ds_read_b128 v[128:131], v5 offset:8192
    v_mfma_f32_16x16x32_bf16 v[76:79], v[104:107], v[64:67], v[76:79]
    v_mfma_f32_16x16x32_bf16 v[72:75], v[108:111], v[52:55], v[72:75]
    ds_read_b128 v[132:135], v5 offset:9216
    v_mfma_f32_16x16x32_bf16 v[76:79], v[108:111], v[68:71], v[76:79]
    s_waitcnt lgkmcnt(4)
    s_nop 0
    v_mfma_f32_16x16x32_bf16 v[80:83], v[112:115], v[40:43], v[32:35]
    ds_read_b128 v[136:139], v5 offset:10240
    v_mfma_f32_16x16x32_bf16 v[84:87], v[112:115], v[56:59], v[36:39]
    v_mfma_f32_16x16x32_bf16 v[80:83], v[116:119], v[44:47], v[80:83]
    ds_read_b128 v[140:143], v5 offset:11264
    v_mfma_f32_16x16x32_bf16 v[84:87], v[116:119], v[60:63], v[84:87]
    s_waitcnt lgkmcnt(4)
    s_nop 0
    v_mfma_f32_16x16x32_bf16 v[80:83], v[120:123], v[48:51], v[80:83]
    ds_read_b128 v[96:99], v5 offset:12288
    v_mfma_f32_16x16x32_bf16 v[84:87], v[120:123], v[64:67], v[84:87]
    v_mfma_f32_16x16x32_bf16 v[80:83], v[124:127], v[52:55], v[80:83]
    ds_read_b128 v[100:103], v5 offset:13312
    v_mfma_f32_16x16x32_bf16 v[84:87], v[124:127], v[68:71], v[84:87]
main_kernel_pv_82:
    s_cmp_eq_u32 s57, 0
    s_cbranch_scc1 main_kernel_sp_83
    s_waitcnt lgkmcnt(4)
    s_nop 0
    v_mfma_f32_16x16x32_bf16 v[152:155], v[128:131], v[88:91], v[152:155]
    ds_read_b128 v[104:107], v5 offset:14336
    v_mfma_f32_16x16x32_bf16 v[156:159], v[128:131], v[92:95], v[156:159]
    v_mfma_f32_16x16x32_bf16 v[160:163], v[132:135], v[88:91], v[160:163]
    ds_read_b128 v[108:111], v5 offset:15360
    v_mfma_f32_16x16x32_bf16 v[164:167], v[132:135], v[92:95], v[164:167]
    s_waitcnt lgkmcnt(4)
    s_nop 0
    v_mfma_f32_16x16x32_bf16 v[168:171], v[136:139], v[88:91], v[168:171]
    v_mfma_f32_16x16x32_bf16 v[172:175], v[136:139], v[92:95], v[172:175]
    v_mfma_f32_16x16x32_bf16 v[176:179], v[140:143], v[88:91], v[176:179]
    v_mfma_f32_16x16x32_bf16 v[180:183], v[140:143], v[92:95], v[180:183]
    s_waitcnt lgkmcnt(2)
    s_nop 0
    v_mfma_f32_16x16x32_bf16 v[184:187], v[96:99], v[88:91], v[184:187]
    v_mfma_f32_16x16x32_bf16 v[188:191], v[96:99], v[92:95], v[188:191]
    v_mfma_f32_16x16x32_bf16 v[192:195], v[100:103], v[88:91], v[192:195]
    v_mfma_f32_16x16x32_bf16 v[196:199], v[100:103], v[92:95], v[196:199]
    s_waitcnt lgkmcnt(0)
    s_nop 0
    v_mfma_f32_16x16x32_bf16 v[200:203], v[104:107], v[88:91], v[200:203]
    v_mfma_f32_16x16x32_bf16 v[204:207], v[104:107], v[92:95], v[204:207]
    v_mfma_f32_16x16x32_bf16 v[248:251], v[28:31], v[88:91], v[248:251]
    v_mfma_f32_16x16x32_bf16 v[208:211], v[108:111], v[88:91], v[208:211]
    v_mfma_f32_16x16x32_bf16 v[212:215], v[108:111], v[92:95], v[212:215]
    v_mfma_f32_16x16x32_bf16 v[252:255], v[28:31], v[92:95], v[252:255]
main_kernel_me_84:
    s_setprio 3
    s_branch main_kernel_lb0_30
main_kernel_last0_31:
    s_cmp_eq_u32 s56, 0
    s_cbranch_scc1 main_kernel_lz_85
    s_waitcnt lgkmcnt(1)
    s_nop 0
    ds_read_b128 v[96:99], v5 offset:8192
    s_waitcnt lgkmcnt(1)
    s_nop 0
    ds_read_b128 v[100:103], v5 offset:9216
    ds_read_b128 v[104:107], v5 offset:10240
    ds_read_b128 v[108:111], v5 offset:11264
    ds_read_b128 v[112:115], v5 offset:12288
    ds_read_b128 v[116:119], v5 offset:13312
    s_setprio 1
    s_waitcnt lgkmcnt(4)
    v_mfma_f32_16x16x32_bf16 v[152:155], v[96:99], v[88:91], v[152:155]
    ds_read_b128 v[120:123], v5 offset:14336
    v_mfma_f32_16x16x32_bf16 v[156:159], v[96:99], v[92:95], v[156:159]
    v_mfma_f32_16x16x32_bf16 v[160:163], v[100:103], v[88:91], v[160:163]
    ds_read_b128 v[124:127], v5 offset:15360
    v_mfma_f32_16x16x32_bf16 v[164:167], v[100:103], v[92:95], v[164:167]
    s_waitcnt lgkmcnt(4)
    s_nop 0
    v_mfma_f32_16x16x32_bf16 v[168:171], v[104:107], v[88:91], v[168:171]
    v_mfma_f32_16x16x32_bf16 v[172:175], v[104:107], v[92:95], v[172:175]
    v_mfma_f32_16x16x32_bf16 v[176:179], v[108:111], v[88:91], v[176:179]
    v_mfma_f32_16x16x32_bf16 v[180:183], v[108:111], v[92:95], v[180:183]
    s_waitcnt lgkmcnt(2)
    s_nop 0
    v_mfma_f32_16x16x32_bf16 v[184:187], v[112:115], v[88:91], v[184:187]
    v_mfma_f32_16x16x32_bf16 v[188:191], v[112:115], v[92:95], v[188:191]
    v_mfma_f32_16x16x32_bf16 v[192:195], v[116:119], v[88:91], v[192:195]
    v_mfma_f32_16x16x32_bf16 v[196:199], v[116:119], v[92:95], v[196:199]
    s_waitcnt lgkmcnt(0)
    s_nop 0
    v_mfma_f32_16x16x32_bf16 v[200:203], v[120:123], v[88:91], v[200:203]
    v_mfma_f32_16x16x32_bf16 v[204:207], v[120:123], v[92:95], v[204:207]
    v_mfma_f32_16x16x32_bf16 v[248:251], v[28:31], v[88:91], v[248:251]
    v_mfma_f32_16x16x32_bf16 v[208:211], v[124:127], v[88:91], v[208:211]
    v_mfma_f32_16x16x32_bf16 v[212:215], v[124:127], v[92:95], v[212:215]
    v_mfma_f32_16x16x32_bf16 v[252:255], v[28:31], v[92:95], v[252:255]
    s_setprio 3
main_kernel_lz_85:
    s_setprio 0
    s_branch main_kernel_merge_28
main_kernel_grp1_27:
    s_mov_b32 s41, 1
    s_mov_b32 s56, 1
    s_nop 0
    ds_read_b128 v[96:99], v4 offset:0
    ds_read_b128 v[100:103], v4 offset:1024
    ds_read_b128 v[104:107], v4 offset:2048
    ds_read_b128 v[108:111], v4 offset:3072
    ds_read_b128 v[112:115], v4 offset:4096
    ds_read_b128 v[116:119], v4 offset:5120
    s_setprio 0
    s_waitcnt lgkmcnt(4)
    v_mfma_f32_16x16x32_bf16 v[72:75], v[96:99], v[40:43], v[32:35]
    ds_read_b128 v[120:123], v4 offset:6144
    v_mfma_f32_16x16x32_bf16 v[76:79], v[96:99], v[56:59], v[36:39]
    v_mfma_f32_16x16x32_bf16 v[72:75], v[100:103], v[44:47], v[72:75]
    ds_read_b128 v[124:127], v4 offset:7168
    v_mfma_f32_16x16x32_bf16 v[76:79], v[100:103], v[60:63], v[76:79]
    s_waitcnt lgkmcnt(4)
    s_nop 0
    v_mfma_f32_16x16x32_bf16 v[72:75], v[104:107], v[48:51], v[72:75]
    v_mfma_f32_16x16x32_bf16 v[76:79], v[104:107], v[64:67], v[76:79]
    s_setprio 2
    s_nop 0
    v_mfma_f32_16x16x32_bf16 v[72:75], v[108:111], v[52:55], v[72:75]
    v_mfma_f32_16x16x32_bf16 v[76:79], v[108:111], v[68:71], v[76:79]
    s_waitcnt lgkmcnt(2)
    s_nop 0
    v_mfma_f32_16x16x32_bf16 v[80:83], v[112:115], v[40:43], v[32:35]
    v_mfma_f32_16x16x32_bf16 v[84:87], v[112:115], v[56:59], v[36:39]
    v_mfma_f32_16x16x32_bf16 v[80:83], v[116:119], v[44:47], v[80:83]
    v_mfma_f32_16x16x32_bf16 v[84:87], v[116:119], v[60:63], v[84:87]
    s_waitcnt vmcnt(4) lgkmcnt(0)
    s_barrier
    s_waitcnt lgkmcnt(0)
    s_nop 0
    v_mfma_f32_16x16x32_bf16 v[80:83], v[120:123], v[48:51], v[80:83]
    v_mfma_f32_16x16x32_bf16 v[84:87], v[120:123], v[64:67], v[84:87]
    v_mfma_f32_16x16x32_bf16 v[80:83], v[124:127], v[52:55], v[80:83]
    v_mfma_f32_16x16x32_bf16 v[84:87], v[124:127], v[68:71], v[84:87]
    s_setprio 3
    .p2align 6
main_kernel_la1_86:
    s_cmp_ge_u32 s27, s38
    s_cbranch_scc1 main_kernel_spec_90
main_kernel_exp_91:
    v_exp_f32 v16, v72
    v_exp_f32 v17, v73
    v_exp_f32 v18, v76
    v_exp_f32 v19, v77
    s_cmp_lt_u32 s28, s43
    s_cselect_b32 s42, s28, 0xf0000000
    s_mov_b32 m0, s29
    s_add_u32 s28, s28, 32768
    buffer_load_dwordx4 v10, s[8:11], s42 offen offset:0 lds
    v_cvt_pk_bf16_f32 v88, v16, v17
    v_cvt_pk_bf16_f32 v92, v18, v19
    v_exp_f32 v20, v74
    v_exp_f32 v21, v75
    v_exp_f32 v22, v78
    buffer_load_dwordx4 v10, s[8:11], s42 offen offset:1024 lds
    v_exp_f32 v23, v79
    v_cvt_pk_bf16_f32 v89, v20, v21
    v_cvt_pk_bf16_f32 v93, v22, v23
    v_exp_f32 v16, v80
    v_exp_f32 v17, v81
    buffer_load_dwordx4 v10, s[8:11], s42 offen offset:2048 lds
    v_exp_f32 v18, v84
    v_exp_f32 v19, v85
    v_cvt_pk_bf16_f32 v90, v16, v17
    v_cvt_pk_bf16_f32 v94, v18, v19
    v_exp_f32 v20, v82
    buffer_load_dwordx4 v10, s[8:11], s42 offen offset:3072 lds
    s_xor_b32 s29, s29, 32768
    v_exp_f32 v21, v83
    v_exp_f32 v22, v86
    v_exp_f32 v23, v87
    v_cvt_pk_bf16_f32 v91, v20, v21
    v_cvt_pk_bf16_f32 v95, v22, v23
    v_or3_b32 v8, v88, v92, v89
    v_or3_b32 v9, v93, v90, v94
    v_or3_b32 v8, v8, v91, v95
    v_or_b32 v8, v8, v9
    v_and_b32 v12, s36, v8
    v_xor_b32 v5, 0x8000, v5
    v_cmp_ne_u32 vcc, 0, v12
    s_add_u32 s27, s27, 1
    s_cbranch_vccnz main_kernel_rare_92
main_kernel_chk_93:
    s_nop 0
    ds_read_b128 v[96:99], v4 offset:8192
    ds_read_b128 v[100:103], v4 offset:9216
    ds_read_b128 v[104:107], v4 offset:10240
    ds_read_b128 v[108:111], v4 offset:11264
    ds_read_b128 v[112:115], v4 offset:12288
    ds_read_b128 v[116:119], v4 offset:13312
    s_mov_b32 s57, s56
    s_cmp_le_u32 s27, s37
    s_cselect_b32 s56, 1, 0
    s_cmp_eq_u32 s56, 0
    s_cbranch_scc1 main_kernel_sq_94
    s_setprio 0
    s_waitcnt lgkmcnt(4)
    s_nop 0
    v_mfma_f32_16x16x32_bf16 v[72:75], v[96:99], v[40:43], v[32:35]
    ds_read_b128 v[120:123], v4 offset:14336
    v_mfma_f32_16x16x32_bf16 v[76:79], v[96:99], v[56:59], v[36:39]
    v_mfma_f32_16x16x32_bf16 v[72:75], v[100:103], v[44:47], v[72:75]
    ds_read_b128 v[124:127], v4 offset:15360
    v_mfma_f32_16x16x32_bf16 v[76:79], v[100:103], v[60:63], v[76:79]
    s_waitcnt lgkmcnt(4)
    s_nop 0
    v_mfma_f32_16x16x32_bf16 v[72:75], v[104:107], v[48:51], v[72:75]
    ds_read_b128 v[128:131], v5 offset:0
    v_mfma_f32_16x16x32_bf16 v[76:79], v[104:107], v[64:67], v[76:79]
    s_setprio 2
    s_nop 0
    v_mfma_f32_16x16x32_bf16 v[72:75], v[108:111], v[52:55], v[72:75]
    ds_read_b128 v[132:135], v5 offset:1024
    v_mfma_f32_16x16x32_bf16 v[76:79], v[108:111], v[68:71], v[76:79]
    s_waitcnt lgkmcnt(4)
    s_nop 0
    v_mfma_f32_16x16x32_bf16 v[80:83], v[112:115], v[40:43], v[32:35]
    ds_read_b128 v[136:139], v5 offset:2048
    v_mfma_f32_16x16x32_bf16 v[84:87], v[112:115], v[56:59], v[36:39]
    v_mfma_f32_16x16x32_bf16 v[80:83], v[116:119], v[44:47], v[80:83]
    ds_read_b128 v[140:143], v5 offset:3072
    v_mfma_f32_16x16x32_bf16 v[84:87], v[116:119], v[60:63], v[84:87]
    s_waitcnt lgkmcnt(4)
    s_nop 0
    v_mfma_f32_16x16x32_bf16 v[80:83], v[120:123], v[48:51], v[80:83]
    ds_read_b128 v[96:99], v5 offset:4096
    v_mfma_f32_16x16x32_bf16 v[84:87], v[120:123], v[64:67], v[84:87]
    v_mfma_f32_16x16x32_bf16 v[80:83], v[124:127], v[52:55], v[80:83]
    ds_read_b128 v[100:103], v5 offset:5120
    v_mfma_f32_16x16x32_bf16 v[84:87], v[124:127], v[68:71], v[84:87]
main_kernel_pv_95:
    s_cmp_eq_u32 s57, 0
    s_cbranch_scc1 main_kernel_sp_96
    s_waitcnt lgkmcnt(4)
    s_nop 0
    v_mfma_f32_16x16x32_bf16 v[152:155], v[128:131], v[88:91], v[152:155]
    ds_read_b128 v[104:107], v5 offset:6144
    v_mfma_f32_16x16x32_bf16 v[156:159], v[128:131], v[92:95], v[156:159]
    v_mfma_f32_16x16x32_bf16 v[160:163], v[132:135], v[88:91], v[160:163]
    ds_read_b128 v[108:111], v5 offset:7168
    v_mfma_f32_16x16x32_bf16 v[164:167], v[132:135], v[92:95], v[164:167]
    s_waitcnt lgkmcnt(4)
    s_nop 0
    v_mfma_f32_16x16x32_bf16 v[168:171], v[136:139], v[88:91], v[168:171]
    v_mfma_f32_16x16x32_bf16 v[172:175], v[136:139], v[92:95], v[172:175]
    v_mfma_f32_16x16x32_bf16 v[176:179], v[140:143], v[88:91], v[176:179]
    v_mfma_f32_16x16x32_bf16 v[180:183], v[140:143], v[92:95], v[180:183]
    s_waitcnt lgkmcnt(2)
    s_nop 0
    v_mfma_f32_16x16x32_bf16 v[184:187], v[96:99], v[88:91], v[184:187]
    v_mfma_f32_16x16x32_bf16 v[188:191], v[96:99], v[92:95], v[188:191]
    s_waitcnt vmcnt(4) lgkmcnt(0)
    s_barrier
    v_mfma_f32_16x16x32_bf16 v[192:195], v[100:103], v[88:91], v[192:195]
    v_mfma_f32_16x16x32_bf16 v[196:199], v[100:103], v[92:95], v[196:199]
    s_waitcnt lgkmcnt(0)
    s_nop 0
    v_mfma_f32_16x16x32_bf16 v[200:203], v[104:107], v[88:91], v[200:203]
    v_mfma_f32_16x16x32_bf16 v[204:207], v[104:107], v[92:95], v[204:207]
    v_mfma_f32_16x16x32_bf16 v[248:251], v[28:31], v[88:91], v[248:251]
    v_mfma_f32_16x16x32_bf16 v[208:211], v[108:111], v[88:91], v[208:211]
    v_mfma_f32_16x16x32_bf16 v[212:215], v[108:111], v[92:95], v[212:215]
    v_mfma_f32_16x16x32_bf16 v[252:255], v[28:31], v[92:95], v[252:255]
main_kernel_me_97:
    s_setprio 3
    s_cmp_ge_u32 s27, s38
    s_cbranch_scc1 main_kernel_spec_98
main_kernel_exp_99:
    v_exp_f32 v16, v72
    v_exp_f32 v17, v73
    v_exp_f32 v18, v76
    v_exp_f32 v19, v77
    v_cvt_pk_bf16_f32 v88, v16, v17
    v_cvt_pk_bf16_f32 v92, v18, v19
    v_exp_f32 v20, v74
    v_exp_f32 v21, v75
    v_exp_f32 v22, v78
    v_exp_f32 v23, v79
    v_cvt_pk_bf16_f32 v89, v20, v21
    v_cvt_pk_bf16_f32 v93, v22, v23
    v_exp_f32 v16, v80
    v_exp_f32 v17, v81
    v_exp_f32 v18, v84
    v_exp_f32 v19, v85
    v_cvt_pk_bf16_f32 v90, v16, v17
    v_cvt_pk_bf16_f32 v94, v18, v19
    v_exp_f32 v20, v82
    v_exp_f32 v21, v83
    v_exp_f32 v22, v86
    v_exp_f32 v23, v87
    v_cvt_pk_bf16_f32 v91, v20, v21
    v_cvt_pk_bf16_f32 v95, v22, v23
    v_or3_b32 v8, v88, v92, v89
    v_or3_b32 v9, v93, v90, v94
    v_or3_b32 v8, v8, v91, v95
    v_or_b32 v8, v8, v9
    v_and_b32 v12, s36, v8
    v_cmp_ne_u32 vcc, 0, v12
    s_add_u32 s27, s27, 1
    s_cbranch_vccnz main_kernel_rare_100
main_kernel_chk_101:
    ds_read_b128 v[96:99], v4 offset:16384
    ds_read_b128 v[100:103], v4 offset:17408
    ds_read_b128 v[104:107], v4 offset:18432
    ds_read_b128 v[108:111], v4 offset:19456
    ds_read_b128 v[112:115], v4 offset:20480
    ds_read_b128 v[116:119], v4 offset:21504
    s_mov_b32 s57, s56
    s_cmp_le_u32 s27, s37
    s_cselect_b32 s56, 1, 0
    s_cmp_eq_u32 s56, 0
    s_cbranch_scc1 main_kernel_sq_102
    s_setprio 0
    s_waitcnt lgkmcnt(4)
    s_nop 0
    v_mfma_f32_16x16x32_bf16 v[72:75], v[96:99], v[40:43], v[32:35]
    ds_read_b128 v[120:123], v4 offset:22528
    v_mfma_f32_16x16x32_bf16 v[76:79], v[96:99], v[56:59], v[36:39]
    v_mfma_f32_16x16x32_bf16 v[72:75], v[100:103], v[44:47], v[72:75]
    ds_read_b128 v[124:127], v4 offset:23552
    v_mfma_f32_16x16x32_bf16 v[76:79], v[100:103], v[60:63], v[76:79]
    s_waitcnt lgkmcnt(4)
    s_nop 0
    v_mfma_f32_16x16x32_bf16 v[72:75], v[104:107], v[48:51], v[72:75]
    ds_read_b128 v[128:131], v5 offset:8192
    v_mfma_f32_16x16x32_bf16 v[76:79], v[104:107], v[64:67], v[76:79]
    s_setprio 2
    s_nop 0
    v_mfma_f32_16x16x32_bf16 v[72:75], v[108:111], v[52:55], v[72:75]
    ds_read_b128 v[132:135], v5 offset:9216
    v_mfma_f32_16x16x32_bf16 v[76:79], v[108:111], v[68:71], v[76:79]
    s_waitcnt lgkmcnt(4)
    s_nop 0
    v_mfma_f32_16x16x32_bf16 v[80:83], v[112:115], v[40:43], v[32:35]
    ds_read_b128 v[136:139], v5 offset:10240
    v_mfma_f32_16x16x32_bf16 v[84:87], v[112:115], v[56:59], v[36:39]
    v_mfma_f32_16x16x32_bf16 v[80:83], v[116:119], v[44:47], v[80:83]
    ds_read_b128 v[140:143], v5 offset:11264
    v_mfma_f32_16x16x32_bf16 v[84:87], v[116:119], v[60:63], v[84:87]
    s_waitcnt lgkmcnt(4)
    s_nop 0
    v_mfma_f32_16x16x32_bf16 v[80:83], v[120:123], v[48:51], v[80:83]
    ds_read_b128 v[96:99], v5 offset:12288
    v_mfma_f32_16x16x32_bf16 v[84:87], v[120:123], v[64:67], v[84:87]
    v_mfma_f32_16x16x32_bf16 v[80:83], v[124:127], v[52:55], v[80:83]
    ds_read_b128 v[100:103], v5 offset:13312
    v_mfma_f32_16x16x32_bf16 v[84:87], v[124:127], v[68:71], v[84:87]
main_kernel_pv_103:
    s_cmp_eq_u32 s57, 0
    s_cbranch_scc1 main_kernel_sp_104
    s_waitcnt lgkmcnt(4)
    s_nop 0
    v_mfma_f32_16x16x32_bf16 v[152:155], v[128:131], v[88:91], v[152:155]
    ds_read_b128 v[104:107], v5 offset:14336
    v_mfma_f32_16x16x32_bf16 v[156:159], v[128:131], v[92:95], v[156:159]
    v_mfma_f32_16x16x32_bf16 v[160:163], v[132:135], v[88:91], v[160:163]
    ds_read_b128 v[108:111], v5 offset:15360
    v_mfma_f32_16x16x32_bf16 v[164:167], v[132:135], v[92:95], v[164:167]
    s_waitcnt lgkmcnt(4)
    s_nop 0
    v_mfma_f32_16x16x32_bf16 v[168:171], v[136:139], v[88:91], v[168:171]
    v_mfma_f32_16x16x32_bf16 v[172:175], v[136:139], v[92:95], v[172:175]
    v_mfma_f32_16x16x32_bf16 v[176:179], v[140:143], v[88:91], v[176:179]
    v_mfma_f32_16x16x32_bf16 v[180:183], v[140:143], v[92:95], v[180:183]
    s_waitcnt lgkmcnt(2)
    s_nop 0
    v_mfma_f32_16x16x32_bf16 v[184:187], v[96:99], v[88:91], v[184:187]
    v_mfma_f32_16x16x32_bf16 v[188:191], v[96:99], v[92:95], v[188:191]
    s_waitcnt vmcnt(4) lgkmcnt(0)
    s_barrier
    v_mfma_f32_16x16x32_bf16 v[192:195], v[100:103], v[88:91], v[192:195]
    v_mfma_f32_16x16x32_bf16 v[196:199], v[100:103], v[92:95], v[196:199]
    s_waitcnt lgkmcnt(0)
    s_nop 0
    v_mfma_f32_16x16x32_bf16 v[200:203], v[104:107], v[88:91], v[200:203]
    v_mfma_f32_16x16x32_bf16 v[204:207], v[104:107], v[92:95], v[204:207]
    v_mfma_f32_16x16x32_bf16 v[248:251], v[28:31], v[88:91], v[248:251]
    v_mfma_f32_16x16x32_bf16 v[208:211], v[108:111], v[88:91], v[208:211]
    v_mfma_f32_16x16x32_bf16 v[212:215], v[108:111], v[92:95], v[212:215]
    v_mfma_f32_16x16x32_bf16 v[252:255], v[28:31], v[92:95], v[252:255]
main_kernel_me_105:
    s_setprio 3
    s_cmp_ge_u32 s27, s38
    s_cbranch_scc1 main_kernel_spec_106
main_kernel_exp_107:
    v_exp_f32 v16, v72
    v_exp_f32 v17, v73
    v_exp_f32 v18, v76
    v_exp_f32 v19, v77
    v_cvt_pk_bf16_f32 v88, v16, v17
    v_cvt_pk_bf16_f32 v92, v18, v19
    v_exp_f32 v20, v74
    v_exp_f32 v21, v75
    v_exp_f32 v22, v78
    v_exp_f32 v23, v79
    v_cvt_pk_bf16_f32 v89, v20, v21
    v_cvt_pk_bf16_f32 v93, v22, v23
    v_exp_f32 v16, v80
    v_exp_f32 v17, v81
    v_exp_f32 v18, v84
    v_exp_f32 v19, v85
    v_cvt_pk_bf16_f32 v90, v16, v17
    v_cvt_pk_bf16_f32 v94, v18, v19
    v_exp_f32 v20, v82
    v_exp_f32 v21, v83
    v_exp_f32 v22, v86
    v_exp_f32 v23, v87
    v_cvt_pk_bf16_f32 v91, v20, v21
    v_cvt_pk_bf16_f32 v95, v22, v23
    v_or3_b32 v8, v88, v92, v89
    v_or3_b32 v9, v93, v90, v94
    v_or3_b32 v8, v8, v91, v95
    v_or_b32 v8, v8, v9
    v_and_b32 v12, s36, v8
    v_cmp_ne_u32 vcc, 0, v12
    s_add_u32 s27, s27, 1
    s_cbranch_vccnz main_kernel_rare_108
main_kernel_chk_109:
    ds_read_b128 v[96:99], v4 offset:24576
    ds_read_b128 v[100:103], v4 offset:25600
    ds_read_b128 v[104:107], v4 offset:26624
    ds_read_b128 v[108:111], v4 offset:27648
    ds_read_b128 v[112:115], v4 offset:28672
    ds_read_b128 v[116:119], v4 offset:29696
    s_mov_b32 s57, s56
    s_cmp_le_u32 s27, s37
    s_cselect_b32 s56, 1, 0
    s_cmp_eq_u32 s56, 0
    s_cbranch_scc1 main_kernel_sq_110
    s_setprio 0
    s_waitcnt lgkmcnt(4)
    s_nop 0
    v_mfma_f32_16x16x32_bf16 v[72:75], v[96:99], v[40:43], v[32:35]
    ds_read_b128 v[120:123], v4 offset:30720
    v_mfma_f32_16x16x32_bf16 v[76:79], v[96:99], v[56:59], v[36:39]
    v_mfma_f32_16x16x32_bf16 v[72:75], v[100:103], v[44:47], v[72:75]
    ds_read_b128 v[124:127], v4 offset:31744
    v_mfma_f32_16x16x32_bf16 v[76:79], v[100:103], v[60:63], v[76:79]
    s_waitcnt lgkmcnt(4)
    s_nop 0
    v_mfma_f32_16x16x32_bf16 v[72:75], v[104:107], v[48:51], v[72:75]
    ds_read_b128 v[128:131], v5 offset:16384
    v_mfma_f32_16x16x32_bf16 v[76:79], v[104:107], v[64:67], v[76:79]
    s_setprio 2
    s_nop 0
    v_mfma_f32_16x16x32_bf16 v[72:75], v[108:111], v[52:55], v[72:75]
    ds_read_b128 v[132:135], v5 offset:17408
    v_mfma_f32_16x16x32_bf16 v[76:79], v[108:111], v[68:71], v[76:79]
    s_waitcnt lgkmcnt(4)
    s_nop 0
    v_mfma_f32_16x16x32_bf16 v[80:83], v[112:115], v[40:43], v[32:35]
    ds_read_b128 v[136:139], v5 offset:18432
    v_mfma_f32_16x16x32_bf16 v[84:87], v[112:115], v[56:59], v[36:39]
    v_mfma_f32_16x16x32_bf16 v[80:83], v[116:119], v[44:47], v[80:83]
    ds_read_b128 v[140:143], v5 offset:19456
    v_mfma_f32_16x16x32_bf16 v[84:87], v[116:119], v[60:63], v[84:87]
    s_waitcnt lgkmcnt(4)
    s_nop 0
    v_mfma_f32_16x16x32_bf16 v[80:83], v[120:123], v[48:51], v[80:83]
    ds_read_b128 v[96:99], v5 offset:20480
    v_mfma_f32_16x16x32_bf16 v[84:87], v[120:123], v[64:67], v[84:87]
    v_mfma_f32_16x16x32_bf16 v[80:83], v[124:127], v[52:55], v[80:83]
    ds_read_b128 v[100:103], v5 offset:21504
    v_mfma_f32_16x16x32_bf16 v[84:87], v[124:127], v[68:71], v[84:87]
main_kernel_pv_111:
    s_cmp_eq_u32 s57, 0
    s_cbranch_scc1 main_kernel_sp_112
    s_waitcnt lgkmcnt(4)
    s_nop 0
    v_mfma_f32_16x16x32_bf16 v[152:155], v[128:131], v[88:91], v[152:155]
    ds_read_b128 v[104:107], v5 offset:22528
    v_mfma_f32_16x16x32_bf16 v[156:159], v[128:131], v[92:95], v[156:159]
    v_mfma_f32_16x16x32_bf16 v[160:163], v[132:135], v[88:91], v[160:163]
    ds_read_b128 v[108:111], v5 offset:23552
    v_mfma_f32_16x16x32_bf16 v[164:167], v[132:135], v[92:95], v[164:167]
    s_waitcnt lgkmcnt(4)
    s_nop 0
    v_mfma_f32_16x16x32_bf16 v[168:171], v[136:139], v[88:91], v[168:171]
    v_mfma_f32_16x16x32_bf16 v[172:175], v[136:139], v[92:95], v[172:175]
    v_mfma_f32_16x16x32_bf16 v[176:179], v[140:143], v[88:91], v[176:179]
    v_mfma_f32_16x16x32_bf16 v[180:183], v[140:143], v[92:95], v[180:183]
    s_waitcnt lgkmcnt(2)
    s_nop 0
    v_mfma_f32_16x16x32_bf16 v[184:187], v[96:99], v[88:91], v[184:187]
    v_mfma_f32_16x16x32_bf16 v[188:191], v[96:99], v[92:95], v[188:191]
    s_waitcnt vmcnt(4) lgkmcnt(0)
    s_barrier
    v_mfma_f32_16x16x32_bf16 v[192:195], v[100:103], v[88:91], v[192:195]
    v_mfma_f32_16x16x32_bf16 v[196:199], v[100:103], v[92:95], v[196:199]
    s_waitcnt lgkmcnt(0)
    s_nop 0
    v_mfma_f32_16x16x32_bf16 v[200:203], v[104:107], v[88:91], v[200:203]
    v_mfma_f32_16x16x32_bf16 v[204:207], v[104:107], v[92:95], v[204:207]
    v_mfma_f32_16x16x32_bf16 v[248:251], v[28:31], v[88:91], v[248:251]
    v_mfma_f32_16x16x32_bf16 v[208:211], v[108:111], v[88:91], v[208:211]
    v_mfma_f32_16x16x32_bf16 v[212:215], v[108:111], v[92:95], v[212:215]
    v_mfma_f32_16x16x32_bf16 v[252:255], v[28:31], v[92:95], v[252:255]
main_kernel_me_113:
    s_setprio 3
    s_cmp_ge_u32 s27, s38
    s_cbranch_scc1 main_kernel_spec_114
main_kernel_exp_115:
    v_exp_f32 v16, v72
    v_exp_f32 v17, v73
    v_exp_f32 v18, v76
    v_exp_f32 v19, v77
    s_cmp_lt_u32 s25, s30
    s_cselect_b32 s42, s25, 0xf0000000
    s_mov_b32 m0, s26
    s_add_u32 s25, s25, 32768
    buffer_load_dwordx4 v10, s[8:11], s42 offen offset:0 lds
    v_cvt_pk_bf16_f32 v88, v16, v17
    v_cvt_pk_bf16_f32 v92, v18, v19
    v_exp_f32 v20, v74
    v_exp_f32 v21, v75
    v_exp_f32 v22, v78
    buffer_load_dwordx4 v10, s[8:11], s42 offen offset:1024 lds
    v_exp_f32 v23, v79
    v_cvt_pk_bf16_f32 v89, v20, v21
    v_cvt_pk_bf16_f32 v93, v22, v23
    v_exp_f32 v16, v80
    v_exp_f32 v17, v81
    buffer_load_dwordx4 v10, s[8:11], s42 offen offset:2048 lds
    v_exp_f32 v18, v84
    v_exp_f32 v19, v85
    v_cvt_pk_bf16_f32 v90, v16, v17
    v_cvt_pk_bf16_f32 v94, v18, v19
    v_exp_f32 v20, v82
    buffer_load_dwordx4 v10, s[8:11], s42 offen offset:3072 lds
    s_xor_b32 s26, s26, 32768
    v_exp_f32 v21, v83
    v_exp_f32 v22, v86
    v_exp_f32 v23, v87
    v_cvt_pk_bf16_f32 v91, v20, v21
    v_cvt_pk_bf16_f32 v95, v22, v23
    v_or3_b32 v8, v88, v92, v89
    v_or3_b32 v9, v93, v90, v94
    v_or3_b32 v8, v8, v91, v95
    v_or_b32 v8, v8, v9
    v_and_b32 v12, s36, v8
    v_xor_b32 v4, 0x8000, v4
    v_cmp_ne_u32 vcc, 0, v12
    s_add_u32 s27, s27, 1
    s_cbranch_vccnz main_kernel_rare_116
main_kernel_chk_117:
    s_sub_u32 s31, s31, 1
    s_cmp_eq_u32 s31, 0
    s_cbranch_scc1 main_kernel_ab1_89
    s_nop 0
    ds_read_b128 v[96:99], v4 offset:0
    ds_read_b128 v[100:103], v4 offset:1024
    ds_read_b128 v[104:107], v4 offset:2048
    ds_read_b128 v[108:111], v4 offset:3072
    ds_read_b128 v[112:115], v4 offset:4096
    ds_read_b128 v[116:119], v4 offset:5120
    s_mov_b32 s57, s56
    s_cmp_le_u32 s27, s37
    s_cselect_b32 s56, 1, 0
    s_cmp_eq_u32 s56, 0
    s_cbranch_scc1 main_kernel_sq_118
    s_setprio 0
    s_waitcnt lgkmcnt(4)
    s_nop 0
    v_mfma_f32_16x16x32_bf16 v[72:75], v[96:99], v[40:43], v[32:35]
    ds_read_b128 v[120:123], v4 offset:6144
    v_mfma_f32_16x16x32_bf16 v[76:79], v[96:99], v[56:59], v[36:39]
    v_mfma_f32_16x16x32_bf16 v[72:75], v[100:103], v[44:47], v[72:75]
    ds_read_b128 v[124:127], v4 offset:7168
    v_mfma_f32_16x16x32_bf16 v[76:79], v[100:103], v[60:63], v[76:79]
    s_waitcnt lgkmcnt(4)
    s_nop 0
    v_mfma_f32_16x16x32_bf16 v[72:75], v[104:107], v[48:51], v[72:75]
    ds_read_b128 v[128:131], v5 offset:24576
    v_mfma_f32_16x16x32_bf16 v[76:79], v[104:107], v[64:67], v[76:79]
    s_setprio 2
    s_nop 0
    v_mfma_f32_16x16x32_bf16 v[72:75], v[108:111], v[52:55], v[72:75]
    ds_read_b128 v[132:135], v5 offset:25600
    v_mfma_f32_16x16x32_bf16 v[76:79], v[108:111], v[68:71], v[76:79]
    s_waitcnt lgkmcnt(4)
    s_nop 0
    v_mfma_f32_16x16x32_bf16 v[80:83], v[112:115], v[40:43], v[32:35]
    ds_read_b128 v[136:139], v5 offset:26624
    v_mfma_f32_16x16x32_bf16 v[84:87], v[112:115], v[56:59], v[36:39]
    v_mfma_f32_16x16x32_bf16 v[80:83], v[116:119], v[44:47], v[80:83]
    ds_read_b128 v[140:143], v5 offset:27648
    v_mfma_f32_16x16x32_bf16 v[84:87], v[116:119], v[60:63], v[84:87]
    s_waitcnt lgkmcnt(4)
    s_nop 0
    v_mfma_f32_16x16x32_bf16 v[80:83], v[120:123], v[48:51], v[80:83]
    ds_read_b128 v[96:99], v5 offset:28672
    v_mfma_f32_16x16x32_bf16 v[84:87], v[120:123], v[64:67], v[84:87]
    v_mfma_f32_16x16x32_bf16 v[80:83], v[124:127], v[52:55], v[80:83]
    ds_read_b128 v[100:103], v5 offset:29696
    v_mfma_f32_16x16x32_bf16 v[84:87], v[124:127], v[68:71], v[84:87]
main_kernel_pv_119:
    s_cmp_eq_u32 s57, 0
    s_cbranch_scc1 main_kernel_sp_120
    s_waitcnt lgkmcnt(4)
    s_nop 0
    v_mfma_f32_16x16x32_bf16 v[152:155], v[128:131], v[88:91], v[152:155]
    ds_read_b128 v[104:107], v5 offset:30720
    v_mfma_f32_16x16x32_bf16 v[156:159], v[128:131], v[92:95], v[156:159]
    v_mfma_f32_16x16x32_bf16 v[160:163], v[132:135], v[88:91], v[160:163]
    ds_read_b128 v[108:111], v5 offset:31744
    v_mfma_f32_16x16x32_bf16 v[164:167], v[132:135], v[92:95], v[164:167]
    s_waitcnt lgkmcnt(4)
    s_nop 0
    v_mfma_f32_16x16x32_bf16 v[168:171], v[136:139], v[88:91], v[168:171]
    v_mfma_f32_16x16x32_bf16 v[172:175], v[136:139], v[92:95], v[172:175]
    v_mfma_f32_16x16x32_bf16 v[176:179], v[140:143], v[88:91], v[176:179]
    v_mfma_f32_16x16x32_bf16 v[180:183], v[140:143], v[92:95], v[180:183]
    s_waitcnt lgkmcnt(2)
    s_nop 0
    v_mfma_f32_16x16x32_bf16 v[184:187], v[96:99], v[88:91], v[184:187]
    v_mfma_f32_16x16x32_bf16 v[188:191], v[96:99], v[92:95], v[188:191]
    s_waitcnt vmcnt(4) lgkmcnt(0)
    s_barrier
    v_mfma_f32_16x16x32_bf16 v[192:195], v[100:103], v[88:91], v[192:195]
    v_mfma_f32_16x16x32_bf16 v[196:199], v[100:103], v[92:95], v[196:199]
    s_waitcnt lgkmcnt(0)
    s_nop 0
    v_mfma_f32_16x16x32_bf16 v[200:203], v[104:107], v[88:91], v[200:203]
    v_mfma_f32_16x16x32_bf16 v[204:207], v[104:107], v[92:95], v[204:207]
    v_mfma_f32_16x16x32_bf16 v[248:251], v[28:31], v[88:91], v[248:251]
    v_mfma_f32_16x16x32_bf16 v[208:211], v[108:111], v[88:91], v[208:211]
    v_mfma_f32_16x16x32_bf16 v[212:215], v[108:111], v[92:95], v[212:215]
    v_mfma_f32_16x16x32_bf16 v[252:255], v[28:31], v[92:95], v[252:255]
main_kernel_me_121:
    s_setprio 3
    s_branch main_kernel_la1_86
main_kernel_ab1_89:
    s_lshl_b32 s31, s22, 1
    s_sub_u32 s31, 15, s31
    s_lshl_b32 s34, s24, 13
    s_add_u32 s34, s34, 131072
    v_add_u32 v1, s34, v7
    ds_read_b128 v[40:43], v1 offset:0
    ds_read_b128 v[44:47], v1 offset:1024
    ds_read_b128 v[48:51], v1 offset:2048
    ds_read_b128 v[52:55], v1 offset:3072
    ds_read_b128 v[56:59], v1 offset:4096
    ds_read_b128 v[60:63], v1 offset:5120
    ds_read_b128 v[64:67], v1 offset:6144
    ds_read_b128 v[68:71], v1 offset:7168
    v_mov_b32 v32, 0
    v_mov_b32 v33, 0
    v_mov_b32 v34, 0
    v_mov_b32 v35, 0
    v_mov_b32 v36, 0
    v_mov_b32 v37, 0
    v_mov_b32 v38, 0
    v_mov_b32 v39, 0
    s_mov_b32 s41, 2
    s_mov_b32 s38, 0
    s_add_u32 s27, s27, 2
    s_sub_u32 s40, s31, 2
    s_lshl_b32 s58, s35, 2
    s_add_u32 s58, s58, s24
    ds_read_b128 v[96:99], v4 offset:16384
    ds_read_b128 v[100:103], v4 offset:17408
    ds_read_b128 v[104:107], v4 offset:18432
    ds_read_b128 v[108:111], v4 offset:19456
    ds_read_b128 v[112:115], v4 offset:20480
    ds_read_b128 v[116:119], v4 offset:21504
    s_mov_b32 s57, s56
    s_cmp_le_u32 s27, s58
    s_cselect_b32 s56, 1, 0
    s_cmp_eq_u32 s56, 0
    s_cbranch_scc1 main_kernel_sq_122
    s_setprio 0
    s_waitcnt lgkmcnt(4)
    s_nop 0
    v_mfma_f32_16x16x32_bf16 v[72:75], v[96:99], v[40:43], v[32:35]
    ds_read_b128 v[120:123], v4 offset:22528
    v_mfma_f32_16x16x32_bf16 v[76:79], v[96:99], v[56:59], v[36:39]
    v_mfma_f32_16x16x32_bf16 v[72:75], v[100:103], v[44:47], v[72:75]
    ds_read_b128 v[124:127], v4 offset:23552
    v_mfma_f32_16x16x32_bf16 v[76:79], v[100:103], v[60:63], v[76:79]
    s_waitcnt lgkmcnt(4)
    s_nop 0
    v_mfma_f32_16x16x32_bf16 v[72:75], v[104:107], v[48:51], v[72:75]
    ds_read_b128 v[128:131], v5 offset:24576
    v_mfma_f32_16x16x32_bf16 v[76:79], v[104:107], v[64:67], v[76:79]
    s_setprio 2
    s_nop 0
    v_mfma_f32_16x16x32_bf16 v[72:75], v[108:111], v[52:55], v[72:75]
    ds_read_b128 v[132:135], v5 offset:25600
    v_mfma_f32_16x16x32_bf16 v[76:79], v[108:111], v[68:71], v[76:79]
    s_waitcnt lgkmcnt(4)
    s_nop 0
    v_mfma_f32_16x16x32_bf16 v[80:83], v[112:115], v[40:43], v[32:35]
    ds_read_b128 v[136:139], v5 offset:26624
    v_mfma_f32_16x16x32_bf16 v[84:87], v[112:115], v[56:59], v[36:39]
    v_mfma_f32_16x16x32_bf16 v[80:83], v[116:119], v[44:47], v[80:83]
    ds_read_b128 v[140:143], v5 offset:27648
    v_mfma_f32_16x16x32_bf16 v[84:87], v[116:119], v[60:63], v[84:87]
    s_waitcnt lgkmcnt(4)
    s_nop 0
    v_mfma_f32_16x16x32_bf16 v[80:83], v[120:123], v[48:51], v[80:83]
    ds_read_b128 v[96:99], v5 offset:28672
    v_mfma_f32_16x16x32_bf16 v[84:87], v[120:123], v[64:67], v[84:87]
    v_mfma_f32_16x16x32_bf16 v[80:83], v[124:127], v[52:55], v[80:83]
    ds_read_b128 v[100:103], v5 offset:29696
    v_mfma_f32_16x16x32_bf16 v[84:87], v[124:127], v[68:71], v[84:87]
main_kernel_pv_123:
    s_cmp_eq_u32 s57, 0
    s_cbranch_scc1 main_kernel_sp_124
    s_waitcnt lgkmcnt(4)
    s_nop 0
    v_mfma_f32_16x16x32_bf16 v[152:155], v[128:131], v[88:91], v[152:155]
    ds_read_b128 v[104:107], v5 offset:30720
    v_mfma_f32_16x16x32_bf16 v[156:159], v[128:131], v[92:95], v[156:159]
    v_mfma_f32_16x16x32_bf16 v[160:163], v[132:135], v[88:91], v[160:163]
    ds_read_b128 v[108:111], v5 offset:31744
    v_mfma_f32_16x16x32_bf16 v[164:167], v[132:135], v[92:95], v[164:167]
    s_waitcnt lgkmcnt(4)
    s_nop 0
    v_mfma_f32_16x16x32_bf16 v[168:171], v[136:139], v[88:91], v[168:171]
    v_mfma_f32_16x16x32_bf16 v[172:175], v[136:139], v[92:95], v[172:175]
    v_mfma_f32_16x16x32_bf16 v[176:179], v[140:143], v[88:91], v[176:179]
    v_mfma_f32_16x16x32_bf16 v[180:183], v[140:143], v[92:95], v[180:183]
    s_waitcnt lgkmcnt(2)
    s_nop 0
    v_mfma_f32_16x16x32_bf16 v[184:187], v[96:99], v[88:91], v[184:187]
    v_mfma_f32_16x16x32_bf16 v[188:191], v[96:99], v[92:95], v[188:191]
    s_waitcnt vmcnt(4) lgkmcnt(0)
    s_barrier
    v_mfma_f32_16x16x32_bf16 v[192:195], v[100:103], v[88:91], v[192:195]
    v_mfma_f32_16x16x32_bf16 v[196:199], v[100:103], v[92:95], v[196:199]
    s_waitcnt lgkmcnt(0)
    s_nop 0
    v_mfma_f32_16x16x32_bf16 v[200:203], v[104:107], v[88:91], v[200:203]
    v_mfma_f32_16x16x32_bf16 v[204:207], v[104:107], v[92:95], v[204:207]
    v_mfma_f32_16x16x32_bf16 v[248:251], v[28:31], v[88:91], v[248:251]
    v_mfma_f32_16x16x32_bf16 v[208:211], v[108:111], v[88:91], v[208:211]
    v_mfma_f32_16x16x32_bf16 v[212:215], v[108:111], v[92:95], v[212:215]
    v_mfma_f32_16x16x32_bf16 v[252:255], v[28:31], v[92:95], v[252:255]
main_kernel_me_125:
    s_setprio 3
    .p2align 6
main_kernel_lb1_87:
    s_cmp_ge_u32 s27, s38
    s_cbranch_scc1 main_kernel_spec_128
main_kernel_exp_129:
    v_exp_f32 v16, v72
    v_exp_f32 v17, v73
    v_exp_f32 v18, v76
    v_exp_f32 v19, v77
    s_cmp_lt_u32 s28, s43
    s_cselect_b32 s42, s28, 0xf0000000
    s_mov_b32 m0, s29
    s_add_u32 s28, s28, 32768
    buffer_load_dwordx4 v10, s[8:11], s42 offen offset:0 lds
    v_cvt_pk_bf16_f32 v88, v16, v17
    v_cvt_pk_bf16_f32 v92, v18, v19
    v_exp_f32 v20, v74
    v_exp_f32 v21, v75
    v_exp_f32 v22, v78
    buffer_load_dwordx4 v10, s[8:11], s42 offen offset:1024 lds
    v_exp_f32 v23, v79
    v_cvt_pk_bf16_f32 v89, v20, v21
    v_cvt_pk_bf16_f32 v93, v22, v23
    v_exp_f32 v16, v80
    v_exp_f32 v17, v81
    buffer_load_dwordx4 v10, s[8:11], s42 offen offset:2048 lds
    v_exp_f32 v18, v84
    v_exp_f32 v19, v85
    v_cvt_pk_bf16_f32 v90, v16, v17
    v_cvt_pk_bf16_f32 v94, v18, v19
    v_exp_f32 v20, v82
    buffer_load_dwordx4 v10, s[8:11], s42 offen offset:3072 lds
    s_xor_b32 s29, s29, 32768
    v_exp_f32 v21, v83
    v_exp_f32 v22, v86
    v_exp_f32 v23, v87
    v_cvt_pk_bf16_f32 v91, v20, v21
    v_cvt_pk_bf16_f32 v95, v22, v23
    v_or3_b32 v8, v88, v92, v89
    v_or3_b32 v9, v93, v90, v94
    v_or3_b32 v8, v8, v91, v95
    v_or_b32 v8, v8, v9
    v_and_b32 v12, s36, v8
    v_xor_b32 v5, 0x8000, v5
    v_cmp_ne_u32 vcc, 0, v12
    s_add_u32 s27, s27, 1
    s_cbranch_vccnz main_kernel_rare_130
main_kernel_chk_131:
    s_cmp_eq_u32 s31, s40
    s_cbranch_scc1 main_kernel_po_127
main_kernel_np_126:
    s_nop 0
    ds_read_b128 v[96:99], v4 offset:24576
    ds_read_b128 v[100:103], v4 offset:25600
    ds_read_b128 v[104:107], v4 offset:26624
    ds_read_b128 v[108:111], v4 offset:27648
    ds_read_b128 v[112:115], v4 offset:28672
    ds_read_b128 v[116:119], v4 offset:29696
    s_mov_b32 s57, s56
    s_cmp_le_u32 s27, s37
    s_cselect_b32 s56, 1, 0
    s_cmp_eq_u32 s56, 0
    s_cbranch_scc1 main_kernel_sq_132
    s_setprio 0
    s_waitcnt lgkmcnt(4)
    s_nop 0
    v_mfma_f32_16x16x32_bf16 v[72:75], v[96:99], v[40:43], v[32:35]
    ds_read_b128 v[120:123], v4 offset:30720
    v_mfma_f32_16x16x32_bf16 v[76:79], v[96:99], v[56:59], v[36:39]
    v_mfma_f32_16x16x32_bf16 v[72:75], v[100:103], v[44:47], v[72:75]
    ds_read_b128 v[124:127], v4 offset:31744
    v_mfma_f32_16x16x32_bf16 v[76:79], v[100:103], v[60:63], v[76:79]
    s_waitcnt lgkmcnt(4)
    s_nop 0
    v_mfma_f32_16x16x32_bf16 v[72:75], v[104:107], v[48:51], v[72:75]
    ds_read_b128 v[128:131], v5 offset:16384
    v_mfma_f32_16x16x32_bf16 v[76:79], v[104:107], v[64:67], v[76:79]
    s_setprio 2
    s_nop 0
    v_mfma_f32_16x16x32_bf16 v[72:75], v[108:111], v[52:55], v[72:75]
    ds_read_b128 v[132:135], v5 offset:17408
    v_mfma_f32_16x16x32_bf16 v[76:79], v[108:111], v[68:71], v[76:79]
    s_waitcnt lgkmcnt(4)
    s_nop 0
    v_mfma_f32_16x16x32_bf16 v[80:83], v[112:115], v[40:43], v[32:35]
    ds_read_b128 v[136:139], v5 offset:18432
    v_mfma_f32_16x16x32_bf16 v[84:87], v[112:115], v[56:59], v[36:39]
    v_mfma_f32_16x16x32_bf16 v[80:83], v[116:119], v[44:47], v[80:83]
    ds_read_b128 v[140:143], v5 offset:19456
    v_mfma_f32_16x16x32_bf16 v[84:87], v[116:119], v[60:63], v[84:87]
    s_waitcnt lgkmcnt(4)
    s_nop 0
    v_mfma_f32_16x16x32_bf16 v[80:83], v[120:123], v[48:51], v[80:83]
    ds_read_b128 v[96:99], v5 offset:20480
    v_mfma_f32_16x16x32_bf16 v[84:87], v[120:123], v[64:67], v[84:87]
    v_mfma_f32_16x16x32_bf16 v[80:83], v[124:127], v[52:55], v[80:83]
    ds_read_b128 v[100:103], v5 offset:21504
    v_mfma_f32_16x16x32_bf16 v[84:87], v[124:127], v[68:71], v[84:87]
main_kernel_pv_133:
    s_cmp_eq_u32 s57, 0
    s_cbranch_scc1 main_kernel_sp_134
    s_waitcnt lgkmcnt(4)
    s_nop 0
    v_mfma_f32_16x16x32_bf16 v[152:155], v[128:131], v[88:91], v[152:155]
    ds_read_b128 v[104:107], v5 offset:22528
    v_mfma_f32_16x16x32_bf16 v[156:159], v[128:131], v[92:95], v[156:159]
    v_mfma_f32_16x16x32_bf16 v[160:163], v[132:135], v[88:91], v[160:163]
    ds_read_b128 v[108:111], v5 offset:23552
    v_mfma_f32_16x16x32_bf16 v[164:167], v[132:135], v[92:95], v[164:167]
    s_waitcnt lgkmcnt(4)
    s_nop 0
    v_mfma_f32_16x16x32_bf16 v[168:171], v[136:139], v[88:91], v[168:171]
    v_mfma_f32_16x16x32_bf16 v[172:175], v[136:139], v[92:95], v[172:175]
    v_mfma_f32_16x16x32_bf16 v[176:179], v[140:143], v[88:91], v[176:179]
    v_mfma_f32_16x16x32_bf16 v[180:183], v[140:143], v[92:95], v[180:183]
    s_waitcnt lgkmcnt(2)
    s_nop 0
    v_mfma_f32_16x16x32_bf16 v[184:187], v[96:99], v[88:91], v[184:187]
    v_mfma_f32_16x16x32_bf16 v[188:191], v[96:99], v[92:95], v[188:191]
    s_waitcnt vmcnt(4) lgkmcnt(0)
    s_barrier
    v_mfma_f32_16x16x32_bf16 v[192:195], v[100:103], v[88:91], v[192:195]
    v_mfma_f32_16x16x32_bf16 v[196:199], v[100:103], v[92:95], v[196:199]
    s_waitcnt lgkmcnt(0)
    s_nop 0
    v_mfma_f32_16x16x32_bf16 v[200:203], v[104:107], v[88:91], v[200:203]
    v_mfma_f32_16x16x32_bf16 v[204:207], v[104:107], v[92:95], v[204:207]
    v_mfma_f32_16x16x32_bf16 v[248:251], v[28:31], v[88:91], v[248:251]
    v_mfma_f32_16x16x32_bf16 v[208:211], v[108:111], v[88:91], v[208:211]
    v_mfma_f32_16x16x32_bf16 v[212:215], v[108:111], v[92:95], v[212:215]
    v_mfma_f32_16x16x32_bf16 v[252:255], v[28:31], v[92:95], v[252:255]
main_kernel_me_135:
    s_setprio 3
    s_cmp_ge_u32 s27, s38
    s_cbranch_scc1 main_kernel_spec_136
main_kernel_exp_137:
    v_exp_f32 v16, v72
    v_exp_f32 v17, v73
    v_exp_f32 v18, v76
    v_exp_f32 v19, v77
    s_cmp_lt_u32 s25, s30
    s_cselect_b32 s42, s25, 0xf0000000
    s_mov_b32 m0, s26
    s_add_u32 s25, s25, 32768
    buffer_load_dwordx4 v10, s[8:11], s42 offen offset:0 lds
    v_cvt_pk_bf16_f32 v88, v16, v17
    v_cvt_pk_bf16_f32 v92, v18, v19
    v_exp_f32 v20, v74
    v_exp_f32 v21, v75
    v_exp_f32 v22, v78
    buffer_load_dwordx4 v10, s[8:11], s42 offen offset:1024 lds
    v_exp_f32 v23, v79
    v_cvt_pk_bf16_f32 v89, v20, v21
    v_cvt_pk_bf16_f32 v93, v22, v23
    v_exp_f32 v16, v80
    v_exp_f32 v17, v81
    buffer_load_dwordx4 v10, s[8:11], s42 offen offset:2048 lds
    v_exp_f32 v18, v84
    v_exp_f32 v19, v85
    v_cvt_pk_bf16_f32 v90, v16, v17
    v_cvt_pk_bf16_f32 v94, v18, v19
    v_exp_f32 v20, v82
    buffer_load_dwordx4 v10, s[8:11], s42 offen offset:3072 lds
    s_xor_b32 s26, s26, 32768
    v_exp_f32 v21, v83
    v_exp_f32 v22, v86
    v_exp_f32 v23, v87
    v_cvt_pk_bf16_f32 v91, v20, v21
    v_cvt_pk_bf16_f32 v95, v22, v23
    v_or3_b32 v8, v88, v92, v89
    v_or3_b32 v9, v93, v90, v94
    v_or3_b32 v8, v8, v91, v95
    v_or_b32 v8, v8, v9
    v_and_b32 v12, s36, v8
    v_xor_b32 v4, 0x8000, v4
    v_cmp_ne_u32 vcc, 0, v12
    s_add_u32 s27, s27, 3
    s_cbranch_vccnz main_kernel_rare_138
main_kernel_chk_139:
    s_sub_u32 s31, s31, 1
    s_cmp_eq_u32 s31, 0
    s_cbranch_scc1 main_kernel_last1_88
    s_nop 0
    ds_read_b128 v[96:99], v4 offset:16384
    ds_read_b128 v[100:103], v4 offset:17408
    ds_read_b128 v[104:107], v4 offset:18432
    ds_read_b128 v[108:111], v4 offset:19456
    ds_read_b128 v[112:115], v4 offset:20480
    ds_read_b128 v[116:119], v4 offset:21504
    s_mov_b32 s57, s56
    s_cmp_le_u32 s27, s37
    s_cselect_b32 s56, 1, 0
    s_cmp_eq_u32 s56, 0
    s_cbranch_scc1 main_kernel_sq_140
    s_setprio 0
    s_waitcnt lgkmcnt(4)
    s_nop 0
    v_mfma_f32_16x16x32_bf16 v[72:75], v[96:99], v[40:43], v[32:35]
    ds_read_b128 v[120:123], v4 offset:22528
    v_mfma_f32_16x16x32_bf16 v[76:79], v[96:99], v[56:59], v[36:39]
    v_mfma_f32_16x16x32_bf16 v[72:75], v[100:103], v[44:47], v[72:75]
    ds_read_b128 v[124:127], v4 offset:23552
    v_mfma_f32_16x16x32_bf16 v[76:79], v[100:103], v[60:63], v[76:79]
    s_waitcnt lgkmcnt(4)
    s_nop 0
    v_mfma_f32_16x16x32_bf16 v[72:75], v[104:107], v[48:51], v[72:75]
    ds_read_b128 v[128:131], v5 offset:24576
    v_mfma_f32_16x16x32_bf16 v[76:79], v[104:107], v[64:67], v[76:79]
    s_setprio 2
    s_nop 0
    v_mfma_f32_16x16x32_bf16 v[72:75], v[108:111], v[52:55], v[72:75]
    ds_read_b128 v[132:135], v5 offset:25600
    v_mfma_f32_16x16x32_bf16 v[76:79], v[108:111], v[68:71], v[76:79]
    s_waitcnt lgkmcnt(4)
    s_nop 0
    v_mfma_f32_16x16x32_bf16 v[80:83], v[112:115], v[40:43], v[32:35]
    ds_read_b128 v[136:139], v5 offset:26624
    v_mfma_f32_16x16x32_bf16 v[84:87], v[112:115], v[56:59], v[36:39]
    v_mfma_f32_16x16x32_bf16 v[80:83], v[116:119], v[44:47], v[80:83]
    ds_read_b128 v[140:143], v5 offset:27648
    v_mfma_f32_16x16x32_bf16 v[84:87], v[116:119], v[60:63], v[84:87]
    s_waitcnt lgkmcnt(4)
    s_nop 0
    v_mfma_f32_16x16x32_bf16 v[80:83], v[120:123], v[48:51], v[80:83]
    ds_read_b128 v[96:99], v5 offset:28672
    v_mfma_f32_16x16x32_bf16 v[84:87], v[120:123], v[64:67], v[84:87]
    v_mfma_f32_16x16x32_bf16 v[80:83], v[124:127], v[52:55], v[80:83]
    ds_read_b128 v[100:103], v5 offset:29696
    v_mfma_f32_16x16x32_bf16 v[84:87], v[124:127], v[68:71], v[84:87]
main_kernel_pv_141:
    s_cmp_eq_u32 s57, 0
    s_cbranch_scc1 main_kernel_sp_142
    s_waitcnt lgkmcnt(4)
    s_nop 0
    v_mfma_f32_16x16x32_bf16 v[152:155], v[128:131], v[88:91], v[152:155]
    ds_read_b128 v[104:107], v5 offset:30720
    v_mfma_f32_16x16x32_bf16 v[156:159], v[128:131], v[92:95], v[156:159]
    v_mfma_f32_16x16x32_bf16 v[160:163], v[132:135], v[88:91], v[160:163]
    ds_read_b128 v[108:111], v5 offset:31744
    v_mfma_f32_16x16x32_bf16 v[164:167], v[132:135], v[92:95], v[164:167]
    s_waitcnt lgkmcnt(4)
    s_nop 0
    v_mfma_f32_16x16x32_bf16 v[168:171], v[136:139], v[88:91], v[168:171]
    v_mfma_f32_16x16x32_bf16 v[172:175], v[136:139], v[92:95], v[172:175]
    v_mfma_f32_16x16x32_bf16 v[176:179], v[140:143], v[88:91], v[176:179]
    v_mfma_f32_16x16x32_bf16 v[180:183], v[140:143], v[92:95], v[180:183]
    s_waitcnt lgkmcnt(2)
    s_nop 0
    v_mfma_f32_16x16x32_bf16 v[184:187], v[96:99], v[88:91], v[184:187]
    v_mfma_f32_16x16x32_bf16 v[188:191], v[96:99], v[92:95], v[188:191]
    s_waitcnt vmcnt(4) lgkmcnt(0)
    s_barrier
    v_mfma_f32_16x16x32_bf16 v[192:195], v[100:103], v[88:91], v[192:195]
    v_mfma_f32_16x16x32_bf16 v[196:199], v[100:103], v[92:95], v[196:199]
    s_waitcnt lgkmcnt(0)
    s_nop 0
    v_mfma_f32_16x16x32_bf16 v[200:203], v[104:107], v[88:91], v[200:203]
    v_mfma_f32_16x16x32_bf16 v[204:207], v[104:107], v[92:95], v[204:207]
    v_mfma_f32_16x16x32_bf16 v[248:251], v[28:31], v[88:91], v[248:251]
    v_mfma_f32_16x16x32_bf16 v[208:211], v[108:111], v[88:91], v[208:211]
    v_mfma_f32_16x16x32_bf16 v[212:215], v[108:111], v[92:95], v[212:215]
    v_mfma_f32_16x16x32_bf16 v[252:255], v[28:31], v[92:95], v[252:255]
main_kernel_me_143:
    s_setprio 3
    s_branch main_kernel_lb1_87
main_kernel_last1_88:
    s_cmp_eq_u32 s56, 0
    s_cbranch_scc1 main_kernel_lz_144
    ds_read_b128 v[96:99], v5 offset:24576
    ds_read_b128 v[100:103], v5 offset:25600
    ds_read_b128 v[104:107], v5 offset:26624
    ds_read_b128 v[108:111], v5 offset:27648
    ds_read_b128 v[112:115], v5 offset:28672
    ds_read_b128 v[116:119], v5 offset:29696
    s_setprio 1
    s_waitcnt lgkmcnt(4)
    v_mfma_f32_16x16x32_bf16 v[152:155], v[96:99], v[88:91], v[152:155]
    ds_read_b128 v[120:123], v5 offset:30720
    v_mfma_f32_16x16x32_bf16 v[156:159], v[96:99], v[92:95], v[156:159]
    v_mfma_f32_16x16x32_bf16 v[160:163], v[100:103], v[88:91], v[160:163]
    ds_read_b128 v[124:127], v5 offset:31744
    v_mfma_f32_16x16x32_bf16 v[164:167], v[100:103], v[92:95], v[164:167]
    s_waitcnt lgkmcnt(4)
    s_nop 0
    v_mfma_f32_16x16x32_bf16 v[168:171], v[104:107], v[88:91], v[168:171]
    v_mfma_f32_16x16x32_bf16 v[172:175], v[104:107], v[92:95], v[172:175]
    v_mfma_f32_16x16x32_bf16 v[176:179], v[108:111], v[88:91], v[176:179]
    v_mfma_f32_16x16x32_bf16 v[180:183], v[108:111], v[92:95], v[180:183]
    s_waitcnt lgkmcnt(2)
    s_nop 0
    v_mfma_f32_16x16x32_bf16 v[184:187], v[112:115], v[88:91], v[184:187]
    v_mfma_f32_16x16x32_bf16 v[188:191], v[112:115], v[92:95], v[188:191]
    v_mfma_f32_16x16x32_bf16 v[192:195], v[116:119], v[88:91], v[192:195]
    v_mfma_f32_16x16x32_bf16 v[196:199], v[116:119], v[92:95], v[196:199]
    s_waitcnt lgkmcnt(0)
    s_nop 0
    v_mfma_f32_16x16x32_bf16 v[200:203], v[120:123], v[88:91], v[200:203]
    v_mfma_f32_16x16x32_bf16 v[204:207], v[120:123], v[92:95], v[204:207]
    v_mfma_f32_16x16x32_bf16 v[248:251], v[28:31], v[88:91], v[248:251]
    v_mfma_f32_16x16x32_bf16 v[208:211], v[124:127], v[88:91], v[208:211]
    v_mfma_f32_16x16x32_bf16 v[212:215], v[124:127], v[92:95], v[212:215]
    v_mfma_f32_16x16x32_bf16 v[252:255], v[28:31], v[92:95], v[252:255]
    s_setprio 3
main_kernel_lz_144:
    s_setprio 0
main_kernel_merge_28:
    s_lshl_b32 s33, s23, 2
    s_add_u32 s33, s33, s24
    s_lshl_b32 s34, s33, 10
    s_add_u32 s34, s34, 0x20000
    v_add_u32 v14, s34, v7
    v_mov_b32 v16, v32
    v_mov_b32 v17, v248
    v_mov_b32 v18, v36
    v_mov_b32 v19, v252
    ds_write_b128 v14, v[16:19]
    v_xor_b32 v14, 0x1000, v14
    s_lshl_b32 s33, s33, 13
    v_add_u32 v15, s33, v7
    v_xor_b32 v1, 0x8000, v15
    s_waitcnt vmcnt(0) lgkmcnt(0)
    s_barrier
    ds_read_b128 v[20:23], v14
    s_cmp_eq_u32 s23, 1
    s_cbranch_scc1 main_kernel_mg1_145
    ds_write_b128 v15, v[184:187] offset:0
    ds_write_b128 v15, v[188:191] offset:1024
    ds_write_b128 v15, v[192:195] offset:2048
    ds_write_b128 v15, v[196:199] offset:3072
    ds_write_b128 v15, v[200:203] offset:4096
    ds_write_b128 v15, v[204:207] offset:5120
    ds_write_b128 v15, v[208:211] offset:6144
    ds_write_b128 v15, v[212:215] offset:7168
    s_waitcnt lgkmcnt(8)
    v_min_f32 v24, v16, v20
    v_sub_f32 v16, v24, v16
    v_sub_f32 v20, v24, v20
    v_exp_f32 v16, v16
    v_exp_f32 v20, v20
    v_mul_f32 v17, v17, v16
    v_fma_f32 v17, v21, v20, v17
    v_rcp_f32 v17, v17
    s_nop 0
    v_mul_f32 v12, v16, v17
    v_mul_f32 v8, v20, v17
    v_min_f32 v24, v18, v22
    v_sub_f32 v18, v24, v18
    v_sub_f32 v22, v24, v22
    v_exp_f32 v18, v18
    v_exp_f32 v22, v22
    v_mul_f32 v19, v19, v18
    v_fma_f32 v19, v23, v22, v19
    v_rcp_f32 v19, v19
    s_nop 0
    v_mul_f32 v13, v18, v19
    v_mul_f32 v9, v22, v19
    v_pk_mul_f32 v[152:153], v[152:153], v[12:13] op_sel:[0,0] op_sel_hi:[1,0]
    v_pk_mul_f32 v[154:155], v[154:155], v[12:13] op_sel:[0,0] op_sel_hi:[1,0]
    v_pk_mul_f32 v[156:157], v[156:157], v[12:13] op_sel:[0,1] op_sel_hi:[1,1]
    v_pk_mul_f32 v[158:159], v[158:159], v[12:13] op_sel:[0,1] op_sel_hi:[1,1]
    v_pk_mul_f32 v[160:161], v[160:161], v[12:13] op_sel:[0,0] op_sel_hi:[1,0]
    v_pk_mul_f32 v[162:163], v[162:163], v[12:13] op_sel:[0,0] op_sel_hi:[1,0]
    v_pk_mul_f32 v[164:165], v[164:165], v[12:13] op_sel:[0,1] op_sel_hi:[1,1]
    v_pk_mul_f32 v[166:167], v[166:167], v[12:13] op_sel:[0,1] op_sel_hi:[1,1]
    v_pk_mul_f32 v[168:169], v[168:169], v[12:13] op_sel:[0,0] op_sel_hi:[1,0]
    v_pk_mul_f32 v[170:171], v[170:171], v[12:13] op_sel:[0,0] op_sel_hi:[1,0]
    v_pk_mul_f32 v[172:173], v[172:173], v[12:13] op_sel:[0,1] op_sel_hi:[1,1]
    v_pk_mul_f32 v[174:175], v[174:175], v[12:13] op_sel:[0,1] op_sel_hi:[1,1]
    v_pk_mul_f32 v[176:177], v[176:177], v[12:13] op_sel:[0,0] op_sel_hi:[1,0]
    v_pk_mul_f32 v[178:179], v[178:179], v[12:13] op_sel:[0,0] op_sel_hi:[1,0]
    v_pk_mul_f32 v[180:181], v[180:181], v[12:13] op_sel:[0,1] op_sel_hi:[1,1]
    v_pk_mul_f32 v[182:183], v[182:183], v[12:13] op_sel:[0,1] op_sel_hi:[1,1]
    s_waitcnt lgkmcnt(0)
    s_barrier
    s_nop 0
    ds_read_b128 v[216:219], v1 offset:0
    ds_read_b128 v[220:223], v1 offset:1024
    ds_read_b128 v[224:227], v1 offset:2048
    ds_read_b128 v[228:231], v1 offset:3072
    ds_read_b128 v[232:235], v1 offset:4096
    ds_read_b128 v[236:239], v1 offset:5120
    ds_read_b128 v[240:243], v1 offset:6144
    ds_read_b128 v[244:247], v1 offset:7168
    s_waitcnt lgkmcnt(7)
    v_pk_fma_f32 v[216:217], v[216:217], v[8:9], v[152:153] op_sel:[0,0,0] op_sel_hi:[1,0,1]
    v_pk_fma_f32 v[218:219], v[218:219], v[8:9], v[154:155] op_sel:[0,0,0] op_sel_hi:[1,0,1]
    s_waitcnt lgkmcnt(6)
    v_pk_fma_f32 v[220:221], v[220:221], v[8:9], v[156:157] op_sel:[0,1,0] op_sel_hi:[1,1,1]
    v_pk_fma_f32 v[222:223], v[222:223], v[8:9], v[158:159] op_sel:[0,1,0] op_sel_hi:[1,1,1]
    s_waitcnt lgkmcnt(5)
    v_pk_fma_f32 v[224:225], v[224:225], v[8:9], v[160:161] op_sel:[0,0,0] op_sel_hi:[1,0,1]
    v_pk_fma_f32 v[226:227], v[226:227], v[8:9], v[162:163] op_sel:[0,0,0] op_sel_hi:[1,0,1]
    s_waitcnt lgkmcnt(4)
    v_pk_fma_f32 v[228:229], v[228:229], v[8:9], v[164:165] op_sel:[0,1,0] op_sel_hi:[1,1,1]
    v_pk_fma_f32 v[230:231], v[230:231], v[8:9], v[166:167] op_sel:[0,1,0] op_sel_hi:[1,1,1]
    s_waitcnt lgkmcnt(3)
    v_pk_fma_f32 v[232:233], v[232:233], v[8:9], v[168:169] op_sel:[0,0,0] op_sel_hi:[1,0,1]
    v_pk_fma_f32 v[234:235], v[234:235], v[8:9], v[170:171] op_sel:[0,0,0] op_sel_hi:[1,0,1]
    s_waitcnt lgkmcnt(2)
    v_pk_fma_f32 v[236:237], v[236:237], v[8:9], v[172:173] op_sel:[0,1,0] op_sel_hi:[1,1,1]
    v_pk_fma_f32 v[238:239], v[238:239], v[8:9], v[174:175] op_sel:[0,1,0] op_sel_hi:[1,1,1]
    s_waitcnt lgkmcnt(1)
    v_pk_fma_f32 v[240:241], v[240:241], v[8:9], v[176:177] op_sel:[0,0,0] op_sel_hi:[1,0,1]
    v_pk_fma_f32 v[242:243], v[242:243], v[8:9], v[178:179] op_sel:[0,0,0] op_sel_hi:[1,0,1]
    s_waitcnt lgkmcnt(0)
    v_pk_fma_f32 v[244:245], v[244:245], v[8:9], v[180:181] op_sel:[0,1,0] op_sel_hi:[1,1,1]
    v_pk_fma_f32 v[246:247], v[246:247], v[8:9], v[182:183] op_sel:[0,1,0] op_sel_hi:[1,1,1]
    s_branch main_kernel_mjoin_146
main_kernel_mg1_145:
    s_nop 0
    ds_write_b128 v15, v[152:155] offset:0
    ds_write_b128 v15, v[156:159] offset:1024
    ds_write_b128 v15, v[160:163] offset:2048
    ds_write_b128 v15, v[164:167] offset:3072
    ds_write_b128 v15, v[168:171] offset:4096
    ds_write_b128 v15, v[172:175] offset:5120
    ds_write_b128 v15, v[176:179] offset:6144
    ds_write_b128 v15, v[180:183] offset:7168
    s_waitcnt lgkmcnt(8)
    v_min_f32 v24, v16, v20
    v_sub_f32 v16, v24, v16
    v_sub_f32 v20, v24, v20
    v_exp_f32 v16, v16
    v_exp_f32 v20, v20
    v_mul_f32 v17, v17, v16
    v_fma_f32 v17, v21, v20, v17
    v_rcp_f32 v17, v17
    s_nop 0
    v_mul_f32 v12, v16, v17
    v_mul_f32 v8, v20, v17
    v_min_f32 v24, v18, v22
    v_sub_f32 v18, v24, v18
    v_sub_f32 v22, v24, v22
    v_exp_f32 v18, v18
    v_exp_f32 v22, v22
    v_mul_f32 v19, v19, v18
    v_fma_f32 v19, v23, v22, v19
    v_rcp_f32 v19, v19
    s_nop 0
    v_mul_f32 v13, v18, v19
    v_mul_f32 v9, v22, v19
    v_pk_mul_f32 v[184:185], v[184:185], v[12:13] op_sel:[0,0] op_sel_hi:[1,0]
    v_pk_mul_f32 v[186:187], v[186:187], v[12:13] op_sel:[0,0] op_sel_hi:[1,0]
    v_pk_mul_f32 v[188:189], v[188:189], v[12:13] op_sel:[0,1] op_sel_hi:[1,1]
    v_pk_mul_f32 v[190:191], v[190:191], v[12:13] op_sel:[0,1] op_sel_hi:[1,1]
    v_pk_mul_f32 v[192:193], v[192:193], v[12:13] op_sel:[0,0] op_sel_hi:[1,0]
    v_pk_mul_f32 v[194:195], v[194:195], v[12:13] op_sel:[0,0] op_sel_hi:[1,0]
    v_pk_mul_f32 v[196:197], v[196:197], v[12:13] op_sel:[0,1] op_sel_hi:[1,1]
    v_pk_mul_f32 v[198:199], v[198:199], v[12:13] op_sel:[0,1] op_sel_hi:[1,1]
    v_pk_mul_f32 v[200:201], v[200:201], v[12:13] op_sel:[0,0] op_sel_hi:[1,0]
    v_pk_mul_f32 v[202:203], v[202:203], v[12:13] op_sel:[0,0] op_sel_hi:[1,0]
    v_pk_mul_f32 v[204:205], v[204:205], v[12:13] op_sel:[0,1] op_sel_hi:[1,1]
    v_pk_mul_f32 v[206:207], v[206:207], v[12:13] op_sel:[0,1] op_sel_hi:[1,1]
    v_pk_mul_f32 v[208:209], v[208:209], v[12:13] op_sel:[0,0] op_sel_hi:[1,0]
    v_pk_mul_f32 v[210:211], v[210:211], v[12:13] op_sel:[0,0] op_sel_hi:[1,0]
    v_pk_mul_f32 v[212:213], v[212:213], v[12:13] op_sel:[0,1] op_sel_hi:[1,1]
    v_pk_mul_f32 v[214:215], v[214:215], v[12:13] op_sel:[0,1] op_sel_hi:[1,1]
    s_waitcnt lgkmcnt(0)
    s_barrier
    s_nop 0
    ds_read_b128 v[216:219], v1 offset:0
    ds_read_b128 v[220:223], v1 offset:1024
    ds_read_b128 v[224:227], v1 offset:2048
    ds_read_b128 v[228:231], v1 offset:3072
    ds_read_b128 v[232:235], v1 offset:4096
    ds_read_b128 v[236:239], v1 offset:5120
    ds_read_b128 v[240:243], v1 offset:6144
    ds_read_b128 v[244:247], v1 offset:7168
    s_waitcnt lgkmcnt(7)
    v_pk_fma_f32 v[216:217], v[216:217], v[8:9], v[184:185] op_sel:[0,0,0] op_sel_hi:[1,0,1]
    v_pk_fma_f32 v[218:219], v[218:219], v[8:9], v[186:187] op_sel:[0,0,0] op_sel_hi:[1,0,1]
    s_waitcnt lgkmcnt(6)
    v_pk_fma_f32 v[220:221], v[220:221], v[8:9], v[188:189] op_sel:[0,1,0] op_sel_hi:[1,1,1]
    v_pk_fma_f32 v[222:223], v[222:223], v[8:9], v[190:191] op_sel:[0,1,0] op_sel_hi:[1,1,1]
    s_waitcnt lgkmcnt(5)
    v_pk_fma_f32 v[224:225], v[224:225], v[8:9], v[192:193] op_sel:[0,0,0] op_sel_hi:[1,0,1]
    v_pk_fma_f32 v[226:227], v[226:227], v[8:9], v[194:195] op_sel:[0,0,0] op_sel_hi:[1,0,1]
    s_waitcnt lgkmcnt(4)
    v_pk_fma_f32 v[228:229], v[228:229], v[8:9], v[196:197] op_sel:[0,1,0] op_sel_hi:[1,1,1]
    v_pk_fma_f32 v[230:231], v[230:231], v[8:9], v[198:199] op_sel:[0,1,0] op_sel_hi:[1,1,1]
    s_waitcnt lgkmcnt(3)
    v_pk_fma_f32 v[232:233], v[232:233], v[8:9], v[200:201] op_sel:[0,0,0] op_sel_hi:[1,0,1]
    v_pk_fma_f32 v[234:235], v[234:235], v[8:9], v[202:203] op_sel:[0,0,0] op_sel_hi:[1,0,1]
    s_waitcnt lgkmcnt(2)
    v_pk_fma_f32 v[236:237], v[236:237], v[8:9], v[204:205] op_sel:[0,1,0] op_sel_hi:[1,1,1]
    v_pk_fma_f32 v[238:239], v[238:239], v[8:9], v[206:207] op_sel:[0,1,0] op_sel_hi:[1,1,1]
    s_waitcnt lgkmcnt(1)
    v_pk_fma_f32 v[240:241], v[240:241], v[8:9], v[208:209] op_sel:[0,0,0] op_sel_hi:[1,0,1]
    v_pk_fma_f32 v[242:243], v[242:243], v[8:9], v[210:211] op_sel:[0,0,0] op_sel_hi:[1,0,1]
    s_waitcnt lgkmcnt(0)
    v_pk_fma_f32 v[244:245], v[244:245], v[8:9], v[212:213] op_sel:[0,1,0] op_sel_hi:[1,1,1]
    v_pk_fma_f32 v[246:247], v[246:247], v[8:9], v[214:215] op_sel:[0,1,0] op_sel_hi:[1,1,1]
main_kernel_mjoin_146:
    v_cvt_pk_bf16_f32 v72, v216, v217
    v_cvt_pk_bf16_f32 v73, v218, v219
    v_cvt_pk_bf16_f32 v74, v224, v225
    v_cvt_pk_bf16_f32 v75, v226, v227
    v_cvt_pk_bf16_f32 v76, v232, v233
    v_cvt_pk_bf16_f32 v77, v234, v235
    v_cvt_pk_bf16_f32 v78, v240, v241
    v_cvt_pk_bf16_f32 v79, v242, v243
    v_cvt_pk_bf16_f32 v80, v220, v221
    v_cvt_pk_bf16_f32 v81, v222, v223
    v_cvt_pk_bf16_f32 v82, v228, v229
    v_cvt_pk_bf16_f32 v83, v230, v231
    v_cvt_pk_bf16_f32 v84, v236, v237
    v_cvt_pk_bf16_f32 v85, v238, v239
    v_cvt_pk_bf16_f32 v86, v244, v245
    v_cvt_pk_bf16_f32 v87, v246, v247
    s_lshl_b32 s40, s23, 11
    s_lshl_b32 s33, s37, 6
    s_add_u32 s33, s33, s21
    s_lshl_b32 s33, s33, 12
    s_add_u32 s33, s33, 50331648
    s_add_u32 s33, s33, s40
    s_add_u32 s34, s33, 0x20000
    buffer_store_dwordx4 v[72:75], v7, s[8:11], s33 offen offset:0 sc1
    buffer_store_dwordx4 v[76:79], v7, s[8:11], s33 offen offset:1024 sc1
    buffer_store_dwordx4 v[80:83], v7, s[8:11], s34 offen offset:0 sc1
    buffer_store_dwordx4 v[84:87], v7, s[8:11], s34 offen offset:1024 sc1
    s_waitcnt vmcnt(0)
    s_barrier
    s_cmp_lg_u32 s20, 0
    s_cbranch_scc1 main_kernel_nctx_147
    s_lshr_b32 s3, s35, 3
    s_lshl_b32 s3, s3, 2
    s_lshr_b32 s4, s21, 3
    s_add_u32 s3, s3, s4
    s_lshl_b32 s3, s3, 5
    s_and_b32 s4, s35, 7
    s_lshl_b32 s4, s4, 2
    s_add_u32 s3, s3, s4
    v_and_b32 v26, 3, v2
    v_add_u32 v26, s3, v26
    s_lshr_b32 s3, s22, 3
    s_lshl_b32 s3, s3, 2
    s_lshr_b32 s4, s21, 3
    s_add_u32 s3, s3, s4
    s_lshl_b32 s3, s3, 5
    s_and_b32 s4, s22, 7
    s_lshl_b32 s4, s4, 2
    s_add_u32 s3, s3, s4
    v_and_b32 v27, 3, v2
    v_add_u32 v27, s3, v27
    v_cmp_gt_u32 vcc, 4, v2
    s_nop 1
    v_cndmask_b32 v26, v27, v26, vcc
    v_lshlrev_b32 v26, 7, v26
    s_and_b32 s3, s21, 7
    s_add_u32 s3, s3, 71303200
    v_mov_b32 v27, 1
    s_mov_b64 exec, 255
    buffer_store_byte v27, v26, s[8:11], s3 offen sc1
    s_mov_b64 exec, -1
main_kernel_nctx_147:
    s_and_b32 s3, s2, 7
    s_lshr_b32 s4, s2, 3
    s_and_b32 s40, s3, 3
    s_lshr_b32 s41, s3, 2
    s_lshl_b32 s41, s41, 3
    s_lshr_b32 s5, s4, 2
    s_add_u32 s41, s41, s5
    s_and_b32 s42, s4, 3
    s_lshr_b32 s43, s20, 2
    s_and_b32 s44, s20, 3
    s_lshl_b32 s45, s42, 1
    s_add_u32 s45, s45, s41
    s_lshl_b32 s45, s45, 1
    v_lshlrev_b32 v16, 4, v2
    v_lshrrev_b32 v1, 4, v2
    s_lshl_b32 s46, s41, 3
    s_lshl_b32 s47, s44, 1
    s_add_u32 s46, s46, s47
    s_lshl_b32 s46, s46, 17
    s_lshl_b32 s47, s40, 1
    s_add_u32 s47, s47, s43
    s_lshl_b32 s48, s47, 14
    s_add_u32 s46, s46, s48
    s_add_u32 s46, s46, 50331648
    v_add_u32 v3, s46, v16
    v_lshrrev_b32 v13, 3, v2
    v_lshlrev_b32 v13, 10, v13
    v_lshlrev_b32 v14, 1, v1
    v_and_b32 v12, 7, v2
    v_xor_b32 v14, v14, v12
    v_lshl_add_u32 v13, v14, 4, v13
    s_lshl_b32 s46, s47, 19
    s_and_b32 s48, s44, 1
    s_lshl_b32 s48, s48, 14
    s_add_u32 s46, s46, s48
    s_lshl_b32 s48, s42, 8
    s_add_u32 s46, s46, s48
    s_lshr_b32 s48, s44, 1
    s_lshl_b32 s48, s48, 7
    s_add_u32 s46, s46, s48
    v_add_u32 v4, s46, v13
    v_add_u32 v5, 7168, v4
    s_lshl_b32 s49, s43, 14
    s_lshl_b32 s50, s44, 11
    s_add_u32 s49, s49, s50
    s_add_u32 s50, s49, 8192
    s_add_u32 s52, s45, 0
    s_and_b32 s52, s52, 15
    s_lshl_b32 s52, s52, 15
    s_add_u32 m0, s50, 0
    s_nop 0
    buffer_load_dwordx4 v4, s[12:15], s52 offen lds
    buffer_load_dwordx4 v5, s[12:15], s52 offen offset:1024 lds
    s_add_u32 s52, s45, 1
    s_and_b32 s52, s52, 15
    s_lshl_b32 s52, s52, 15
    s_add_u32 m0, s50, 32768
    s_nop 0
    buffer_load_dwordx4 v4, s[12:15], s52 offen lds
    buffer_load_dwordx4 v5, s[12:15], s52 offen offset:1024 lds
    s_add_u32 s52, s45, 2
    s_and_b32 s52, s52, 15
    s_lshl_b32 s52, s52, 15
    s_add_u32 m0, s50, 65536
    s_nop 0
    buffer_load_dwordx4 v4, s[12:15], s52 offen lds
    buffer_load_dwordx4 v5, s[12:15], s52 offen offset:1024 lds
    s_add_u32 s52, s45, 3
    s_and_b32 s52, s52, 15
    s_lshl_b32 s52, s52, 15
    s_add_u32 m0, s50, 98304
    s_nop 0
    buffer_load_dwordx4 v4, s[12:15], s52 offen lds
    buffer_load_dwordx4 v5, s[12:15], s52 offen offset:1024 lds
    s_lshr_b32 s46, s20, 1
    s_and_b32 s46, s46, 1
    s_lshl_b32 s47, s46, 12
    s_lshl_b32 s48, s43, 14
    s_add_u32 s47, s47, s48
    v_add_u32 v6, s47, v16
    v_add_u32 v7, 0x10000, v6
    v_and_b32 v12, 15, v2
    v_lshrrev_b32 v13, 2, v12
    v_and_b32 v12, 3, v12
    v_lshlrev_b32 v12, 3, v12
    v_lshl_add_u32 v14, v1, 2, v13
    v_lshl_add_u32 v12, v14, 7, v12
    s_and_b32 s47, s20, 1
    s_lshl_b32 s47, s47, 12
    s_add_u32 s47, s47, s48
    s_add_u32 s47, s47, 8192
    v_add_u32 v12, s47, v12
    v_bfe_u32 v14, v14, 1, 2
    v_xor_b32 v15, 0, v14
    v_lshl_add_u32 v8, v15, 5, v12
    v_add_u32 v17, 0x10000, v8
    v_xor_b32 v15, 1, v14
    v_lshl_add_u32 v9, v15, 5, v12
    v_add_u32 v18, 0x10000, v9
    v_xor_b32 v15, 2, v14
    v_lshl_add_u32 v10, v15, 5, v12
    v_add_u32 v19, 0x10000, v10
    v_xor_b32 v15, 3, v14
    v_lshl_add_u32 v11, v15, 5, v12
    v_add_u32 v20, 0x10000, v11
    s_lshl_b32 s53, s3, 5
    s_add_u32 s53, s53, s4
    s_lshl_b32 s53, s53, 7
    s_add_u32 s53, s53, 71303168
    v_and_b32 v12, 7, v2
    v_lshlrev_b32 v12, 2, v12
    v_add_u32 v12, 64, v12
    v_and_b32 v13, 1, v2
    v_lshlrev_b32 v13, 2, v13
    v_add_u32 v13, 32, v13
    v_cmp_gt_u32 vcc, 8, v2
    s_nop 1
    v_cndmask_b32 v12, v13, v12, vcc
    s_mov_b32 s48, 0x10000
    s_cmp_lg_u32 s20, 0
    s_cbranch_scc1 main_kernel_polled_149
main_kernel_polle_148:
    buffer_load_dword v14, v12, s[8:11], s53 offen sc1
    s_waitcnt vmcnt(0)
    v_cmp_ne_u32 vcc, 0x01010101, v14
    s_nop 0
    s_cbranch_vccz main_kernel_polled_149
    s_sleep 4
    s_sub_u32 s48, s48, 1
    s_cmp_lg_u32 s48, 0
    s_cbranch_scc1 main_kernel_polle_148
main_kernel_polled_149:
    s_barrier
    s_add_u32 s51, s45, 0
    s_and_b32 s51, s51, 15
    s_lshl_b32 s51, s51, 10
    s_add_u32 m0, s49, 0
    s_nop 0
    buffer_load_dwordx4 v3, s[8:11], s51 offen lds
    s_add_u32 s51, s51, 130048
    buffer_load_dwordx4 v3, s[8:11], s51 offen offset:1024 lds
    s_add_u32 s51, s45, 1
    s_and_b32 s51, s51, 15
    s_lshl_b32 s51, s51, 10
    s_add_u32 m0, s49, 32768
    s_nop 0
    buffer_load_dwordx4 v3, s[8:11], s51 offen lds
    s_add_u32 s51, s51, 130048
    buffer_load_dwordx4 v3, s[8:11], s51 offen offset:1024 lds
    s_add_u32 s51, s45, 2
    s_and_b32 s51, s51, 15
    s_lshl_b32 s51, s51, 10
    s_add_u32 m0, s49, 65536
    s_nop 0
    buffer_load_dwordx4 v3, s[8:11], s51 offen lds
    s_add_u32 s51, s51, 130048
    buffer_load_dwordx4 v3, s[8:11], s51 offen offset:1024 lds
    s_add_u32 s51, s45, 3
    s_and_b32 s51, s51, 15
    s_lshl_b32 s51, s51, 10
    s_add_u32 m0, s49, 98304
    s_nop 0
    buffer_load_dwordx4 v3, s[8:11], s51 offen lds
    s_add_u32 s51, s51, 130048
    buffer_load_dwordx4 v3, s[8:11], s51 offen offset:1024 lds
    s_lshl_b32 s48, s3, 18
    s_lshl_b32 s47, s4, 7
    s_add_u32 s48, s48, s47
    s_add_u32 s48, s48, 69206016
    v_lshrrev_b32 v240, 3, v0
    v_lshlrev_b32 v240, 12, v240
    v_and_b32 v241, 7, v0
    v_lshl_add_u32 v240, v241, 4, v240
    buffer_load_dwordx4 v[244:247], v240, s[8:11], s48 offen
    s_waitcnt vmcnt(7)
    s_barrier
    ds_read_b64_tr_b16 v[48:49], v8 offset:0
    ds_read_b64_tr_b16 v[50:51], v8 offset:2048
    ds_read_b128 v[32:35], v6 offset:0
    ds_read_b64_tr_b16 v[52:53], v9 offset:0
    ds_read_b64_tr_b16 v[54:55], v9 offset:2048
    ds_read_b128 v[36:39], v6 offset:1024
    ds_read_b64_tr_b16 v[56:57], v10 offset:0
    ds_read_b64_tr_b16 v[58:59], v10 offset:2048
    ds_read_b128 v[40:43], v6 offset:2048
    ds_read_b64_tr_b16 v[60:61], v11 offset:0
    ds_read_b64_tr_b16 v[62:63], v11 offset:2048
    ds_read_b128 v[44:47], v6 offset:3072
    s_waitcnt lgkmcnt(9)
    s_nop 0
    v_mfma_f32_16x16x32_bf16 v[96:99], v[48:51], v[32:35], 0
    s_waitcnt lgkmcnt(6)
    s_nop 0
    v_mfma_f32_16x16x32_bf16 v[112:115], v[48:51], v[36:39], 0
    s_waitcnt vmcnt(5) lgkmcnt(0)
    s_barrier
    ds_read_b64_tr_b16 v[80:81], v8 offset:32768
    ds_read_b64_tr_b16 v[82:83], v8 offset:34816
    v_mfma_f32_16x16x32_bf16 v[128:131], v[48:51], v[40:43], 0
    ds_read_b128 v[64:67], v6 offset:32768
    v_mfma_f32_16x16x32_bf16 v[144:147], v[48:51], v[44:47], 0
    ds_read_b64_tr_b16 v[84:85], v9 offset:32768
    ds_read_b64_tr_b16 v[86:87], v9 offset:34816
    s_add_u32 s51, s45, 4
    s_and_b32 s51, s51, 15
    s_lshl_b32 s51, s51, 10
    s_add_u32 m0, s49, 0
    v_mfma_f32_16x16x32_bf16 v[100:103], v[52:55], v[32:35], 0
    ds_read_b128 v[68:71], v6 offset:33792
    v_mfma_f32_16x16x32_bf16 v[116:119], v[52:55], v[36:39], 0
    ds_read_b64_tr_b16 v[88:89], v10 offset:32768
    ds_read_b64_tr_b16 v[90:91], v10 offset:34816
    buffer_load_dwordx4 v3, s[8:11], s51 offen lds
    v_mfma_f32_16x16x32_bf16 v[132:135], v[52:55], v[40:43], 0
    ds_read_b128 v[72:75], v6 offset:34816
    v_mfma_f32_16x16x32_bf16 v[148:151], v[52:55], v[44:47], 0
    ds_read_b64_tr_b16 v[92:93], v11 offset:32768
    ds_read_b64_tr_b16 v[94:95], v11 offset:34816
    s_add_u32 s51, s51, 130048
    buffer_load_dwordx4 v3, s[8:11], s51 offen offset:1024 lds
    v_mfma_f32_16x16x32_bf16 v[104:107], v[56:59], v[32:35], 0
    ds_read_b128 v[76:79], v6 offset:35840
    v_mfma_f32_16x16x32_bf16 v[120:123], v[56:59], v[36:39], 0
    s_add_u32 s52, s45, 4
    s_and_b32 s52, s52, 15
    s_lshl_b32 s52, s52, 15
    s_add_u32 m0, s50, 0
    v_mfma_f32_16x16x32_bf16 v[136:139], v[56:59], v[40:43], 0
    v_mfma_f32_16x16x32_bf16 v[152:155], v[56:59], v[44:47], 0
    buffer_load_dwordx4 v4, s[12:15], s52 offen lds
    v_mfma_f32_16x16x32_bf16 v[108:111], v[60:63], v[32:35], 0
    v_mfma_f32_16x16x32_bf16 v[124:127], v[60:63], v[36:39], 0
    buffer_load_dwordx4 v5, s[12:15], s52 offen offset:1024 lds
    v_mfma_f32_16x16x32_bf16 v[140:143], v[60:63], v[40:43], 0
    v_mfma_f32_16x16x32_bf16 v[156:159], v[60:63], v[44:47], 0
    s_waitcnt lgkmcnt(9)
    s_nop 0
    v_mfma_f32_16x16x32_bf16 v[96:99], v[80:83], v[64:67], v[96:99]
    s_waitcnt lgkmcnt(6)
    s_nop 0
    v_mfma_f32_16x16x32_bf16 v[112:115], v[80:83], v[68:71], v[112:115]
    s_waitcnt vmcnt(7) lgkmcnt(0)
    s_barrier
    ds_read_b64_tr_b16 v[48:49], v17 offset:0
    ds_read_b64_tr_b16 v[50:51], v17 offset:2048
    v_mfma_f32_16x16x32_bf16 v[128:131], v[80:83], v[72:75], v[128:131]
    ds_read_b128 v[32:35], v7 offset:0
    v_mfma_f32_16x16x32_bf16 v[144:147], v[80:83], v[76:79], v[144:147]
    ds_read_b64_tr_b16 v[52:53], v18 offset:0
    ds_read_b64_tr_b16 v[54:55], v18 offset:2048
    s_add_u32 s51, s45, 5
    s_and_b32 s51, s51, 15
    s_lshl_b32 s51, s51, 10
    s_add_u32 m0, s49, 32768
    s_nop 0
    v_mfma_f32_16x16x32_bf16 v[100:103], v[84:87], v[64:67], v[100:103]
    ds_read_b128 v[36:39], v7 offset:1024
    v_mfma_f32_16x16x32_bf16 v[116:119], v[84:87], v[68:71], v[116:119]
    ds_read_b64_tr_b16 v[56:57], v19 offset:0
    ds_read_b64_tr_b16 v[58:59], v19 offset:2048
    buffer_load_dwordx4 v3, s[8:11], s51 offen lds
    v_mfma_f32_16x16x32_bf16 v[132:135], v[84:87], v[72:75], v[132:135]
    ds_read_b128 v[40:43], v7 offset:2048
    v_mfma_f32_16x16x32_bf16 v[148:151], v[84:87], v[76:79], v[148:151]
    ds_read_b64_tr_b16 v[60:61], v20 offset:0
    ds_read_b64_tr_b16 v[62:63], v20 offset:2048
    s_add_u32 s51, s51, 130048
    buffer_load_dwordx4 v3, s[8:11], s51 offen offset:1024 lds
    v_mfma_f32_16x16x32_bf16 v[104:107], v[88:91], v[64:67], v[104:107]
    ds_read_b128 v[44:47], v7 offset:3072
    v_mfma_f32_16x16x32_bf16 v[120:123], v[88:91], v[68:71], v[120:123]
    s_add_u32 s52, s45, 5
    s_and_b32 s52, s52, 15
    s_lshl_b32 s52, s52, 15
    s_add_u32 m0, s50, 32768
    s_nop 0
    v_mfma_f32_16x16x32_bf16 v[136:139], v[88:91], v[72:75], v[136:139]
    v_mfma_f32_16x16x32_bf16 v[152:155], v[88:91], v[76:79], v[152:155]
    buffer_load_dwordx4 v4, s[12:15], s52 offen lds
    v_mfma_f32_16x16x32_bf16 v[108:111], v[92:95], v[64:67], v[108:111]
    v_mfma_f32_16x16x32_bf16 v[124:127], v[92:95], v[68:71], v[124:127]
    buffer_load_dwordx4 v5, s[12:15], s52 offen offset:1024 lds
    v_mfma_f32_16x16x32_bf16 v[140:143], v[92:95], v[72:75], v[140:143]
    v_mfma_f32_16x16x32_bf16 v[156:159], v[92:95], v[76:79], v[156:159]
    s_waitcnt lgkmcnt(9)
    s_nop 0
    v_mfma_f32_16x16x32_bf16 v[96:99], v[48:51], v[32:35], v[96:99]
    s_waitcnt lgkmcnt(6)
    s_nop 0
    v_mfma_f32_16x16x32_bf16 v[112:115], v[48:51], v[36:39], v[112:115]
    s_waitcnt vmcnt(9) lgkmcnt(0)
    s_barrier
    ds_read_b64_tr_b16 v[80:81], v17 offset:32768
    ds_read_b64_tr_b16 v[82:83], v17 offset:34816
    v_mfma_f32_16x16x32_bf16 v[128:131], v[48:51], v[40:43], v[128:131]
    ds_read_b128 v[64:67], v7 offset:32768
    v_mfma_f32_16x16x32_bf16 v[144:147], v[48:51], v[44:47], v[144:147]
    ds_read_b64_tr_b16 v[84:85], v18 offset:32768
    ds_read_b64_tr_b16 v[86:87], v18 offset:34816
    s_add_u32 s51, s45, 6
    s_and_b32 s51, s51, 15
    s_lshl_b32 s51, s51, 10
    s_add_u32 m0, s49, 65536
    s_nop 0
    v_mfma_f32_16x16x32_bf16 v[100:103], v[52:55], v[32:35], v[100:103]
    ds_read_b128 v[68:71], v7 offset:33792
    v_mfma_f32_16x16x32_bf16 v[116:119], v[52:55], v[36:39], v[116:119]
    ds_read_b64_tr_b16 v[88:89], v19 offset:32768
    ds_read_b64_tr_b16 v[90:91], v19 offset:34816
    buffer_load_dwordx4 v3, s[8:11], s51 offen lds
    v_mfma_f32_16x16x32_bf16 v[132:135], v[52:55], v[40:43], v[132:135]
    ds_read_b128 v[72:75], v7 offset:34816
    v_mfma_f32_16x16x32_bf16 v[148:151], v[52:55], v[44:47], v[148:151]
    ds_read_b64_tr_b16 v[92:93], v20 offset:32768
    ds_read_b64_tr_b16 v[94:95], v20 offset:34816
    s_add_u32 s51, s51, 130048
    buffer_load_dwordx4 v3, s[8:11], s51 offen offset:1024 lds
    v_mfma_f32_16x16x32_bf16 v[104:107], v[56:59], v[32:35], v[104:107]
    ds_read_b128 v[76:79], v7 offset:35840
    v_mfma_f32_16x16x32_bf16 v[120:123], v[56:59], v[36:39], v[120:123]
    s_add_u32 s52, s45, 6
    s_and_b32 s52, s52, 15
    s_lshl_b32 s52, s52, 15
    s_add_u32 m0, s50, 65536
    s_nop 0
    v_mfma_f32_16x16x32_bf16 v[136:139], v[56:59], v[40:43], v[136:139]
    v_mfma_f32_16x16x32_bf16 v[152:155], v[56:59], v[44:47], v[152:155]
    buffer_load_dwordx4 v4, s[12:15], s52 offen lds
    v_mfma_f32_16x16x32_bf16 v[108:111], v[60:63], v[32:35], v[108:111]
    v_mfma_f32_16x16x32_bf16 v[124:127], v[60:63], v[36:39], v[124:127]
    buffer_load_dwordx4 v5, s[12:15], s52 offen offset:1024 lds
    v_mfma_f32_16x16x32_bf16 v[140:143], v[60:63], v[40:43], v[140:143]
    v_mfma_f32_16x16x32_bf16 v[156:159], v[60:63], v[44:47], v[156:159]
    s_waitcnt lgkmcnt(9)
    s_nop 0
    v_mfma_f32_16x16x32_bf16 v[96:99], v[80:83], v[64:67], v[96:99]
    s_waitcnt lgkmcnt(6)
    s_nop 0
    v_mfma_f32_16x16x32_bf16 v[112:115], v[80:83], v[68:71], v[112:115]
    s_waitcnt vmcnt(8) lgkmcnt(0)
    s_barrier
    ds_read_b64_tr_b16 v[48:49], v8 offset:0
    ds_read_b64_tr_b16 v[50:51], v8 offset:2048
    v_mfma_f32_16x16x32_bf16 v[128:131], v[80:83], v[72:75], v[128:131]
    ds_read_b128 v[32:35], v6 offset:0
    v_mfma_f32_16x16x32_bf16 v[144:147], v[80:83], v[76:79], v[144:147]
    ds_read_b64_tr_b16 v[52:53], v9 offset:0
    ds_read_b64_tr_b16 v[54:55], v9 offset:2048
    s_add_u32 s51, s45, 7
    s_and_b32 s51, s51, 15
    s_lshl_b32 s51, s51, 10
    s_add_u32 m0, s49, 98304
    s_nop 0
    v_mfma_f32_16x16x32_bf16 v[100:103], v[84:87], v[64:67], v[100:103]
    ds_read_b128 v[36:39], v6 offset:1024
    v_mfma_f32_16x16x32_bf16 v[116:119], v[84:87], v[68:71], v[116:119]
    ds_read_b64_tr_b16 v[56:57], v10 offset:0
    ds_read_b64_tr_b16 v[58:59], v10 offset:2048
    buffer_load_dwordx4 v3, s[8:11], s51 offen lds
    v_mfma_f32_16x16x32_bf16 v[132:135], v[84:87], v[72:75], v[132:135]
    ds_read_b128 v[40:43], v6 offset:2048
    v_mfma_f32_16x16x32_bf16 v[148:151], v[84:87], v[76:79], v[148:151]
    ds_read_b64_tr_b16 v[60:61], v11 offset:0
    ds_read_b64_tr_b16 v[62:63], v11 offset:2048
    s_add_u32 s51, s51, 130048
    buffer_load_dwordx4 v3, s[8:11], s51 offen offset:1024 lds
    v_mfma_f32_16x16x32_bf16 v[104:107], v[88:91], v[64:67], v[104:107]
    ds_read_b128 v[44:47], v6 offset:3072
    v_mfma_f32_16x16x32_bf16 v[120:123], v[88:91], v[68:71], v[120:123]
    s_add_u32 s52, s45, 7
    s_and_b32 s52, s52, 15
    s_lshl_b32 s52, s52, 15
    s_add_u32 m0, s50, 98304
    s_nop 0
    v_mfma_f32_16x16x32_bf16 v[136:139], v[88:91], v[72:75], v[136:139]
    v_mfma_f32_16x16x32_bf16 v[152:155], v[88:91], v[76:79], v[152:155]
    buffer_load_dwordx4 v4, s[12:15], s52 offen lds
    v_mfma_f32_16x16x32_bf16 v[108:111], v[92:95], v[64:67], v[108:111]
    v_mfma_f32_16x16x32_bf16 v[124:127], v[92:95], v[68:71], v[124:127]
    buffer_load_dwordx4 v5, s[12:15], s52 offen offset:1024 lds
    v_mfma_f32_16x16x32_bf16 v[140:143], v[92:95], v[72:75], v[140:143]
    v_mfma_f32_16x16x32_bf16 v[156:159], v[92:95], v[76:79], v[156:159]
    s_waitcnt lgkmcnt(9)
    s_nop 0
    v_mfma_f32_16x16x32_bf16 v[96:99], v[48:51], v[32:35], v[96:99]
    s_waitcnt lgkmcnt(6)
    s_nop 0
    v_mfma_f32_16x16x32_bf16 v[112:115], v[48:51], v[36:39], v[112:115]
    s_waitcnt vmcnt(8) lgkmcnt(0)
    s_barrier
    ds_read_b64_tr_b16 v[80:81], v8 offset:32768
    ds_read_b64_tr_b16 v[82:83], v8 offset:34816
    v_mfma_f32_16x16x32_bf16 v[128:131], v[48:51], v[40:43], v[128:131]
    ds_read_b128 v[64:67], v6 offset:32768
    v_mfma_f32_16x16x32_bf16 v[144:147], v[48:51], v[44:47], v[144:147]
    ds_read_b64_tr_b16 v[84:85], v9 offset:32768
    ds_read_b64_tr_b16 v[86:87], v9 offset:34816
    s_add_u32 s51, s45, 8
    s_and_b32 s51, s51, 15
    s_lshl_b32 s51, s51, 10
    s_add_u32 m0, s49, 0
    v_mfma_f32_16x16x32_bf16 v[100:103], v[52:55], v[32:35], v[100:103]
    ds_read_b128 v[68:71], v6 offset:33792
    v_mfma_f32_16x16x32_bf16 v[116:119], v[52:55], v[36:39], v[116:119]
    ds_read_b64_tr_b16 v[88:89], v10 offset:32768
    ds_read_b64_tr_b16 v[90:91], v10 offset:34816
    buffer_load_dwordx4 v3, s[8:11], s51 offen lds
    v_mfma_f32_16x16x32_bf16 v[132:135], v[52:55], v[40:43], v[132:135]
    ds_read_b128 v[72:75], v6 offset:34816
    v_mfma_f32_16x16x32_bf16 v[148:151], v[52:55], v[44:47], v[148:151]
    ds_read_b64_tr_b16 v[92:93], v11 offset:32768
    ds_read_b64_tr_b16 v[94:95], v11 offset:34816
    s_add_u32 s51, s51, 130048
    buffer_load_dwordx4 v3, s[8:11], s51 offen offset:1024 lds
    v_mfma_f32_16x16x32_bf16 v[104:107], v[56:59], v[32:35], v[104:107]
    ds_read_b128 v[76:79], v6 offset:35840
    v_mfma_f32_16x16x32_bf16 v[120:123], v[56:59], v[36:39], v[120:123]
    s_add_u32 s52, s45, 8
    s_and_b32 s52, s52, 15
    s_lshl_b32 s52, s52, 15
    s_add_u32 m0, s50, 0
    v_mfma_f32_16x16x32_bf16 v[136:139], v[56:59], v[40:43], v[136:139]
    v_mfma_f32_16x16x32_bf16 v[152:155], v[56:59], v[44:47], v[152:155]
    buffer_load_dwordx4 v4, s[12:15], s52 offen lds
    v_mfma_f32_16x16x32_bf16 v[108:111], v[60:63], v[32:35], v[108:111]
    v_mfma_f32_16x16x32_bf16 v[124:127], v[60:63], v[36:39], v[124:127]
    buffer_load_dwordx4 v5, s[12:15], s52 offen offset:1024 lds
    v_mfma_f32_16x16x32_bf16 v[140:143], v[60:63], v[40:43], v[140:143]
    v_mfma_f32_16x16x32_bf16 v[156:159], v[60:63], v[44:47], v[156:159]
    s_waitcnt lgkmcnt(9)
    s_nop 0
    v_mfma_f32_16x16x32_bf16 v[96:99], v[80:83], v[64:67], v[96:99]
    s_waitcnt lgkmcnt(6)
    s_nop 0
    v_mfma_f32_16x16x32_bf16 v[112:115], v[80:83], v[68:71], v[112:115]
    s_waitcnt vmcnt(8) lgkmcnt(0)
    s_barrier
    ds_read_b64_tr_b16 v[48:49], v17 offset:0
    ds_read_b64_tr_b16 v[50:51], v17 offset:2048
    v_mfma_f32_16x16x32_bf16 v[128:131], v[80:83], v[72:75], v[128:131]
    ds_read_b128 v[32:35], v7 offset:0
    v_mfma_f32_16x16x32_bf16 v[144:147], v[80:83], v[76:79], v[144:147]
    ds_read_b64_tr_b16 v[52:53], v18 offset:0
    ds_read_b64_tr_b16 v[54:55], v18 offset:2048
    s_add_u32 s51, s45, 9
    s_and_b32 s51, s51, 15
    s_lshl_b32 s51, s51, 10
    s_add_u32 m0, s49, 32768
    s_nop 0
    v_mfma_f32_16x16x32_bf16 v[100:103], v[84:87], v[64:67], v[100:103]
    ds_read_b128 v[36:39], v7 offset:1024
    v_mfma_f32_16x16x32_bf16 v[116:119], v[84:87], v[68:71], v[116:119]
    ds_read_b64_tr_b16 v[56:57], v19 offset:0
    ds_read_b64_tr_b16 v[58:59], v19 offset:2048
    buffer_load_dwordx4 v3, s[8:11], s51 offen lds
    v_mfma_f32_16x16x32_bf16 v[132:135], v[84:87], v[72:75], v[132:135]
    ds_read_b128 v[40:43], v7 offset:2048
    v_mfma_f32_16x16x32_bf16 v[148:151], v[84:87], v[76:79], v[148:151]
    ds_read_b64_tr_b16 v[60:61], v20 offset:0
    ds_read_b64_tr_b16 v[62:63], v20 offset:2048
    s_add_u32 s51, s51, 130048
    buffer_load_dwordx4 v3, s[8:11], s51 offen offset:1024 lds
    v_mfma_f32_16x16x32_bf16 v[104:107], v[88:91], v[64:67], v[104:107]
    ds_read_b128 v[44:47], v7 offset:3072
    v_mfma_f32_16x16x32_bf16 v[120:123], v[88:91], v[68:71], v[120:123]
    s_add_u32 s52, s45, 9
    s_and_b32 s52, s52, 15
    s_lshl_b32 s52, s52, 15
    s_add_u32 m0, s50, 32768
    s_nop 0
    v_mfma_f32_16x16x32_bf16 v[136:139], v[88:91], v[72:75], v[136:139]
    v_mfma_f32_16x16x32_bf16 v[152:155], v[88:91], v[76:79], v[152:155]
    buffer_load_dwordx4 v4, s[12:15], s52 offen lds
    v_mfma_f32_16x16x32_bf16 v[108:111], v[92:95], v[64:67], v[108:111]
    v_mfma_f32_16x16x32_bf16 v[124:127], v[92:95], v[68:71], v[124:127]
    buffer_load_dwordx4 v5, s[12:15], s52 offen offset:1024 lds
    v_mfma_f32_16x16x32_bf16 v[140:143], v[92:95], v[72:75], v[140:143]
    v_mfma_f32_16x16x32_bf16 v[156:159], v[92:95], v[76:79], v[156:159]
    s_waitcnt lgkmcnt(9)
    s_nop 0
    v_mfma_f32_16x16x32_bf16 v[96:99], v[48:51], v[32:35], v[96:99]
    s_waitcnt lgkmcnt(6)
    s_nop 0
    v_mfma_f32_16x16x32_bf16 v[112:115], v[48:51], v[36:39], v[112:115]
    s_waitcnt vmcnt(8) lgkmcnt(0)
    s_barrier
    ds_read_b64_tr_b16 v[80:81], v17 offset:32768
    ds_read_b64_tr_b16 v[82:83], v17 offset:34816
    v_mfma_f32_16x16x32_bf16 v[128:131], v[48:51], v[40:43], v[128:131]
    ds_read_b128 v[64:67], v7 offset:32768
    v_mfma_f32_16x16x32_bf16 v[144:147], v[48:51], v[44:47], v[144:147]
    ds_read_b64_tr_b16 v[84:85], v18 offset:32768
    ds_read_b64_tr_b16 v[86:87], v18 offset:34816
    s_add_u32 s51, s45, 10
    s_and_b32 s51, s51, 15
    s_lshl_b32 s51, s51, 10
    s_add_u32 m0, s49, 65536
    s_nop 0
    v_mfma_f32_16x16x32_bf16 v[100:103], v[52:55], v[32:35], v[100:103]
    ds_read_b128 v[68:71], v7 offset:33792
    v_mfma_f32_16x16x32_bf16 v[116:119], v[52:55], v[36:39], v[116:119]
    ds_read_b64_tr_b16 v[88:89], v19 offset:32768
    ds_read_b64_tr_b16 v[90:91], v19 offset:34816
    buffer_load_dwordx4 v3, s[8:11], s51 offen lds
    v_mfma_f32_16x16x32_bf16 v[132:135], v[52:55], v[40:43], v[132:135]
    ds_read_b128 v[72:75], v7 offset:34816
    v_mfma_f32_16x16x32_bf16 v[148:151], v[52:55], v[44:47], v[148:151]
    ds_read_b64_tr_b16 v[92:93], v20 offset:32768
    ds_read_b64_tr_b16 v[94:95], v20 offset:34816
    s_add_u32 s51, s51, 130048
    buffer_load_dwordx4 v3, s[8:11], s51 offen offset:1024 lds
    v_mfma_f32_16x16x32_bf16 v[104:107], v[56:59], v[32:35], v[104:107]
    ds_read_b128 v[76:79], v7 offset:35840
    v_mfma_f32_16x16x32_bf16 v[120:123], v[56:59], v[36:39], v[120:123]
    s_add_u32 s52, s45, 10
    s_and_b32 s52, s52, 15
    s_lshl_b32 s52, s52, 15
    s_add_u32 m0, s50, 65536
    s_nop 0
    v_mfma_f32_16x16x32_bf16 v[136:139], v[56:59], v[40:43], v[136:139]
    v_mfma_f32_16x16x32_bf16 v[152:155], v[56:59], v[44:47], v[152:155]
    buffer_load_dwordx4 v4, s[12:15], s52 offen lds
    v_mfma_f32_16x16x32_bf16 v[108:111], v[60:63], v[32:35], v[108:111]
    v_mfma_f32_16x16x32_bf16 v[124:127], v[60:63], v[36:39], v[124:127]
    buffer_load_dwordx4 v5, s[12:15], s52 offen offset:1024 lds
    v_mfma_f32_16x16x32_bf16 v[140:143], v[60:63], v[40:43], v[140:143]
    v_mfma_f32_16x16x32_bf16 v[156:159], v[60:63], v[44:47], v[156:159]
    s_waitcnt lgkmcnt(9)
    s_nop 0
    v_mfma_f32_16x16x32_bf16 v[96:99], v[80:83], v[64:67], v[96:99]
    s_waitcnt lgkmcnt(6)
    s_nop 0
    v_mfma_f32_16x16x32_bf16 v[112:115], v[80:83], v[68:71], v[112:115]
    s_waitcnt vmcnt(8) lgkmcnt(0)
    s_barrier
    ds_read_b64_tr_b16 v[48:49], v8 offset:0
    ds_read_b64_tr_b16 v[50:51], v8 offset:2048
    v_mfma_f32_16x16x32_bf16 v[128:131], v[80:83], v[72:75], v[128:131]
    ds_read_b128 v[32:35], v6 offset:0
    v_mfma_f32_16x16x32_bf16 v[144:147], v[80:83], v[76:79], v[144:147]
    ds_read_b64_tr_b16 v[52:53], v9 offset:0
    ds_read_b64_tr_b16 v[54:55], v9 offset:2048
    s_add_u32 s51, s45, 11
    s_and_b32 s51, s51, 15
    s_lshl_b32 s51, s51, 10
    s_add_u32 m0, s49, 98304
    s_nop 0
    v_mfma_f32_16x16x32_bf16 v[100:103], v[84:87], v[64:67], v[100:103]
    ds_read_b128 v[36:39], v6 offset:1024
    v_mfma_f32_16x16x32_bf16 v[116:119], v[84:87], v[68:71], v[116:119]
    ds_read_b64_tr_b16 v[56:57], v10 offset:0
    ds_read_b64_tr_b16 v[58:59], v10 offset:2048
    buffer_load_dwordx4 v3, s[8:11], s51 offen lds
    v_mfma_f32_16x16x32_bf16 v[132:135], v[84:87], v[72:75], v[132:135]
    ds_read_b128 v[40:43], v6 offset:2048
    v_mfma_f32_16x16x32_bf16 v[148:151], v[84:87], v[76:79], v[148:151]
    ds_read_b64_tr_b16 v[60:61], v11 offset:0
    ds_read_b64_tr_b16 v[62:63], v11 offset:2048
    s_add_u32 s51, s51, 130048
    buffer_load_dwordx4 v3, s[8:11], s51 offen offset:1024 lds
    v_mfma_f32_16x16x32_bf16 v[104:107], v[88:91], v[64:67], v[104:107]
    ds_read_b128 v[44:47], v6 offset:3072
    v_mfma_f32_16x16x32_bf16 v[120:123], v[88:91], v[68:71], v[120:123]
    s_add_u32 s52, s45, 11
    s_and_b32 s52, s52, 15
    s_lshl_b32 s52, s52, 15
    s_add_u32 m0, s50, 98304
    s_nop 0
    v_mfma_f32_16x16x32_bf16 v[136:139], v[88:91], v[72:75], v[136:139]
    v_mfma_f32_16x16x32_bf16 v[152:155], v[88:91], v[76:79], v[152:155]
    buffer_load_dwordx4 v4, s[12:15], s52 offen lds
    v_mfma_f32_16x16x32_bf16 v[108:111], v[92:95], v[64:67], v[108:111]
    v_mfma_f32_16x16x32_bf16 v[124:127], v[92:95], v[68:71], v[124:127]
    buffer_load_dwordx4 v5, s[12:15], s52 offen offset:1024 lds
    v_mfma_f32_16x16x32_bf16 v[140:143], v[92:95], v[72:75], v[140:143]
    v_mfma_f32_16x16x32_bf16 v[156:159], v[92:95], v[76:79], v[156:159]
    s_waitcnt lgkmcnt(9)
    s_nop 0
    v_mfma_f32_16x16x32_bf16 v[96:99], v[48:51], v[32:35], v[96:99]
    s_waitcnt lgkmcnt(6)
    s_nop 0
    v_mfma_f32_16x16x32_bf16 v[112:115], v[48:51], v[36:39], v[112:115]
    s_waitcnt vmcnt(8) lgkmcnt(0)
    s_barrier
    ds_read_b64_tr_b16 v[80:81], v8 offset:32768
    ds_read_b64_tr_b16 v[82:83], v8 offset:34816
    v_mfma_f32_16x16x32_bf16 v[128:131], v[48:51], v[40:43], v[128:131]
    ds_read_b128 v[64:67], v6 offset:32768
    v_mfma_f32_16x16x32_bf16 v[144:147], v[48:51], v[44:47], v[144:147]
    ds_read_b64_tr_b16 v[84:85], v9 offset:32768
    ds_read_b64_tr_b16 v[86:87], v9 offset:34816
    s_add_u32 s51, s45, 12
    s_and_b32 s51, s51, 15
    s_lshl_b32 s51, s51, 10
    s_add_u32 m0, s49, 0
    v_mfma_f32_16x16x32_bf16 v[100:103], v[52:55], v[32:35], v[100:103]
    ds_read_b128 v[68:71], v6 offset:33792
    v_mfma_f32_16x16x32_bf16 v[116:119], v[52:55], v[36:39], v[116:119]
    ds_read_b64_tr_b16 v[88:89], v10 offset:32768
    ds_read_b64_tr_b16 v[90:91], v10 offset:34816
    buffer_load_dwordx4 v3, s[8:11], s51 offen lds
    v_mfma_f32_16x16x32_bf16 v[132:135], v[52:55], v[40:43], v[132:135]
    ds_read_b128 v[72:75], v6 offset:34816
    v_mfma_f32_16x16x32_bf16 v[148:151], v[52:55], v[44:47], v[148:151]
    ds_read_b64_tr_b16 v[92:93], v11 offset:32768
    ds_read_b64_tr_b16 v[94:95], v11 offset:34816
    s_add_u32 s51, s51, 130048
    buffer_load_dwordx4 v3, s[8:11], s51 offen offset:1024 lds
    v_mfma_f32_16x16x32_bf16 v[104:107], v[56:59], v[32:35], v[104:107]
    ds_read_b128 v[76:79], v6 offset:35840
    v_mfma_f32_16x16x32_bf16 v[120:123], v[56:59], v[36:39], v[120:123]
    s_add_u32 s52, s45, 12
    s_and_b32 s52, s52, 15
    s_lshl_b32 s52, s52, 15
    s_add_u32 m0, s50, 0
    v_mfma_f32_16x16x32_bf16 v[136:139], v[56:59], v[40:43], v[136:139]
    v_mfma_f32_16x16x32_bf16 v[152:155], v[56:59], v[44:47], v[152:155]
    buffer_load_dwordx4 v4, s[12:15], s52 offen lds
    v_mfma_f32_16x16x32_bf16 v[108:111], v[60:63], v[32:35], v[108:111]
    v_mfma_f32_16x16x32_bf16 v[124:127], v[60:63], v[36:39], v[124:127]
    buffer_load_dwordx4 v5, s[12:15], s52 offen offset:1024 lds
    v_mfma_f32_16x16x32_bf16 v[140:143], v[60:63], v[40:43], v[140:143]
    v_mfma_f32_16x16x32_bf16 v[156:159], v[60:63], v[44:47], v[156:159]
    s_waitcnt lgkmcnt(9)
    s_nop 0
    v_mfma_f32_16x16x32_bf16 v[96:99], v[80:83], v[64:67], v[96:99]
    s_waitcnt lgkmcnt(6)
    s_nop 0
    v_mfma_f32_16x16x32_bf16 v[112:115], v[80:83], v[68:71], v[112:115]
    s_waitcnt vmcnt(8) lgkmcnt(0)
    s_barrier
    ds_read_b64_tr_b16 v[48:49], v17 offset:0
    ds_read_b64_tr_b16 v[50:51], v17 offset:2048
    v_mfma_f32_16x16x32_bf16 v[128:131], v[80:83], v[72:75], v[128:131]
    ds_read_b128 v[32:35], v7 offset:0
    v_mfma_f32_16x16x32_bf16 v[144:147], v[80:83], v[76:79], v[144:147]
    ds_read_b64_tr_b16 v[52:53], v18 offset:0
    ds_read_b64_tr_b16 v[54:55], v18 offset:2048
    s_add_u32 s51, s45, 13
    s_and_b32 s51, s51, 15
    s_lshl_b32 s51, s51, 10
    s_add_u32 m0, s49, 32768
    s_nop 0
    v_mfma_f32_16x16x32_bf16 v[100:103], v[84:87], v[64:67], v[100:103]
    ds_read_b128 v[36:39], v7 offset:1024
    v_mfma_f32_16x16x32_bf16 v[116:119], v[84:87], v[68:71], v[116:119]
    ds_read_b64_tr_b16 v[56:57], v19 offset:0
    ds_read_b64_tr_b16 v[58:59], v19 offset:2048
    buffer_load_dwordx4 v3, s[8:11], s51 offen lds
    v_mfma_f32_16x16x32_bf16 v[132:135], v[84:87], v[72:75], v[132:135]
    ds_read_b128 v[40:43], v7 offset:2048
    v_mfma_f32_16x16x32_bf16 v[148:151], v[84:87], v[76:79], v[148:151]
    ds_read_b64_tr_b16 v[60:61], v20 offset:0
    ds_read_b64_tr_b16 v[62:63], v20 offset:2048
    s_add_u32 s51, s51, 130048
    buffer_load_dwordx4 v3, s[8:11], s51 offen offset:1024 lds
    v_mfma_f32_16x16x32_bf16 v[104:107], v[88:91], v[64:67], v[104:107]
    ds_read_b128 v[44:47], v7 offset:3072
    v_mfma_f32_16x16x32_bf16 v[120:123], v[88:91], v[68:71], v[120:123]
    s_add_u32 s52, s45, 13
    s_and_b32 s52, s52, 15
    s_lshl_b32 s52, s52, 15
    s_add_u32 m0, s50, 32768
    s_nop 0
    v_mfma_f32_16x16x32_bf16 v[136:139], v[88:91], v[72:75], v[136:139]
    v_mfma_f32_16x16x32_bf16 v[152:155], v[88:91], v[76:79], v[152:155]
    buffer_load_dwordx4 v4, s[12:15], s52 offen lds
    v_mfma_f32_16x16x32_bf16 v[108:111], v[92:95], v[64:67], v[108:111]
    v_mfma_f32_16x16x32_bf16 v[124:127], v[92:95], v[68:71], v[124:127]
    buffer_load_dwordx4 v5, s[12:15], s52 offen offset:1024 lds
    v_mfma_f32_16x16x32_bf16 v[140:143], v[92:95], v[72:75], v[140:143]
    v_mfma_f32_16x16x32_bf16 v[156:159], v[92:95], v[76:79], v[156:159]
    s_waitcnt lgkmcnt(9)
    s_nop 0
    v_mfma_f32_16x16x32_bf16 v[96:99], v[48:51], v[32:35], v[96:99]
    s_waitcnt lgkmcnt(6)
    s_nop 0
    v_mfma_f32_16x16x32_bf16 v[112:115], v[48:51], v[36:39], v[112:115]
    s_waitcnt vmcnt(8) lgkmcnt(0)
    s_barrier
    ds_read_b64_tr_b16 v[80:81], v17 offset:32768
    ds_read_b64_tr_b16 v[82:83], v17 offset:34816
    v_mfma_f32_16x16x32_bf16 v[128:131], v[48:51], v[40:43], v[128:131]
    ds_read_b128 v[64:67], v7 offset:32768
    v_mfma_f32_16x16x32_bf16 v[144:147], v[48:51], v[44:47], v[144:147]
    ds_read_b64_tr_b16 v[84:85], v18 offset:32768
    ds_read_b64_tr_b16 v[86:87], v18 offset:34816
    s_add_u32 s51, s45, 14
    s_and_b32 s51, s51, 15
    s_lshl_b32 s51, s51, 10
    s_add_u32 m0, s49, 65536
    s_nop 0
    v_mfma_f32_16x16x32_bf16 v[100:103], v[52:55], v[32:35], v[100:103]
    ds_read_b128 v[68:71], v7 offset:33792
    v_mfma_f32_16x16x32_bf16 v[116:119], v[52:55], v[36:39], v[116:119]
    ds_read_b64_tr_b16 v[88:89], v19 offset:32768
    ds_read_b64_tr_b16 v[90:91], v19 offset:34816
    buffer_load_dwordx4 v3, s[8:11], s51 offen lds
    v_mfma_f32_16x16x32_bf16 v[132:135], v[52:55], v[40:43], v[132:135]
    ds_read_b128 v[72:75], v7 offset:34816
    v_mfma_f32_16x16x32_bf16 v[148:151], v[52:55], v[44:47], v[148:151]
    ds_read_b64_tr_b16 v[92:93], v20 offset:32768
    ds_read_b64_tr_b16 v[94:95], v20 offset:34816
    s_add_u32 s51, s51, 130048
    buffer_load_dwordx4 v3, s[8:11], s51 offen offset:1024 lds
    v_mfma_f32_16x16x32_bf16 v[104:107], v[56:59], v[32:35], v[104:107]
    ds_read_b128 v[76:79], v7 offset:35840
    v_mfma_f32_16x16x32_bf16 v[120:123], v[56:59], v[36:39], v[120:123]
    s_add_u32 s52, s45, 14
    s_and_b32 s52, s52, 15
    s_lshl_b32 s52, s52, 15
    s_add_u32 m0, s50, 65536
    s_nop 0
    v_mfma_f32_16x16x32_bf16 v[136:139], v[56:59], v[40:43], v[136:139]
    v_mfma_f32_16x16x32_bf16 v[152:155], v[56:59], v[44:47], v[152:155]
    buffer_load_dwordx4 v4, s[12:15], s52 offen lds
    v_mfma_f32_16x16x32_bf16 v[108:111], v[60:63], v[32:35], v[108:111]
    v_mfma_f32_16x16x32_bf16 v[124:127], v[60:63], v[36:39], v[124:127]
    buffer_load_dwordx4 v5, s[12:15], s52 offen offset:1024 lds
    v_mfma_f32_16x16x32_bf16 v[140:143], v[60:63], v[40:43], v[140:143]
    v_mfma_f32_16x16x32_bf16 v[156:159], v[60:63], v[44:47], v[156:159]
    s_waitcnt lgkmcnt(9)
    s_nop 0
    v_mfma_f32_16x16x32_bf16 v[96:99], v[80:83], v[64:67], v[96:99]
    s_waitcnt lgkmcnt(6)
    s_nop 0
    v_mfma_f32_16x16x32_bf16 v[112:115], v[80:83], v[68:71], v[112:115]
    s_waitcnt vmcnt(8) lgkmcnt(0)
    s_barrier
    ds_read_b64_tr_b16 v[48:49], v8 offset:0
    ds_read_b64_tr_b16 v[50:51], v8 offset:2048
    v_mfma_f32_16x16x32_bf16 v[128:131], v[80:83], v[72:75], v[128:131]
    ds_read_b128 v[32:35], v6 offset:0
    v_mfma_f32_16x16x32_bf16 v[144:147], v[80:83], v[76:79], v[144:147]
    ds_read_b64_tr_b16 v[52:53], v9 offset:0
    ds_read_b64_tr_b16 v[54:55], v9 offset:2048
    s_add_u32 s51, s45, 15
    s_and_b32 s51, s51, 15
    s_lshl_b32 s51, s51, 10
    s_add_u32 m0, s49, 98304
    s_nop 0
    v_mfma_f32_16x16x32_bf16 v[100:103], v[84:87], v[64:67], v[100:103]
    ds_read_b128 v[36:39], v6 offset:1024
    v_mfma_f32_16x16x32_bf16 v[116:119], v[84:87], v[68:71], v[116:119]
    ds_read_b64_tr_b16 v[56:57], v10 offset:0
    ds_read_b64_tr_b16 v[58:59], v10 offset:2048
    buffer_load_dwordx4 v3, s[8:11], s51 offen lds
    v_mfma_f32_16x16x32_bf16 v[132:135], v[84:87], v[72:75], v[132:135]
    ds_read_b128 v[40:43], v6 offset:2048
    v_mfma_f32_16x16x32_bf16 v[148:151], v[84:87], v[76:79], v[148:151]
    ds_read_b64_tr_b16 v[60:61], v11 offset:0
    ds_read_b64_tr_b16 v[62:63], v11 offset:2048
    s_add_u32 s51, s51, 130048
    buffer_load_dwordx4 v3, s[8:11], s51 offen offset:1024 lds
    v_mfma_f32_16x16x32_bf16 v[104:107], v[88:91], v[64:67], v[104:107]
    ds_read_b128 v[44:47], v6 offset:3072
    v_mfma_f32_16x16x32_bf16 v[120:123], v[88:91], v[68:71], v[120:123]
    s_add_u32 s52, s45, 15
    s_and_b32 s52, s52, 15
    s_lshl_b32 s52, s52, 15
    s_add_u32 m0, s50, 98304
    s_nop 0
    v_mfma_f32_16x16x32_bf16 v[136:139], v[88:91], v[72:75], v[136:139]
    v_mfma_f32_16x16x32_bf16 v[152:155], v[88:91], v[76:79], v[152:155]
    buffer_load_dwordx4 v4, s[12:15], s52 offen lds
    v_mfma_f32_16x16x32_bf16 v[108:111], v[92:95], v[64:67], v[108:111]
    v_mfma_f32_16x16x32_bf16 v[124:127], v[92:95], v[68:71], v[124:127]
    buffer_load_dwordx4 v5, s[12:15], s52 offen offset:1024 lds
    v_mfma_f32_16x16x32_bf16 v[140:143], v[92:95], v[72:75], v[140:143]
    v_mfma_f32_16x16x32_bf16 v[156:159], v[92:95], v[76:79], v[156:159]
    s_waitcnt lgkmcnt(9)
    s_nop 0
    v_mfma_f32_16x16x32_bf16 v[96:99], v[48:51], v[32:35], v[96:99]
    s_waitcnt lgkmcnt(6)
    s_nop 0
    v_mfma_f32_16x16x32_bf16 v[112:115], v[48:51], v[36:39], v[112:115]
    s_waitcnt vmcnt(8) lgkmcnt(0)
    s_barrier
    ds_read_b64_tr_b16 v[80:81], v8 offset:32768
    ds_read_b64_tr_b16 v[82:83], v8 offset:34816
    v_mfma_f32_16x16x32_bf16 v[128:131], v[48:51], v[40:43], v[128:131]
    ds_read_b128 v[64:67], v6 offset:32768
    v_mfma_f32_16x16x32_bf16 v[144:147], v[48:51], v[44:47], v[144:147]
    ds_read_b64_tr_b16 v[84:85], v9 offset:32768
    ds_read_b64_tr_b16 v[86:87], v9 offset:34816
    v_mfma_f32_16x16x32_bf16 v[100:103], v[52:55], v[32:35], v[100:103]
    ds_read_b128 v[68:71], v6 offset:33792
    v_mfma_f32_16x16x32_bf16 v[116:119], v[52:55], v[36:39], v[116:119]
    ds_read_b64_tr_b16 v[88:89], v10 offset:32768
    ds_read_b64_tr_b16 v[90:91], v10 offset:34816
    v_mfma_f32_16x16x32_bf16 v[132:135], v[52:55], v[40:43], v[132:135]
    ds_read_b128 v[72:75], v6 offset:34816
    v_mfma_f32_16x16x32_bf16 v[148:151], v[52:55], v[44:47], v[148:151]
    ds_read_b64_tr_b16 v[92:93], v11 offset:32768
    ds_read_b64_tr_b16 v[94:95], v11 offset:34816
    v_mfma_f32_16x16x32_bf16 v[104:107], v[56:59], v[32:35], v[104:107]
    ds_read_b128 v[76:79], v6 offset:35840
    v_mfma_f32_16x16x32_bf16 v[120:123], v[56:59], v[36:39], v[120:123]
    v_mfma_f32_16x16x32_bf16 v[136:139], v[56:59], v[40:43], v[136:139]
    v_mfma_f32_16x16x32_bf16 v[152:155], v[56:59], v[44:47], v[152:155]
    v_mfma_f32_16x16x32_bf16 v[108:111], v[60:63], v[32:35], v[108:111]
    v_mfma_f32_16x16x32_bf16 v[124:127], v[60:63], v[36:39], v[124:127]
    v_mfma_f32_16x16x32_bf16 v[140:143], v[60:63], v[40:43], v[140:143]
    v_mfma_f32_16x16x32_bf16 v[156:159], v[60:63], v[44:47], v[156:159]
    s_waitcnt lgkmcnt(9)
    s_nop 0
    v_mfma_f32_16x16x32_bf16 v[96:99], v[80:83], v[64:67], v[96:99]
    s_waitcnt lgkmcnt(6)
    s_nop 0
    v_mfma_f32_16x16x32_bf16 v[112:115], v[80:83], v[68:71], v[112:115]
    s_waitcnt vmcnt(4) lgkmcnt(0)
    s_barrier
    ds_read_b64_tr_b16 v[48:49], v17 offset:0
    ds_read_b64_tr_b16 v[50:51], v17 offset:2048
    v_mfma_f32_16x16x32_bf16 v[128:131], v[80:83], v[72:75], v[128:131]
    ds_read_b128 v[32:35], v7 offset:0
    v_mfma_f32_16x16x32_bf16 v[144:147], v[80:83], v[76:79], v[144:147]
    ds_read_b64_tr_b16 v[52:53], v18 offset:0
    ds_read_b64_tr_b16 v[54:55], v18 offset:2048
    v_mfma_f32_16x16x32_bf16 v[100:103], v[84:87], v[64:67], v[100:103]
    ds_read_b128 v[36:39], v7 offset:1024
    v_mfma_f32_16x16x32_bf16 v[116:119], v[84:87], v[68:71], v[116:119]
    ds_read_b64_tr_b16 v[56:57], v19 offset:0
    ds_read_b64_tr_b16 v[58:59], v19 offset:2048
    v_mfma_f32_16x16x32_bf16 v[132:135], v[84:87], v[72:75], v[132:135]
    ds_read_b128 v[40:43], v7 offset:2048
    v_mfma_f32_16x16x32_bf16 v[148:151], v[84:87], v[76:79], v[148:151]
    ds_read_b64_tr_b16 v[60:61], v20 offset:0
    ds_read_b64_tr_b16 v[62:63], v20 offset:2048
    v_mfma_f32_16x16x32_bf16 v[104:107], v[88:91], v[64:67], v[104:107]
    ds_read_b128 v[44:47], v7 offset:3072
    v_mfma_f32_16x16x32_bf16 v[120:123], v[88:91], v[68:71], v[120:123]
    v_mfma_f32_16x16x32_bf16 v[136:139], v[88:91], v[72:75], v[136:139]
    v_mfma_f32_16x16x32_bf16 v[152:155], v[88:91], v[76:79], v[152:155]
    v_mfma_f32_16x16x32_bf16 v[108:111], v[92:95], v[64:67], v[108:111]
    v_mfma_f32_16x16x32_bf16 v[124:127], v[92:95], v[68:71], v[124:127]
    v_mfma_f32_16x16x32_bf16 v[140:143], v[92:95], v[72:75], v[140:143]
    v_mfma_f32_16x16x32_bf16 v[156:159], v[92:95], v[76:79], v[156:159]
    s_waitcnt lgkmcnt(9)
    s_nop 0
    v_mfma_f32_16x16x32_bf16 v[96:99], v[48:51], v[32:35], v[96:99]
    s_waitcnt lgkmcnt(6)
    s_nop 0
    v_mfma_f32_16x16x32_bf16 v[112:115], v[48:51], v[36:39], v[112:115]
    s_waitcnt vmcnt(0) lgkmcnt(0)
    s_barrier
    ds_read_b64_tr_b16 v[80:81], v17 offset:32768
    ds_read_b64_tr_b16 v[82:83], v17 offset:34816
    v_mfma_f32_16x16x32_bf16 v[128:131], v[48:51], v[40:43], v[128:131]
    ds_read_b128 v[64:67], v7 offset:32768
    v_mfma_f32_16x16x32_bf16 v[144:147], v[48:51], v[44:47], v[144:147]
    ds_read_b64_tr_b16 v[84:85], v18 offset:32768
    ds_read_b64_tr_b16 v[86:87], v18 offset:34816
    v_mfma_f32_16x16x32_bf16 v[100:103], v[52:55], v[32:35], v[100:103]
    ds_read_b128 v[68:71], v7 offset:33792
    v_mfma_f32_16x16x32_bf16 v[116:119], v[52:55], v[36:39], v[116:119]
    ds_read_b64_tr_b16 v[88:89], v19 offset:32768
    ds_read_b64_tr_b16 v[90:91], v19 offset:34816
    v_mfma_f32_16x16x32_bf16 v[132:135], v[52:55], v[40:43], v[132:135]
    ds_read_b128 v[72:75], v7 offset:34816
    v_mfma_f32_16x16x32_bf16 v[148:151], v[52:55], v[44:47], v[148:151]
    ds_read_b64_tr_b16 v[92:93], v20 offset:32768
    ds_read_b64_tr_b16 v[94:95], v20 offset:34816
    v_mfma_f32_16x16x32_bf16 v[104:107], v[56:59], v[32:35], v[104:107]
    ds_read_b128 v[76:79], v7 offset:35840
    v_mfma_f32_16x16x32_bf16 v[120:123], v[56:59], v[36:39], v[120:123]
    v_mfma_f32_16x16x32_bf16 v[136:139], v[56:59], v[40:43], v[136:139]
    v_mfma_f32_16x16x32_bf16 v[152:155], v[56:59], v[44:47], v[152:155]
    v_mfma_f32_16x16x32_bf16 v[108:111], v[60:63], v[32:35], v[108:111]
    v_mfma_f32_16x16x32_bf16 v[124:127], v[60:63], v[36:39], v[124:127]
    v_mfma_f32_16x16x32_bf16 v[140:143], v[60:63], v[40:43], v[140:143]
    v_mfma_f32_16x16x32_bf16 v[156:159], v[60:63], v[44:47], v[156:159]
    s_waitcnt lgkmcnt(9)
    s_nop 0
    v_mfma_f32_16x16x32_bf16 v[96:99], v[80:83], v[64:67], v[96:99]
    s_waitcnt lgkmcnt(6)
    s_nop 0
    v_mfma_f32_16x16x32_bf16 v[112:115], v[80:83], v[68:71], v[112:115]
    s_waitcnt lgkmcnt(3)
    s_nop 0
    v_mfma_f32_16x16x32_bf16 v[128:131], v[80:83], v[72:75], v[128:131]
    s_waitcnt lgkmcnt(0)
    s_nop 0
    v_mfma_f32_16x16x32_bf16 v[144:147], v[80:83], v[76:79], v[144:147]
    v_mfma_f32_16x16x32_bf16 v[100:103], v[84:87], v[64:67], v[100:103]
    v_mfma_f32_16x16x32_bf16 v[116:119], v[84:87], v[68:71], v[116:119]
    v_mfma_f32_16x16x32_bf16 v[132:135], v[84:87], v[72:75], v[132:135]
    v_mfma_f32_16x16x32_bf16 v[148:151], v[84:87], v[76:79], v[148:151]
    v_mfma_f32_16x16x32_bf16 v[104:107], v[88:91], v[64:67], v[104:107]
    v_mfma_f32_16x16x32_bf16 v[120:123], v[88:91], v[68:71], v[120:123]
    v_mfma_f32_16x16x32_bf16 v[136:139], v[88:91], v[72:75], v[136:139]
    v_mfma_f32_16x16x32_bf16 v[152:155], v[88:91], v[76:79], v[152:155]
    v_mfma_f32_16x16x32_bf16 v[108:111], v[92:95], v[64:67], v[108:111]
    v_mfma_f32_16x16x32_bf16 v[124:127], v[92:95], v[68:71], v[124:127]
    v_mfma_f32_16x16x32_bf16 v[140:143], v[92:95], v[72:75], v[140:143]
    v_mfma_f32_16x16x32_bf16 v[156:159], v[92:95], v[76:79], v[156:159]
    v_and_b32 v12, 15, v2
    s_lshl_b32 s47, s46, 15
    s_lshl_b32 s48, s43, 16
    s_add_u32 s47, s47, s48
    v_lshl_add_u32 v13, v12, 9, s47
    v_xor_b32 v14, v1, v12
    s_and_b32 s47, s20, 1
    s_lshl_b32 s47, s47, 8
    v_add_u32 v13, s47, v13
    v_lshlrev_b32 v240, 4, v0
    v_add_u32 v240, 0x20000, v240
    s_barrier
    ds_write_b128 v240, v[244:247]
    v_xor_b32 v15, 0, v14
    v_lshl_add_u32 v8, v15, 4, v13
    v_xor_b32 v15, 4, v14
    v_lshl_add_u32 v9, v15, 4, v13
    v_xor_b32 v15, 8, v14
    v_lshl_add_u32 v10, v15, 4, v13
    v_xor_b32 v15, 12, v14
    v_lshl_add_u32 v11, v15, 4, v13
    ds_write_b128 v8, v[96:99] offset:0
    ds_write_b128 v9, v[100:103] offset:0
    ds_write_b128 v10, v[104:107] offset:0
    ds_write_b128 v11, v[108:111] offset:0
    ds_write_b128 v8, v[112:115] offset:8192
    ds_write_b128 v9, v[116:119] offset:8192
    ds_write_b128 v10, v[120:123] offset:8192
    ds_write_b128 v11, v[124:127] offset:8192
    ds_write_b128 v8, v[128:131] offset:16384
    ds_write_b128 v9, v[132:135] offset:16384
    ds_write_b128 v10, v[136:139] offset:16384
    ds_write_b128 v11, v[140:143] offset:16384
    ds_write_b128 v8, v[144:147] offset:24576
    ds_write_b128 v9, v[148:151] offset:24576
    ds_write_b128 v10, v[152:155] offset:24576
    ds_write_b128 v11, v[156:159] offset:24576
    v_lshrrev_b32 v12, 4, v0
    v_and_b32 v13, 15, v0
    v_lshlrev_b32 v14, 1, v13
    v_and_b32 v15, 15, v12
    v_xor_b32 v14, v14, v15
    v_lshlrev_b32 v5, 9, v12
    v_lshl_add_u32 v6, v14, 4, v5
    v_xor_b32 v14, 1, v14
    v_lshl_add_u32 v7, v14, 4, v5
    v_add_u32 v4, 0x10000, v6
    v_add_u32 v5, 0x10000, v7
    v_and_b32 v241, 15, v2
    v_lshrrev_b32 v243, 2, v241
    v_lshl_add_u32 v243, v1, 3, v243
    v_lshlrev_b32 v243, 7, v243
    v_and_b32 v240, 3, v241
    v_lshl_add_u32 v243, v240, 3, v243
    s_lshl_b32 s46, s44, 5
    s_lshl_b32 s47, s43, 12
    s_add_u32 s46, s46, s47
    s_add_u32 s46, s46, 0x20000
    v_add_u32 v243, s46, v243
    v_lshlrev_b32 v3, 4, v0
    v_add_u32 v2, 8192, v3
    s_lshl_b32 s46, s41, 2
    s_add_u32 s46, s46, s42
    s_lshl_b32 s46, s46, 18
    s_add_u32 s46, s46, 75497472
    s_lshl_b32 s47, s40, 14
    s_add_u32 s47, s47, s46
    s_waitcnt lgkmcnt(0)
    s_barrier
    s_nop 0
    ds_read_b64_tr_b16 v[244:245], v243
    ds_read_b64_tr_b16 v[246:247], v243 offset:512
    ds_read_b128 v[32:35], v6 offset:0
    ds_read_b128 v[36:39], v7 offset:0
    ds_read_b128 v[40:43], v4 offset:0
    ds_read_b128 v[44:47], v5 offset:0
    ds_read_b128 v[48:51], v6 offset:16384
    ds_read_b128 v[52:55], v7 offset:16384
    ds_read_b128 v[56:59], v4 offset:16384
    ds_read_b128 v[60:63], v5 offset:16384
    ds_read_b128 v[64:67], v6 offset:32768
    ds_read_b128 v[68:71], v7 offset:32768
    ds_read_b128 v[72:75], v4 offset:32768
    ds_read_b128 v[76:79], v5 offset:32768
    ds_read_b128 v[80:83], v6 offset:49152
    ds_read_b128 v[84:87], v7 offset:49152
    ds_read_b128 v[88:91], v4 offset:49152
    ds_read_b128 v[92:95], v5 offset:49152
    s_waitcnt lgkmcnt(13)
    v_add_f32 v32, v32, v40
    v_add_f32 v33, v33, v41
    v_add_f32 v34, v34, v42
    v_add_f32 v35, v35, v43
    s_waitcnt lgkmcnt(12)
    v_add_f32 v36, v36, v44
    v_add_f32 v37, v37, v45
    v_add_f32 v38, v38, v46
    v_add_f32 v39, v39, v47
    s_add_u32 s48, s47, 0
    s_cmp_eq_u32 s40, 0
    s_cselect_b32 s48, 0xf0000000, s48
    buffer_store_dwordx4 v[32:35], v3, s[8:11], s48 offen sc1
    buffer_store_dwordx4 v[36:39], v2, s[8:11], s48 offen sc1
    s_waitcnt lgkmcnt(9)
    v_add_f32 v48, v48, v56
    v_add_f32 v49, v49, v57
    v_add_f32 v50, v50, v58
    v_add_f32 v51, v51, v59
    s_waitcnt lgkmcnt(8)
    v_add_f32 v52, v52, v60
    v_add_f32 v53, v53, v61
    v_add_f32 v54, v54, v62
    v_add_f32 v55, v55, v63
    s_add_u32 s48, s47, 65536
    s_cmp_eq_u32 s40, 1
    s_cselect_b32 s48, 0xf0000000, s48
    buffer_store_dwordx4 v[48:51], v3, s[8:11], s48 offen sc1
    buffer_store_dwordx4 v[52:55], v2, s[8:11], s48 offen sc1
    s_waitcnt lgkmcnt(5)
    v_add_f32 v64, v64, v72
    v_add_f32 v65, v65, v73
    v_add_f32 v66, v66, v74
    v_add_f32 v67, v67, v75
    s_waitcnt lgkmcnt(4)
    v_add_f32 v68, v68, v76
    v_add_f32 v69, v69, v77
    v_add_f32 v70, v70, v78
    v_add_f32 v71, v71, v79
    s_add_u32 s48, s47, 131072
    s_cmp_eq_u32 s40, 2
    s_cselect_b32 s48, 0xf0000000, s48
    buffer_store_dwordx4 v[64:67], v3, s[8:11], s48 offen sc1
    buffer_store_dwordx4 v[68:71], v2, s[8:11], s48 offen sc1
    s_waitcnt lgkmcnt(1)
    v_add_f32 v80, v80, v88
    v_add_f32 v81, v81, v89
    v_add_f32 v82, v82, v90
    v_add_f32 v83, v83, v91
    s_waitcnt lgkmcnt(0)
    v_add_f32 v84, v84, v92
    v_add_f32 v85, v85, v93
    v_add_f32 v86, v86, v94
    v_add_f32 v87, v87, v95
    s_add_u32 s48, s47, 196608
    s_cmp_eq_u32 s40, 3
    s_cselect_b32 s48, 0xf0000000, s48
    buffer_store_dwordx4 v[80:83], v3, s[8:11], s48 offen sc1
    buffer_store_dwordx4 v[84:87], v2, s[8:11], s48 offen sc1
    s_lshl_b32 s48, s40, 14
    v_add_u32 v4, s48, v4
    v_add_u32 v5, s48, v5
    v_add_u32 v6, s48, v6
    v_add_u32 v7, s48, v7
    ds_read_b128 v[96:99], v6
    ds_read_b128 v[100:103], v7
    ds_read_b128 v[104:107], v4
    ds_read_b128 v[108:111], v5
    v_lshlrev_b32 v241, 11, v241
    v_lshl_add_u32 v241, v1, 4, v241
    s_lshl_b32 s48, s4, 2
    s_add_u32 s48, s48, s44
    s_lshl_b32 s48, s48, 15
    s_lshl_b32 s49, s3, 7
    s_add_u32 s48, s48, s49
    s_lshl_b32 s49, s43, 6
    s_add_u32 s48, s48, s49
    s_waitcnt vmcnt(0)
    s_barrier
    buffer_store_dwordx4 v[244:247], v241, s[16:19], s48 offen
    s_andn2_b32 s48, s3, 3
    v_and_b32 v14, 63, v0
    v_add_u32 v14, s48, v14
    v_lshlrev_b32 v14, 5, v14
    v_add_u32 v14, s4, v14
    v_lshlrev_b32 v14, 7, v14
    s_add_u32 s48, s40, 71303264
    v_mov_b32 v15, 1
    v_mov_b32 v16, 96
    s_mov_b32 s49, 0x10000
    s_cmp_lg_u32 s20, 0
    s_cbranch_scc1 main_kernel_pollxd_151
    s_mov_b64 exec, 15
    buffer_store_byte v15, v14, s[8:11], s48 offen sc1
    s_mov_b64 exec, -1
main_kernel_pollx_150:
    buffer_load_dword v15, v16, s[8:11], s53 offen sc1
    s_waitcnt vmcnt(0)
    v_cmp_ne_u32 vcc, 0x01010101, v15
    s_nop 0
    s_cbranch_vccz main_kernel_pollxd_151
    s_sleep 2
    s_sub_u32 s49, s49, 1
    s_cmp_lg_u32 s49, 0
    s_cbranch_scc1 main_kernel_pollx_150
main_kernel_pollxd_151:
    s_barrier
    s_lshl_b32 s47, s40, 16
    s_add_u32 s47, s47, s46
    s_add_u32 s48, s47, 0
    s_cmp_eq_u32 s40, 0
    s_cselect_b32 s48, 0xf0000000, s48
    buffer_load_dwordx4 v[32:35], v3, s[8:11], s48 offen sc1
    buffer_load_dwordx4 v[36:39], v2, s[8:11], s48 offen sc1
    s_add_u32 s48, s47, 16384
    s_cmp_eq_u32 s40, 1
    s_cselect_b32 s48, 0xf0000000, s48
    buffer_load_dwordx4 v[40:43], v3, s[8:11], s48 offen sc1
    buffer_load_dwordx4 v[44:47], v2, s[8:11], s48 offen sc1
    s_add_u32 s48, s47, 32768
    s_cmp_eq_u32 s40, 2
    s_cselect_b32 s48, 0xf0000000, s48
    buffer_load_dwordx4 v[48:51], v3, s[8:11], s48 offen sc1
    buffer_load_dwordx4 v[52:55], v2, s[8:11], s48 offen sc1
    s_add_u32 s48, s47, 49152
    s_cmp_eq_u32 s40, 3
    s_cselect_b32 s48, 0xf0000000, s48
    buffer_load_dwordx4 v[56:59], v3, s[8:11], s48 offen sc1
    buffer_load_dwordx4 v[60:63], v2, s[8:11], s48 offen sc1
    s_waitcnt lgkmcnt(1)
    v_add_f32 v96, v96, v104
    v_add_f32 v97, v97, v105
    v_add_f32 v98, v98, v106
    v_add_f32 v99, v99, v107
    s_waitcnt lgkmcnt(0)
    v_add_f32 v100, v100, v108
    v_add_f32 v101, v101, v109
    v_add_f32 v102, v102, v110
    v_add_f32 v103, v103, v111
    s_waitcnt vmcnt(5)
    v_add_f32 v32, v32, v40
    s_waitcnt vmcnt(1)
    v_add_f32 v48, v48, v56
    v_add_f32 v33, v33, v41
    v_add_f32 v49, v49, v57
    v_add_f32 v34, v34, v42
    v_add_f32 v50, v50, v58
    v_add_f32 v35, v35, v43
    v_add_f32 v51, v51, v59
    v_add_f32 v36, v36, v44
    s_waitcnt vmcnt(0)
    v_add_f32 v52, v52, v60
    v_add_f32 v37, v37, v45
    v_add_f32 v53, v53, v61
    v_add_f32 v38, v38, v46
    v_add_f32 v54, v54, v62
    v_add_f32 v39, v39, v47
    v_add_f32 v55, v55, v63
    v_add_f32 v32, v32, v48
    v_add_f32 v32, v32, v96
    v_add_f32 v33, v33, v49
    v_add_f32 v33, v33, v97
    v_add_f32 v34, v34, v50
    v_add_f32 v34, v34, v98
    v_add_f32 v35, v35, v51
    v_add_f32 v35, v35, v99
    v_add_f32 v36, v36, v52
    v_add_f32 v36, v36, v100
    v_add_f32 v37, v37, v53
    v_add_f32 v37, v37, v101
    v_add_f32 v38, v38, v54
    v_add_f32 v38, v38, v102
    v_add_f32 v39, v39, v55
    v_add_f32 v39, v39, v103
    v_cvt_pk_bf16_f32 v32, v32, v33
    v_cvt_pk_bf16_f32 v33, v34, v35
    v_cvt_pk_bf16_f32 v34, v36, v37
    v_cvt_pk_bf16_f32 v35, v38, v39
    s_lshl_b32 s47, s41, 2
    s_add_u32 s47, s47, s40
    s_lshl_b32 s47, s47, 16
    s_lshl_b32 s48, s42, 8
    s_add_u32 s47, s47, s48
    s_add_u32 s47, s47, 1024
    v_lshlrev_b32 v12, 11, v12
    v_lshl_add_u32 v12, v13, 4, v12
    buffer_store_dwordx4 v[32:35], v12, s[16:19], s47 offen
    s_endpgm
main_kernel_spec_33:
    s_cmp_lt_u32 s27, s37
    s_cbranch_scc1 main_kernel_i_152
    s_sub_u32 s33, s37, s27
    s_lshl_b32 s33, s33, 5
    v_add_u32 v12, s33, v6
    v_mov_b32 v13, 4286578688
    v_cmp_gt_i32 s[44:45], 0, v12
    v_cmp_gt_i32 s[46:47], 1, v12
    v_cmp_gt_i32 s[48:49], 2, v12
    v_cmp_gt_i32 s[50:51], 3, v12
    v_cndmask_b32 v72, v72, v13, s[44:45]
    v_cndmask_b32 v73, v73, v13, s[46:47]
    v_cndmask_b32 v74, v74, v13, s[48:49]
    v_cndmask_b32 v75, v75, v13, s[50:51]
    v_cmp_gt_i32 s[44:45], -16, v12
    v_cmp_gt_i32 s[46:47], -15, v12
    v_cmp_gt_i32 s[48:49], -14, v12
    v_cmp_gt_i32 s[50:51], -13, v12
    v_cndmask_b32 v76, v76, v13, s[44:45]
    v_cndmask_b32 v77, v77, v13, s[46:47]
    v_cndmask_b32 v78, v78, v13, s[48:49]
    v_cndmask_b32 v79, v79, v13, s[50:51]
    v_cmp_gt_i32 s[44:45], 16, v12
    v_cmp_gt_i32 s[46:47], 17, v12
    v_cmp_gt_i32 s[48:49], 18, v12
    v_cmp_gt_i32 s[50:51], 19, v12
    v_cndmask_b32 v80, v80, v13, s[44:45]
    v_cndmask_b32 v81, v81, v13, s[46:47]
    v_cndmask_b32 v82, v82, v13, s[48:49]
    v_cndmask_b32 v83, v83, v13, s[50:51]
    v_cmp_gt_i32 s[44:45], 0, v12
    v_cmp_gt_i32 s[46:47], 1, v12
    v_cmp_gt_i32 s[48:49], 2, v12
    v_cmp_gt_i32 s[50:51], 3, v12
    v_cndmask_b32 v84, v84, v13, s[44:45]
    v_cndmask_b32 v85, v85, v13, s[46:47]
    v_cndmask_b32 v86, v86, v13, s[48:49]
    v_cndmask_b32 v87, v87, v13, s[50:51]
main_kernel_i_152:
    s_cmp_eq_u32 s41, 0
    s_cbranch_scc1 main_kernel_exp_34
    v_max3_f32 v12, v72, v73, v74
    v_max3_f32 v12, v12, v75, v80
    v_max3_f32 v12, v12, v81, v82
    v_max_f32 v12, v12, v83
    v_max3_f32 v13, v76, v77, v78
    v_max3_f32 v13, v13, v79, v84
    v_max3_f32 v13, v13, v85, v86
    v_max_f32 v13, v13, v87
    v_mov_b32 v14, v12
    v_mov_b32 v15, v13
    s_nop 0
    v_permlane16_swap_b32 v12, v14
    v_permlane16_swap_b32 v13, v15
    v_max_f32 v12, v12, v14
    v_max_f32 v13, v13, v15
    v_mov_b32 v14, v12
    v_mov_b32 v15, v13
    s_nop 0
    v_permlane32_swap_b32 v12, v14
    v_permlane32_swap_b32 v13, v15
    v_max_f32 v12, v12, v14
    v_max_f32 v13, v13, v15
    v_max_f32 v12, 0xf149f2ca, v12
    v_add_f32 v12, 1092616192, v12
    v_sub_f32 v32, 0, v12
    v_sub_f32 v33, 0, v12
    v_sub_f32 v34, 0, v12
    v_sub_f32 v35, 0, v12
    v_sub_f32 v72, v72, v12
    v_sub_f32 v73, v73, v12
    v_sub_f32 v74, v74, v12
    v_sub_f32 v75, v75, v12
    v_sub_f32 v80, v80, v12
    v_sub_f32 v81, v81, v12
    v_sub_f32 v82, v82, v12
    v_sub_f32 v83, v83, v12
    v_max_f32 v13, 0xf149f2ca, v13
    v_add_f32 v13, 1092616192, v13
    v_sub_f32 v36, 0, v13
    v_sub_f32 v37, 0, v13
    v_sub_f32 v38, 0, v13
    v_sub_f32 v39, 0, v13
    v_sub_f32 v76, v76, v13
    v_sub_f32 v77, v77, v13
    v_sub_f32 v78, v78, v13
    v_sub_f32 v79, v79, v13
    v_sub_f32 v84, v84, v13
    v_sub_f32 v85, v85, v13
    v_sub_f32 v86, v86, v13
    v_sub_f32 v87, v87, v13
    s_mov_b32 s41, 0
    s_mov_b32 s38, s37
    s_branch main_kernel_exp_34
main_kernel_rare_35:
    v_max3_f32 v12, v72, v73, v74
    v_max3_f32 v12, v12, v75, v80
    v_max3_f32 v12, v12, v81, v82
    v_max_f32 v12, v12, v83
    v_max3_f32 v13, v76, v77, v78
    v_max3_f32 v13, v13, v79, v84
    v_max3_f32 v13, v13, v85, v86
    v_max_f32 v13, v13, v87
    v_mov_b32 v14, v12
    v_mov_b32 v15, v13
    s_nop 0
    v_permlane16_swap_b32 v12, v14
    v_permlane16_swap_b32 v13, v15
    v_max_f32 v12, v12, v14
    v_max_f32 v13, v13, v15
    v_mov_b32 v14, v12
    v_mov_b32 v15, v13
    s_nop 0
    v_permlane32_swap_b32 v12, v14
    v_permlane32_swap_b32 v13, v15
    v_max_f32 v12, v12, v14
    v_max_f32 v13, v13, v15
    v_add_f32 v12, 1092616192, v12
    v_max_f32 v12, 0, v12
    v_sub_f32 v14, 0, v12
    v_exp_f32 v14, v14
    v_sub_f32 v72, v72, v12
    v_sub_f32 v73, v73, v12
    v_sub_f32 v74, v74, v12
    v_sub_f32 v75, v75, v12
    v_sub_f32 v80, v80, v12
    v_sub_f32 v81, v81, v12
    v_sub_f32 v82, v82, v12
    v_sub_f32 v83, v83, v12
    v_sub_f32 v32, v32, v12
    v_sub_f32 v33, v33, v12
    v_sub_f32 v34, v34, v12
    v_sub_f32 v35, v35, v12
    v_mul_f32 v248, v248, v14
    v_mul_f32 v249, v249, v14
    v_mul_f32 v250, v250, v14
    v_mul_f32 v251, v251, v14
    v_mul_f32 v152, v152, v14
    v_mul_f32 v153, v153, v14
    v_mul_f32 v154, v154, v14
    v_mul_f32 v155, v155, v14
    v_mul_f32 v160, v160, v14
    v_mul_f32 v161, v161, v14
    v_mul_f32 v162, v162, v14
    v_mul_f32 v163, v163, v14
    v_mul_f32 v168, v168, v14
    v_mul_f32 v169, v169, v14
    v_mul_f32 v170, v170, v14
    v_mul_f32 v171, v171, v14
    v_mul_f32 v176, v176, v14
    v_mul_f32 v177, v177, v14
    v_mul_f32 v178, v178, v14
    v_mul_f32 v179, v179, v14
    v_mul_f32 v184, v184, v14
    v_mul_f32 v185, v185, v14
    v_mul_f32 v186, v186, v14
    v_mul_f32 v187, v187, v14
    v_mul_f32 v192, v192, v14
    v_mul_f32 v193, v193, v14
    v_mul_f32 v194, v194, v14
    v_mul_f32 v195, v195, v14
    v_mul_f32 v200, v200, v14
    v_mul_f32 v201, v201, v14
    v_mul_f32 v202, v202, v14
    v_mul_f32 v203, v203, v14
    v_mul_f32 v208, v208, v14
    v_mul_f32 v209, v209, v14
    v_mul_f32 v210, v210, v14
    v_mul_f32 v211, v211, v14
    v_add_f32 v13, 1092616192, v13
    v_max_f32 v13, 0, v13
    v_sub_f32 v15, 0, v13
    v_exp_f32 v15, v15
    v_sub_f32 v76, v76, v13
    v_sub_f32 v77, v77, v13
    v_sub_f32 v78, v78, v13
    v_sub_f32 v79, v79, v13
    v_sub_f32 v84, v84, v13
    v_sub_f32 v85, v85, v13
    v_sub_f32 v86, v86, v13
    v_sub_f32 v87, v87, v13
    v_sub_f32 v36, v36, v13
    v_sub_f32 v37, v37, v13
    v_sub_f32 v38, v38, v13
    v_sub_f32 v39, v39, v13
    v_mul_f32 v252, v252, v15
    v_mul_f32 v253, v253, v15
    v_mul_f32 v254, v254, v15
    v_mul_f32 v255, v255, v15
    v_mul_f32 v156, v156, v15
    v_mul_f32 v157, v157, v15
    v_mul_f32 v158, v158, v15
    v_mul_f32 v159, v159, v15
    v_mul_f32 v164, v164, v15
    v_mul_f32 v165, v165, v15
    v_mul_f32 v166, v166, v15
    v_mul_f32 v167, v167, v15
    v_mul_f32 v172, v172, v15
    v_mul_f32 v173, v173, v15
    v_mul_f32 v174, v174, v15
    v_mul_f32 v175, v175, v15
    v_mul_f32 v180, v180, v15
    v_mul_f32 v181, v181, v15
    v_mul_f32 v182, v182, v15
    v_mul_f32 v183, v183, v15
    v_mul_f32 v188, v188, v15
    v_mul_f32 v189, v189, v15
    v_mul_f32 v190, v190, v15
    v_mul_f32 v191, v191, v15
    v_mul_f32 v196, v196, v15
    v_mul_f32 v197, v197, v15
    v_mul_f32 v198, v198, v15
    v_mul_f32 v199, v199, v15
    v_mul_f32 v204, v204, v15
    v_mul_f32 v205, v205, v15
    v_mul_f32 v206, v206, v15
    v_mul_f32 v207, v207, v15
    v_mul_f32 v212, v212, v15
    v_mul_f32 v213, v213, v15
    v_mul_f32 v214, v214, v15
    v_mul_f32 v215, v215, v15
    v_exp_f32 v16, v72
    v_exp_f32 v17, v73
    v_exp_f32 v18, v76
    v_exp_f32 v19, v77
    v_cvt_pk_bf16_f32 v88, v16, v17
    v_cvt_pk_bf16_f32 v92, v18, v19
    v_exp_f32 v20, v74
    v_exp_f32 v21, v75
    v_exp_f32 v22, v78
    v_exp_f32 v23, v79
    v_cvt_pk_bf16_f32 v89, v20, v21
    v_cvt_pk_bf16_f32 v93, v22, v23
    v_exp_f32 v16, v80
    v_exp_f32 v17, v81
    v_exp_f32 v18, v84
    v_exp_f32 v19, v85
    v_cvt_pk_bf16_f32 v90, v16, v17
    v_cvt_pk_bf16_f32 v94, v18, v19
    v_exp_f32 v20, v82
    v_exp_f32 v21, v83
    v_exp_f32 v22, v86
    v_exp_f32 v23, v87
    v_cvt_pk_bf16_f32 v91, v20, v21
    v_cvt_pk_bf16_f32 v95, v22, v23
    v_or3_b32 v8, v88, v92, v89
    v_or3_b32 v9, v93, v90, v94
    v_or3_b32 v8, v8, v91, v95
    v_or_b32 v8, v8, v9
    s_branch main_kernel_chk_36
main_kernel_sq_37:
    ds_read_b128 v[128:131], v5 offset:0
    ds_read_b128 v[132:135], v5 offset:1024
    ds_read_b128 v[136:139], v5 offset:2048
    ds_read_b128 v[140:143], v5 offset:3072
    s_waitcnt lgkmcnt(9)
    s_nop 0
    ds_read_b128 v[96:99], v5 offset:4096
    s_waitcnt lgkmcnt(9)
    s_nop 0
    ds_read_b128 v[100:103], v5 offset:5120
    s_branch main_kernel_pv_38
main_kernel_sp_39:
    s_branch main_kernel_me_40
main_kernel_spec_41:
    s_cmp_lt_u32 s27, s37
    s_cbranch_scc1 main_kernel_i_153
    s_sub_u32 s33, s37, s27
    s_lshl_b32 s33, s33, 5
    v_add_u32 v12, s33, v6
    v_mov_b32 v13, 4286578688
    v_cmp_gt_i32 s[44:45], 0, v12
    v_cmp_gt_i32 s[46:47], 1, v12
    v_cmp_gt_i32 s[48:49], 2, v12
    v_cmp_gt_i32 s[50:51], 3, v12
    v_cndmask_b32 v72, v72, v13, s[44:45]
    v_cndmask_b32 v73, v73, v13, s[46:47]
    v_cndmask_b32 v74, v74, v13, s[48:49]
    v_cndmask_b32 v75, v75, v13, s[50:51]
    v_cmp_gt_i32 s[44:45], -16, v12
    v_cmp_gt_i32 s[46:47], -15, v12
    v_cmp_gt_i32 s[48:49], -14, v12
    v_cmp_gt_i32 s[50:51], -13, v12
    v_cndmask_b32 v76, v76, v13, s[44:45]
    v_cndmask_b32 v77, v77, v13, s[46:47]
    v_cndmask_b32 v78, v78, v13, s[48:49]
    v_cndmask_b32 v79, v79, v13, s[50:51]
    v_cmp_gt_i32 s[44:45], 16, v12
    v_cmp_gt_i32 s[46:47], 17, v12
    v_cmp_gt_i32 s[48:49], 18, v12
    v_cmp_gt_i32 s[50:51], 19, v12
    v_cndmask_b32 v80, v80, v13, s[44:45]
    v_cndmask_b32 v81, v81, v13, s[46:47]
    v_cndmask_b32 v82, v82, v13, s[48:49]
    v_cndmask_b32 v83, v83, v13, s[50:51]
    v_cmp_gt_i32 s[44:45], 0, v12
    v_cmp_gt_i32 s[46:47], 1, v12
    v_cmp_gt_i32 s[48:49], 2, v12
    v_cmp_gt_i32 s[50:51], 3, v12
    v_cndmask_b32 v84, v84, v13, s[44:45]
    v_cndmask_b32 v85, v85, v13, s[46:47]
    v_cndmask_b32 v86, v86, v13, s[48:49]
    v_cndmask_b32 v87, v87, v13, s[50:51]
main_kernel_i_153:
    s_cmp_eq_u32 s41, 0
    s_cbranch_scc1 main_kernel_exp_42
    v_max3_f32 v12, v72, v73, v74
    v_max3_f32 v12, v12, v75, v80
    v_max3_f32 v12, v12, v81, v82
    v_max_f32 v12, v12, v83
    v_max3_f32 v13, v76, v77, v78
    v_max3_f32 v13, v13, v79, v84
    v_max3_f32 v13, v13, v85, v86
    v_max_f32 v13, v13, v87
    v_mov_b32 v14, v12
    v_mov_b32 v15, v13
    s_nop 0
    v_permlane16_swap_b32 v12, v14
    v_permlane16_swap_b32 v13, v15
    v_max_f32 v12, v12, v14
    v_max_f32 v13, v13, v15
    v_mov_b32 v14, v12
    v_mov_b32 v15, v13
    s_nop 0
    v_permlane32_swap_b32 v12, v14
    v_permlane32_swap_b32 v13, v15
    v_max_f32 v12, v12, v14
    v_max_f32 v13, v13, v15
    v_max_f32 v12, 0xf149f2ca, v12
    v_add_f32 v12, 1092616192, v12
    v_sub_f32 v32, 0, v12
    v_sub_f32 v33, 0, v12
    v_sub_f32 v34, 0, v12
    v_sub_f32 v35, 0, v12
    v_sub_f32 v72, v72, v12
    v_sub_f32 v73, v73, v12
    v_sub_f32 v74, v74, v12
    v_sub_f32 v75, v75, v12
    v_sub_f32 v80, v80, v12
    v_sub_f32 v81, v81, v12
    v_sub_f32 v82, v82, v12
    v_sub_f32 v83, v83, v12
    v_max_f32 v13, 0xf149f2ca, v13
    v_add_f32 v13, 1092616192, v13
    v_sub_f32 v36, 0, v13
    v_sub_f32 v37, 0, v13
    v_sub_f32 v38, 0, v13
    v_sub_f32 v39, 0, v13
    v_sub_f32 v76, v76, v13
    v_sub_f32 v77, v77, v13
    v_sub_f32 v78, v78, v13
    v_sub_f32 v79, v79, v13
    v_sub_f32 v84, v84, v13
    v_sub_f32 v85, v85, v13
    v_sub_f32 v86, v86, v13
    v_sub_f32 v87, v87, v13
    s_mov_b32 s41, 0
    s_mov_b32 s38, s37
    s_branch main_kernel_exp_42
main_kernel_rare_43:
    v_max3_f32 v12, v72, v73, v74
    v_max3_f32 v12, v12, v75, v80
    v_max3_f32 v12, v12, v81, v82
    v_max_f32 v12, v12, v83
    v_max3_f32 v13, v76, v77, v78
    v_max3_f32 v13, v13, v79, v84
    v_max3_f32 v13, v13, v85, v86
    v_max_f32 v13, v13, v87
    v_mov_b32 v14, v12
    v_mov_b32 v15, v13
    s_nop 0
    v_permlane16_swap_b32 v12, v14
    v_permlane16_swap_b32 v13, v15
    v_max_f32 v12, v12, v14
    v_max_f32 v13, v13, v15
    v_mov_b32 v14, v12
    v_mov_b32 v15, v13
    s_nop 0
    v_permlane32_swap_b32 v12, v14
    v_permlane32_swap_b32 v13, v15
    v_max_f32 v12, v12, v14
    v_max_f32 v13, v13, v15
    v_add_f32 v12, 1092616192, v12
    v_max_f32 v12, 0, v12
    v_sub_f32 v14, 0, v12
    v_exp_f32 v14, v14
    v_sub_f32 v72, v72, v12
    v_sub_f32 v73, v73, v12
    v_sub_f32 v74, v74, v12
    v_sub_f32 v75, v75, v12
    v_sub_f32 v80, v80, v12
    v_sub_f32 v81, v81, v12
    v_sub_f32 v82, v82, v12
    v_sub_f32 v83, v83, v12
    v_sub_f32 v32, v32, v12
    v_sub_f32 v33, v33, v12
    v_sub_f32 v34, v34, v12
    v_sub_f32 v35, v35, v12
    v_mul_f32 v248, v248, v14
    v_mul_f32 v249, v249, v14
    v_mul_f32 v250, v250, v14
    v_mul_f32 v251, v251, v14
    v_mul_f32 v152, v152, v14
    v_mul_f32 v153, v153, v14
    v_mul_f32 v154, v154, v14
    v_mul_f32 v155, v155, v14
    v_mul_f32 v160, v160, v14
    v_mul_f32 v161, v161, v14
    v_mul_f32 v162, v162, v14
    v_mul_f32 v163, v163, v14
    v_mul_f32 v168, v168, v14
    v_mul_f32 v169, v169, v14
    v_mul_f32 v170, v170, v14
    v_mul_f32 v171, v171, v14
    v_mul_f32 v176, v176, v14
    v_mul_f32 v177, v177, v14
    v_mul_f32 v178, v178, v14
    v_mul_f32 v179, v179, v14
    v_mul_f32 v184, v184, v14
    v_mul_f32 v185, v185, v14
    v_mul_f32 v186, v186, v14
    v_mul_f32 v187, v187, v14
    v_mul_f32 v192, v192, v14
    v_mul_f32 v193, v193, v14
    v_mul_f32 v194, v194, v14
    v_mul_f32 v195, v195, v14
    v_mul_f32 v200, v200, v14
    v_mul_f32 v201, v201, v14
    v_mul_f32 v202, v202, v14
    v_mul_f32 v203, v203, v14
    v_mul_f32 v208, v208, v14
    v_mul_f32 v209, v209, v14
    v_mul_f32 v210, v210, v14
    v_mul_f32 v211, v211, v14
    v_add_f32 v13, 1092616192, v13
    v_max_f32 v13, 0, v13
    v_sub_f32 v15, 0, v13
    v_exp_f32 v15, v15
    v_sub_f32 v76, v76, v13
    v_sub_f32 v77, v77, v13
    v_sub_f32 v78, v78, v13
    v_sub_f32 v79, v79, v13
    v_sub_f32 v84, v84, v13
    v_sub_f32 v85, v85, v13
    v_sub_f32 v86, v86, v13
    v_sub_f32 v87, v87, v13
    v_sub_f32 v36, v36, v13
    v_sub_f32 v37, v37, v13
    v_sub_f32 v38, v38, v13
    v_sub_f32 v39, v39, v13
    v_mul_f32 v252, v252, v15
    v_mul_f32 v253, v253, v15
    v_mul_f32 v254, v254, v15
    v_mul_f32 v255, v255, v15
    v_mul_f32 v156, v156, v15
    v_mul_f32 v157, v157, v15
    v_mul_f32 v158, v158, v15
    v_mul_f32 v159, v159, v15
    v_mul_f32 v164, v164, v15
    v_mul_f32 v165, v165, v15
    v_mul_f32 v166, v166, v15
    v_mul_f32 v167, v167, v15
    v_mul_f32 v172, v172, v15
    v_mul_f32 v173, v173, v15
    v_mul_f32 v174, v174, v15
    v_mul_f32 v175, v175, v15
    v_mul_f32 v180, v180, v15
    v_mul_f32 v181, v181, v15
    v_mul_f32 v182, v182, v15
    v_mul_f32 v183, v183, v15
    v_mul_f32 v188, v188, v15
    v_mul_f32 v189, v189, v15
    v_mul_f32 v190, v190, v15
    v_mul_f32 v191, v191, v15
    v_mul_f32 v196, v196, v15
    v_mul_f32 v197, v197, v15
    v_mul_f32 v198, v198, v15
    v_mul_f32 v199, v199, v15
    v_mul_f32 v204, v204, v15
    v_mul_f32 v205, v205, v15
    v_mul_f32 v206, v206, v15
    v_mul_f32 v207, v207, v15
    v_mul_f32 v212, v212, v15
    v_mul_f32 v213, v213, v15
    v_mul_f32 v214, v214, v15
    v_mul_f32 v215, v215, v15
    v_exp_f32 v16, v72
    v_exp_f32 v17, v73
    v_exp_f32 v18, v76
    v_exp_f32 v19, v77
    v_cvt_pk_bf16_f32 v88, v16, v17
    v_cvt_pk_bf16_f32 v92, v18, v19
    v_exp_f32 v20, v74
    v_exp_f32 v21, v75
    v_exp_f32 v22, v78
    v_exp_f32 v23, v79
    v_cvt_pk_bf16_f32 v89, v20, v21
    v_cvt_pk_bf16_f32 v93, v22, v23
    v_exp_f32 v16, v80
    v_exp_f32 v17, v81
    v_exp_f32 v18, v84
    v_exp_f32 v19, v85
    v_cvt_pk_bf16_f32 v90, v16, v17
    v_cvt_pk_bf16_f32 v94, v18, v19
    v_exp_f32 v20, v82
    v_exp_f32 v21, v83
    v_exp_f32 v22, v86
    v_exp_f32 v23, v87
    v_cvt_pk_bf16_f32 v91, v20, v21
    v_cvt_pk_bf16_f32 v95, v22, v23
    v_or3_b32 v8, v88, v92, v89
    v_or3_b32 v9, v93, v90, v94
    v_or3_b32 v8, v8, v91, v95
    v_or_b32 v8, v8, v9
    s_branch main_kernel_chk_44
main_kernel_sq_45:
    ds_read_b128 v[128:131], v5 offset:8192
    ds_read_b128 v[132:135], v5 offset:9216
    ds_read_b128 v[136:139], v5 offset:10240
    ds_read_b128 v[140:143], v5 offset:11264
    s_waitcnt lgkmcnt(9)
    s_nop 0
    ds_read_b128 v[96:99], v5 offset:12288
    s_waitcnt lgkmcnt(9)
    s_nop 0
    ds_read_b128 v[100:103], v5 offset:13312
    s_branch main_kernel_pv_46
main_kernel_sp_47:
    s_branch main_kernel_me_48
main_kernel_spec_49:
    s_cmp_lt_u32 s27, s37
    s_cbranch_scc1 main_kernel_i_154
    s_sub_u32 s33, s37, s27
    s_lshl_b32 s33, s33, 5
    v_add_u32 v12, s33, v6
    v_mov_b32 v13, 4286578688
    v_cmp_gt_i32 s[44:45], 0, v12
    v_cmp_gt_i32 s[46:47], 1, v12
    v_cmp_gt_i32 s[48:49], 2, v12
    v_cmp_gt_i32 s[50:51], 3, v12
    v_cndmask_b32 v72, v72, v13, s[44:45]
    v_cndmask_b32 v73, v73, v13, s[46:47]
    v_cndmask_b32 v74, v74, v13, s[48:49]
    v_cndmask_b32 v75, v75, v13, s[50:51]
    v_cmp_gt_i32 s[44:45], -16, v12
    v_cmp_gt_i32 s[46:47], -15, v12
    v_cmp_gt_i32 s[48:49], -14, v12
    v_cmp_gt_i32 s[50:51], -13, v12
    v_cndmask_b32 v76, v76, v13, s[44:45]
    v_cndmask_b32 v77, v77, v13, s[46:47]
    v_cndmask_b32 v78, v78, v13, s[48:49]
    v_cndmask_b32 v79, v79, v13, s[50:51]
    v_cmp_gt_i32 s[44:45], 16, v12
    v_cmp_gt_i32 s[46:47], 17, v12
    v_cmp_gt_i32 s[48:49], 18, v12
    v_cmp_gt_i32 s[50:51], 19, v12
    v_cndmask_b32 v80, v80, v13, s[44:45]
    v_cndmask_b32 v81, v81, v13, s[46:47]
    v_cndmask_b32 v82, v82, v13, s[48:49]
    v_cndmask_b32 v83, v83, v13, s[50:51]
    v_cmp_gt_i32 s[44:45], 0, v12
    v_cmp_gt_i32 s[46:47], 1, v12
    v_cmp_gt_i32 s[48:49], 2, v12
    v_cmp_gt_i32 s[50:51], 3, v12
    v_cndmask_b32 v84, v84, v13, s[44:45]
    v_cndmask_b32 v85, v85, v13, s[46:47]
    v_cndmask_b32 v86, v86, v13, s[48:49]
    v_cndmask_b32 v87, v87, v13, s[50:51]
main_kernel_i_154:
    s_cmp_eq_u32 s41, 0
    s_cbranch_scc1 main_kernel_exp_50
    v_max3_f32 v12, v72, v73, v74
    v_max3_f32 v12, v12, v75, v80
    v_max3_f32 v12, v12, v81, v82
    v_max_f32 v12, v12, v83
    v_max3_f32 v13, v76, v77, v78
    v_max3_f32 v13, v13, v79, v84
    v_max3_f32 v13, v13, v85, v86
    v_max_f32 v13, v13, v87
    v_mov_b32 v14, v12
    v_mov_b32 v15, v13
    s_nop 0
    v_permlane16_swap_b32 v12, v14
    v_permlane16_swap_b32 v13, v15
    v_max_f32 v12, v12, v14
    v_max_f32 v13, v13, v15
    v_mov_b32 v14, v12
    v_mov_b32 v15, v13
    s_nop 0
    v_permlane32_swap_b32 v12, v14
    v_permlane32_swap_b32 v13, v15
    v_max_f32 v12, v12, v14
    v_max_f32 v13, v13, v15
    v_max_f32 v12, 0xf149f2ca, v12
    v_add_f32 v12, 1092616192, v12
    v_sub_f32 v32, 0, v12
    v_sub_f32 v33, 0, v12
    v_sub_f32 v34, 0, v12
    v_sub_f32 v35, 0, v12
    v_sub_f32 v72, v72, v12
    v_sub_f32 v73, v73, v12
    v_sub_f32 v74, v74, v12
    v_sub_f32 v75, v75, v12
    v_sub_f32 v80, v80, v12
    v_sub_f32 v81, v81, v12
    v_sub_f32 v82, v82, v12
    v_sub_f32 v83, v83, v12
    v_max_f32 v13, 0xf149f2ca, v13
    v_add_f32 v13, 1092616192, v13
    v_sub_f32 v36, 0, v13
    v_sub_f32 v37, 0, v13
    v_sub_f32 v38, 0, v13
    v_sub_f32 v39, 0, v13
    v_sub_f32 v76, v76, v13
    v_sub_f32 v77, v77, v13
    v_sub_f32 v78, v78, v13
    v_sub_f32 v79, v79, v13
    v_sub_f32 v84, v84, v13
    v_sub_f32 v85, v85, v13
    v_sub_f32 v86, v86, v13
    v_sub_f32 v87, v87, v13
    s_mov_b32 s41, 0
    s_mov_b32 s38, s37
    s_branch main_kernel_exp_50
main_kernel_rare_51:
    v_max3_f32 v12, v72, v73, v74
    v_max3_f32 v12, v12, v75, v80
    v_max3_f32 v12, v12, v81, v82
    v_max_f32 v12, v12, v83
    v_max3_f32 v13, v76, v77, v78
    v_max3_f32 v13, v13, v79, v84
    v_max3_f32 v13, v13, v85, v86
    v_max_f32 v13, v13, v87
    v_mov_b32 v14, v12
    v_mov_b32 v15, v13
    s_nop 0
    v_permlane16_swap_b32 v12, v14
    v_permlane16_swap_b32 v13, v15
    v_max_f32 v12, v12, v14
    v_max_f32 v13, v13, v15
    v_mov_b32 v14, v12
    v_mov_b32 v15, v13
    s_nop 0
    v_permlane32_swap_b32 v12, v14
    v_permlane32_swap_b32 v13, v15
    v_max_f32 v12, v12, v14
    v_max_f32 v13, v13, v15
    v_add_f32 v12, 1092616192, v12
    v_max_f32 v12, 0, v12
    v_sub_f32 v14, 0, v12
    v_exp_f32 v14, v14
    v_sub_f32 v72, v72, v12
    v_sub_f32 v73, v73, v12
    v_sub_f32 v74, v74, v12
    v_sub_f32 v75, v75, v12
    v_sub_f32 v80, v80, v12
    v_sub_f32 v81, v81, v12
    v_sub_f32 v82, v82, v12
    v_sub_f32 v83, v83, v12
    v_sub_f32 v32, v32, v12
    v_sub_f32 v33, v33, v12
    v_sub_f32 v34, v34, v12
    v_sub_f32 v35, v35, v12
    v_mul_f32 v248, v248, v14
    v_mul_f32 v249, v249, v14
    v_mul_f32 v250, v250, v14
    v_mul_f32 v251, v251, v14
    v_mul_f32 v152, v152, v14
    v_mul_f32 v153, v153, v14
    v_mul_f32 v154, v154, v14
    v_mul_f32 v155, v155, v14
    v_mul_f32 v160, v160, v14
    v_mul_f32 v161, v161, v14
    v_mul_f32 v162, v162, v14
    v_mul_f32 v163, v163, v14
    v_mul_f32 v168, v168, v14
    v_mul_f32 v169, v169, v14
    v_mul_f32 v170, v170, v14
    v_mul_f32 v171, v171, v14
    v_mul_f32 v176, v176, v14
    v_mul_f32 v177, v177, v14
    v_mul_f32 v178, v178, v14
    v_mul_f32 v179, v179, v14
    v_mul_f32 v184, v184, v14
    v_mul_f32 v185, v185, v14
    v_mul_f32 v186, v186, v14
    v_mul_f32 v187, v187, v14
    v_mul_f32 v192, v192, v14
    v_mul_f32 v193, v193, v14
    v_mul_f32 v194, v194, v14
    v_mul_f32 v195, v195, v14
    v_mul_f32 v200, v200, v14
    v_mul_f32 v201, v201, v14
    v_mul_f32 v202, v202, v14
    v_mul_f32 v203, v203, v14
    v_mul_f32 v208, v208, v14
    v_mul_f32 v209, v209, v14
    v_mul_f32 v210, v210, v14
    v_mul_f32 v211, v211, v14
    v_add_f32 v13, 1092616192, v13
    v_max_f32 v13, 0, v13
    v_sub_f32 v15, 0, v13
    v_exp_f32 v15, v15
    v_sub_f32 v76, v76, v13
    v_sub_f32 v77, v77, v13
    v_sub_f32 v78, v78, v13
    v_sub_f32 v79, v79, v13
    v_sub_f32 v84, v84, v13
    v_sub_f32 v85, v85, v13
    v_sub_f32 v86, v86, v13
    v_sub_f32 v87, v87, v13
    v_sub_f32 v36, v36, v13
    v_sub_f32 v37, v37, v13
    v_sub_f32 v38, v38, v13
    v_sub_f32 v39, v39, v13
    v_mul_f32 v252, v252, v15
    v_mul_f32 v253, v253, v15
    v_mul_f32 v254, v254, v15
    v_mul_f32 v255, v255, v15
    v_mul_f32 v156, v156, v15
    v_mul_f32 v157, v157, v15
    v_mul_f32 v158, v158, v15
    v_mul_f32 v159, v159, v15
    v_mul_f32 v164, v164, v15
    v_mul_f32 v165, v165, v15
    v_mul_f32 v166, v166, v15
    v_mul_f32 v167, v167, v15
    v_mul_f32 v172, v172, v15
    v_mul_f32 v173, v173, v15
    v_mul_f32 v174, v174, v15
    v_mul_f32 v175, v175, v15
    v_mul_f32 v180, v180, v15
    v_mul_f32 v181, v181, v15
    v_mul_f32 v182, v182, v15
    v_mul_f32 v183, v183, v15
    v_mul_f32 v188, v188, v15
    v_mul_f32 v189, v189, v15
    v_mul_f32 v190, v190, v15
    v_mul_f32 v191, v191, v15
    v_mul_f32 v196, v196, v15
    v_mul_f32 v197, v197, v15
    v_mul_f32 v198, v198, v15
    v_mul_f32 v199, v199, v15
    v_mul_f32 v204, v204, v15
    v_mul_f32 v205, v205, v15
    v_mul_f32 v206, v206, v15
    v_mul_f32 v207, v207, v15
    v_mul_f32 v212, v212, v15
    v_mul_f32 v213, v213, v15
    v_mul_f32 v214, v214, v15
    v_mul_f32 v215, v215, v15
    v_exp_f32 v16, v72
    v_exp_f32 v17, v73
    v_exp_f32 v18, v76
    v_exp_f32 v19, v77
    v_cvt_pk_bf16_f32 v88, v16, v17
    v_cvt_pk_bf16_f32 v92, v18, v19
    v_exp_f32 v20, v74
    v_exp_f32 v21, v75
    v_exp_f32 v22, v78
    v_exp_f32 v23, v79
    v_cvt_pk_bf16_f32 v89, v20, v21
    v_cvt_pk_bf16_f32 v93, v22, v23
    v_exp_f32 v16, v80
    v_exp_f32 v17, v81
    v_exp_f32 v18, v84
    v_exp_f32 v19, v85
    v_cvt_pk_bf16_f32 v90, v16, v17
    v_cvt_pk_bf16_f32 v94, v18, v19
    v_exp_f32 v20, v82
    v_exp_f32 v21, v83
    v_exp_f32 v22, v86
    v_exp_f32 v23, v87
    v_cvt_pk_bf16_f32 v91, v20, v21
    v_cvt_pk_bf16_f32 v95, v22, v23
    v_or3_b32 v8, v88, v92, v89
    v_or3_b32 v9, v93, v90, v94
    v_or3_b32 v8, v8, v91, v95
    v_or_b32 v8, v8, v9
    s_branch main_kernel_chk_52
main_kernel_sq_53:
    ds_read_b128 v[128:131], v5 offset:16384
    ds_read_b128 v[132:135], v5 offset:17408
    ds_read_b128 v[136:139], v5 offset:18432
    ds_read_b128 v[140:143], v5 offset:19456
    s_waitcnt lgkmcnt(9)
    s_nop 0
    ds_read_b128 v[96:99], v5 offset:20480
    s_waitcnt lgkmcnt(9)
    s_nop 0
    ds_read_b128 v[100:103], v5 offset:21504
    s_branch main_kernel_pv_54
main_kernel_sp_55:
    s_branch main_kernel_me_56
main_kernel_spec_57:
    s_cmp_lt_u32 s27, s37
    s_cbranch_scc1 main_kernel_i_155
    s_sub_u32 s33, s37, s27
    s_lshl_b32 s33, s33, 5
    v_add_u32 v12, s33, v6
    v_mov_b32 v13, 4286578688
    v_cmp_gt_i32 s[44:45], 0, v12
    v_cmp_gt_i32 s[46:47], 1, v12
    v_cmp_gt_i32 s[48:49], 2, v12
    v_cmp_gt_i32 s[50:51], 3, v12
    v_cndmask_b32 v72, v72, v13, s[44:45]
    v_cndmask_b32 v73, v73, v13, s[46:47]
    v_cndmask_b32 v74, v74, v13, s[48:49]
    v_cndmask_b32 v75, v75, v13, s[50:51]
    v_cmp_gt_i32 s[44:45], -16, v12
    v_cmp_gt_i32 s[46:47], -15, v12
    v_cmp_gt_i32 s[48:49], -14, v12
    v_cmp_gt_i32 s[50:51], -13, v12
    v_cndmask_b32 v76, v76, v13, s[44:45]
    v_cndmask_b32 v77, v77, v13, s[46:47]
    v_cndmask_b32 v78, v78, v13, s[48:49]
    v_cndmask_b32 v79, v79, v13, s[50:51]
    v_cmp_gt_i32 s[44:45], 16, v12
    v_cmp_gt_i32 s[46:47], 17, v12
    v_cmp_gt_i32 s[48:49], 18, v12
    v_cmp_gt_i32 s[50:51], 19, v12
    v_cndmask_b32 v80, v80, v13, s[44:45]
    v_cndmask_b32 v81, v81, v13, s[46:47]
    v_cndmask_b32 v82, v82, v13, s[48:49]
    v_cndmask_b32 v83, v83, v13, s[50:51]
    v_cmp_gt_i32 s[44:45], 0, v12
    v_cmp_gt_i32 s[46:47], 1, v12
    v_cmp_gt_i32 s[48:49], 2, v12
    v_cmp_gt_i32 s[50:51], 3, v12
    v_cndmask_b32 v84, v84, v13, s[44:45]
    v_cndmask_b32 v85, v85, v13, s[46:47]
    v_cndmask_b32 v86, v86, v13, s[48:49]
    v_cndmask_b32 v87, v87, v13, s[50:51]
main_kernel_i_155:
    s_cmp_eq_u32 s41, 0
    s_cbranch_scc1 main_kernel_exp_58
    v_max3_f32 v12, v72, v73, v74
    v_max3_f32 v12, v12, v75, v80
    v_max3_f32 v12, v12, v81, v82
    v_max_f32 v12, v12, v83
    v_max3_f32 v13, v76, v77, v78
    v_max3_f32 v13, v13, v79, v84
    v_max3_f32 v13, v13, v85, v86
    v_max_f32 v13, v13, v87
    v_mov_b32 v14, v12
    v_mov_b32 v15, v13
    s_nop 0
    v_permlane16_swap_b32 v12, v14
    v_permlane16_swap_b32 v13, v15
    v_max_f32 v12, v12, v14
    v_max_f32 v13, v13, v15
    v_mov_b32 v14, v12
    v_mov_b32 v15, v13
    s_nop 0
    v_permlane32_swap_b32 v12, v14
    v_permlane32_swap_b32 v13, v15
    v_max_f32 v12, v12, v14
    v_max_f32 v13, v13, v15
    v_max_f32 v12, 0xf149f2ca, v12
    v_add_f32 v12, 1092616192, v12
    v_sub_f32 v32, 0, v12
    v_sub_f32 v33, 0, v12
    v_sub_f32 v34, 0, v12
    v_sub_f32 v35, 0, v12
    v_sub_f32 v72, v72, v12
    v_sub_f32 v73, v73, v12
    v_sub_f32 v74, v74, v12
    v_sub_f32 v75, v75, v12
    v_sub_f32 v80, v80, v12
    v_sub_f32 v81, v81, v12
    v_sub_f32 v82, v82, v12
    v_sub_f32 v83, v83, v12
    v_max_f32 v13, 0xf149f2ca, v13
    v_add_f32 v13, 1092616192, v13
    v_sub_f32 v36, 0, v13
    v_sub_f32 v37, 0, v13
    v_sub_f32 v38, 0, v13
    v_sub_f32 v39, 0, v13
    v_sub_f32 v76, v76, v13
    v_sub_f32 v77, v77, v13
    v_sub_f32 v78, v78, v13
    v_sub_f32 v79, v79, v13
    v_sub_f32 v84, v84, v13
    v_sub_f32 v85, v85, v13
    v_sub_f32 v86, v86, v13
    v_sub_f32 v87, v87, v13
    s_mov_b32 s41, 0
    s_mov_b32 s38, s37
    s_branch main_kernel_exp_58
main_kernel_rare_59:
    v_max3_f32 v12, v72, v73, v74
    v_max3_f32 v12, v12, v75, v80
    v_max3_f32 v12, v12, v81, v82
    v_max_f32 v12, v12, v83
    v_max3_f32 v13, v76, v77, v78
    v_max3_f32 v13, v13, v79, v84
    v_max3_f32 v13, v13, v85, v86
    v_max_f32 v13, v13, v87
    v_mov_b32 v14, v12
    v_mov_b32 v15, v13
    s_nop 0
    v_permlane16_swap_b32 v12, v14
    v_permlane16_swap_b32 v13, v15
    v_max_f32 v12, v12, v14
    v_max_f32 v13, v13, v15
    v_mov_b32 v14, v12
    v_mov_b32 v15, v13
    s_nop 0
    v_permlane32_swap_b32 v12, v14
    v_permlane32_swap_b32 v13, v15
    v_max_f32 v12, v12, v14
    v_max_f32 v13, v13, v15
    v_add_f32 v12, 1092616192, v12
    v_max_f32 v12, 0, v12
    v_sub_f32 v14, 0, v12
    v_exp_f32 v14, v14
    v_sub_f32 v72, v72, v12
    v_sub_f32 v73, v73, v12
    v_sub_f32 v74, v74, v12
    v_sub_f32 v75, v75, v12
    v_sub_f32 v80, v80, v12
    v_sub_f32 v81, v81, v12
    v_sub_f32 v82, v82, v12
    v_sub_f32 v83, v83, v12
    v_sub_f32 v32, v32, v12
    v_sub_f32 v33, v33, v12
    v_sub_f32 v34, v34, v12
    v_sub_f32 v35, v35, v12
    v_mul_f32 v248, v248, v14
    v_mul_f32 v249, v249, v14
    v_mul_f32 v250, v250, v14
    v_mul_f32 v251, v251, v14
    v_mul_f32 v152, v152, v14
    v_mul_f32 v153, v153, v14
    v_mul_f32 v154, v154, v14
    v_mul_f32 v155, v155, v14
    v_mul_f32 v160, v160, v14
    v_mul_f32 v161, v161, v14
    v_mul_f32 v162, v162, v14
    v_mul_f32 v163, v163, v14
    v_mul_f32 v168, v168, v14
    v_mul_f32 v169, v169, v14
    v_mul_f32 v170, v170, v14
    v_mul_f32 v171, v171, v14
    v_mul_f32 v176, v176, v14
    v_mul_f32 v177, v177, v14
    v_mul_f32 v178, v178, v14
    v_mul_f32 v179, v179, v14
    v_mul_f32 v184, v184, v14
    v_mul_f32 v185, v185, v14
    v_mul_f32 v186, v186, v14
    v_mul_f32 v187, v187, v14
    v_mul_f32 v192, v192, v14
    v_mul_f32 v193, v193, v14
    v_mul_f32 v194, v194, v14
    v_mul_f32 v195, v195, v14
    v_mul_f32 v200, v200, v14
    v_mul_f32 v201, v201, v14
    v_mul_f32 v202, v202, v14
    v_mul_f32 v203, v203, v14
    v_mul_f32 v208, v208, v14
    v_mul_f32 v209, v209, v14
    v_mul_f32 v210, v210, v14
    v_mul_f32 v211, v211, v14
    v_add_f32 v13, 1092616192, v13
    v_max_f32 v13, 0, v13
    v_sub_f32 v15, 0, v13
    v_exp_f32 v15, v15
    v_sub_f32 v76, v76, v13
    v_sub_f32 v77, v77, v13
    v_sub_f32 v78, v78, v13
    v_sub_f32 v79, v79, v13
    v_sub_f32 v84, v84, v13
    v_sub_f32 v85, v85, v13
    v_sub_f32 v86, v86, v13
    v_sub_f32 v87, v87, v13
    v_sub_f32 v36, v36, v13
    v_sub_f32 v37, v37, v13
    v_sub_f32 v38, v38, v13
    v_sub_f32 v39, v39, v13
    v_mul_f32 v252, v252, v15
    v_mul_f32 v253, v253, v15
    v_mul_f32 v254, v254, v15
    v_mul_f32 v255, v255, v15
    v_mul_f32 v156, v156, v15
    v_mul_f32 v157, v157, v15
    v_mul_f32 v158, v158, v15
    v_mul_f32 v159, v159, v15
    v_mul_f32 v164, v164, v15
    v_mul_f32 v165, v165, v15
    v_mul_f32 v166, v166, v15
    v_mul_f32 v167, v167, v15
    v_mul_f32 v172, v172, v15
    v_mul_f32 v173, v173, v15
    v_mul_f32 v174, v174, v15
    v_mul_f32 v175, v175, v15
    v_mul_f32 v180, v180, v15
    v_mul_f32 v181, v181, v15
    v_mul_f32 v182, v182, v15
    v_mul_f32 v183, v183, v15
    v_mul_f32 v188, v188, v15
    v_mul_f32 v189, v189, v15
    v_mul_f32 v190, v190, v15
    v_mul_f32 v191, v191, v15
    v_mul_f32 v196, v196, v15
    v_mul_f32 v197, v197, v15
    v_mul_f32 v198, v198, v15
    v_mul_f32 v199, v199, v15
    v_mul_f32 v204, v204, v15
    v_mul_f32 v205, v205, v15
    v_mul_f32 v206, v206, v15
    v_mul_f32 v207, v207, v15
    v_mul_f32 v212, v212, v15
    v_mul_f32 v213, v213, v15
    v_mul_f32 v214, v214, v15
    v_mul_f32 v215, v215, v15
    v_exp_f32 v16, v72
    v_exp_f32 v17, v73
    v_exp_f32 v18, v76
    v_exp_f32 v19, v77
    v_cvt_pk_bf16_f32 v88, v16, v17
    v_cvt_pk_bf16_f32 v92, v18, v19
    v_exp_f32 v20, v74
    v_exp_f32 v21, v75
    v_exp_f32 v22, v78
    v_exp_f32 v23, v79
    v_cvt_pk_bf16_f32 v89, v20, v21
    v_cvt_pk_bf16_f32 v93, v22, v23
    v_exp_f32 v16, v80
    v_exp_f32 v17, v81
    v_exp_f32 v18, v84
    v_exp_f32 v19, v85
    v_cvt_pk_bf16_f32 v90, v16, v17
    v_cvt_pk_bf16_f32 v94, v18, v19
    v_exp_f32 v20, v82
    v_exp_f32 v21, v83
    v_exp_f32 v22, v86
    v_exp_f32 v23, v87
    v_cvt_pk_bf16_f32 v91, v20, v21
    v_cvt_pk_bf16_f32 v95, v22, v23
    v_or3_b32 v8, v88, v92, v89
    v_or3_b32 v9, v93, v90, v94
    v_or3_b32 v8, v8, v91, v95
    v_or_b32 v8, v8, v9
    s_branch main_kernel_chk_60
main_kernel_sq_61:
    ds_read_b128 v[128:131], v5 offset:24576
    ds_read_b128 v[132:135], v5 offset:25600
    ds_read_b128 v[136:139], v5 offset:26624
    ds_read_b128 v[140:143], v5 offset:27648
    s_waitcnt lgkmcnt(9)
    s_nop 0
    ds_read_b128 v[96:99], v5 offset:28672
    s_waitcnt lgkmcnt(9)
    s_nop 0
    ds_read_b128 v[100:103], v5 offset:29696
    s_branch main_kernel_pv_62
main_kernel_sp_63:
    s_branch main_kernel_me_64
main_kernel_sq_65:
    ds_read_b128 v[128:131], v5 offset:24576
    ds_read_b128 v[132:135], v5 offset:25600
    ds_read_b128 v[136:139], v5 offset:26624
    ds_read_b128 v[140:143], v5 offset:27648
    s_waitcnt lgkmcnt(9)
    s_nop 0
    ds_read_b128 v[96:99], v5 offset:28672
    s_waitcnt lgkmcnt(9)
    s_nop 0
    ds_read_b128 v[100:103], v5 offset:29696
    s_branch main_kernel_pv_66
main_kernel_sp_67:
    s_branch main_kernel_me_68
main_kernel_spec_69:
    s_cmp_lt_u32 s27, s37
    s_cbranch_scc1 main_kernel_i_156
    s_sub_u32 s33, s37, s27
    s_lshl_b32 s33, s33, 5
    v_add_u32 v12, s33, v6
    v_mov_b32 v13, 4286578688
    v_cmp_gt_i32 s[44:45], 0, v12
    v_cmp_gt_i32 s[46:47], 1, v12
    v_cmp_gt_i32 s[48:49], 2, v12
    v_cmp_gt_i32 s[50:51], 3, v12
    v_cndmask_b32 v72, v72, v13, s[44:45]
    v_cndmask_b32 v73, v73, v13, s[46:47]
    v_cndmask_b32 v74, v74, v13, s[48:49]
    v_cndmask_b32 v75, v75, v13, s[50:51]
    v_cmp_gt_i32 s[44:45], -16, v12
    v_cmp_gt_i32 s[46:47], -15, v12
    v_cmp_gt_i32 s[48:49], -14, v12
    v_cmp_gt_i32 s[50:51], -13, v12
    v_cndmask_b32 v76, v76, v13, s[44:45]
    v_cndmask_b32 v77, v77, v13, s[46:47]
    v_cndmask_b32 v78, v78, v13, s[48:49]
    v_cndmask_b32 v79, v79, v13, s[50:51]
    v_cmp_gt_i32 s[44:45], 16, v12
    v_cmp_gt_i32 s[46:47], 17, v12
    v_cmp_gt_i32 s[48:49], 18, v12
    v_cmp_gt_i32 s[50:51], 19, v12
    v_cndmask_b32 v80, v80, v13, s[44:45]
    v_cndmask_b32 v81, v81, v13, s[46:47]
    v_cndmask_b32 v82, v82, v13, s[48:49]
    v_cndmask_b32 v83, v83, v13, s[50:51]
    v_cmp_gt_i32 s[44:45], 0, v12
    v_cmp_gt_i32 s[46:47], 1, v12
    v_cmp_gt_i32 s[48:49], 2, v12
    v_cmp_gt_i32 s[50:51], 3, v12
    v_cndmask_b32 v84, v84, v13, s[44:45]
    v_cndmask_b32 v85, v85, v13, s[46:47]
    v_cndmask_b32 v86, v86, v13, s[48:49]
    v_cndmask_b32 v87, v87, v13, s[50:51]
main_kernel_i_156:
    s_cmp_eq_u32 s41, 0
    s_cbranch_scc1 main_kernel_exp_70
    v_max3_f32 v12, v72, v73, v74
    v_max3_f32 v12, v12, v75, v80
    v_max3_f32 v12, v12, v81, v82
    v_max_f32 v12, v12, v83
    v_max3_f32 v13, v76, v77, v78
    v_max3_f32 v13, v13, v79, v84
    v_max3_f32 v13, v13, v85, v86
    v_max_f32 v13, v13, v87
    v_mov_b32 v14, v12
    v_mov_b32 v15, v13
    s_nop 0
    v_permlane16_swap_b32 v12, v14
    v_permlane16_swap_b32 v13, v15
    v_max_f32 v12, v12, v14
    v_max_f32 v13, v13, v15
    v_mov_b32 v14, v12
    v_mov_b32 v15, v13
    s_nop 0
    v_permlane32_swap_b32 v12, v14
    v_permlane32_swap_b32 v13, v15
    v_max_f32 v12, v12, v14
    v_max_f32 v13, v13, v15
    v_max_f32 v12, 0xf149f2ca, v12
    v_add_f32 v12, 1092616192, v12
    v_sub_f32 v32, 0, v12
    v_sub_f32 v33, 0, v12
    v_sub_f32 v34, 0, v12
    v_sub_f32 v35, 0, v12
    v_sub_f32 v72, v72, v12
    v_sub_f32 v73, v73, v12
    v_sub_f32 v74, v74, v12
    v_sub_f32 v75, v75, v12
    v_sub_f32 v80, v80, v12
    v_sub_f32 v81, v81, v12
    v_sub_f32 v82, v82, v12
    v_sub_f32 v83, v83, v12
    v_max_f32 v13, 0xf149f2ca, v13
    v_add_f32 v13, 1092616192, v13
    v_sub_f32 v36, 0, v13
    v_sub_f32 v37, 0, v13
    v_sub_f32 v38, 0, v13
    v_sub_f32 v39, 0, v13
    v_sub_f32 v76, v76, v13
    v_sub_f32 v77, v77, v13
    v_sub_f32 v78, v78, v13
    v_sub_f32 v79, v79, v13
    v_sub_f32 v84, v84, v13
    v_sub_f32 v85, v85, v13
    v_sub_f32 v86, v86, v13
    v_sub_f32 v87, v87, v13
    s_mov_b32 s41, 0
    s_mov_b32 s38, s37
    s_branch main_kernel_exp_70
main_kernel_rare_71:
    v_max3_f32 v12, v72, v73, v74
    v_max3_f32 v12, v12, v75, v80
    v_max3_f32 v12, v12, v81, v82
    v_max_f32 v12, v12, v83
    v_max3_f32 v13, v76, v77, v78
    v_max3_f32 v13, v13, v79, v84
    v_max3_f32 v13, v13, v85, v86
    v_max_f32 v13, v13, v87
    v_mov_b32 v14, v12
    v_mov_b32 v15, v13
    s_nop 0
    v_permlane16_swap_b32 v12, v14
    v_permlane16_swap_b32 v13, v15
    v_max_f32 v12, v12, v14
    v_max_f32 v13, v13, v15
    v_mov_b32 v14, v12
    v_mov_b32 v15, v13
    s_nop 0
    v_permlane32_swap_b32 v12, v14
    v_permlane32_swap_b32 v13, v15
    v_max_f32 v12, v12, v14
    v_max_f32 v13, v13, v15
    v_add_f32 v12, 1092616192, v12
    v_max_f32 v12, 0, v12
    v_sub_f32 v14, 0, v12
    v_exp_f32 v14, v14
    v_sub_f32 v72, v72, v12
    v_sub_f32 v73, v73, v12
    v_sub_f32 v74, v74, v12
    v_sub_f32 v75, v75, v12
    v_sub_f32 v80, v80, v12
    v_sub_f32 v81, v81, v12
    v_sub_f32 v82, v82, v12
    v_sub_f32 v83, v83, v12
    v_sub_f32 v32, v32, v12
    v_sub_f32 v33, v33, v12
    v_sub_f32 v34, v34, v12
    v_sub_f32 v35, v35, v12
    v_mul_f32 v248, v248, v14
    v_mul_f32 v249, v249, v14
    v_mul_f32 v250, v250, v14
    v_mul_f32 v251, v251, v14
    v_mul_f32 v152, v152, v14
    v_mul_f32 v153, v153, v14
    v_mul_f32 v154, v154, v14
    v_mul_f32 v155, v155, v14
    v_mul_f32 v160, v160, v14
    v_mul_f32 v161, v161, v14
    v_mul_f32 v162, v162, v14
    v_mul_f32 v163, v163, v14
    v_mul_f32 v168, v168, v14
    v_mul_f32 v169, v169, v14
    v_mul_f32 v170, v170, v14
    v_mul_f32 v171, v171, v14
    v_mul_f32 v176, v176, v14
    v_mul_f32 v177, v177, v14
    v_mul_f32 v178, v178, v14
    v_mul_f32 v179, v179, v14
    v_mul_f32 v184, v184, v14
    v_mul_f32 v185, v185, v14
    v_mul_f32 v186, v186, v14
    v_mul_f32 v187, v187, v14
    v_mul_f32 v192, v192, v14
    v_mul_f32 v193, v193, v14
    v_mul_f32 v194, v194, v14
    v_mul_f32 v195, v195, v14
    v_mul_f32 v200, v200, v14
    v_mul_f32 v201, v201, v14
    v_mul_f32 v202, v202, v14
    v_mul_f32 v203, v203, v14
    v_mul_f32 v208, v208, v14
    v_mul_f32 v209, v209, v14
    v_mul_f32 v210, v210, v14
    v_mul_f32 v211, v211, v14
    v_add_f32 v13, 1092616192, v13
    v_max_f32 v13, 0, v13
    v_sub_f32 v15, 0, v13
    v_exp_f32 v15, v15
    v_sub_f32 v76, v76, v13
    v_sub_f32 v77, v77, v13
    v_sub_f32 v78, v78, v13
    v_sub_f32 v79, v79, v13
    v_sub_f32 v84, v84, v13
    v_sub_f32 v85, v85, v13
    v_sub_f32 v86, v86, v13
    v_sub_f32 v87, v87, v13
    v_sub_f32 v36, v36, v13
    v_sub_f32 v37, v37, v13
    v_sub_f32 v38, v38, v13
    v_sub_f32 v39, v39, v13
    v_mul_f32 v252, v252, v15
    v_mul_f32 v253, v253, v15
    v_mul_f32 v254, v254, v15
    v_mul_f32 v255, v255, v15
    v_mul_f32 v156, v156, v15
    v_mul_f32 v157, v157, v15
    v_mul_f32 v158, v158, v15
    v_mul_f32 v159, v159, v15
    v_mul_f32 v164, v164, v15
    v_mul_f32 v165, v165, v15
    v_mul_f32 v166, v166, v15
    v_mul_f32 v167, v167, v15
    v_mul_f32 v172, v172, v15
    v_mul_f32 v173, v173, v15
    v_mul_f32 v174, v174, v15
    v_mul_f32 v175, v175, v15
    v_mul_f32 v180, v180, v15
    v_mul_f32 v181, v181, v15
    v_mul_f32 v182, v182, v15
    v_mul_f32 v183, v183, v15
    v_mul_f32 v188, v188, v15
    v_mul_f32 v189, v189, v15
    v_mul_f32 v190, v190, v15
    v_mul_f32 v191, v191, v15
    v_mul_f32 v196, v196, v15
    v_mul_f32 v197, v197, v15
    v_mul_f32 v198, v198, v15
    v_mul_f32 v199, v199, v15
    v_mul_f32 v204, v204, v15
    v_mul_f32 v205, v205, v15
    v_mul_f32 v206, v206, v15
    v_mul_f32 v207, v207, v15
    v_mul_f32 v212, v212, v15
    v_mul_f32 v213, v213, v15
    v_mul_f32 v214, v214, v15
    v_mul_f32 v215, v215, v15
    v_exp_f32 v16, v72
    v_exp_f32 v17, v73
    v_exp_f32 v18, v76
    v_exp_f32 v19, v77
    v_cvt_pk_bf16_f32 v88, v16, v17
    v_cvt_pk_bf16_f32 v92, v18, v19
    v_exp_f32 v20, v74
    v_exp_f32 v21, v75
    v_exp_f32 v22, v78
    v_exp_f32 v23, v79
    v_cvt_pk_bf16_f32 v89, v20, v21
    v_cvt_pk_bf16_f32 v93, v22, v23
    v_exp_f32 v16, v80
    v_exp_f32 v17, v81
    v_exp_f32 v18, v84
    v_exp_f32 v19, v85
    v_cvt_pk_bf16_f32 v90, v16, v17
    v_cvt_pk_bf16_f32 v94, v18, v19
    v_exp_f32 v20, v82
    v_exp_f32 v21, v83
    v_exp_f32 v22, v86
    v_exp_f32 v23, v87
    v_cvt_pk_bf16_f32 v91, v20, v21
    v_cvt_pk_bf16_f32 v95, v22, v23
    v_or3_b32 v8, v88, v92, v89
    v_or3_b32 v9, v93, v90, v94
    v_or3_b32 v8, v8, v91, v95
    v_or_b32 v8, v8, v9
    s_branch main_kernel_chk_72
main_kernel_sq_73:
    ds_read_b128 v[128:131], v5 offset:0
    ds_read_b128 v[132:135], v5 offset:1024
    ds_read_b128 v[136:139], v5 offset:2048
    ds_read_b128 v[140:143], v5 offset:3072
    s_waitcnt lgkmcnt(9)
    s_nop 0
    ds_read_b128 v[96:99], v5 offset:4096
    s_waitcnt lgkmcnt(9)
    s_nop 0
    ds_read_b128 v[100:103], v5 offset:5120
    s_branch main_kernel_pv_74
main_kernel_sp_75:
    s_branch main_kernel_me_76
main_kernel_spec_77:
    s_cmp_lt_u32 s27, s37
    s_cbranch_scc1 main_kernel_i_157
    s_sub_u32 s33, s37, s27
    s_lshl_b32 s33, s33, 5
    v_add_u32 v12, s33, v6
    v_mov_b32 v13, 4286578688
    v_cmp_gt_i32 s[44:45], 0, v12
    v_cmp_gt_i32 s[46:47], 1, v12
    v_cmp_gt_i32 s[48:49], 2, v12
    v_cmp_gt_i32 s[50:51], 3, v12
    v_cndmask_b32 v72, v72, v13, s[44:45]
    v_cndmask_b32 v73, v73, v13, s[46:47]
    v_cndmask_b32 v74, v74, v13, s[48:49]
    v_cndmask_b32 v75, v75, v13, s[50:51]
    v_cmp_gt_i32 s[44:45], -16, v12
    v_cmp_gt_i32 s[46:47], -15, v12
    v_cmp_gt_i32 s[48:49], -14, v12
    v_cmp_gt_i32 s[50:51], -13, v12
    v_cndmask_b32 v76, v76, v13, s[44:45]
    v_cndmask_b32 v77, v77, v13, s[46:47]
    v_cndmask_b32 v78, v78, v13, s[48:49]
    v_cndmask_b32 v79, v79, v13, s[50:51]
    v_cmp_gt_i32 s[44:45], 16, v12
    v_cmp_gt_i32 s[46:47], 17, v12
    v_cmp_gt_i32 s[48:49], 18, v12
    v_cmp_gt_i32 s[50:51], 19, v12
    v_cndmask_b32 v80, v80, v13, s[44:45]
    v_cndmask_b32 v81, v81, v13, s[46:47]
    v_cndmask_b32 v82, v82, v13, s[48:49]
    v_cndmask_b32 v83, v83, v13, s[50:51]
    v_cmp_gt_i32 s[44:45], 0, v12
    v_cmp_gt_i32 s[46:47], 1, v12
    v_cmp_gt_i32 s[48:49], 2, v12
    v_cmp_gt_i32 s[50:51], 3, v12
    v_cndmask_b32 v84, v84, v13, s[44:45]
    v_cndmask_b32 v85, v85, v13, s[46:47]
    v_cndmask_b32 v86, v86, v13, s[48:49]
    v_cndmask_b32 v87, v87, v13, s[50:51]
main_kernel_i_157:
    s_cmp_eq_u32 s41, 0
    s_cbranch_scc1 main_kernel_exp_78
    v_max3_f32 v12, v72, v73, v74
    v_max3_f32 v12, v12, v75, v80
    v_max3_f32 v12, v12, v81, v82
    v_max_f32 v12, v12, v83
    v_max3_f32 v13, v76, v77, v78
    v_max3_f32 v13, v13, v79, v84
    v_max3_f32 v13, v13, v85, v86
    v_max_f32 v13, v13, v87
    v_mov_b32 v14, v12
    v_mov_b32 v15, v13
    s_nop 0
    v_permlane16_swap_b32 v12, v14
    v_permlane16_swap_b32 v13, v15
    v_max_f32 v12, v12, v14
    v_max_f32 v13, v13, v15
    v_mov_b32 v14, v12
    v_mov_b32 v15, v13
    s_nop 0
    v_permlane32_swap_b32 v12, v14
    v_permlane32_swap_b32 v13, v15
    v_max_f32 v12, v12, v14
    v_max_f32 v13, v13, v15
    v_max_f32 v12, 0xf149f2ca, v12
    v_add_f32 v12, 1092616192, v12
    v_sub_f32 v32, 0, v12
    v_sub_f32 v33, 0, v12
    v_sub_f32 v34, 0, v12
    v_sub_f32 v35, 0, v12
    v_sub_f32 v72, v72, v12
    v_sub_f32 v73, v73, v12
    v_sub_f32 v74, v74, v12
    v_sub_f32 v75, v75, v12
    v_sub_f32 v80, v80, v12
    v_sub_f32 v81, v81, v12
    v_sub_f32 v82, v82, v12
    v_sub_f32 v83, v83, v12
    v_max_f32 v13, 0xf149f2ca, v13
    v_add_f32 v13, 1092616192, v13
    v_sub_f32 v36, 0, v13
    v_sub_f32 v37, 0, v13
    v_sub_f32 v38, 0, v13
    v_sub_f32 v39, 0, v13
    v_sub_f32 v76, v76, v13
    v_sub_f32 v77, v77, v13
    v_sub_f32 v78, v78, v13
    v_sub_f32 v79, v79, v13
    v_sub_f32 v84, v84, v13
    v_sub_f32 v85, v85, v13
    v_sub_f32 v86, v86, v13
    v_sub_f32 v87, v87, v13
    s_mov_b32 s41, 0
    s_mov_b32 s38, s37
    s_branch main_kernel_exp_78
main_kernel_rare_79:
    v_max3_f32 v12, v72, v73, v74
    v_max3_f32 v12, v12, v75, v80
    v_max3_f32 v12, v12, v81, v82
    v_max_f32 v12, v12, v83
    v_max3_f32 v13, v76, v77, v78
    v_max3_f32 v13, v13, v79, v84
    v_max3_f32 v13, v13, v85, v86
    v_max_f32 v13, v13, v87
    v_mov_b32 v14, v12
    v_mov_b32 v15, v13
    s_nop 0
    v_permlane16_swap_b32 v12, v14
    v_permlane16_swap_b32 v13, v15
    v_max_f32 v12, v12, v14
    v_max_f32 v13, v13, v15
    v_mov_b32 v14, v12
    v_mov_b32 v15, v13
    s_nop 0
    v_permlane32_swap_b32 v12, v14
    v_permlane32_swap_b32 v13, v15
    v_max_f32 v12, v12, v14
    v_max_f32 v13, v13, v15
    v_add_f32 v12, 1092616192, v12
    v_max_f32 v12, 0, v12
    v_sub_f32 v14, 0, v12
    v_exp_f32 v14, v14
    v_sub_f32 v72, v72, v12
    v_sub_f32 v73, v73, v12
    v_sub_f32 v74, v74, v12
    v_sub_f32 v75, v75, v12
    v_sub_f32 v80, v80, v12
    v_sub_f32 v81, v81, v12
    v_sub_f32 v82, v82, v12
    v_sub_f32 v83, v83, v12
    v_sub_f32 v32, v32, v12
    v_sub_f32 v33, v33, v12
    v_sub_f32 v34, v34, v12
    v_sub_f32 v35, v35, v12
    v_mul_f32 v248, v248, v14
    v_mul_f32 v249, v249, v14
    v_mul_f32 v250, v250, v14
    v_mul_f32 v251, v251, v14
    v_mul_f32 v152, v152, v14
    v_mul_f32 v153, v153, v14
    v_mul_f32 v154, v154, v14
    v_mul_f32 v155, v155, v14
    v_mul_f32 v160, v160, v14
    v_mul_f32 v161, v161, v14
    v_mul_f32 v162, v162, v14
    v_mul_f32 v163, v163, v14
    v_mul_f32 v168, v168, v14
    v_mul_f32 v169, v169, v14
    v_mul_f32 v170, v170, v14
    v_mul_f32 v171, v171, v14
    v_mul_f32 v176, v176, v14
    v_mul_f32 v177, v177, v14
    v_mul_f32 v178, v178, v14
    v_mul_f32 v179, v179, v14
    v_mul_f32 v184, v184, v14
    v_mul_f32 v185, v185, v14
    v_mul_f32 v186, v186, v14
    v_mul_f32 v187, v187, v14
    v_mul_f32 v192, v192, v14
    v_mul_f32 v193, v193, v14
    v_mul_f32 v194, v194, v14
    v_mul_f32 v195, v195, v14
    v_mul_f32 v200, v200, v14
    v_mul_f32 v201, v201, v14
    v_mul_f32 v202, v202, v14
    v_mul_f32 v203, v203, v14
    v_mul_f32 v208, v208, v14
    v_mul_f32 v209, v209, v14
    v_mul_f32 v210, v210, v14
    v_mul_f32 v211, v211, v14
    v_add_f32 v13, 1092616192, v13
    v_max_f32 v13, 0, v13
    v_sub_f32 v15, 0, v13
    v_exp_f32 v15, v15
    v_sub_f32 v76, v76, v13
    v_sub_f32 v77, v77, v13
    v_sub_f32 v78, v78, v13
    v_sub_f32 v79, v79, v13
    v_sub_f32 v84, v84, v13
    v_sub_f32 v85, v85, v13
    v_sub_f32 v86, v86, v13
    v_sub_f32 v87, v87, v13
    v_sub_f32 v36, v36, v13
    v_sub_f32 v37, v37, v13
    v_sub_f32 v38, v38, v13
    v_sub_f32 v39, v39, v13
    v_mul_f32 v252, v252, v15
    v_mul_f32 v253, v253, v15
    v_mul_f32 v254, v254, v15
    v_mul_f32 v255, v255, v15
    v_mul_f32 v156, v156, v15
    v_mul_f32 v157, v157, v15
    v_mul_f32 v158, v158, v15
    v_mul_f32 v159, v159, v15
    v_mul_f32 v164, v164, v15
    v_mul_f32 v165, v165, v15
    v_mul_f32 v166, v166, v15
    v_mul_f32 v167, v167, v15
    v_mul_f32 v172, v172, v15
    v_mul_f32 v173, v173, v15
    v_mul_f32 v174, v174, v15
    v_mul_f32 v175, v175, v15
    v_mul_f32 v180, v180, v15
    v_mul_f32 v181, v181, v15
    v_mul_f32 v182, v182, v15
    v_mul_f32 v183, v183, v15
    v_mul_f32 v188, v188, v15
    v_mul_f32 v189, v189, v15
    v_mul_f32 v190, v190, v15
    v_mul_f32 v191, v191, v15
    v_mul_f32 v196, v196, v15
    v_mul_f32 v197, v197, v15
    v_mul_f32 v198, v198, v15
    v_mul_f32 v199, v199, v15
    v_mul_f32 v204, v204, v15
    v_mul_f32 v205, v205, v15
    v_mul_f32 v206, v206, v15
    v_mul_f32 v207, v207, v15
    v_mul_f32 v212, v212, v15
    v_mul_f32 v213, v213, v15
    v_mul_f32 v214, v214, v15
    v_mul_f32 v215, v215, v15
    v_exp_f32 v16, v72
    v_exp_f32 v17, v73
    v_exp_f32 v18, v76
    v_exp_f32 v19, v77
    v_cvt_pk_bf16_f32 v88, v16, v17
    v_cvt_pk_bf16_f32 v92, v18, v19
    v_exp_f32 v20, v74
    v_exp_f32 v21, v75
    v_exp_f32 v22, v78
    v_exp_f32 v23, v79
    v_cvt_pk_bf16_f32 v89, v20, v21
    v_cvt_pk_bf16_f32 v93, v22, v23
    v_exp_f32 v16, v80
    v_exp_f32 v17, v81
    v_exp_f32 v18, v84
    v_exp_f32 v19, v85
    v_cvt_pk_bf16_f32 v90, v16, v17
    v_cvt_pk_bf16_f32 v94, v18, v19
    v_exp_f32 v20, v82
    v_exp_f32 v21, v83
    v_exp_f32 v22, v86
    v_exp_f32 v23, v87
    v_cvt_pk_bf16_f32 v91, v20, v21
    v_cvt_pk_bf16_f32 v95, v22, v23
    v_or3_b32 v8, v88, v92, v89
    v_or3_b32 v9, v93, v90, v94
    v_or3_b32 v8, v8, v91, v95
    v_or_b32 v8, v8, v9
    s_branch main_kernel_chk_80
main_kernel_sq_81:
    ds_read_b128 v[128:131], v5 offset:8192
    ds_read_b128 v[132:135], v5 offset:9216
    ds_read_b128 v[136:139], v5 offset:10240
    ds_read_b128 v[140:143], v5 offset:11264
    s_waitcnt lgkmcnt(9)
    s_nop 0
    ds_read_b128 v[96:99], v5 offset:12288
    s_waitcnt lgkmcnt(9)
    s_nop 0
    ds_read_b128 v[100:103], v5 offset:13312
    s_branch main_kernel_pv_82
main_kernel_sp_83:
    s_branch main_kernel_me_84
main_kernel_spec_90:
    s_cmp_lg_u32 s41, 2
    s_cbranch_scc1 main_kernel_nf_159
    v_rcp_f32 v12, v248
    s_nop 0
    v_rcp_f32 v13, v252
    v_mul_f32 v152, v152, v12
    v_mul_f32 v153, v153, v12
    v_mul_f32 v154, v154, v12
    v_mul_f32 v155, v155, v12
    v_cvt_pk_bf16_f32 v216, v152, v153
    v_cvt_pk_bf16_f32 v217, v154, v155
    v_mul_f32 v160, v160, v12
    v_mul_f32 v161, v161, v12
    v_mul_f32 v162, v162, v12
    v_mul_f32 v163, v163, v12
    v_cvt_pk_bf16_f32 v218, v160, v161
    v_cvt_pk_bf16_f32 v219, v162, v163
    v_mul_f32 v168, v168, v12
    v_mul_f32 v169, v169, v12
    v_mul_f32 v170, v170, v12
    v_mul_f32 v171, v171, v12
    v_cvt_pk_bf16_f32 v220, v168, v169
    v_cvt_pk_bf16_f32 v221, v170, v171
    v_mul_f32 v176, v176, v12
    v_mul_f32 v177, v177, v12
    v_mul_f32 v178, v178, v12
    v_mul_f32 v179, v179, v12
    v_cvt_pk_bf16_f32 v222, v176, v177
    v_cvt_pk_bf16_f32 v223, v178, v179
    v_mul_f32 v184, v184, v12
    v_mul_f32 v185, v185, v12
    v_mul_f32 v186, v186, v12
    v_mul_f32 v187, v187, v12
    v_cvt_pk_bf16_f32 v224, v184, v185
    v_cvt_pk_bf16_f32 v225, v186, v187
    v_mul_f32 v192, v192, v12
    v_mul_f32 v193, v193, v12
    v_mul_f32 v194, v194, v12
    v_mul_f32 v195, v195, v12
    v_cvt_pk_bf16_f32 v226, v192, v193
    v_cvt_pk_bf16_f32 v227, v194, v195
    v_mul_f32 v200, v200, v12
    v_mul_f32 v201, v201, v12
    v_mul_f32 v202, v202, v12
    v_mul_f32 v203, v203, v12
    v_cvt_pk_bf16_f32 v228, v200, v201
    v_cvt_pk_bf16_f32 v229, v202, v203
    v_mul_f32 v208, v208, v12
    v_mul_f32 v209, v209, v12
    v_mul_f32 v210, v210, v12
    v_mul_f32 v211, v211, v12
    v_cvt_pk_bf16_f32 v230, v208, v209
    v_cvt_pk_bf16_f32 v231, v210, v211
    v_mul_f32 v156, v156, v13
    v_mul_f32 v157, v157, v13
    v_mul_f32 v158, v158, v13
    v_mul_f32 v159, v159, v13
    v_cvt_pk_bf16_f32 v232, v156, v157
    v_cvt_pk_bf16_f32 v233, v158, v159
    v_mul_f32 v164, v164, v13
    v_mul_f32 v165, v165, v13
    v_mul_f32 v166, v166, v13
    v_mul_f32 v167, v167, v13
    v_cvt_pk_bf16_f32 v234, v164, v165
    v_cvt_pk_bf16_f32 v235, v166, v167
    v_mul_f32 v172, v172, v13
    v_mul_f32 v173, v173, v13
    v_mul_f32 v174, v174, v13
    v_mul_f32 v175, v175, v13
    v_cvt_pk_bf16_f32 v236, v172, v173
    v_cvt_pk_bf16_f32 v237, v174, v175
    v_mul_f32 v180, v180, v13
    v_mul_f32 v181, v181, v13
    v_mul_f32 v182, v182, v13
    v_mul_f32 v183, v183, v13
    v_cvt_pk_bf16_f32 v238, v180, v181
    v_cvt_pk_bf16_f32 v239, v182, v183
    v_mul_f32 v188, v188, v13
    v_mul_f32 v189, v189, v13
    v_mul_f32 v190, v190, v13
    v_mul_f32 v191, v191, v13
    v_cvt_pk_bf16_f32 v240, v188, v189
    v_cvt_pk_bf16_f32 v241, v190, v191
    v_mul_f32 v196, v196, v13
    v_mul_f32 v197, v197, v13
    v_mul_f32 v198, v198, v13
    v_mul_f32 v199, v199, v13
    v_cvt_pk_bf16_f32 v242, v196, v197
    v_cvt_pk_bf16_f32 v243, v198, v199
    v_mul_f32 v204, v204, v13
    v_mul_f32 v205, v205, v13
    v_mul_f32 v206, v206, v13
    v_mul_f32 v207, v207, v13
    v_cvt_pk_bf16_f32 v244, v204, v205
    v_cvt_pk_bf16_f32 v245, v206, v207
    v_mul_f32 v212, v212, v13
    v_mul_f32 v213, v213, v13
    v_mul_f32 v214, v214, v13
    v_mul_f32 v215, v215, v13
    v_cvt_pk_bf16_f32 v246, v212, v213
    v_cvt_pk_bf16_f32 v247, v214, v215
    s_lshl_b32 s33, s37, 6
    s_add_u32 s33, s33, s21
    s_lshl_b32 s33, s33, 12
    s_add_u32 s33, s33, 50331648
    s_add_u32 s34, s33, 0x20000
    buffer_store_dwordx4 v[216:219], v7, s[8:11], s33 offen offset:0 sc1
    buffer_store_dwordx4 v[220:223], v7, s[8:11], s33 offen offset:1024 sc1
    buffer_store_dwordx4 v[224:227], v7, s[8:11], s33 offen offset:2048 sc1
    buffer_store_dwordx4 v[228:231], v7, s[8:11], s33 offen offset:3072 sc1
    buffer_store_dwordx4 v[232:235], v7, s[8:11], s34 offen offset:0 sc1
    buffer_store_dwordx4 v[236:239], v7, s[8:11], s34 offen offset:1024 sc1
    buffer_store_dwordx4 v[240:243], v7, s[8:11], s34 offen offset:2048 sc1
    buffer_store_dwordx4 v[244:247], v7, s[8:11], s34 offen offset:3072 sc1
    v_mov_b32 v152, 0
    v_mov_b32 v153, 0
    v_mov_b32 v154, 0
    v_mov_b32 v155, 0
    v_mov_b32 v156, 0
    v_mov_b32 v157, 0
    v_mov_b32 v158, 0
    v_mov_b32 v159, 0
    v_mov_b32 v160, 0
    v_mov_b32 v161, 0
    v_mov_b32 v162, 0
    v_mov_b32 v163, 0
    v_mov_b32 v164, 0
    v_mov_b32 v165, 0
    v_mov_b32 v166, 0
    v_mov_b32 v167, 0
    v_mov_b32 v168, 0
    v_mov_b32 v169, 0
    v_mov_b32 v170, 0
    v_mov_b32 v171, 0
    v_mov_b32 v172, 0
    v_mov_b32 v173, 0
    v_mov_b32 v174, 0
    v_mov_b32 v175, 0
    v_mov_b32 v176, 0
    v_mov_b32 v177, 0
    v_mov_b32 v178, 0
    v_mov_b32 v179, 0
    v_mov_b32 v180, 0
    v_mov_b32 v181, 0
    v_mov_b32 v182, 0
    v_mov_b32 v183, 0
    v_mov_b32 v184, 0
    v_mov_b32 v185, 0
    v_mov_b32 v186, 0
    v_mov_b32 v187, 0
    v_mov_b32 v188, 0
    v_mov_b32 v189, 0
    v_mov_b32 v190, 0
    v_mov_b32 v191, 0
    v_mov_b32 v192, 0
    v_mov_b32 v193, 0
    v_mov_b32 v194, 0
    v_mov_b32 v195, 0
    v_mov_b32 v196, 0
    v_mov_b32 v197, 0
    v_mov_b32 v198, 0
    v_mov_b32 v199, 0
    v_mov_b32 v200, 0
    v_mov_b32 v201, 0
    v_mov_b32 v202, 0
    v_mov_b32 v203, 0
    v_mov_b32 v204, 0
    v_mov_b32 v205, 0
    v_mov_b32 v206, 0
    v_mov_b32 v207, 0
    v_mov_b32 v208, 0
    v_mov_b32 v209, 0
    v_mov_b32 v210, 0
    v_mov_b32 v211, 0
    v_mov_b32 v212, 0
    v_mov_b32 v213, 0
    v_mov_b32 v214, 0
    v_mov_b32 v215, 0
    v_mov_b32 v248, 0
    v_mov_b32 v249, 0
    v_mov_b32 v250, 0
    v_mov_b32 v251, 0
    v_mov_b32 v252, 0
    v_mov_b32 v253, 0
    v_mov_b32 v254, 0
    v_mov_b32 v255, 0
    s_lshl_b32 s37, s35, 2
    s_add_u32 s37, s37, s24
main_kernel_nf_159:
    s_cmp_lt_u32 s27, s37
    s_cbranch_scc1 main_kernel_i_158
    s_sub_u32 s33, s37, s27
    s_lshl_b32 s33, s33, 5
    v_add_u32 v12, s33, v6
    v_mov_b32 v13, 4286578688
    v_cmp_gt_i32 s[44:45], 0, v12
    v_cmp_gt_i32 s[46:47], 1, v12
    v_cmp_gt_i32 s[48:49], 2, v12
    v_cmp_gt_i32 s[50:51], 3, v12
    v_cndmask_b32 v72, v72, v13, s[44:45]
    v_cndmask_b32 v73, v73, v13, s[46:47]
    v_cndmask_b32 v74, v74, v13, s[48:49]
    v_cndmask_b32 v75, v75, v13, s[50:51]
    v_cmp_gt_i32 s[44:45], -16, v12
    v_cmp_gt_i32 s[46:47], -15, v12
    v_cmp_gt_i32 s[48:49], -14, v12
    v_cmp_gt_i32 s[50:51], -13, v12
    v_cndmask_b32 v76, v76, v13, s[44:45]
    v_cndmask_b32 v77, v77, v13, s[46:47]
    v_cndmask_b32 v78, v78, v13, s[48:49]
    v_cndmask_b32 v79, v79, v13, s[50:51]
    v_cmp_gt_i32 s[44:45], 16, v12
    v_cmp_gt_i32 s[46:47], 17, v12
    v_cmp_gt_i32 s[48:49], 18, v12
    v_cmp_gt_i32 s[50:51], 19, v12
    v_cndmask_b32 v80, v80, v13, s[44:45]
    v_cndmask_b32 v81, v81, v13, s[46:47]
    v_cndmask_b32 v82, v82, v13, s[48:49]
    v_cndmask_b32 v83, v83, v13, s[50:51]
    v_cmp_gt_i32 s[44:45], 0, v12
    v_cmp_gt_i32 s[46:47], 1, v12
    v_cmp_gt_i32 s[48:49], 2, v12
    v_cmp_gt_i32 s[50:51], 3, v12
    v_cndmask_b32 v84, v84, v13, s[44:45]
    v_cndmask_b32 v85, v85, v13, s[46:47]
    v_cndmask_b32 v86, v86, v13, s[48:49]
    v_cndmask_b32 v87, v87, v13, s[50:51]
main_kernel_i_158:
    s_cmp_eq_u32 s41, 0
    s_cbranch_scc1 main_kernel_exp_91
    v_max3_f32 v12, v72, v73, v74
    v_max3_f32 v12, v12, v75, v80
    v_max3_f32 v12, v12, v81, v82
    v_max_f32 v12, v12, v83
    v_max3_f32 v13, v76, v77, v78
    v_max3_f32 v13, v13, v79, v84
    v_max3_f32 v13, v13, v85, v86
    v_max_f32 v13, v13, v87
    v_mov_b32 v14, v12
    v_mov_b32 v15, v13
    s_nop 0
    v_permlane16_swap_b32 v12, v14
    v_permlane16_swap_b32 v13, v15
    v_max_f32 v12, v12, v14
    v_max_f32 v13, v13, v15
    v_mov_b32 v14, v12
    v_mov_b32 v15, v13
    s_nop 0
    v_permlane32_swap_b32 v12, v14
    v_permlane32_swap_b32 v13, v15
    v_max_f32 v12, v12, v14
    v_max_f32 v13, v13, v15
    v_max_f32 v12, 0xf149f2ca, v12
    v_add_f32 v12, 1092616192, v12
    v_sub_f32 v32, 0, v12
    v_sub_f32 v33, 0, v12
    v_sub_f32 v34, 0, v12
    v_sub_f32 v35, 0, v12
    v_sub_f32 v72, v72, v12
    v_sub_f32 v73, v73, v12
    v_sub_f32 v74, v74, v12
    v_sub_f32 v75, v75, v12
    v_sub_f32 v80, v80, v12
    v_sub_f32 v81, v81, v12
    v_sub_f32 v82, v82, v12
    v_sub_f32 v83, v83, v12
    v_max_f32 v13, 0xf149f2ca, v13
    v_add_f32 v13, 1092616192, v13
    v_sub_f32 v36, 0, v13
    v_sub_f32 v37, 0, v13
    v_sub_f32 v38, 0, v13
    v_sub_f32 v39, 0, v13
    v_sub_f32 v76, v76, v13
    v_sub_f32 v77, v77, v13
    v_sub_f32 v78, v78, v13
    v_sub_f32 v79, v79, v13
    v_sub_f32 v84, v84, v13
    v_sub_f32 v85, v85, v13
    v_sub_f32 v86, v86, v13
    v_sub_f32 v87, v87, v13
    s_mov_b32 s41, 0
    s_mov_b32 s38, s37
    s_branch main_kernel_exp_91
main_kernel_rare_92:
    v_max3_f32 v12, v72, v73, v74
    v_max3_f32 v12, v12, v75, v80
    v_max3_f32 v12, v12, v81, v82
    v_max_f32 v12, v12, v83
    v_max3_f32 v13, v76, v77, v78
    v_max3_f32 v13, v13, v79, v84
    v_max3_f32 v13, v13, v85, v86
    v_max_f32 v13, v13, v87
    v_mov_b32 v14, v12
    v_mov_b32 v15, v13
    s_nop 0
    v_permlane16_swap_b32 v12, v14
    v_permlane16_swap_b32 v13, v15
    v_max_f32 v12, v12, v14
    v_max_f32 v13, v13, v15
    v_mov_b32 v14, v12
    v_mov_b32 v15, v13
    s_nop 0
    v_permlane32_swap_b32 v12, v14
    v_permlane32_swap_b32 v13, v15
    v_max_f32 v12, v12, v14
    v_max_f32 v13, v13, v15
    v_add_f32 v12, 1092616192, v12
    v_max_f32 v12, 0, v12
    v_sub_f32 v14, 0, v12
    v_exp_f32 v14, v14
    v_sub_f32 v72, v72, v12
    v_sub_f32 v73, v73, v12
    v_sub_f32 v74, v74, v12
    v_sub_f32 v75, v75, v12
    v_sub_f32 v80, v80, v12
    v_sub_f32 v81, v81, v12
    v_sub_f32 v82, v82, v12
    v_sub_f32 v83, v83, v12
    v_sub_f32 v32, v32, v12
    v_sub_f32 v33, v33, v12
    v_sub_f32 v34, v34, v12
    v_sub_f32 v35, v35, v12
    v_mul_f32 v248, v248, v14
    v_mul_f32 v249, v249, v14
    v_mul_f32 v250, v250, v14
    v_mul_f32 v251, v251, v14
    v_mul_f32 v152, v152, v14
    v_mul_f32 v153, v153, v14
    v_mul_f32 v154, v154, v14
    v_mul_f32 v155, v155, v14
    v_mul_f32 v160, v160, v14
    v_mul_f32 v161, v161, v14
    v_mul_f32 v162, v162, v14
    v_mul_f32 v163, v163, v14
    v_mul_f32 v168, v168, v14
    v_mul_f32 v169, v169, v14
    v_mul_f32 v170, v170, v14
    v_mul_f32 v171, v171, v14
    v_mul_f32 v176, v176, v14
    v_mul_f32 v177, v177, v14
    v_mul_f32 v178, v178, v14
    v_mul_f32 v179, v179, v14
    v_mul_f32 v184, v184, v14
    v_mul_f32 v185, v185, v14
    v_mul_f32 v186, v186, v14
    v_mul_f32 v187, v187, v14
    v_mul_f32 v192, v192, v14
    v_mul_f32 v193, v193, v14
    v_mul_f32 v194, v194, v14
    v_mul_f32 v195, v195, v14
    v_mul_f32 v200, v200, v14
    v_mul_f32 v201, v201, v14
    v_mul_f32 v202, v202, v14
    v_mul_f32 v203, v203, v14
    v_mul_f32 v208, v208, v14
    v_mul_f32 v209, v209, v14
    v_mul_f32 v210, v210, v14
    v_mul_f32 v211, v211, v14
    v_add_f32 v13, 1092616192, v13
    v_max_f32 v13, 0, v13
    v_sub_f32 v15, 0, v13
    v_exp_f32 v15, v15
    v_sub_f32 v76, v76, v13
    v_sub_f32 v77, v77, v13
    v_sub_f32 v78, v78, v13
    v_sub_f32 v79, v79, v13
    v_sub_f32 v84, v84, v13
    v_sub_f32 v85, v85, v13
    v_sub_f32 v86, v86, v13
    v_sub_f32 v87, v87, v13
    v_sub_f32 v36, v36, v13
    v_sub_f32 v37, v37, v13
    v_sub_f32 v38, v38, v13
    v_sub_f32 v39, v39, v13
    v_mul_f32 v252, v252, v15
    v_mul_f32 v253, v253, v15
    v_mul_f32 v254, v254, v15
    v_mul_f32 v255, v255, v15
    v_mul_f32 v156, v156, v15
    v_mul_f32 v157, v157, v15
    v_mul_f32 v158, v158, v15
    v_mul_f32 v159, v159, v15
    v_mul_f32 v164, v164, v15
    v_mul_f32 v165, v165, v15
    v_mul_f32 v166, v166, v15
    v_mul_f32 v167, v167, v15
    v_mul_f32 v172, v172, v15
    v_mul_f32 v173, v173, v15
    v_mul_f32 v174, v174, v15
    v_mul_f32 v175, v175, v15
    v_mul_f32 v180, v180, v15
    v_mul_f32 v181, v181, v15
    v_mul_f32 v182, v182, v15
    v_mul_f32 v183, v183, v15
    v_mul_f32 v188, v188, v15
    v_mul_f32 v189, v189, v15
    v_mul_f32 v190, v190, v15
    v_mul_f32 v191, v191, v15
    v_mul_f32 v196, v196, v15
    v_mul_f32 v197, v197, v15
    v_mul_f32 v198, v198, v15
    v_mul_f32 v199, v199, v15
    v_mul_f32 v204, v204, v15
    v_mul_f32 v205, v205, v15
    v_mul_f32 v206, v206, v15
    v_mul_f32 v207, v207, v15
    v_mul_f32 v212, v212, v15
    v_mul_f32 v213, v213, v15
    v_mul_f32 v214, v214, v15
    v_mul_f32 v215, v215, v15
    v_exp_f32 v16, v72
    v_exp_f32 v17, v73
    v_exp_f32 v18, v76
    v_exp_f32 v19, v77
    v_cvt_pk_bf16_f32 v88, v16, v17
    v_cvt_pk_bf16_f32 v92, v18, v19
    v_exp_f32 v20, v74
    v_exp_f32 v21, v75
    v_exp_f32 v22, v78
    v_exp_f32 v23, v79
    v_cvt_pk_bf16_f32 v89, v20, v21
    v_cvt_pk_bf16_f32 v93, v22, v23
    v_exp_f32 v16, v80
    v_exp_f32 v17, v81
    v_exp_f32 v18, v84
    v_exp_f32 v19, v85
    v_cvt_pk_bf16_f32 v90, v16, v17
    v_cvt_pk_bf16_f32 v94, v18, v19
    v_exp_f32 v20, v82
    v_exp_f32 v21, v83
    v_exp_f32 v22, v86
    v_exp_f32 v23, v87
    v_cvt_pk_bf16_f32 v91, v20, v21
    v_cvt_pk_bf16_f32 v95, v22, v23
    v_or3_b32 v8, v88, v92, v89
    v_or3_b32 v9, v93, v90, v94
    v_or3_b32 v8, v8, v91, v95
    v_or_b32 v8, v8, v9
    s_branch main_kernel_chk_93
main_kernel_sq_94:
    ds_read_b128 v[128:131], v5 offset:0
    ds_read_b128 v[132:135], v5 offset:1024
    ds_read_b128 v[136:139], v5 offset:2048
    ds_read_b128 v[140:143], v5 offset:3072
    s_waitcnt lgkmcnt(9)
    s_nop 0
    ds_read_b128 v[96:99], v5 offset:4096
    s_waitcnt lgkmcnt(9)
    s_nop 0
    ds_read_b128 v[100:103], v5 offset:5120
    s_branch main_kernel_pv_95
main_kernel_sp_96:
    s_waitcnt vmcnt(4) lgkmcnt(0)
    s_barrier
    s_branch main_kernel_me_97
main_kernel_spec_98:
    s_cmp_lg_u32 s41, 2
    s_cbranch_scc1 main_kernel_nf_161
    v_rcp_f32 v12, v248
    s_nop 1
    v_rcp_f32 v13, v252
    v_mul_f32 v152, v152, v12
    v_mul_f32 v153, v153, v12
    v_mul_f32 v154, v154, v12
    v_mul_f32 v155, v155, v12
    v_cvt_pk_bf16_f32 v216, v152, v153
    v_cvt_pk_bf16_f32 v217, v154, v155
    v_mul_f32 v160, v160, v12
    v_mul_f32 v161, v161, v12
    v_mul_f32 v162, v162, v12
    v_mul_f32 v163, v163, v12
    v_cvt_pk_bf16_f32 v218, v160, v161
    v_cvt_pk_bf16_f32 v219, v162, v163
    v_mul_f32 v168, v168, v12
    v_mul_f32 v169, v169, v12
    v_mul_f32 v170, v170, v12
    v_mul_f32 v171, v171, v12
    v_cvt_pk_bf16_f32 v220, v168, v169
    v_cvt_pk_bf16_f32 v221, v170, v171
    v_mul_f32 v176, v176, v12
    v_mul_f32 v177, v177, v12
    v_mul_f32 v178, v178, v12
    v_mul_f32 v179, v179, v12
    v_cvt_pk_bf16_f32 v222, v176, v177
    v_cvt_pk_bf16_f32 v223, v178, v179
    v_mul_f32 v184, v184, v12
    v_mul_f32 v185, v185, v12
    v_mul_f32 v186, v186, v12
    v_mul_f32 v187, v187, v12
    v_cvt_pk_bf16_f32 v224, v184, v185
    v_cvt_pk_bf16_f32 v225, v186, v187
    v_mul_f32 v192, v192, v12
    v_mul_f32 v193, v193, v12
    v_mul_f32 v194, v194, v12
    v_mul_f32 v195, v195, v12
    v_cvt_pk_bf16_f32 v226, v192, v193
    v_cvt_pk_bf16_f32 v227, v194, v195
    v_mul_f32 v200, v200, v12
    v_mul_f32 v201, v201, v12
    v_mul_f32 v202, v202, v12
    v_mul_f32 v203, v203, v12
    v_cvt_pk_bf16_f32 v228, v200, v201
    v_cvt_pk_bf16_f32 v229, v202, v203
    v_mul_f32 v208, v208, v12
    v_mul_f32 v209, v209, v12
    v_mul_f32 v210, v210, v12
    v_mul_f32 v211, v211, v12
    v_cvt_pk_bf16_f32 v230, v208, v209
    v_cvt_pk_bf16_f32 v231, v210, v211
    v_mul_f32 v156, v156, v13
    v_mul_f32 v157, v157, v13
    v_mul_f32 v158, v158, v13
    v_mul_f32 v159, v159, v13
    v_cvt_pk_bf16_f32 v232, v156, v157
    v_cvt_pk_bf16_f32 v233, v158, v159
    v_mul_f32 v164, v164, v13
    v_mul_f32 v165, v165, v13
    v_mul_f32 v166, v166, v13
    v_mul_f32 v167, v167, v13
    v_cvt_pk_bf16_f32 v234, v164, v165
    v_cvt_pk_bf16_f32 v235, v166, v167
    v_mul_f32 v172, v172, v13
    v_mul_f32 v173, v173, v13
    v_mul_f32 v174, v174, v13
    v_mul_f32 v175, v175, v13
    v_cvt_pk_bf16_f32 v236, v172, v173
    v_cvt_pk_bf16_f32 v237, v174, v175
    v_mul_f32 v180, v180, v13
    v_mul_f32 v181, v181, v13
    v_mul_f32 v182, v182, v13
    v_mul_f32 v183, v183, v13
    v_cvt_pk_bf16_f32 v238, v180, v181
    v_cvt_pk_bf16_f32 v239, v182, v183
    v_mul_f32 v188, v188, v13
    v_mul_f32 v189, v189, v13
    v_mul_f32 v190, v190, v13
    v_mul_f32 v191, v191, v13
    v_cvt_pk_bf16_f32 v240, v188, v189
    v_cvt_pk_bf16_f32 v241, v190, v191
    v_mul_f32 v196, v196, v13
    v_mul_f32 v197, v197, v13
    v_mul_f32 v198, v198, v13
    v_mul_f32 v199, v199, v13
    v_cvt_pk_bf16_f32 v242, v196, v197
    v_cvt_pk_bf16_f32 v243, v198, v199
    v_mul_f32 v204, v204, v13
    v_mul_f32 v205, v205, v13
    v_mul_f32 v206, v206, v13
    v_mul_f32 v207, v207, v13
    v_cvt_pk_bf16_f32 v244, v204, v205
    v_cvt_pk_bf16_f32 v245, v206, v207
    v_mul_f32 v212, v212, v13
    v_mul_f32 v213, v213, v13
    v_mul_f32 v214, v214, v13
    v_mul_f32 v215, v215, v13
    v_cvt_pk_bf16_f32 v246, v212, v213
    v_cvt_pk_bf16_f32 v247, v214, v215
    s_lshl_b32 s33, s37, 6
    s_add_u32 s33, s33, s21
    s_lshl_b32 s33, s33, 12
    s_add_u32 s33, s33, 50331648
    s_add_u32 s34, s33, 0x20000
    buffer_store_dwordx4 v[216:219], v7, s[8:11], s33 offen offset:0 sc1
    buffer_store_dwordx4 v[220:223], v7, s[8:11], s33 offen offset:1024 sc1
    buffer_store_dwordx4 v[224:227], v7, s[8:11], s33 offen offset:2048 sc1
    buffer_store_dwordx4 v[228:231], v7, s[8:11], s33 offen offset:3072 sc1
    buffer_store_dwordx4 v[232:235], v7, s[8:11], s34 offen offset:0 sc1
    buffer_store_dwordx4 v[236:239], v7, s[8:11], s34 offen offset:1024 sc1
    buffer_store_dwordx4 v[240:243], v7, s[8:11], s34 offen offset:2048 sc1
    buffer_store_dwordx4 v[244:247], v7, s[8:11], s34 offen offset:3072 sc1
    v_mov_b32 v152, 0
    v_mov_b32 v153, 0
    v_mov_b32 v154, 0
    v_mov_b32 v155, 0
    v_mov_b32 v156, 0
    v_mov_b32 v157, 0
    v_mov_b32 v158, 0
    v_mov_b32 v159, 0
    v_mov_b32 v160, 0
    v_mov_b32 v161, 0
    v_mov_b32 v162, 0
    v_mov_b32 v163, 0
    v_mov_b32 v164, 0
    v_mov_b32 v165, 0
    v_mov_b32 v166, 0
    v_mov_b32 v167, 0
    v_mov_b32 v168, 0
    v_mov_b32 v169, 0
    v_mov_b32 v170, 0
    v_mov_b32 v171, 0
    v_mov_b32 v172, 0
    v_mov_b32 v173, 0
    v_mov_b32 v174, 0
    v_mov_b32 v175, 0
    v_mov_b32 v176, 0
    v_mov_b32 v177, 0
    v_mov_b32 v178, 0
    v_mov_b32 v179, 0
    v_mov_b32 v180, 0
    v_mov_b32 v181, 0
    v_mov_b32 v182, 0
    v_mov_b32 v183, 0
    v_mov_b32 v184, 0
    v_mov_b32 v185, 0
    v_mov_b32 v186, 0
    v_mov_b32 v187, 0
    v_mov_b32 v188, 0
    v_mov_b32 v189, 0
    v_mov_b32 v190, 0
    v_mov_b32 v191, 0
    v_mov_b32 v192, 0
    v_mov_b32 v193, 0
    v_mov_b32 v194, 0
    v_mov_b32 v195, 0
    v_mov_b32 v196, 0
    v_mov_b32 v197, 0
    v_mov_b32 v198, 0
    v_mov_b32 v199, 0
    v_mov_b32 v200, 0
    v_mov_b32 v201, 0
    v_mov_b32 v202, 0
    v_mov_b32 v203, 0
    v_mov_b32 v204, 0
    v_mov_b32 v205, 0
    v_mov_b32 v206, 0
    v_mov_b32 v207, 0
    v_mov_b32 v208, 0
    v_mov_b32 v209, 0
    v_mov_b32 v210, 0
    v_mov_b32 v211, 0
    v_mov_b32 v212, 0
    v_mov_b32 v213, 0
    v_mov_b32 v214, 0
    v_mov_b32 v215, 0
    v_mov_b32 v248, 0
    v_mov_b32 v249, 0
    v_mov_b32 v250, 0
    v_mov_b32 v251, 0
    v_mov_b32 v252, 0
    v_mov_b32 v253, 0
    v_mov_b32 v254, 0
    v_mov_b32 v255, 0
    s_lshl_b32 s37, s35, 2
    s_add_u32 s37, s37, s24
main_kernel_nf_161:
    s_cmp_lt_u32 s27, s37
    s_cbranch_scc1 main_kernel_i_160
    s_sub_u32 s33, s37, s27
    s_lshl_b32 s33, s33, 5
    v_add_u32 v12, s33, v6
    v_mov_b32 v13, 4286578688
    v_cmp_gt_i32 s[44:45], 0, v12
    v_cmp_gt_i32 s[46:47], 1, v12
    v_cmp_gt_i32 s[48:49], 2, v12
    v_cmp_gt_i32 s[50:51], 3, v12
    v_cndmask_b32 v72, v72, v13, s[44:45]
    v_cndmask_b32 v73, v73, v13, s[46:47]
    v_cndmask_b32 v74, v74, v13, s[48:49]
    v_cndmask_b32 v75, v75, v13, s[50:51]
    v_cmp_gt_i32 s[44:45], -16, v12
    v_cmp_gt_i32 s[46:47], -15, v12
    v_cmp_gt_i32 s[48:49], -14, v12
    v_cmp_gt_i32 s[50:51], -13, v12
    v_cndmask_b32 v76, v76, v13, s[44:45]
    v_cndmask_b32 v77, v77, v13, s[46:47]
    v_cndmask_b32 v78, v78, v13, s[48:49]
    v_cndmask_b32 v79, v79, v13, s[50:51]
    v_cmp_gt_i32 s[44:45], 16, v12
    v_cmp_gt_i32 s[46:47], 17, v12
    v_cmp_gt_i32 s[48:49], 18, v12
    v_cmp_gt_i32 s[50:51], 19, v12
    v_cndmask_b32 v80, v80, v13, s[44:45]
    v_cndmask_b32 v81, v81, v13, s[46:47]
    v_cndmask_b32 v82, v82, v13, s[48:49]
    v_cndmask_b32 v83, v83, v13, s[50:51]
    v_cmp_gt_i32 s[44:45], 0, v12
    v_cmp_gt_i32 s[46:47], 1, v12
    v_cmp_gt_i32 s[48:49], 2, v12
    v_cmp_gt_i32 s[50:51], 3, v12
    v_cndmask_b32 v84, v84, v13, s[44:45]
    v_cndmask_b32 v85, v85, v13, s[46:47]
    v_cndmask_b32 v86, v86, v13, s[48:49]
    v_cndmask_b32 v87, v87, v13, s[50:51]
main_kernel_i_160:
    s_cmp_eq_u32 s41, 0
    s_cbranch_scc1 main_kernel_exp_99
    v_max3_f32 v12, v72, v73, v74
    v_max3_f32 v12, v12, v75, v80
    v_max3_f32 v12, v12, v81, v82
    v_max_f32 v12, v12, v83
    v_max3_f32 v13, v76, v77, v78
    v_max3_f32 v13, v13, v79, v84
    v_max3_f32 v13, v13, v85, v86
    v_max_f32 v13, v13, v87
    v_mov_b32 v14, v12
    v_mov_b32 v15, v13
    s_nop 0
    v_permlane16_swap_b32 v12, v14
    v_permlane16_swap_b32 v13, v15
    v_max_f32 v12, v12, v14
    v_max_f32 v13, v13, v15
    v_mov_b32 v14, v12
    v_mov_b32 v15, v13
    s_nop 0
    v_permlane32_swap_b32 v12, v14
    v_permlane32_swap_b32 v13, v15
    v_max_f32 v12, v12, v14
    v_max_f32 v13, v13, v15
    v_max_f32 v12, 0xf149f2ca, v12
    v_add_f32 v12, 1092616192, v12
    v_sub_f32 v32, 0, v12
    v_sub_f32 v33, 0, v12
    v_sub_f32 v34, 0, v12
    v_sub_f32 v35, 0, v12
    v_sub_f32 v72, v72, v12
    v_sub_f32 v73, v73, v12
    v_sub_f32 v74, v74, v12
    v_sub_f32 v75, v75, v12
    v_sub_f32 v80, v80, v12
    v_sub_f32 v81, v81, v12
    v_sub_f32 v82, v82, v12
    v_sub_f32 v83, v83, v12
    v_max_f32 v13, 0xf149f2ca, v13
    v_add_f32 v13, 1092616192, v13
    v_sub_f32 v36, 0, v13
    v_sub_f32 v37, 0, v13
    v_sub_f32 v38, 0, v13
    v_sub_f32 v39, 0, v13
    v_sub_f32 v76, v76, v13
    v_sub_f32 v77, v77, v13
    v_sub_f32 v78, v78, v13
    v_sub_f32 v79, v79, v13
    v_sub_f32 v84, v84, v13
    v_sub_f32 v85, v85, v13
    v_sub_f32 v86, v86, v13
    v_sub_f32 v87, v87, v13
    s_mov_b32 s41, 0
    s_mov_b32 s38, s37
    s_branch main_kernel_exp_99
main_kernel_rare_100:
    v_max3_f32 v12, v72, v73, v74
    v_max3_f32 v12, v12, v75, v80
    v_max3_f32 v12, v12, v81, v82
    v_max_f32 v12, v12, v83
    v_max3_f32 v13, v76, v77, v78
    v_max3_f32 v13, v13, v79, v84
    v_max3_f32 v13, v13, v85, v86
    v_max_f32 v13, v13, v87
    v_mov_b32 v14, v12
    v_mov_b32 v15, v13
    s_nop 0
    v_permlane16_swap_b32 v12, v14
    v_permlane16_swap_b32 v13, v15
    v_max_f32 v12, v12, v14
    v_max_f32 v13, v13, v15
    v_mov_b32 v14, v12
    v_mov_b32 v15, v13
    s_nop 0
    v_permlane32_swap_b32 v12, v14
    v_permlane32_swap_b32 v13, v15
    v_max_f32 v12, v12, v14
    v_max_f32 v13, v13, v15
    v_add_f32 v12, 1092616192, v12
    v_max_f32 v12, 0, v12
    v_sub_f32 v14, 0, v12
    v_exp_f32 v14, v14
    v_sub_f32 v72, v72, v12
    v_sub_f32 v73, v73, v12
    v_sub_f32 v74, v74, v12
    v_sub_f32 v75, v75, v12
    v_sub_f32 v80, v80, v12
    v_sub_f32 v81, v81, v12
    v_sub_f32 v82, v82, v12
    v_sub_f32 v83, v83, v12
    v_sub_f32 v32, v32, v12
    v_sub_f32 v33, v33, v12
    v_sub_f32 v34, v34, v12
    v_sub_f32 v35, v35, v12
    v_mul_f32 v248, v248, v14
    v_mul_f32 v249, v249, v14
    v_mul_f32 v250, v250, v14
    v_mul_f32 v251, v251, v14
    v_mul_f32 v152, v152, v14
    v_mul_f32 v153, v153, v14
    v_mul_f32 v154, v154, v14
    v_mul_f32 v155, v155, v14
    v_mul_f32 v160, v160, v14
    v_mul_f32 v161, v161, v14
    v_mul_f32 v162, v162, v14
    v_mul_f32 v163, v163, v14
    v_mul_f32 v168, v168, v14
    v_mul_f32 v169, v169, v14
    v_mul_f32 v170, v170, v14
    v_mul_f32 v171, v171, v14
    v_mul_f32 v176, v176, v14
    v_mul_f32 v177, v177, v14
    v_mul_f32 v178, v178, v14
    v_mul_f32 v179, v179, v14
    v_mul_f32 v184, v184, v14
    v_mul_f32 v185, v185, v14
    v_mul_f32 v186, v186, v14
    v_mul_f32 v187, v187, v14
    v_mul_f32 v192, v192, v14
    v_mul_f32 v193, v193, v14
    v_mul_f32 v194, v194, v14
    v_mul_f32 v195, v195, v14
    v_mul_f32 v200, v200, v14
    v_mul_f32 v201, v201, v14
    v_mul_f32 v202, v202, v14
    v_mul_f32 v203, v203, v14
    v_mul_f32 v208, v208, v14
    v_mul_f32 v209, v209, v14
    v_mul_f32 v210, v210, v14
    v_mul_f32 v211, v211, v14
    v_add_f32 v13, 1092616192, v13
    v_max_f32 v13, 0, v13
    v_sub_f32 v15, 0, v13
    v_exp_f32 v15, v15
    v_sub_f32 v76, v76, v13
    v_sub_f32 v77, v77, v13
    v_sub_f32 v78, v78, v13
    v_sub_f32 v79, v79, v13
    v_sub_f32 v84, v84, v13
    v_sub_f32 v85, v85, v13
    v_sub_f32 v86, v86, v13
    v_sub_f32 v87, v87, v13
    v_sub_f32 v36, v36, v13
    v_sub_f32 v37, v37, v13
    v_sub_f32 v38, v38, v13
    v_sub_f32 v39, v39, v13
    v_mul_f32 v252, v252, v15
    v_mul_f32 v253, v253, v15
    v_mul_f32 v254, v254, v15
    v_mul_f32 v255, v255, v15
    v_mul_f32 v156, v156, v15
    v_mul_f32 v157, v157, v15
    v_mul_f32 v158, v158, v15
    v_mul_f32 v159, v159, v15
    v_mul_f32 v164, v164, v15
    v_mul_f32 v165, v165, v15
    v_mul_f32 v166, v166, v15
    v_mul_f32 v167, v167, v15
    v_mul_f32 v172, v172, v15
    v_mul_f32 v173, v173, v15
    v_mul_f32 v174, v174, v15
    v_mul_f32 v175, v175, v15
    v_mul_f32 v180, v180, v15
    v_mul_f32 v181, v181, v15
    v_mul_f32 v182, v182, v15
    v_mul_f32 v183, v183, v15
    v_mul_f32 v188, v188, v15
    v_mul_f32 v189, v189, v15
    v_mul_f32 v190, v190, v15
    v_mul_f32 v191, v191, v15
    v_mul_f32 v196, v196, v15
    v_mul_f32 v197, v197, v15
    v_mul_f32 v198, v198, v15
    v_mul_f32 v199, v199, v15
    v_mul_f32 v204, v204, v15
    v_mul_f32 v205, v205, v15
    v_mul_f32 v206, v206, v15
    v_mul_f32 v207, v207, v15
    v_mul_f32 v212, v212, v15
    v_mul_f32 v213, v213, v15
    v_mul_f32 v214, v214, v15
    v_mul_f32 v215, v215, v15
    v_exp_f32 v16, v72
    v_exp_f32 v17, v73
    v_exp_f32 v18, v76
    v_exp_f32 v19, v77
    v_cvt_pk_bf16_f32 v88, v16, v17
    v_cvt_pk_bf16_f32 v92, v18, v19
    v_exp_f32 v20, v74
    v_exp_f32 v21, v75
    v_exp_f32 v22, v78
    v_exp_f32 v23, v79
    v_cvt_pk_bf16_f32 v89, v20, v21
    v_cvt_pk_bf16_f32 v93, v22, v23
    v_exp_f32 v16, v80
    v_exp_f32 v17, v81
    v_exp_f32 v18, v84
    v_exp_f32 v19, v85
    v_cvt_pk_bf16_f32 v90, v16, v17
    v_cvt_pk_bf16_f32 v94, v18, v19
    v_exp_f32 v20, v82
    v_exp_f32 v21, v83
    v_exp_f32 v22, v86
    v_exp_f32 v23, v87
    v_cvt_pk_bf16_f32 v91, v20, v21
    v_cvt_pk_bf16_f32 v95, v22, v23
    v_or3_b32 v8, v88, v92, v89
    v_or3_b32 v9, v93, v90, v94
    v_or3_b32 v8, v8, v91, v95
    v_or_b32 v8, v8, v9
    s_branch main_kernel_chk_101
main_kernel_sq_102:
    ds_read_b128 v[128:131], v5 offset:8192
    ds_read_b128 v[132:135], v5 offset:9216
    ds_read_b128 v[136:139], v5 offset:10240
    ds_read_b128 v[140:143], v5 offset:11264
    s_waitcnt lgkmcnt(9)
    s_nop 0
    ds_read_b128 v[96:99], v5 offset:12288
    s_waitcnt lgkmcnt(9)
    s_nop 0
    ds_read_b128 v[100:103], v5 offset:13312
    s_branch main_kernel_pv_103
main_kernel_sp_104:
    s_waitcnt vmcnt(4) lgkmcnt(0)
    s_barrier
    s_branch main_kernel_me_105
main_kernel_spec_106:
    s_cmp_lg_u32 s41, 2
    s_cbranch_scc1 main_kernel_nf_163
    v_rcp_f32 v12, v248
    s_nop 1
    v_rcp_f32 v13, v252
    v_mul_f32 v152, v152, v12
    v_mul_f32 v153, v153, v12
    v_mul_f32 v154, v154, v12
    v_mul_f32 v155, v155, v12
    v_cvt_pk_bf16_f32 v216, v152, v153
    v_cvt_pk_bf16_f32 v217, v154, v155
    v_mul_f32 v160, v160, v12
    v_mul_f32 v161, v161, v12
    v_mul_f32 v162, v162, v12
    v_mul_f32 v163, v163, v12
    v_cvt_pk_bf16_f32 v218, v160, v161
    v_cvt_pk_bf16_f32 v219, v162, v163
    v_mul_f32 v168, v168, v12
    v_mul_f32 v169, v169, v12
    v_mul_f32 v170, v170, v12
    v_mul_f32 v171, v171, v12
    v_cvt_pk_bf16_f32 v220, v168, v169
    v_cvt_pk_bf16_f32 v221, v170, v171
    v_mul_f32 v176, v176, v12
    v_mul_f32 v177, v177, v12
    v_mul_f32 v178, v178, v12
    v_mul_f32 v179, v179, v12
    v_cvt_pk_bf16_f32 v222, v176, v177
    v_cvt_pk_bf16_f32 v223, v178, v179
    v_mul_f32 v184, v184, v12
    v_mul_f32 v185, v185, v12
    v_mul_f32 v186, v186, v12
    v_mul_f32 v187, v187, v12
    v_cvt_pk_bf16_f32 v224, v184, v185
    v_cvt_pk_bf16_f32 v225, v186, v187
    v_mul_f32 v192, v192, v12
    v_mul_f32 v193, v193, v12
    v_mul_f32 v194, v194, v12
    v_mul_f32 v195, v195, v12
    v_cvt_pk_bf16_f32 v226, v192, v193
    v_cvt_pk_bf16_f32 v227, v194, v195
    v_mul_f32 v200, v200, v12
    v_mul_f32 v201, v201, v12
    v_mul_f32 v202, v202, v12
    v_mul_f32 v203, v203, v12
    v_cvt_pk_bf16_f32 v228, v200, v201
    v_cvt_pk_bf16_f32 v229, v202, v203
    v_mul_f32 v208, v208, v12
    v_mul_f32 v209, v209, v12
    v_mul_f32 v210, v210, v12
    v_mul_f32 v211, v211, v12
    v_cvt_pk_bf16_f32 v230, v208, v209
    v_cvt_pk_bf16_f32 v231, v210, v211
    v_mul_f32 v156, v156, v13
    v_mul_f32 v157, v157, v13
    v_mul_f32 v158, v158, v13
    v_mul_f32 v159, v159, v13
    v_cvt_pk_bf16_f32 v232, v156, v157
    v_cvt_pk_bf16_f32 v233, v158, v159
    v_mul_f32 v164, v164, v13
    v_mul_f32 v165, v165, v13
    v_mul_f32 v166, v166, v13
    v_mul_f32 v167, v167, v13
    v_cvt_pk_bf16_f32 v234, v164, v165
    v_cvt_pk_bf16_f32 v235, v166, v167
    v_mul_f32 v172, v172, v13
    v_mul_f32 v173, v173, v13
    v_mul_f32 v174, v174, v13
    v_mul_f32 v175, v175, v13
    v_cvt_pk_bf16_f32 v236, v172, v173
    v_cvt_pk_bf16_f32 v237, v174, v175
    v_mul_f32 v180, v180, v13
    v_mul_f32 v181, v181, v13
    v_mul_f32 v182, v182, v13
    v_mul_f32 v183, v183, v13
    v_cvt_pk_bf16_f32 v238, v180, v181
    v_cvt_pk_bf16_f32 v239, v182, v183
    v_mul_f32 v188, v188, v13
    v_mul_f32 v189, v189, v13
    v_mul_f32 v190, v190, v13
    v_mul_f32 v191, v191, v13
    v_cvt_pk_bf16_f32 v240, v188, v189
    v_cvt_pk_bf16_f32 v241, v190, v191
    v_mul_f32 v196, v196, v13
    v_mul_f32 v197, v197, v13
    v_mul_f32 v198, v198, v13
    v_mul_f32 v199, v199, v13
    v_cvt_pk_bf16_f32 v242, v196, v197
    v_cvt_pk_bf16_f32 v243, v198, v199
    v_mul_f32 v204, v204, v13
    v_mul_f32 v205, v205, v13
    v_mul_f32 v206, v206, v13
    v_mul_f32 v207, v207, v13
    v_cvt_pk_bf16_f32 v244, v204, v205
    v_cvt_pk_bf16_f32 v245, v206, v207
    v_mul_f32 v212, v212, v13
    v_mul_f32 v213, v213, v13
    v_mul_f32 v214, v214, v13
    v_mul_f32 v215, v215, v13
    v_cvt_pk_bf16_f32 v246, v212, v213
    v_cvt_pk_bf16_f32 v247, v214, v215
    s_lshl_b32 s33, s37, 6
    s_add_u32 s33, s33, s21
    s_lshl_b32 s33, s33, 12
    s_add_u32 s33, s33, 50331648
    s_add_u32 s34, s33, 0x20000
    buffer_store_dwordx4 v[216:219], v7, s[8:11], s33 offen offset:0 sc1
    buffer_store_dwordx4 v[220:223], v7, s[8:11], s33 offen offset:1024 sc1
    buffer_store_dwordx4 v[224:227], v7, s[8:11], s33 offen offset:2048 sc1
    buffer_store_dwordx4 v[228:231], v7, s[8:11], s33 offen offset:3072 sc1
    buffer_store_dwordx4 v[232:235], v7, s[8:11], s34 offen offset:0 sc1
    buffer_store_dwordx4 v[236:239], v7, s[8:11], s34 offen offset:1024 sc1
    buffer_store_dwordx4 v[240:243], v7, s[8:11], s34 offen offset:2048 sc1
    buffer_store_dwordx4 v[244:247], v7, s[8:11], s34 offen offset:3072 sc1
    v_mov_b32 v152, 0
    v_mov_b32 v153, 0
    v_mov_b32 v154, 0
    v_mov_b32 v155, 0
    v_mov_b32 v156, 0
    v_mov_b32 v157, 0
    v_mov_b32 v158, 0
    v_mov_b32 v159, 0
    v_mov_b32 v160, 0
    v_mov_b32 v161, 0
    v_mov_b32 v162, 0
    v_mov_b32 v163, 0
    v_mov_b32 v164, 0
    v_mov_b32 v165, 0
    v_mov_b32 v166, 0
    v_mov_b32 v167, 0
    v_mov_b32 v168, 0
    v_mov_b32 v169, 0
    v_mov_b32 v170, 0
    v_mov_b32 v171, 0
    v_mov_b32 v172, 0
    v_mov_b32 v173, 0
    v_mov_b32 v174, 0
    v_mov_b32 v175, 0
    v_mov_b32 v176, 0
    v_mov_b32 v177, 0
    v_mov_b32 v178, 0
    v_mov_b32 v179, 0
    v_mov_b32 v180, 0
    v_mov_b32 v181, 0
    v_mov_b32 v182, 0
    v_mov_b32 v183, 0
    v_mov_b32 v184, 0
    v_mov_b32 v185, 0
    v_mov_b32 v186, 0
    v_mov_b32 v187, 0
    v_mov_b32 v188, 0
    v_mov_b32 v189, 0
    v_mov_b32 v190, 0
    v_mov_b32 v191, 0
    v_mov_b32 v192, 0
    v_mov_b32 v193, 0
    v_mov_b32 v194, 0
    v_mov_b32 v195, 0
    v_mov_b32 v196, 0
    v_mov_b32 v197, 0
    v_mov_b32 v198, 0
    v_mov_b32 v199, 0
    v_mov_b32 v200, 0
    v_mov_b32 v201, 0
    v_mov_b32 v202, 0
    v_mov_b32 v203, 0
    v_mov_b32 v204, 0
    v_mov_b32 v205, 0
    v_mov_b32 v206, 0
    v_mov_b32 v207, 0
    v_mov_b32 v208, 0
    v_mov_b32 v209, 0
    v_mov_b32 v210, 0
    v_mov_b32 v211, 0
    v_mov_b32 v212, 0
    v_mov_b32 v213, 0
    v_mov_b32 v214, 0
    v_mov_b32 v215, 0
    v_mov_b32 v248, 0
    v_mov_b32 v249, 0
    v_mov_b32 v250, 0
    v_mov_b32 v251, 0
    v_mov_b32 v252, 0
    v_mov_b32 v253, 0
    v_mov_b32 v254, 0
    v_mov_b32 v255, 0
    s_lshl_b32 s37, s35, 2
    s_add_u32 s37, s37, s24
main_kernel_nf_163:
    s_cmp_lt_u32 s27, s37
    s_cbranch_scc1 main_kernel_i_162
    s_sub_u32 s33, s37, s27
    s_lshl_b32 s33, s33, 5
    v_add_u32 v12, s33, v6
    v_mov_b32 v13, 4286578688
    v_cmp_gt_i32 s[44:45], 0, v12
    v_cmp_gt_i32 s[46:47], 1, v12
    v_cmp_gt_i32 s[48:49], 2, v12
    v_cmp_gt_i32 s[50:51], 3, v12
    v_cndmask_b32 v72, v72, v13, s[44:45]
    v_cndmask_b32 v73, v73, v13, s[46:47]
    v_cndmask_b32 v74, v74, v13, s[48:49]
    v_cndmask_b32 v75, v75, v13, s[50:51]
    v_cmp_gt_i32 s[44:45], -16, v12
    v_cmp_gt_i32 s[46:47], -15, v12
    v_cmp_gt_i32 s[48:49], -14, v12
    v_cmp_gt_i32 s[50:51], -13, v12
    v_cndmask_b32 v76, v76, v13, s[44:45]
    v_cndmask_b32 v77, v77, v13, s[46:47]
    v_cndmask_b32 v78, v78, v13, s[48:49]
    v_cndmask_b32 v79, v79, v13, s[50:51]
    v_cmp_gt_i32 s[44:45], 16, v12
    v_cmp_gt_i32 s[46:47], 17, v12
    v_cmp_gt_i32 s[48:49], 18, v12
    v_cmp_gt_i32 s[50:51], 19, v12
    v_cndmask_b32 v80, v80, v13, s[44:45]
    v_cndmask_b32 v81, v81, v13, s[46:47]
    v_cndmask_b32 v82, v82, v13, s[48:49]
    v_cndmask_b32 v83, v83, v13, s[50:51]
    v_cmp_gt_i32 s[44:45], 0, v12
    v_cmp_gt_i32 s[46:47], 1, v12
    v_cmp_gt_i32 s[48:49], 2, v12
    v_cmp_gt_i32 s[50:51], 3, v12
    v_cndmask_b32 v84, v84, v13, s[44:45]
    v_cndmask_b32 v85, v85, v13, s[46:47]
    v_cndmask_b32 v86, v86, v13, s[48:49]
    v_cndmask_b32 v87, v87, v13, s[50:51]
main_kernel_i_162:
    s_cmp_eq_u32 s41, 0
    s_cbranch_scc1 main_kernel_exp_107
    v_max3_f32 v12, v72, v73, v74
    v_max3_f32 v12, v12, v75, v80
    v_max3_f32 v12, v12, v81, v82
    v_max_f32 v12, v12, v83
    v_max3_f32 v13, v76, v77, v78
    v_max3_f32 v13, v13, v79, v84
    v_max3_f32 v13, v13, v85, v86
    v_max_f32 v13, v13, v87
    v_mov_b32 v14, v12
    v_mov_b32 v15, v13
    s_nop 0
    v_permlane16_swap_b32 v12, v14
    v_permlane16_swap_b32 v13, v15
    v_max_f32 v12, v12, v14
    v_max_f32 v13, v13, v15
    v_mov_b32 v14, v12
    v_mov_b32 v15, v13
    s_nop 0
    v_permlane32_swap_b32 v12, v14
    v_permlane32_swap_b32 v13, v15
    v_max_f32 v12, v12, v14
    v_max_f32 v13, v13, v15
    v_max_f32 v12, 0xf149f2ca, v12
    v_add_f32 v12, 1092616192, v12
    v_sub_f32 v32, 0, v12
    v_sub_f32 v33, 0, v12
    v_sub_f32 v34, 0, v12
    v_sub_f32 v35, 0, v12
    v_sub_f32 v72, v72, v12
    v_sub_f32 v73, v73, v12
    v_sub_f32 v74, v74, v12
    v_sub_f32 v75, v75, v12
    v_sub_f32 v80, v80, v12
    v_sub_f32 v81, v81, v12
    v_sub_f32 v82, v82, v12
    v_sub_f32 v83, v83, v12
    v_max_f32 v13, 0xf149f2ca, v13
    v_add_f32 v13, 1092616192, v13
    v_sub_f32 v36, 0, v13
    v_sub_f32 v37, 0, v13
    v_sub_f32 v38, 0, v13
    v_sub_f32 v39, 0, v13
    v_sub_f32 v76, v76, v13
    v_sub_f32 v77, v77, v13
    v_sub_f32 v78, v78, v13
    v_sub_f32 v79, v79, v13
    v_sub_f32 v84, v84, v13
    v_sub_f32 v85, v85, v13
    v_sub_f32 v86, v86, v13
    v_sub_f32 v87, v87, v13
    s_mov_b32 s41, 0
    s_mov_b32 s38, s37
    s_branch main_kernel_exp_107
main_kernel_rare_108:
    v_max3_f32 v12, v72, v73, v74
    v_max3_f32 v12, v12, v75, v80
    v_max3_f32 v12, v12, v81, v82
    v_max_f32 v12, v12, v83
    v_max3_f32 v13, v76, v77, v78
    v_max3_f32 v13, v13, v79, v84
    v_max3_f32 v13, v13, v85, v86
    v_max_f32 v13, v13, v87
    v_mov_b32 v14, v12
    v_mov_b32 v15, v13
    s_nop 0
    v_permlane16_swap_b32 v12, v14
    v_permlane16_swap_b32 v13, v15
    v_max_f32 v12, v12, v14
    v_max_f32 v13, v13, v15
    v_mov_b32 v14, v12
    v_mov_b32 v15, v13
    s_nop 0
    v_permlane32_swap_b32 v12, v14
    v_permlane32_swap_b32 v13, v15
    v_max_f32 v12, v12, v14
    v_max_f32 v13, v13, v15
    v_add_f32 v12, 1092616192, v12
    v_max_f32 v12, 0, v12
    v_sub_f32 v14, 0, v12
    v_exp_f32 v14, v14
    v_sub_f32 v72, v72, v12
    v_sub_f32 v73, v73, v12
    v_sub_f32 v74, v74, v12
    v_sub_f32 v75, v75, v12
    v_sub_f32 v80, v80, v12
    v_sub_f32 v81, v81, v12
    v_sub_f32 v82, v82, v12
    v_sub_f32 v83, v83, v12
    v_sub_f32 v32, v32, v12
    v_sub_f32 v33, v33, v12
    v_sub_f32 v34, v34, v12
    v_sub_f32 v35, v35, v12
    v_mul_f32 v248, v248, v14
    v_mul_f32 v249, v249, v14
    v_mul_f32 v250, v250, v14
    v_mul_f32 v251, v251, v14
    v_mul_f32 v152, v152, v14
    v_mul_f32 v153, v153, v14
    v_mul_f32 v154, v154, v14
    v_mul_f32 v155, v155, v14
    v_mul_f32 v160, v160, v14
    v_mul_f32 v161, v161, v14
    v_mul_f32 v162, v162, v14
    v_mul_f32 v163, v163, v14
    v_mul_f32 v168, v168, v14
    v_mul_f32 v169, v169, v14
    v_mul_f32 v170, v170, v14
    v_mul_f32 v171, v171, v14
    v_mul_f32 v176, v176, v14
    v_mul_f32 v177, v177, v14
    v_mul_f32 v178, v178, v14
    v_mul_f32 v179, v179, v14
    v_mul_f32 v184, v184, v14
    v_mul_f32 v185, v185, v14
    v_mul_f32 v186, v186, v14
    v_mul_f32 v187, v187, v14
    v_mul_f32 v192, v192, v14
    v_mul_f32 v193, v193, v14
    v_mul_f32 v194, v194, v14
    v_mul_f32 v195, v195, v14
    v_mul_f32 v200, v200, v14
    v_mul_f32 v201, v201, v14
    v_mul_f32 v202, v202, v14
    v_mul_f32 v203, v203, v14
    v_mul_f32 v208, v208, v14
    v_mul_f32 v209, v209, v14
    v_mul_f32 v210, v210, v14
    v_mul_f32 v211, v211, v14
    v_add_f32 v13, 1092616192, v13
    v_max_f32 v13, 0, v13
    v_sub_f32 v15, 0, v13
    v_exp_f32 v15, v15
    v_sub_f32 v76, v76, v13
    v_sub_f32 v77, v77, v13
    v_sub_f32 v78, v78, v13
    v_sub_f32 v79, v79, v13
    v_sub_f32 v84, v84, v13
    v_sub_f32 v85, v85, v13
    v_sub_f32 v86, v86, v13
    v_sub_f32 v87, v87, v13
    v_sub_f32 v36, v36, v13
    v_sub_f32 v37, v37, v13
    v_sub_f32 v38, v38, v13
    v_sub_f32 v39, v39, v13
    v_mul_f32 v252, v252, v15
    v_mul_f32 v253, v253, v15
    v_mul_f32 v254, v254, v15
    v_mul_f32 v255, v255, v15
    v_mul_f32 v156, v156, v15
    v_mul_f32 v157, v157, v15
    v_mul_f32 v158, v158, v15
    v_mul_f32 v159, v159, v15
    v_mul_f32 v164, v164, v15
    v_mul_f32 v165, v165, v15
    v_mul_f32 v166, v166, v15
    v_mul_f32 v167, v167, v15
    v_mul_f32 v172, v172, v15
    v_mul_f32 v173, v173, v15
    v_mul_f32 v174, v174, v15
    v_mul_f32 v175, v175, v15
    v_mul_f32 v180, v180, v15
    v_mul_f32 v181, v181, v15
    v_mul_f32 v182, v182, v15
    v_mul_f32 v183, v183, v15
    v_mul_f32 v188, v188, v15
    v_mul_f32 v189, v189, v15
    v_mul_f32 v190, v190, v15
    v_mul_f32 v191, v191, v15
    v_mul_f32 v196, v196, v15
    v_mul_f32 v197, v197, v15
    v_mul_f32 v198, v198, v15
    v_mul_f32 v199, v199, v15
    v_mul_f32 v204, v204, v15
    v_mul_f32 v205, v205, v15
    v_mul_f32 v206, v206, v15
    v_mul_f32 v207, v207, v15
    v_mul_f32 v212, v212, v15
    v_mul_f32 v213, v213, v15
    v_mul_f32 v214, v214, v15
    v_mul_f32 v215, v215, v15
    v_exp_f32 v16, v72
    v_exp_f32 v17, v73
    v_exp_f32 v18, v76
    v_exp_f32 v19, v77
    v_cvt_pk_bf16_f32 v88, v16, v17
    v_cvt_pk_bf16_f32 v92, v18, v19
    v_exp_f32 v20, v74
    v_exp_f32 v21, v75
    v_exp_f32 v22, v78
    v_exp_f32 v23, v79
    v_cvt_pk_bf16_f32 v89, v20, v21
    v_cvt_pk_bf16_f32 v93, v22, v23
    v_exp_f32 v16, v80
    v_exp_f32 v17, v81
    v_exp_f32 v18, v84
    v_exp_f32 v19, v85
    v_cvt_pk_bf16_f32 v90, v16, v17
    v_cvt_pk_bf16_f32 v94, v18, v19
    v_exp_f32 v20, v82
    v_exp_f32 v21, v83
    v_exp_f32 v22, v86
    v_exp_f32 v23, v87
    v_cvt_pk_bf16_f32 v91, v20, v21
    v_cvt_pk_bf16_f32 v95, v22, v23
    v_or3_b32 v8, v88, v92, v89
    v_or3_b32 v9, v93, v90, v94
    v_or3_b32 v8, v8, v91, v95
    v_or_b32 v8, v8, v9
    s_branch main_kernel_chk_109
main_kernel_sq_110:
    ds_read_b128 v[128:131], v5 offset:16384
    ds_read_b128 v[132:135], v5 offset:17408
    ds_read_b128 v[136:139], v5 offset:18432
    ds_read_b128 v[140:143], v5 offset:19456
    s_waitcnt lgkmcnt(9)
    s_nop 0
    ds_read_b128 v[96:99], v5 offset:20480
    s_waitcnt lgkmcnt(9)
    s_nop 0
    ds_read_b128 v[100:103], v5 offset:21504
    s_branch main_kernel_pv_111
main_kernel_sp_112:
    s_waitcnt vmcnt(4) lgkmcnt(0)
    s_barrier
    s_branch main_kernel_me_113
main_kernel_spec_114:
    s_cmp_lg_u32 s41, 2
    s_cbranch_scc1 main_kernel_nf_165
    v_rcp_f32 v12, v248
    s_nop 1
    v_rcp_f32 v13, v252
    v_mul_f32 v152, v152, v12
    v_mul_f32 v153, v153, v12
    v_mul_f32 v154, v154, v12
    v_mul_f32 v155, v155, v12
    v_cvt_pk_bf16_f32 v216, v152, v153
    v_cvt_pk_bf16_f32 v217, v154, v155
    v_mul_f32 v160, v160, v12
    v_mul_f32 v161, v161, v12
    v_mul_f32 v162, v162, v12
    v_mul_f32 v163, v163, v12
    v_cvt_pk_bf16_f32 v218, v160, v161
    v_cvt_pk_bf16_f32 v219, v162, v163
    v_mul_f32 v168, v168, v12
    v_mul_f32 v169, v169, v12
    v_mul_f32 v170, v170, v12
    v_mul_f32 v171, v171, v12
    v_cvt_pk_bf16_f32 v220, v168, v169
    v_cvt_pk_bf16_f32 v221, v170, v171
    v_mul_f32 v176, v176, v12
    v_mul_f32 v177, v177, v12
    v_mul_f32 v178, v178, v12
    v_mul_f32 v179, v179, v12
    v_cvt_pk_bf16_f32 v222, v176, v177
    v_cvt_pk_bf16_f32 v223, v178, v179
    v_mul_f32 v184, v184, v12
    v_mul_f32 v185, v185, v12
    v_mul_f32 v186, v186, v12
    v_mul_f32 v187, v187, v12
    v_cvt_pk_bf16_f32 v224, v184, v185
    v_cvt_pk_bf16_f32 v225, v186, v187
    v_mul_f32 v192, v192, v12
    v_mul_f32 v193, v193, v12
    v_mul_f32 v194, v194, v12
    v_mul_f32 v195, v195, v12
    v_cvt_pk_bf16_f32 v226, v192, v193
    v_cvt_pk_bf16_f32 v227, v194, v195
    v_mul_f32 v200, v200, v12
    v_mul_f32 v201, v201, v12
    v_mul_f32 v202, v202, v12
    v_mul_f32 v203, v203, v12
    v_cvt_pk_bf16_f32 v228, v200, v201
    v_cvt_pk_bf16_f32 v229, v202, v203
    v_mul_f32 v208, v208, v12
    v_mul_f32 v209, v209, v12
    v_mul_f32 v210, v210, v12
    v_mul_f32 v211, v211, v12
    v_cvt_pk_bf16_f32 v230, v208, v209
    v_cvt_pk_bf16_f32 v231, v210, v211
    v_mul_f32 v156, v156, v13
    v_mul_f32 v157, v157, v13
    v_mul_f32 v158, v158, v13
    v_mul_f32 v159, v159, v13
    v_cvt_pk_bf16_f32 v232, v156, v157
    v_cvt_pk_bf16_f32 v233, v158, v159
    v_mul_f32 v164, v164, v13
    v_mul_f32 v165, v165, v13
    v_mul_f32 v166, v166, v13
    v_mul_f32 v167, v167, v13
    v_cvt_pk_bf16_f32 v234, v164, v165
    v_cvt_pk_bf16_f32 v235, v166, v167
    v_mul_f32 v172, v172, v13
    v_mul_f32 v173, v173, v13
    v_mul_f32 v174, v174, v13
    v_mul_f32 v175, v175, v13
    v_cvt_pk_bf16_f32 v236, v172, v173
    v_cvt_pk_bf16_f32 v237, v174, v175
    v_mul_f32 v180, v180, v13
    v_mul_f32 v181, v181, v13
    v_mul_f32 v182, v182, v13
    v_mul_f32 v183, v183, v13
    v_cvt_pk_bf16_f32 v238, v180, v181
    v_cvt_pk_bf16_f32 v239, v182, v183
    v_mul_f32 v188, v188, v13
    v_mul_f32 v189, v189, v13
    v_mul_f32 v190, v190, v13
    v_mul_f32 v191, v191, v13
    v_cvt_pk_bf16_f32 v240, v188, v189
    v_cvt_pk_bf16_f32 v241, v190, v191
    v_mul_f32 v196, v196, v13
    v_mul_f32 v197, v197, v13
    v_mul_f32 v198, v198, v13
    v_mul_f32 v199, v199, v13
    v_cvt_pk_bf16_f32 v242, v196, v197
    v_cvt_pk_bf16_f32 v243, v198, v199
    v_mul_f32 v204, v204, v13
    v_mul_f32 v205, v205, v13
    v_mul_f32 v206, v206, v13
    v_mul_f32 v207, v207, v13
    v_cvt_pk_bf16_f32 v244, v204, v205
    v_cvt_pk_bf16_f32 v245, v206, v207
    v_mul_f32 v212, v212, v13
    v_mul_f32 v213, v213, v13
    v_mul_f32 v214, v214, v13
    v_mul_f32 v215, v215, v13
    v_cvt_pk_bf16_f32 v246, v212, v213
    v_cvt_pk_bf16_f32 v247, v214, v215
    s_lshl_b32 s33, s37, 6
    s_add_u32 s33, s33, s21
    s_lshl_b32 s33, s33, 12
    s_add_u32 s33, s33, 50331648
    s_add_u32 s34, s33, 0x20000
    buffer_store_dwordx4 v[216:219], v7, s[8:11], s33 offen offset:0 sc1
    buffer_store_dwordx4 v[220:223], v7, s[8:11], s33 offen offset:1024 sc1
    buffer_store_dwordx4 v[224:227], v7, s[8:11], s33 offen offset:2048 sc1
    buffer_store_dwordx4 v[228:231], v7, s[8:11], s33 offen offset:3072 sc1
    buffer_store_dwordx4 v[232:235], v7, s[8:11], s34 offen offset:0 sc1
    buffer_store_dwordx4 v[236:239], v7, s[8:11], s34 offen offset:1024 sc1
    buffer_store_dwordx4 v[240:243], v7, s[8:11], s34 offen offset:2048 sc1
    buffer_store_dwordx4 v[244:247], v7, s[8:11], s34 offen offset:3072 sc1
    v_mov_b32 v152, 0
    v_mov_b32 v153, 0
    v_mov_b32 v154, 0
    v_mov_b32 v155, 0
    v_mov_b32 v156, 0
    v_mov_b32 v157, 0
    v_mov_b32 v158, 0
    v_mov_b32 v159, 0
    v_mov_b32 v160, 0
    v_mov_b32 v161, 0
    v_mov_b32 v162, 0
    v_mov_b32 v163, 0
    v_mov_b32 v164, 0
    v_mov_b32 v165, 0
    v_mov_b32 v166, 0
    v_mov_b32 v167, 0
    v_mov_b32 v168, 0
    v_mov_b32 v169, 0
    v_mov_b32 v170, 0
    v_mov_b32 v171, 0
    v_mov_b32 v172, 0
    v_mov_b32 v173, 0
    v_mov_b32 v174, 0
    v_mov_b32 v175, 0
    v_mov_b32 v176, 0
    v_mov_b32 v177, 0
    v_mov_b32 v178, 0
    v_mov_b32 v179, 0
    v_mov_b32 v180, 0
    v_mov_b32 v181, 0
    v_mov_b32 v182, 0
    v_mov_b32 v183, 0
    v_mov_b32 v184, 0
    v_mov_b32 v185, 0
    v_mov_b32 v186, 0
    v_mov_b32 v187, 0
    v_mov_b32 v188, 0
    v_mov_b32 v189, 0
    v_mov_b32 v190, 0
    v_mov_b32 v191, 0
    v_mov_b32 v192, 0
    v_mov_b32 v193, 0
    v_mov_b32 v194, 0
    v_mov_b32 v195, 0
    v_mov_b32 v196, 0
    v_mov_b32 v197, 0
    v_mov_b32 v198, 0
    v_mov_b32 v199, 0
    v_mov_b32 v200, 0
    v_mov_b32 v201, 0
    v_mov_b32 v202, 0
    v_mov_b32 v203, 0
    v_mov_b32 v204, 0
    v_mov_b32 v205, 0
    v_mov_b32 v206, 0
    v_mov_b32 v207, 0
    v_mov_b32 v208, 0
    v_mov_b32 v209, 0
    v_mov_b32 v210, 0
    v_mov_b32 v211, 0
    v_mov_b32 v212, 0
    v_mov_b32 v213, 0
    v_mov_b32 v214, 0
    v_mov_b32 v215, 0
    v_mov_b32 v248, 0
    v_mov_b32 v249, 0
    v_mov_b32 v250, 0
    v_mov_b32 v251, 0
    v_mov_b32 v252, 0
    v_mov_b32 v253, 0
    v_mov_b32 v254, 0
    v_mov_b32 v255, 0
    s_lshl_b32 s37, s35, 2
    s_add_u32 s37, s37, s24
main_kernel_nf_165:
    s_cmp_lt_u32 s27, s37
    s_cbranch_scc1 main_kernel_i_164
    s_sub_u32 s33, s37, s27
    s_lshl_b32 s33, s33, 5
    v_add_u32 v12, s33, v6
    v_mov_b32 v13, 4286578688
    v_cmp_gt_i32 s[44:45], 0, v12
    v_cmp_gt_i32 s[46:47], 1, v12
    v_cmp_gt_i32 s[48:49], 2, v12
    v_cmp_gt_i32 s[50:51], 3, v12
    v_cndmask_b32 v72, v72, v13, s[44:45]
    v_cndmask_b32 v73, v73, v13, s[46:47]
    v_cndmask_b32 v74, v74, v13, s[48:49]
    v_cndmask_b32 v75, v75, v13, s[50:51]
    v_cmp_gt_i32 s[44:45], -16, v12
    v_cmp_gt_i32 s[46:47], -15, v12
    v_cmp_gt_i32 s[48:49], -14, v12
    v_cmp_gt_i32 s[50:51], -13, v12
    v_cndmask_b32 v76, v76, v13, s[44:45]
    v_cndmask_b32 v77, v77, v13, s[46:47]
    v_cndmask_b32 v78, v78, v13, s[48:49]
    v_cndmask_b32 v79, v79, v13, s[50:51]
    v_cmp_gt_i32 s[44:45], 16, v12
    v_cmp_gt_i32 s[46:47], 17, v12
    v_cmp_gt_i32 s[48:49], 18, v12
    v_cmp_gt_i32 s[50:51], 19, v12
    v_cndmask_b32 v80, v80, v13, s[44:45]
    v_cndmask_b32 v81, v81, v13, s[46:47]
    v_cndmask_b32 v82, v82, v13, s[48:49]
    v_cndmask_b32 v83, v83, v13, s[50:51]
    v_cmp_gt_i32 s[44:45], 0, v12
    v_cmp_gt_i32 s[46:47], 1, v12
    v_cmp_gt_i32 s[48:49], 2, v12
    v_cmp_gt_i32 s[50:51], 3, v12
    v_cndmask_b32 v84, v84, v13, s[44:45]
    v_cndmask_b32 v85, v85, v13, s[46:47]
    v_cndmask_b32 v86, v86, v13, s[48:49]
    v_cndmask_b32 v87, v87, v13, s[50:51]
main_kernel_i_164:
    s_cmp_eq_u32 s41, 0
    s_cbranch_scc1 main_kernel_exp_115
    v_max3_f32 v12, v72, v73, v74
    v_max3_f32 v12, v12, v75, v80
    v_max3_f32 v12, v12, v81, v82
    v_max_f32 v12, v12, v83
    v_max3_f32 v13, v76, v77, v78
    v_max3_f32 v13, v13, v79, v84
    v_max3_f32 v13, v13, v85, v86
    v_max_f32 v13, v13, v87
    v_mov_b32 v14, v12
    v_mov_b32 v15, v13
    s_nop 0
    v_permlane16_swap_b32 v12, v14
    v_permlane16_swap_b32 v13, v15
    v_max_f32 v12, v12, v14
    v_max_f32 v13, v13, v15
    v_mov_b32 v14, v12
    v_mov_b32 v15, v13
    s_nop 0
    v_permlane32_swap_b32 v12, v14
    v_permlane32_swap_b32 v13, v15
    v_max_f32 v12, v12, v14
    v_max_f32 v13, v13, v15
    v_max_f32 v12, 0xf149f2ca, v12
    v_add_f32 v12, 1092616192, v12
    v_sub_f32 v32, 0, v12
    v_sub_f32 v33, 0, v12
    v_sub_f32 v34, 0, v12
    v_sub_f32 v35, 0, v12
    v_sub_f32 v72, v72, v12
    v_sub_f32 v73, v73, v12
    v_sub_f32 v74, v74, v12
    v_sub_f32 v75, v75, v12
    v_sub_f32 v80, v80, v12
    v_sub_f32 v81, v81, v12
    v_sub_f32 v82, v82, v12
    v_sub_f32 v83, v83, v12
    v_max_f32 v13, 0xf149f2ca, v13
    v_add_f32 v13, 1092616192, v13
    v_sub_f32 v36, 0, v13
    v_sub_f32 v37, 0, v13
    v_sub_f32 v38, 0, v13
    v_sub_f32 v39, 0, v13
    v_sub_f32 v76, v76, v13
    v_sub_f32 v77, v77, v13
    v_sub_f32 v78, v78, v13
    v_sub_f32 v79, v79, v13
    v_sub_f32 v84, v84, v13
    v_sub_f32 v85, v85, v13
    v_sub_f32 v86, v86, v13
    v_sub_f32 v87, v87, v13
    s_mov_b32 s41, 0
    s_mov_b32 s38, s37
    s_branch main_kernel_exp_115
main_kernel_rare_116:
    v_max3_f32 v12, v72, v73, v74
    v_max3_f32 v12, v12, v75, v80
    v_max3_f32 v12, v12, v81, v82
    v_max_f32 v12, v12, v83
    v_max3_f32 v13, v76, v77, v78
    v_max3_f32 v13, v13, v79, v84
    v_max3_f32 v13, v13, v85, v86
    v_max_f32 v13, v13, v87
    v_mov_b32 v14, v12
    v_mov_b32 v15, v13
    s_nop 0
    v_permlane16_swap_b32 v12, v14
    v_permlane16_swap_b32 v13, v15
    v_max_f32 v12, v12, v14
    v_max_f32 v13, v13, v15
    v_mov_b32 v14, v12
    v_mov_b32 v15, v13
    s_nop 0
    v_permlane32_swap_b32 v12, v14
    v_permlane32_swap_b32 v13, v15
    v_max_f32 v12, v12, v14
    v_max_f32 v13, v13, v15
    v_add_f32 v12, 1092616192, v12
    v_max_f32 v12, 0, v12
    v_sub_f32 v14, 0, v12
    v_exp_f32 v14, v14
    v_sub_f32 v72, v72, v12
    v_sub_f32 v73, v73, v12
    v_sub_f32 v74, v74, v12
    v_sub_f32 v75, v75, v12
    v_sub_f32 v80, v80, v12
    v_sub_f32 v81, v81, v12
    v_sub_f32 v82, v82, v12
    v_sub_f32 v83, v83, v12
    v_sub_f32 v32, v32, v12
    v_sub_f32 v33, v33, v12
    v_sub_f32 v34, v34, v12
    v_sub_f32 v35, v35, v12
    v_mul_f32 v248, v248, v14
    v_mul_f32 v249, v249, v14
    v_mul_f32 v250, v250, v14
    v_mul_f32 v251, v251, v14
    v_mul_f32 v152, v152, v14
    v_mul_f32 v153, v153, v14
    v_mul_f32 v154, v154, v14
    v_mul_f32 v155, v155, v14
    v_mul_f32 v160, v160, v14
    v_mul_f32 v161, v161, v14
    v_mul_f32 v162, v162, v14
    v_mul_f32 v163, v163, v14
    v_mul_f32 v168, v168, v14
    v_mul_f32 v169, v169, v14
    v_mul_f32 v170, v170, v14
    v_mul_f32 v171, v171, v14
    v_mul_f32 v176, v176, v14
    v_mul_f32 v177, v177, v14
    v_mul_f32 v178, v178, v14
    v_mul_f32 v179, v179, v14
    v_mul_f32 v184, v184, v14
    v_mul_f32 v185, v185, v14
    v_mul_f32 v186, v186, v14
    v_mul_f32 v187, v187, v14
    v_mul_f32 v192, v192, v14
    v_mul_f32 v193, v193, v14
    v_mul_f32 v194, v194, v14
    v_mul_f32 v195, v195, v14
    v_mul_f32 v200, v200, v14
    v_mul_f32 v201, v201, v14
    v_mul_f32 v202, v202, v14
    v_mul_f32 v203, v203, v14
    v_mul_f32 v208, v208, v14
    v_mul_f32 v209, v209, v14
    v_mul_f32 v210, v210, v14
    v_mul_f32 v211, v211, v14
    v_add_f32 v13, 1092616192, v13
    v_max_f32 v13, 0, v13
    v_sub_f32 v15, 0, v13
    v_exp_f32 v15, v15
    v_sub_f32 v76, v76, v13
    v_sub_f32 v77, v77, v13
    v_sub_f32 v78, v78, v13
    v_sub_f32 v79, v79, v13
    v_sub_f32 v84, v84, v13
    v_sub_f32 v85, v85, v13
    v_sub_f32 v86, v86, v13
    v_sub_f32 v87, v87, v13
    v_sub_f32 v36, v36, v13
    v_sub_f32 v37, v37, v13
    v_sub_f32 v38, v38, v13
    v_sub_f32 v39, v39, v13
    v_mul_f32 v252, v252, v15
    v_mul_f32 v253, v253, v15
    v_mul_f32 v254, v254, v15
    v_mul_f32 v255, v255, v15
    v_mul_f32 v156, v156, v15
    v_mul_f32 v157, v157, v15
    v_mul_f32 v158, v158, v15
    v_mul_f32 v159, v159, v15
    v_mul_f32 v164, v164, v15
    v_mul_f32 v165, v165, v15
    v_mul_f32 v166, v166, v15
    v_mul_f32 v167, v167, v15
    v_mul_f32 v172, v172, v15
    v_mul_f32 v173, v173, v15
    v_mul_f32 v174, v174, v15
    v_mul_f32 v175, v175, v15
    v_mul_f32 v180, v180, v15
    v_mul_f32 v181, v181, v15
    v_mul_f32 v182, v182, v15
    v_mul_f32 v183, v183, v15
    v_mul_f32 v188, v188, v15
    v_mul_f32 v189, v189, v15
    v_mul_f32 v190, v190, v15
    v_mul_f32 v191, v191, v15
    v_mul_f32 v196, v196, v15
    v_mul_f32 v197, v197, v15
    v_mul_f32 v198, v198, v15
    v_mul_f32 v199, v199, v15
    v_mul_f32 v204, v204, v15
    v_mul_f32 v205, v205, v15
    v_mul_f32 v206, v206, v15
    v_mul_f32 v207, v207, v15
    v_mul_f32 v212, v212, v15
    v_mul_f32 v213, v213, v15
    v_mul_f32 v214, v214, v15
    v_mul_f32 v215, v215, v15
    v_exp_f32 v16, v72
    v_exp_f32 v17, v73
    v_exp_f32 v18, v76
    v_exp_f32 v19, v77
    v_cvt_pk_bf16_f32 v88, v16, v17
    v_cvt_pk_bf16_f32 v92, v18, v19
    v_exp_f32 v20, v74
    v_exp_f32 v21, v75
    v_exp_f32 v22, v78
    v_exp_f32 v23, v79
    v_cvt_pk_bf16_f32 v89, v20, v21
    v_cvt_pk_bf16_f32 v93, v22, v23
    v_exp_f32 v16, v80
    v_exp_f32 v17, v81
    v_exp_f32 v18, v84
    v_exp_f32 v19, v85
    v_cvt_pk_bf16_f32 v90, v16, v17
    v_cvt_pk_bf16_f32 v94, v18, v19
    v_exp_f32 v20, v82
    v_exp_f32 v21, v83
    v_exp_f32 v22, v86
    v_exp_f32 v23, v87
    v_cvt_pk_bf16_f32 v91, v20, v21
    v_cvt_pk_bf16_f32 v95, v22, v23
    v_or3_b32 v8, v88, v92, v89
    v_or3_b32 v9, v93, v90, v94
    v_or3_b32 v8, v8, v91, v95
    v_or_b32 v8, v8, v9
    s_branch main_kernel_chk_117
main_kernel_sq_118:
    ds_read_b128 v[128:131], v5 offset:24576
    ds_read_b128 v[132:135], v5 offset:25600
    ds_read_b128 v[136:139], v5 offset:26624
    ds_read_b128 v[140:143], v5 offset:27648
    s_waitcnt lgkmcnt(9)
    s_nop 0
    ds_read_b128 v[96:99], v5 offset:28672
    s_waitcnt lgkmcnt(9)
    s_nop 0
    ds_read_b128 v[100:103], v5 offset:29696
    s_branch main_kernel_pv_119
main_kernel_sp_120:
    s_waitcnt vmcnt(4) lgkmcnt(0)
    s_barrier
    s_branch main_kernel_me_121
main_kernel_sq_122:
    ds_read_b128 v[128:131], v5 offset:24576
    ds_read_b128 v[132:135], v5 offset:25600
    ds_read_b128 v[136:139], v5 offset:26624
    ds_read_b128 v[140:143], v5 offset:27648
    s_waitcnt lgkmcnt(9)
    s_nop 0
    ds_read_b128 v[96:99], v5 offset:28672
    s_waitcnt lgkmcnt(9)
    s_nop 0
    ds_read_b128 v[100:103], v5 offset:29696
    s_branch main_kernel_pv_123
main_kernel_sp_124:
    s_waitcnt vmcnt(4) lgkmcnt(0)
    s_barrier
    s_branch main_kernel_me_125
main_kernel_po_127:
    s_cmp_lg_u32 s20, 4
    s_cbranch_scc1 main_kernel_nctx_166
    s_lshr_b32 s3, s22, 3
    s_lshl_b32 s3, s3, 2
    s_lshr_b32 s4, s21, 3
    s_add_u32 s3, s3, s4
    s_lshl_b32 s3, s3, 5
    s_and_b32 s4, s22, 7
    s_lshl_b32 s4, s4, 2
    s_add_u32 s3, s3, s4
    v_and_b32 v26, 3, v2
    v_add_u32 v26, s3, v26
    v_lshlrev_b32 v26, 7, v26
    s_and_b32 s3, s21, 7
    s_add_u32 s3, s3, 71303200
    v_mov_b32 v27, 1
    s_mov_b64 exec, 15
    buffer_store_byte v27, v26, s[8:11], s3 offen sc1
    s_mov_b64 exec, -1
main_kernel_nctx_166:
    s_branch main_kernel_np_126
main_kernel_spec_128:
    s_cmp_lg_u32 s41, 2
    s_cbranch_scc1 main_kernel_nf_168
    v_rcp_f32 v12, v248
    s_nop 1
    v_rcp_f32 v13, v252
    v_mul_f32 v152, v152, v12
    v_mul_f32 v153, v153, v12
    v_mul_f32 v154, v154, v12
    v_mul_f32 v155, v155, v12
    v_cvt_pk_bf16_f32 v216, v152, v153
    v_cvt_pk_bf16_f32 v217, v154, v155
    v_mul_f32 v160, v160, v12
    v_mul_f32 v161, v161, v12
    v_mul_f32 v162, v162, v12
    v_mul_f32 v163, v163, v12
    v_cvt_pk_bf16_f32 v218, v160, v161
    v_cvt_pk_bf16_f32 v219, v162, v163
    v_mul_f32 v168, v168, v12
    v_mul_f32 v169, v169, v12
    v_mul_f32 v170, v170, v12
    v_mul_f32 v171, v171, v12
    v_cvt_pk_bf16_f32 v220, v168, v169
    v_cvt_pk_bf16_f32 v221, v170, v171
    v_mul_f32 v176, v176, v12
    v_mul_f32 v177, v177, v12
    v_mul_f32 v178, v178, v12
    v_mul_f32 v179, v179, v12
    v_cvt_pk_bf16_f32 v222, v176, v177
    v_cvt_pk_bf16_f32 v223, v178, v179
    v_mul_f32 v184, v184, v12
    v_mul_f32 v185, v185, v12
    v_mul_f32 v186, v186, v12
    v_mul_f32 v187, v187, v12
    v_cvt_pk_bf16_f32 v224, v184, v185
    v_cvt_pk_bf16_f32 v225, v186, v187
    v_mul_f32 v192, v192, v12
    v_mul_f32 v193, v193, v12
    v_mul_f32 v194, v194, v12
    v_mul_f32 v195, v195, v12
    v_cvt_pk_bf16_f32 v226, v192, v193
    v_cvt_pk_bf16_f32 v227, v194, v195
    v_mul_f32 v200, v200, v12
    v_mul_f32 v201, v201, v12
    v_mul_f32 v202, v202, v12
    v_mul_f32 v203, v203, v12
    v_cvt_pk_bf16_f32 v228, v200, v201
    v_cvt_pk_bf16_f32 v229, v202, v203
    v_mul_f32 v208, v208, v12
    v_mul_f32 v209, v209, v12
    v_mul_f32 v210, v210, v12
    v_mul_f32 v211, v211, v12
    v_cvt_pk_bf16_f32 v230, v208, v209
    v_cvt_pk_bf16_f32 v231, v210, v211
    v_mul_f32 v156, v156, v13
    v_mul_f32 v157, v157, v13
    v_mul_f32 v158, v158, v13
    v_mul_f32 v159, v159, v13
    v_cvt_pk_bf16_f32 v232, v156, v157
    v_cvt_pk_bf16_f32 v233, v158, v159
    v_mul_f32 v164, v164, v13
    v_mul_f32 v165, v165, v13
    v_mul_f32 v166, v166, v13
    v_mul_f32 v167, v167, v13
    v_cvt_pk_bf16_f32 v234, v164, v165
    v_cvt_pk_bf16_f32 v235, v166, v167
    v_mul_f32 v172, v172, v13
    v_mul_f32 v173, v173, v13
    v_mul_f32 v174, v174, v13
    v_mul_f32 v175, v175, v13
    v_cvt_pk_bf16_f32 v236, v172, v173
    v_cvt_pk_bf16_f32 v237, v174, v175
    v_mul_f32 v180, v180, v13
    v_mul_f32 v181, v181, v13
    v_mul_f32 v182, v182, v13
    v_mul_f32 v183, v183, v13
    v_cvt_pk_bf16_f32 v238, v180, v181
    v_cvt_pk_bf16_f32 v239, v182, v183
    v_mul_f32 v188, v188, v13
    v_mul_f32 v189, v189, v13
    v_mul_f32 v190, v190, v13
    v_mul_f32 v191, v191, v13
    v_cvt_pk_bf16_f32 v240, v188, v189
    v_cvt_pk_bf16_f32 v241, v190, v191
    v_mul_f32 v196, v196, v13
    v_mul_f32 v197, v197, v13
    v_mul_f32 v198, v198, v13
    v_mul_f32 v199, v199, v13
    v_cvt_pk_bf16_f32 v242, v196, v197
    v_cvt_pk_bf16_f32 v243, v198, v199
    v_mul_f32 v204, v204, v13
    v_mul_f32 v205, v205, v13
    v_mul_f32 v206, v206, v13
    v_mul_f32 v207, v207, v13
    v_cvt_pk_bf16_f32 v244, v204, v205
    v_cvt_pk_bf16_f32 v245, v206, v207
    v_mul_f32 v212, v212, v13
    v_mul_f32 v213, v213, v13
    v_mul_f32 v214, v214, v13
    v_mul_f32 v215, v215, v13
    v_cvt_pk_bf16_f32 v246, v212, v213
    v_cvt_pk_bf16_f32 v247, v214, v215
    s_lshl_b32 s33, s37, 6
    s_add_u32 s33, s33, s21
    s_lshl_b32 s33, s33, 12
    s_add_u32 s33, s33, 50331648
    s_add_u32 s34, s33, 0x20000
    buffer_store_dwordx4 v[216:219], v7, s[8:11], s33 offen offset:0 sc1
    buffer_store_dwordx4 v[220:223], v7, s[8:11], s33 offen offset:1024 sc1
    buffer_store_dwordx4 v[224:227], v7, s[8:11], s33 offen offset:2048 sc1
    buffer_store_dwordx4 v[228:231], v7, s[8:11], s33 offen offset:3072 sc1
    buffer_store_dwordx4 v[232:235], v7, s[8:11], s34 offen offset:0 sc1
    buffer_store_dwordx4 v[236:239], v7, s[8:11], s34 offen offset:1024 sc1
    buffer_store_dwordx4 v[240:243], v7, s[8:11], s34 offen offset:2048 sc1
    buffer_store_dwordx4 v[244:247], v7, s[8:11], s34 offen offset:3072 sc1
    v_mov_b32 v152, 0
    v_mov_b32 v153, 0
    v_mov_b32 v154, 0
    v_mov_b32 v155, 0
    v_mov_b32 v156, 0
    v_mov_b32 v157, 0
    v_mov_b32 v158, 0
    v_mov_b32 v159, 0
    v_mov_b32 v160, 0
    v_mov_b32 v161, 0
    v_mov_b32 v162, 0
    v_mov_b32 v163, 0
    v_mov_b32 v164, 0
    v_mov_b32 v165, 0
    v_mov_b32 v166, 0
    v_mov_b32 v167, 0
    v_mov_b32 v168, 0
    v_mov_b32 v169, 0
    v_mov_b32 v170, 0
    v_mov_b32 v171, 0
    v_mov_b32 v172, 0
    v_mov_b32 v173, 0
    v_mov_b32 v174, 0
    v_mov_b32 v175, 0
    v_mov_b32 v176, 0
    v_mov_b32 v177, 0
    v_mov_b32 v178, 0
    v_mov_b32 v179, 0
    v_mov_b32 v180, 0
    v_mov_b32 v181, 0
    v_mov_b32 v182, 0
    v_mov_b32 v183, 0
    v_mov_b32 v184, 0
    v_mov_b32 v185, 0
    v_mov_b32 v186, 0
    v_mov_b32 v187, 0
    v_mov_b32 v188, 0
    v_mov_b32 v189, 0
    v_mov_b32 v190, 0
    v_mov_b32 v191, 0
    v_mov_b32 v192, 0
    v_mov_b32 v193, 0
    v_mov_b32 v194, 0
    v_mov_b32 v195, 0
    v_mov_b32 v196, 0
    v_mov_b32 v197, 0
    v_mov_b32 v198, 0
    v_mov_b32 v199, 0
    v_mov_b32 v200, 0
    v_mov_b32 v201, 0
    v_mov_b32 v202, 0
    v_mov_b32 v203, 0
    v_mov_b32 v204, 0
    v_mov_b32 v205, 0
    v_mov_b32 v206, 0
    v_mov_b32 v207, 0
    v_mov_b32 v208, 0
    v_mov_b32 v209, 0
    v_mov_b32 v210, 0
    v_mov_b32 v211, 0
    v_mov_b32 v212, 0
    v_mov_b32 v213, 0
    v_mov_b32 v214, 0
    v_mov_b32 v215, 0
    v_mov_b32 v248, 0
    v_mov_b32 v249, 0
    v_mov_b32 v250, 0
    v_mov_b32 v251, 0
    v_mov_b32 v252, 0
    v_mov_b32 v253, 0
    v_mov_b32 v254, 0
    v_mov_b32 v255, 0
    s_lshl_b32 s37, s35, 2
    s_add_u32 s37, s37, s24
main_kernel_nf_168:
    s_cmp_lt_u32 s27, s37
    s_cbranch_scc1 main_kernel_i_167
    s_sub_u32 s33, s37, s27
    s_lshl_b32 s33, s33, 5
    v_add_u32 v12, s33, v6
    v_mov_b32 v13, 4286578688
    v_cmp_gt_i32 s[44:45], 0, v12
    v_cmp_gt_i32 s[46:47], 1, v12
    v_cmp_gt_i32 s[48:49], 2, v12
    v_cmp_gt_i32 s[50:51], 3, v12
    v_cndmask_b32 v72, v72, v13, s[44:45]
    v_cndmask_b32 v73, v73, v13, s[46:47]
    v_cndmask_b32 v74, v74, v13, s[48:49]
    v_cndmask_b32 v75, v75, v13, s[50:51]
    v_cmp_gt_i32 s[44:45], -16, v12
    v_cmp_gt_i32 s[46:47], -15, v12
    v_cmp_gt_i32 s[48:49], -14, v12
    v_cmp_gt_i32 s[50:51], -13, v12
    v_cndmask_b32 v76, v76, v13, s[44:45]
    v_cndmask_b32 v77, v77, v13, s[46:47]
    v_cndmask_b32 v78, v78, v13, s[48:49]
    v_cndmask_b32 v79, v79, v13, s[50:51]
    v_cmp_gt_i32 s[44:45], 16, v12
    v_cmp_gt_i32 s[46:47], 17, v12
    v_cmp_gt_i32 s[48:49], 18, v12
    v_cmp_gt_i32 s[50:51], 19, v12
    v_cndmask_b32 v80, v80, v13, s[44:45]
    v_cndmask_b32 v81, v81, v13, s[46:47]
    v_cndmask_b32 v82, v82, v13, s[48:49]
    v_cndmask_b32 v83, v83, v13, s[50:51]
    v_cmp_gt_i32 s[44:45], 0, v12
    v_cmp_gt_i32 s[46:47], 1, v12
    v_cmp_gt_i32 s[48:49], 2, v12
    v_cmp_gt_i32 s[50:51], 3, v12
    v_cndmask_b32 v84, v84, v13, s[44:45]
    v_cndmask_b32 v85, v85, v13, s[46:47]
    v_cndmask_b32 v86, v86, v13, s[48:49]
    v_cndmask_b32 v87, v87, v13, s[50:51]
main_kernel_i_167:
    s_cmp_eq_u32 s41, 0
    s_cbranch_scc1 main_kernel_exp_129
    v_max3_f32 v12, v72, v73, v74
    v_max3_f32 v12, v12, v75, v80
    v_max3_f32 v12, v12, v81, v82
    v_max_f32 v12, v12, v83
    v_max3_f32 v13, v76, v77, v78
    v_max3_f32 v13, v13, v79, v84
    v_max3_f32 v13, v13, v85, v86
    v_max_f32 v13, v13, v87
    v_mov_b32 v14, v12
    v_mov_b32 v15, v13
    s_nop 0
    v_permlane16_swap_b32 v12, v14
    v_permlane16_swap_b32 v13, v15
    v_max_f32 v12, v12, v14
    v_max_f32 v13, v13, v15
    v_mov_b32 v14, v12
    v_mov_b32 v15, v13
    s_nop 0
    v_permlane32_swap_b32 v12, v14
    v_permlane32_swap_b32 v13, v15
    v_max_f32 v12, v12, v14
    v_max_f32 v13, v13, v15
    v_max_f32 v12, 0xf149f2ca, v12
    v_add_f32 v12, 1092616192, v12
    v_sub_f32 v32, 0, v12
    v_sub_f32 v33, 0, v12
    v_sub_f32 v34, 0, v12
    v_sub_f32 v35, 0, v12
    v_sub_f32 v72, v72, v12
    v_sub_f32 v73, v73, v12
    v_sub_f32 v74, v74, v12
    v_sub_f32 v75, v75, v12
    v_sub_f32 v80, v80, v12
    v_sub_f32 v81, v81, v12
    v_sub_f32 v82, v82, v12
    v_sub_f32 v83, v83, v12
    v_max_f32 v13, 0xf149f2ca, v13
    v_add_f32 v13, 1092616192, v13
    v_sub_f32 v36, 0, v13
    v_sub_f32 v37, 0, v13
    v_sub_f32 v38, 0, v13
    v_sub_f32 v39, 0, v13
    v_sub_f32 v76, v76, v13
    v_sub_f32 v77, v77, v13
    v_sub_f32 v78, v78, v13
    v_sub_f32 v79, v79, v13
    v_sub_f32 v84, v84, v13
    v_sub_f32 v85, v85, v13
    v_sub_f32 v86, v86, v13
    v_sub_f32 v87, v87, v13
    s_mov_b32 s41, 0
    s_mov_b32 s38, s37
    s_branch main_kernel_exp_129
main_kernel_rare_130:
    v_max3_f32 v12, v72, v73, v74
    v_max3_f32 v12, v12, v75, v80
    v_max3_f32 v12, v12, v81, v82
    v_max_f32 v12, v12, v83
    v_max3_f32 v13, v76, v77, v78
    v_max3_f32 v13, v13, v79, v84
    v_max3_f32 v13, v13, v85, v86
    v_max_f32 v13, v13, v87
    v_mov_b32 v14, v12
    v_mov_b32 v15, v13
    s_nop 0
    v_permlane16_swap_b32 v12, v14
    v_permlane16_swap_b32 v13, v15
    v_max_f32 v12, v12, v14
    v_max_f32 v13, v13, v15
    v_mov_b32 v14, v12
    v_mov_b32 v15, v13
    s_nop 0
    v_permlane32_swap_b32 v12, v14
    v_permlane32_swap_b32 v13, v15
    v_max_f32 v12, v12, v14
    v_max_f32 v13, v13, v15
    v_add_f32 v12, 1092616192, v12
    v_max_f32 v12, 0, v12
    v_sub_f32 v14, 0, v12
    v_exp_f32 v14, v14
    v_sub_f32 v72, v72, v12
    v_sub_f32 v73, v73, v12
    v_sub_f32 v74, v74, v12
    v_sub_f32 v75, v75, v12
    v_sub_f32 v80, v80, v12
    v_sub_f32 v81, v81, v12
    v_sub_f32 v82, v82, v12
    v_sub_f32 v83, v83, v12
    v_sub_f32 v32, v32, v12
    v_sub_f32 v33, v33, v12
    v_sub_f32 v34, v34, v12
    v_sub_f32 v35, v35, v12
    v_mul_f32 v248, v248, v14
    v_mul_f32 v249, v249, v14
    v_mul_f32 v250, v250, v14
    v_mul_f32 v251, v251, v14
    v_mul_f32 v152, v152, v14
    v_mul_f32 v153, v153, v14
    v_mul_f32 v154, v154, v14
    v_mul_f32 v155, v155, v14
    v_mul_f32 v160, v160, v14
    v_mul_f32 v161, v161, v14
    v_mul_f32 v162, v162, v14
    v_mul_f32 v163, v163, v14
    v_mul_f32 v168, v168, v14
    v_mul_f32 v169, v169, v14
    v_mul_f32 v170, v170, v14
    v_mul_f32 v171, v171, v14
    v_mul_f32 v176, v176, v14
    v_mul_f32 v177, v177, v14
    v_mul_f32 v178, v178, v14
    v_mul_f32 v179, v179, v14
    v_mul_f32 v184, v184, v14
    v_mul_f32 v185, v185, v14
    v_mul_f32 v186, v186, v14
    v_mul_f32 v187, v187, v14
    v_mul_f32 v192, v192, v14
    v_mul_f32 v193, v193, v14
    v_mul_f32 v194, v194, v14
    v_mul_f32 v195, v195, v14
    v_mul_f32 v200, v200, v14
    v_mul_f32 v201, v201, v14
    v_mul_f32 v202, v202, v14
    v_mul_f32 v203, v203, v14
    v_mul_f32 v208, v208, v14
    v_mul_f32 v209, v209, v14
    v_mul_f32 v210, v210, v14
    v_mul_f32 v211, v211, v14
    v_add_f32 v13, 1092616192, v13
    v_max_f32 v13, 0, v13
    v_sub_f32 v15, 0, v13
    v_exp_f32 v15, v15
    v_sub_f32 v76, v76, v13
    v_sub_f32 v77, v77, v13
    v_sub_f32 v78, v78, v13
    v_sub_f32 v79, v79, v13
    v_sub_f32 v84, v84, v13
    v_sub_f32 v85, v85, v13
    v_sub_f32 v86, v86, v13
    v_sub_f32 v87, v87, v13
    v_sub_f32 v36, v36, v13
    v_sub_f32 v37, v37, v13
    v_sub_f32 v38, v38, v13
    v_sub_f32 v39, v39, v13
    v_mul_f32 v252, v252, v15
    v_mul_f32 v253, v253, v15
    v_mul_f32 v254, v254, v15
    v_mul_f32 v255, v255, v15
    v_mul_f32 v156, v156, v15
    v_mul_f32 v157, v157, v15
    v_mul_f32 v158, v158, v15
    v_mul_f32 v159, v159, v15
    v_mul_f32 v164, v164, v15
    v_mul_f32 v165, v165, v15
    v_mul_f32 v166, v166, v15
    v_mul_f32 v167, v167, v15
    v_mul_f32 v172, v172, v15
    v_mul_f32 v173, v173, v15
    v_mul_f32 v174, v174, v15
    v_mul_f32 v175, v175, v15
    v_mul_f32 v180, v180, v15
    v_mul_f32 v181, v181, v15
    v_mul_f32 v182, v182, v15
    v_mul_f32 v183, v183, v15
    v_mul_f32 v188, v188, v15
    v_mul_f32 v189, v189, v15
    v_mul_f32 v190, v190, v15
    v_mul_f32 v191, v191, v15
    v_mul_f32 v196, v196, v15
    v_mul_f32 v197, v197, v15
    v_mul_f32 v198, v198, v15
    v_mul_f32 v199, v199, v15
    v_mul_f32 v204, v204, v15
    v_mul_f32 v205, v205, v15
    v_mul_f32 v206, v206, v15
    v_mul_f32 v207, v207, v15
    v_mul_f32 v212, v212, v15
    v_mul_f32 v213, v213, v15
    v_mul_f32 v214, v214, v15
    v_mul_f32 v215, v215, v15
    v_exp_f32 v16, v72
    v_exp_f32 v17, v73
    v_exp_f32 v18, v76
    v_exp_f32 v19, v77
    v_cvt_pk_bf16_f32 v88, v16, v17
    v_cvt_pk_bf16_f32 v92, v18, v19
    v_exp_f32 v20, v74
    v_exp_f32 v21, v75
    v_exp_f32 v22, v78
    v_exp_f32 v23, v79
    v_cvt_pk_bf16_f32 v89, v20, v21
    v_cvt_pk_bf16_f32 v93, v22, v23
    v_exp_f32 v16, v80
    v_exp_f32 v17, v81
    v_exp_f32 v18, v84
    v_exp_f32 v19, v85
    v_cvt_pk_bf16_f32 v90, v16, v17
    v_cvt_pk_bf16_f32 v94, v18, v19
    v_exp_f32 v20, v82
    v_exp_f32 v21, v83
    v_exp_f32 v22, v86
    v_exp_f32 v23, v87
    v_cvt_pk_bf16_f32 v91, v20, v21
    v_cvt_pk_bf16_f32 v95, v22, v23
    v_or3_b32 v8, v88, v92, v89
    v_or3_b32 v9, v93, v90, v94
    v_or3_b32 v8, v8, v91, v95
    v_or_b32 v8, v8, v9
    s_branch main_kernel_chk_131
main_kernel_sq_132:
    ds_read_b128 v[128:131], v5 offset:16384
    ds_read_b128 v[132:135], v5 offset:17408
    ds_read_b128 v[136:139], v5 offset:18432
    ds_read_b128 v[140:143], v5 offset:19456
    s_waitcnt lgkmcnt(9)
    s_nop 0
    ds_read_b128 v[96:99], v5 offset:20480
    s_waitcnt lgkmcnt(9)
    s_nop 0
    ds_read_b128 v[100:103], v5 offset:21504
    s_branch main_kernel_pv_133
main_kernel_sp_134:
    s_waitcnt vmcnt(4) lgkmcnt(0)
    s_barrier
    s_branch main_kernel_me_135
main_kernel_spec_136:
    s_cmp_lg_u32 s41, 2
    s_cbranch_scc1 main_kernel_nf_170
    v_rcp_f32 v12, v248
    s_nop 1
    v_rcp_f32 v13, v252
    v_mul_f32 v152, v152, v12
    v_mul_f32 v153, v153, v12
    v_mul_f32 v154, v154, v12
    v_mul_f32 v155, v155, v12
    v_cvt_pk_bf16_f32 v216, v152, v153
    v_cvt_pk_bf16_f32 v217, v154, v155
    v_mul_f32 v160, v160, v12
    v_mul_f32 v161, v161, v12
    v_mul_f32 v162, v162, v12
    v_mul_f32 v163, v163, v12
    v_cvt_pk_bf16_f32 v218, v160, v161
    v_cvt_pk_bf16_f32 v219, v162, v163
    v_mul_f32 v168, v168, v12
    v_mul_f32 v169, v169, v12
    v_mul_f32 v170, v170, v12
    v_mul_f32 v171, v171, v12
    v_cvt_pk_bf16_f32 v220, v168, v169
    v_cvt_pk_bf16_f32 v221, v170, v171
    v_mul_f32 v176, v176, v12
    v_mul_f32 v177, v177, v12
    v_mul_f32 v178, v178, v12
    v_mul_f32 v179, v179, v12
    v_cvt_pk_bf16_f32 v222, v176, v177
    v_cvt_pk_bf16_f32 v223, v178, v179
    v_mul_f32 v184, v184, v12
    v_mul_f32 v185, v185, v12
    v_mul_f32 v186, v186, v12
    v_mul_f32 v187, v187, v12
    v_cvt_pk_bf16_f32 v224, v184, v185
    v_cvt_pk_bf16_f32 v225, v186, v187
    v_mul_f32 v192, v192, v12
    v_mul_f32 v193, v193, v12
    v_mul_f32 v194, v194, v12
    v_mul_f32 v195, v195, v12
    v_cvt_pk_bf16_f32 v226, v192, v193
    v_cvt_pk_bf16_f32 v227, v194, v195
    v_mul_f32 v200, v200, v12
    v_mul_f32 v201, v201, v12
    v_mul_f32 v202, v202, v12
    v_mul_f32 v203, v203, v12
    v_cvt_pk_bf16_f32 v228, v200, v201
    v_cvt_pk_bf16_f32 v229, v202, v203
    v_mul_f32 v208, v208, v12
    v_mul_f32 v209, v209, v12
    v_mul_f32 v210, v210, v12
    v_mul_f32 v211, v211, v12
    v_cvt_pk_bf16_f32 v230, v208, v209
    v_cvt_pk_bf16_f32 v231, v210, v211
    v_mul_f32 v156, v156, v13
    v_mul_f32 v157, v157, v13
    v_mul_f32 v158, v158, v13
    v_mul_f32 v159, v159, v13
    v_cvt_pk_bf16_f32 v232, v156, v157
    v_cvt_pk_bf16_f32 v233, v158, v159
    v_mul_f32 v164, v164, v13
    v_mul_f32 v165, v165, v13
    v_mul_f32 v166, v166, v13
    v_mul_f32 v167, v167, v13
    v_cvt_pk_bf16_f32 v234, v164, v165
    v_cvt_pk_bf16_f32 v235, v166, v167
    v_mul_f32 v172, v172, v13
    v_mul_f32 v173, v173, v13
    v_mul_f32 v174, v174, v13
    v_mul_f32 v175, v175, v13
    v_cvt_pk_bf16_f32 v236, v172, v173
    v_cvt_pk_bf16_f32 v237, v174, v175
    v_mul_f32 v180, v180, v13
    v_mul_f32 v181, v181, v13
    v_mul_f32 v182, v182, v13
    v_mul_f32 v183, v183, v13
    v_cvt_pk_bf16_f32 v238, v180, v181
    v_cvt_pk_bf16_f32 v239, v182, v183
    v_mul_f32 v188, v188, v13
    v_mul_f32 v189, v189, v13
    v_mul_f32 v190, v190, v13
    v_mul_f32 v191, v191, v13
    v_cvt_pk_bf16_f32 v240, v188, v189
    v_cvt_pk_bf16_f32 v241, v190, v191
    v_mul_f32 v196, v196, v13
    v_mul_f32 v197, v197, v13
    v_mul_f32 v198, v198, v13
    v_mul_f32 v199, v199, v13
    v_cvt_pk_bf16_f32 v242, v196, v197
    v_cvt_pk_bf16_f32 v243, v198, v199
    v_mul_f32 v204, v204, v13
    v_mul_f32 v205, v205, v13
    v_mul_f32 v206, v206, v13
    v_mul_f32 v207, v207, v13
    v_cvt_pk_bf16_f32 v244, v204, v205
    v_cvt_pk_bf16_f32 v245, v206, v207
    v_mul_f32 v212, v212, v13
    v_mul_f32 v213, v213, v13
    v_mul_f32 v214, v214, v13
    v_mul_f32 v215, v215, v13
    v_cvt_pk_bf16_f32 v246, v212, v213
    v_cvt_pk_bf16_f32 v247, v214, v215
    s_lshl_b32 s33, s37, 6
    s_add_u32 s33, s33, s21
    s_lshl_b32 s33, s33, 12
    s_add_u32 s33, s33, 50331648
    s_add_u32 s34, s33, 0x20000
    buffer_store_dwordx4 v[216:219], v7, s[8:11], s33 offen offset:0 sc1
    buffer_store_dwordx4 v[220:223], v7, s[8:11], s33 offen offset:1024 sc1
    buffer_store_dwordx4 v[224:227], v7, s[8:11], s33 offen offset:2048 sc1
    buffer_store_dwordx4 v[228:231], v7, s[8:11], s33 offen offset:3072 sc1
    buffer_store_dwordx4 v[232:235], v7, s[8:11], s34 offen offset:0 sc1
    buffer_store_dwordx4 v[236:239], v7, s[8:11], s34 offen offset:1024 sc1
    buffer_store_dwordx4 v[240:243], v7, s[8:11], s34 offen offset:2048 sc1
    buffer_store_dwordx4 v[244:247], v7, s[8:11], s34 offen offset:3072 sc1
    v_mov_b32 v152, 0
    v_mov_b32 v153, 0
    v_mov_b32 v154, 0
    v_mov_b32 v155, 0
    v_mov_b32 v156, 0
    v_mov_b32 v157, 0
    v_mov_b32 v158, 0
    v_mov_b32 v159, 0
    v_mov_b32 v160, 0
    v_mov_b32 v161, 0
    v_mov_b32 v162, 0
    v_mov_b32 v163, 0
    v_mov_b32 v164, 0
    v_mov_b32 v165, 0
    v_mov_b32 v166, 0
    v_mov_b32 v167, 0
    v_mov_b32 v168, 0
    v_mov_b32 v169, 0
    v_mov_b32 v170, 0
    v_mov_b32 v171, 0
    v_mov_b32 v172, 0
    v_mov_b32 v173, 0
    v_mov_b32 v174, 0
    v_mov_b32 v175, 0
    v_mov_b32 v176, 0
    v_mov_b32 v177, 0
    v_mov_b32 v178, 0
    v_mov_b32 v179, 0
    v_mov_b32 v180, 0
    v_mov_b32 v181, 0
    v_mov_b32 v182, 0
    v_mov_b32 v183, 0
    v_mov_b32 v184, 0
    v_mov_b32 v185, 0
    v_mov_b32 v186, 0
    v_mov_b32 v187, 0
    v_mov_b32 v188, 0
    v_mov_b32 v189, 0
    v_mov_b32 v190, 0
    v_mov_b32 v191, 0
    v_mov_b32 v192, 0
    v_mov_b32 v193, 0
    v_mov_b32 v194, 0
    v_mov_b32 v195, 0
    v_mov_b32 v196, 0
    v_mov_b32 v197, 0
    v_mov_b32 v198, 0
    v_mov_b32 v199, 0
    v_mov_b32 v200, 0
    v_mov_b32 v201, 0
    v_mov_b32 v202, 0
    v_mov_b32 v203, 0
    v_mov_b32 v204, 0
    v_mov_b32 v205, 0
    v_mov_b32 v206, 0
    v_mov_b32 v207, 0
    v_mov_b32 v208, 0
    v_mov_b32 v209, 0
    v_mov_b32 v210, 0
    v_mov_b32 v211, 0
    v_mov_b32 v212, 0
    v_mov_b32 v213, 0
    v_mov_b32 v214, 0
    v_mov_b32 v215, 0
    v_mov_b32 v248, 0
    v_mov_b32 v249, 0
    v_mov_b32 v250, 0
    v_mov_b32 v251, 0
    v_mov_b32 v252, 0
    v_mov_b32 v253, 0
    v_mov_b32 v254, 0
    v_mov_b32 v255, 0
    s_lshl_b32 s37, s35, 2
    s_add_u32 s37, s37, s24
main_kernel_nf_170:
    s_cmp_lt_u32 s27, s37
    s_cbranch_scc1 main_kernel_i_169
    s_sub_u32 s33, s37, s27
    s_lshl_b32 s33, s33, 5
    v_add_u32 v12, s33, v6
    v_mov_b32 v13, 4286578688
    v_cmp_gt_i32 s[44:45], 0, v12
    v_cmp_gt_i32 s[46:47], 1, v12
    v_cmp_gt_i32 s[48:49], 2, v12
    v_cmp_gt_i32 s[50:51], 3, v12
    v_cndmask_b32 v72, v72, v13, s[44:45]
    v_cndmask_b32 v73, v73, v13, s[46:47]
    v_cndmask_b32 v74, v74, v13, s[48:49]
    v_cndmask_b32 v75, v75, v13, s[50:51]
    v_cmp_gt_i32 s[44:45], -16, v12
    v_cmp_gt_i32 s[46:47], -15, v12
    v_cmp_gt_i32 s[48:49], -14, v12
    v_cmp_gt_i32 s[50:51], -13, v12
    v_cndmask_b32 v76, v76, v13, s[44:45]
    v_cndmask_b32 v77, v77, v13, s[46:47]
    v_cndmask_b32 v78, v78, v13, s[48:49]
    v_cndmask_b32 v79, v79, v13, s[50:51]
    v_cmp_gt_i32 s[44:45], 16, v12
    v_cmp_gt_i32 s[46:47], 17, v12
    v_cmp_gt_i32 s[48:49], 18, v12
    v_cmp_gt_i32 s[50:51], 19, v12
    v_cndmask_b32 v80, v80, v13, s[44:45]
    v_cndmask_b32 v81, v81, v13, s[46:47]
    v_cndmask_b32 v82, v82, v13, s[48:49]
    v_cndmask_b32 v83, v83, v13, s[50:51]
    v_cmp_gt_i32 s[44:45], 0, v12
    v_cmp_gt_i32 s[46:47], 1, v12
    v_cmp_gt_i32 s[48:49], 2, v12
    v_cmp_gt_i32 s[50:51], 3, v12
    v_cndmask_b32 v84, v84, v13, s[44:45]
    v_cndmask_b32 v85, v85, v13, s[46:47]
    v_cndmask_b32 v86, v86, v13, s[48:49]
    v_cndmask_b32 v87, v87, v13, s[50:51]
main_kernel_i_169:
    s_cmp_eq_u32 s41, 0
    s_cbranch_scc1 main_kernel_exp_137
    v_max3_f32 v12, v72, v73, v74
    v_max3_f32 v12, v12, v75, v80
    v_max3_f32 v12, v12, v81, v82
    v_max_f32 v12, v12, v83
    v_max3_f32 v13, v76, v77, v78
    v_max3_f32 v13, v13, v79, v84
    v_max3_f32 v13, v13, v85, v86
    v_max_f32 v13, v13, v87
    v_mov_b32 v14, v12
    v_mov_b32 v15, v13
    s_nop 0
    v_permlane16_swap_b32 v12, v14
    v_permlane16_swap_b32 v13, v15
    v_max_f32 v12, v12, v14
    v_max_f32 v13, v13, v15
    v_mov_b32 v14, v12
    v_mov_b32 v15, v13
    s_nop 0
    v_permlane32_swap_b32 v12, v14
    v_permlane32_swap_b32 v13, v15
    v_max_f32 v12, v12, v14
    v_max_f32 v13, v13, v15
    v_max_f32 v12, 0xf149f2ca, v12
    v_add_f32 v12, 1092616192, v12
    v_sub_f32 v32, 0, v12
    v_sub_f32 v33, 0, v12
    v_sub_f32 v34, 0, v12
    v_sub_f32 v35, 0, v12
    v_sub_f32 v72, v72, v12
    v_sub_f32 v73, v73, v12
    v_sub_f32 v74, v74, v12
    v_sub_f32 v75, v75, v12
    v_sub_f32 v80, v80, v12
    v_sub_f32 v81, v81, v12
    v_sub_f32 v82, v82, v12
    v_sub_f32 v83, v83, v12
    v_max_f32 v13, 0xf149f2ca, v13
    v_add_f32 v13, 1092616192, v13
    v_sub_f32 v36, 0, v13
    v_sub_f32 v37, 0, v13
    v_sub_f32 v38, 0, v13
    v_sub_f32 v39, 0, v13
    v_sub_f32 v76, v76, v13
    v_sub_f32 v77, v77, v13
    v_sub_f32 v78, v78, v13
    v_sub_f32 v79, v79, v13
    v_sub_f32 v84, v84, v13
    v_sub_f32 v85, v85, v13
    v_sub_f32 v86, v86, v13
    v_sub_f32 v87, v87, v13
    s_mov_b32 s41, 0
    s_mov_b32 s38, s37
    s_branch main_kernel_exp_137
main_kernel_rare_138:
    v_max3_f32 v12, v72, v73, v74
    v_max3_f32 v12, v12, v75, v80
    v_max3_f32 v12, v12, v81, v82
    v_max_f32 v12, v12, v83
    v_max3_f32 v13, v76, v77, v78
    v_max3_f32 v13, v13, v79, v84
    v_max3_f32 v13, v13, v85, v86
    v_max_f32 v13, v13, v87
    v_mov_b32 v14, v12
    v_mov_b32 v15, v13
    s_nop 0
    v_permlane16_swap_b32 v12, v14
    v_permlane16_swap_b32 v13, v15
    v_max_f32 v12, v12, v14
    v_max_f32 v13, v13, v15
    v_mov_b32 v14, v12
    v_mov_b32 v15, v13
    s_nop 0
    v_permlane32_swap_b32 v12, v14
    v_permlane32_swap_b32 v13, v15
    v_max_f32 v12, v12, v14
    v_max_f32 v13, v13, v15
    v_add_f32 v12, 1092616192, v12
    v_max_f32 v12, 0, v12
    v_sub_f32 v14, 0, v12
    v_exp_f32 v14, v14
    v_sub_f32 v72, v72, v12
    v_sub_f32 v73, v73, v12
    v_sub_f32 v74, v74, v12
    v_sub_f32 v75, v75, v12
    v_sub_f32 v80, v80, v12
    v_sub_f32 v81, v81, v12
    v_sub_f32 v82, v82, v12
    v_sub_f32 v83, v83, v12
    v_sub_f32 v32, v32, v12
    v_sub_f32 v33, v33, v12
    v_sub_f32 v34, v34, v12
    v_sub_f32 v35, v35, v12
    v_mul_f32 v248, v248, v14
    v_mul_f32 v249, v249, v14
    v_mul_f32 v250, v250, v14
    v_mul_f32 v251, v251, v14
    v_mul_f32 v152, v152, v14
    v_mul_f32 v153, v153, v14
    v_mul_f32 v154, v154, v14
    v_mul_f32 v155, v155, v14
    v_mul_f32 v160, v160, v14
    v_mul_f32 v161, v161, v14
    v_mul_f32 v162, v162, v14
    v_mul_f32 v163, v163, v14
    v_mul_f32 v168, v168, v14
    v_mul_f32 v169, v169, v14
    v_mul_f32 v170, v170, v14
    v_mul_f32 v171, v171, v14
    v_mul_f32 v176, v176, v14
    v_mul_f32 v177, v177, v14
    v_mul_f32 v178, v178, v14
    v_mul_f32 v179, v179, v14
    v_mul_f32 v184, v184, v14
    v_mul_f32 v185, v185, v14
    v_mul_f32 v186, v186, v14
    v_mul_f32 v187, v187, v14
    v_mul_f32 v192, v192, v14
    v_mul_f32 v193, v193, v14
    v_mul_f32 v194, v194, v14
    v_mul_f32 v195, v195, v14
    v_mul_f32 v200, v200, v14
    v_mul_f32 v201, v201, v14
    v_mul_f32 v202, v202, v14
    v_mul_f32 v203, v203, v14
    v_mul_f32 v208, v208, v14
    v_mul_f32 v209, v209, v14
    v_mul_f32 v210, v210, v14
    v_mul_f32 v211, v211, v14
    v_add_f32 v13, 1092616192, v13
    v_max_f32 v13, 0, v13
    v_sub_f32 v15, 0, v13
    v_exp_f32 v15, v15
    v_sub_f32 v76, v76, v13
    v_sub_f32 v77, v77, v13
    v_sub_f32 v78, v78, v13
    v_sub_f32 v79, v79, v13
    v_sub_f32 v84, v84, v13
    v_sub_f32 v85, v85, v13
    v_sub_f32 v86, v86, v13
    v_sub_f32 v87, v87, v13
    v_sub_f32 v36, v36, v13
    v_sub_f32 v37, v37, v13
    v_sub_f32 v38, v38, v13
    v_sub_f32 v39, v39, v13
    v_mul_f32 v252, v252, v15
    v_mul_f32 v253, v253, v15
    v_mul_f32 v254, v254, v15
    v_mul_f32 v255, v255, v15
    v_mul_f32 v156, v156, v15
    v_mul_f32 v157, v157, v15
    v_mul_f32 v158, v158, v15
    v_mul_f32 v159, v159, v15
    v_mul_f32 v164, v164, v15
    v_mul_f32 v165, v165, v15
    v_mul_f32 v166, v166, v15
    v_mul_f32 v167, v167, v15
    v_mul_f32 v172, v172, v15
    v_mul_f32 v173, v173, v15
    v_mul_f32 v174, v174, v15
    v_mul_f32 v175, v175, v15
    v_mul_f32 v180, v180, v15
    v_mul_f32 v181, v181, v15
    v_mul_f32 v182, v182, v15
    v_mul_f32 v183, v183, v15
    v_mul_f32 v188, v188, v15
    v_mul_f32 v189, v189, v15
    v_mul_f32 v190, v190, v15
    v_mul_f32 v191, v191, v15
    v_mul_f32 v196, v196, v15
    v_mul_f32 v197, v197, v15
    v_mul_f32 v198, v198, v15
    v_mul_f32 v199, v199, v15
    v_mul_f32 v204, v204, v15
    v_mul_f32 v205, v205, v15
    v_mul_f32 v206, v206, v15
    v_mul_f32 v207, v207, v15
    v_mul_f32 v212, v212, v15
    v_mul_f32 v213, v213, v15
    v_mul_f32 v214, v214, v15
    v_mul_f32 v215, v215, v15
    v_exp_f32 v16, v72
    v_exp_f32 v17, v73
    v_exp_f32 v18, v76
    v_exp_f32 v19, v77
    v_cvt_pk_bf16_f32 v88, v16, v17
    v_cvt_pk_bf16_f32 v92, v18, v19
    v_exp_f32 v20, v74
    v_exp_f32 v21, v75
    v_exp_f32 v22, v78
    v_exp_f32 v23, v79
    v_cvt_pk_bf16_f32 v89, v20, v21
    v_cvt_pk_bf16_f32 v93, v22, v23
    v_exp_f32 v16, v80
    v_exp_f32 v17, v81
    v_exp_f32 v18, v84
    v_exp_f32 v19, v85
    v_cvt_pk_bf16_f32 v90, v16, v17
    v_cvt_pk_bf16_f32 v94, v18, v19
    v_exp_f32 v20, v82
    v_exp_f32 v21, v83
    v_exp_f32 v22, v86
    v_exp_f32 v23, v87
    v_cvt_pk_bf16_f32 v91, v20, v21
    v_cvt_pk_bf16_f32 v95, v22, v23
    v_or3_b32 v8, v88, v92, v89
    v_or3_b32 v9, v93, v90, v94
    v_or3_b32 v8, v8, v91, v95
    v_or_b32 v8, v8, v9
    s_branch main_kernel_chk_139
main_kernel_sq_140:
    ds_read_b128 v[128:131], v5 offset:24576
    ds_read_b128 v[132:135], v5 offset:25600
    ds_read_b128 v[136:139], v5 offset:26624
    ds_read_b128 v[140:143], v5 offset:27648
    s_waitcnt lgkmcnt(9)
    s_nop 0
    ds_read_b128 v[96:99], v5 offset:28672
    s_waitcnt lgkmcnt(9)
    s_nop 0
    ds_read_b128 v[100:103], v5 offset:29696
    s_branch main_kernel_pv_141
main_kernel_sp_142:
    s_waitcnt vmcnt(4) lgkmcnt(0)
    s_barrier
    s_branch main_kernel_me_143
main_kernel_end_1:
    s_endpgm
.section .rodata,"a"
.p2align 6
.amdhsa_kernel main_kernel
  .amdhsa_next_free_vgpr 256
  .amdhsa_next_free_sgpr 102
  .amdhsa_accum_offset 256
  .amdhsa_group_segment_fixed_size 0
  .amdhsa_kernarg_size 128
  .amdhsa_user_sgpr_count 2
  .amdhsa_user_sgpr_kernarg_segment_ptr 1
  .amdhsa_system_sgpr_workgroup_id_x 1
  .amdhsa_float_denorm_mode_32 3
  .amdhsa_float_denorm_mode_16_64 3
.end_amdhsa_kernel
```
